```python
import torch

def _softmax(x, axis=-1):
    return torch.softmax(x, dim=axis)
def _gelu(x):
    return torch.nn.functional.gelu(x, approximate="tanh")
def _silu(x):
    return torch.nn.functional.silu(x)
def _sigmoid(x):
    return torch.sigmoid(x)
def _layernorm(x, axis=-1, eps=1e-5):
    m = x.mean(dim=axis, keepdim=True)
    v = x.var(dim=axis, keepdim=True, unbiased=False)
    return (x - m) / torch.sqrt(v + eps)
def _scatter_add(tgt, idx, src, axis=0):
    return tgt.clone().index_add_(axis, idx, src)
def _segment_sum(src, seg, n):
    out = torch.zeros((n,) + src.shape[1:], dtype=src.dtype)
    return out.index_add_(0, seg, src)
def _pad(x, pw):
    flat = tuple(v for pair in reversed(pw) for v in pair)
    return torch.nn.functional.pad(x, flat)

kernel_name = 'recurrent_scan__spectral_gfnet__glu_gated_swiglu__prompt'

def setup_inputs():

    _w = (lambda a: (lambda t: t.to(torch.bfloat16) if t.is_floating_point() else t)(torch.as_tensor(a)))
    def _A_setup():
        B, S, D = 1, 2048, 640
        Df = D // 2 + 1
        return {
            "x": _w((lambda *s: torch.randn(*s, dtype=torch.bfloat16) * 0.2)(B, S, D)),
            "w_r": _w((lambda *s: torch.randn(*s, dtype=torch.bfloat16) * 1.6)(S, Df) * 0.02),
            "w_i": _w((lambda *s: torch.randn(*s, dtype=torch.bfloat16) * 1.6)(S, Df) * 0.02),
        }
    _A_in = _A_setup()

    def _B_setup():
        B, S, D, F = 1, 2048, 640, 1536
        return {
            "x": _w((lambda *s: torch.randn(*s, dtype=torch.bfloat16) * 0.2)(B, S, D)),
            "w1": _w((lambda *s: torch.randn(*s, dtype=torch.bfloat16) * 0.8)(D, F) * (2.0 / D) ** 0.5),
            "w3": _w((lambda *s: torch.randn(*s, dtype=torch.bfloat16) * 0.8)(D, F) * (2.0 / D) ** 0.5),
            "w2": _w((lambda *s: torch.randn(*s, dtype=torch.bfloat16) * 0.8)(F, D) * (2.0 / F) ** 0.5),
        }
    _B_in = _B_setup()

    return {
        "A_x": _A_in["x"],
        "A_w_r": _A_in["w_r"],
        "A_w_i": _A_in["w_i"],
        "B_x": _B_in["x"],
        "B_w1": _B_in["w1"],
        "B_w3": _B_in["w3"],
        "B_w2": _B_in["w2"],
    }

def reference(A_x, A_w_r, A_w_i, B_x, B_w1, B_w3, B_w2):
    def _A_ref(x, w_r, w_i):
        B, S, D = x.shape
        X = (lambda x, axes=(-2,-1): torch.fft.rfft2(x.float(), dim=axes))(x, axes=(-2, -1))
        W = w_r + 1j * w_i
        X = X * W
        y = (lambda x, s, axes=(-2,-1): torch.fft.irfft2(x, s=s, dim=axes).to(torch.bfloat16))(X, (S, D), axes=(-2, -1))
        return y

    def _B_ref(x, w1, w3, w2):
        gate = torch.einsum("bsd,df->bsf", x, w1)
        up = torch.einsum("bsd,df->bsf", x, w3)
        h = _silu(gate) * up
        out = torch.einsum("bsf,fd->bsd", h, w2)
        return out

    x = A_x
    xn = _layernorm(x, axis=-1)
    s = _A_ref(xn, A_w_r, A_w_i)
    g = _silu(_B_ref(xn, B_w1, B_w3, B_w2))
    return x + s * g
```

```asm
; @launch grid=(256,1,1) block=(256,1,1) lds=163840
.amdgcn_target "amdgcn-amd-amdhsa--gfx950"
.text
.globl recurrent_scan__spectral_gfnet__glu_gated_swiglu__prompt_kernel
.p2align 8
.type recurrent_scan__spectral_gfnet__glu_gated_swiglu__prompt_kernel,@function
recurrent_scan__spectral_gfnet__glu_gated_swiglu__prompt_kernel:
    s_cmp_ge_u32 s2, 256
    s_cbranch_scc1 k_done
    s_load_dwordx16 s[36:51], s[0:1], 0
    s_load_dwordx4 s[52:55], s[0:1], 64
    s_and_b32 s4, s2, 7
    s_lshr_b32 s5, s2, 3
    s_getpc_b64 s[8:9]
    s_add_u32 s8, s8, recurrent_scan__spectral_gfnet__glu_gated_swiglu__prompt_kernel@rel32@lo+4
    s_addc_u32 s9, s9, recurrent_scan__spectral_gfnet__glu_gated_swiglu__prompt_kernel@rel32@hi+12
    s_and_b32 s9, s9, 0xffff
    s_mov_b32 s10, 131072
    s_mov_b32 s11, 0x00020000
    s_mov_b32 s10, k_end-recurrent_scan__spectral_gfnet__glu_gated_swiglu__prompt_kernel
    v_lshlrev_b32 v1, 7, v0
    s_lshl_b32 s3, s5, 12
    v_cmp_gt_u32 vcc, 32, v0
    s_and_saveexec_b64 s[100:101], vcc
    s_cbranch_execz k_nopf
    buffer_load_dword v255, v1, s[8:11], s3 offen
k_nopf:
    s_mov_b64 exec, s[100:101]
    s_getpc_b64 s[8:9]
    s_add_u32 s8, s8, tab_ft@rel32@lo+4
    s_addc_u32 s9, s9, tab_ft@rel32@hi+12
    s_and_b32 s9, s9, 0xffff
    s_mov_b32 s10, 473088
    s_mov_b32 s11, 0x00020000
    v_subrev_u32 v2, 64, v0
    v_lshlrev_b32 v1, 7, v2
    s_lshl_b32 s3, s5, 14
    v_cmp_gt_u32 vcc, 128, v2
    s_and_saveexec_b64 s[100:101], vcc
    s_cbranch_execz k_nopf2
    buffer_load_dword v255, v1, s[8:11], s3 offen
k_nopf2:
    s_mov_b64 exec, s[100:101]
    s_cmp_ge_u32 s5, 24
    s_cbranch_scc1 k1_aux
    s_and_b32 s30, s4, 1
    s_lshl_b32 s30, s30, 3
    s_and_b32 s6, s5, 7
    s_add_u32 s30, s30, s6
    s_lshr_b32 s31, s4, 1
    s_mul_i32 s31, s31, 3
    s_lshr_b32 s6, s5, 3
    s_add_u32 s31, s31, s6
    s_waitcnt lgkmcnt(0)
    s_add_u32 s96, s54, 7864320
    s_addc_u32 s97, s55, 0
    s_and_b32 s97, s97, 0xffff
    s_mov_b32 s98, 3072
    s_mov_b32 s99, 0x00020000
    s_mov_b32 s8, s36
    s_and_b32 s9, s37, 0xffff
    s_mov_b32 s10, 2621440
    s_mov_b32 s11, 0x00020000
    s_mov_b32 s12, s44
    s_and_b32 s13, s45, 0xffff
    s_mov_b32 s14, 1966080
    s_mov_b32 s15, 0x00020000
    s_mov_b32 s16, s46
    s_and_b32 s17, s47, 0xffff
    s_mov_b32 s18, 1966080
    s_mov_b32 s19, 0x00020000
    v_and_b32 v1, 63, v0
    v_lshrrev_b32 v2, 6, v0
    s_add_u32 s59, s30, s31
    v_readfirstlane_b32 s24, v2
    s_cmp_ge_u32 s59, 20
    s_cselect_b32 s3, 20, 0
    s_sub_u32 s59, s59, s3
    s_cmp_ge_u32 s59, 10
    s_cselect_b32 s3, 10, 0
    s_sub_u32 s59, s59, s3
    s_cmp_ge_u32 s59, 5
    s_cselect_b32 s3, 5, 0
    s_sub_u32 s76, s59, s3
    s_cselect_b32 s74, s76, 99
    s_cselect_b32 s75, s59, 99
    s_lshr_b32 s32, s24, 1
    s_and_b32 s33, s24, 1
    s_lshl_b32 s25, s24, 12
    s_add_u32 s26, s25, 49152
    s_mov_b32 s29, 0x3f803f80
    v_lshrrev_b32 v2, 3, v1
    v_and_b32 v3, 7, v1
    s_lshl_b32 s3, s24, 5
    v_add_u32 v2, s3, v2
    s_lshl_b32 s34, s30, 7
    s_mov_b32 s35, 1280
    v_add_u32 v4, 0, v2
    v_lshrrev_b32 v5, 1, v4
    v_and_b32 v5, 7, v5
    v_xor_b32 v5, v5, v3
    v_add_u32 v4, s34, v4
    v_mul_lo_u32 v4, v4, s35
    v_lshl_add_u32 v10, v5, 4, v4
    v_add_u32 v4, 8, v2
    v_lshrrev_b32 v5, 1, v4
    v_and_b32 v5, 7, v5
    v_xor_b32 v5, v5, v3
    v_add_u32 v4, s34, v4
    v_mul_lo_u32 v4, v4, s35
    v_lshl_add_u32 v11, v5, 4, v4
    v_add_u32 v4, 16, v2
    v_lshrrev_b32 v5, 1, v4
    v_and_b32 v5, 7, v5
    v_xor_b32 v5, v5, v3
    v_add_u32 v4, s34, v4
    v_mul_lo_u32 v4, v4, s35
    v_lshl_add_u32 v12, v5, 4, v4
    v_add_u32 v4, 24, v2
    v_lshrrev_b32 v5, 1, v4
    v_and_b32 v5, 7, v5
    v_xor_b32 v5, v5, v3
    v_add_u32 v4, s34, v4
    v_mul_lo_u32 v4, v4, s35
    v_lshl_add_u32 v13, v5, 4, v4
    v_lshrrev_b32 v2, 4, v1
    v_and_b32 v3, 15, v1
    v_lshlrev_b32 v4, 2, v2
    v_xor_b32 v3, v3, v4
    s_lshl_b32 s3, s24, 4
    v_add_u32 v2, s3, v2
    s_mov_b32 s35, 3072
    v_mul_lo_u32 v2, v2, s35
    v_lshl_add_u32 v2, v3, 4, v2
    s_lshl_b32 s3, s31, 8
    v_add_u32 v2, s3, v2
    v_add_u32 v14, 0, v2
    v_add_u32 v15, 12288, v2
    v_add_u32 v16, 24576, v2
    v_add_u32 v17, 36864, v2
    s_lshl_b32 s27, s59, 7
    s_mul_i32 s28, s27, 1536
    s_add_u32 m0, s25, 0
    s_nop 0
    buffer_load_dwordx4 v10, s[8:11], s27 offen lds
    s_add_u32 m0, s25, 1024
    s_nop 0
    buffer_load_dwordx4 v11, s[8:11], s27 offen lds
    s_add_u32 m0, s25, 2048
    s_nop 0
    buffer_load_dwordx4 v12, s[8:11], s27 offen lds
    s_add_u32 m0, s25, 3072
    s_nop 0
    buffer_load_dwordx4 v13, s[8:11], s27 offen lds
    s_add_u32 m0, s26, 0
    s_nop 0
    buffer_load_dwordx4 v14, s[12:15], s28 offen lds
    s_add_u32 m0, s26, 49152
    s_nop 0
    buffer_load_dwordx4 v14, s[16:19], s28 offen lds
    s_add_u32 m0, s26, 1024
    s_nop 0
    buffer_load_dwordx4 v15, s[12:15], s28 offen lds
    s_add_u32 m0, s26, 50176
    s_nop 0
    buffer_load_dwordx4 v15, s[16:19], s28 offen lds
    s_add_u32 m0, s26, 2048
    s_nop 0
    buffer_load_dwordx4 v16, s[12:15], s28 offen lds
    s_add_u32 m0, s26, 51200
    s_nop 0
    buffer_load_dwordx4 v16, s[16:19], s28 offen lds
    s_add_u32 m0, s26, 3072
    s_nop 0
    buffer_load_dwordx4 v17, s[12:15], s28 offen lds
    s_add_u32 m0, s26, 52224
    s_nop 0
    buffer_load_dwordx4 v17, s[16:19], s28 offen lds
    s_add_u32 s20, s54, 0
    s_addc_u32 s21, s55, 0
    s_and_b32 s21, s21, 0xffff
    s_mov_b32 s22, 6356992
    s_mov_b32 s23, 0x00020000
    s_add_u32 s4, s54, 7340032
    s_addc_u32 s5, s55, 0
    s_and_b32 s5, s5, 0xffff
    s_mov_b32 s6, 286720
    s_mov_b32 s7, 0x00020000
    s_mov_b32 s92, s52
    s_and_b32 s93, s53, 0xffff
    s_mov_b32 s94, 256
    s_mov_b32 s95, 0x00020000
    v_and_b32 v2, 31, v1
    v_lshrrev_b32 v3, 5, v1
    v_lshrrev_b32 v4, 1, v2
    v_and_b32 v4, 7, v4
    s_lshl_b32 s3, s32, 6
    s_lshl_b32 s35, s33, 5
    s_add_u32 s3, s3, s35
    v_add_u32 v5, s3, v2
    v_lshlrev_b32 v30, 3, v5
    v_lshlrev_b32 v5, 7, v5
    v_add_u32 v6, 0, v3
    v_xor_b32 v6, v6, v4
    v_lshl_add_u32 v18, v6, 4, v5
    v_xor_b32 v88, 0x1000, v18
    v_add_u32 v6, 2, v3
    v_xor_b32 v6, v6, v4
    v_lshl_add_u32 v19, v6, 4, v5
    v_xor_b32 v89, 0x1000, v19
    v_add_u32 v6, 4, v3
    v_xor_b32 v6, v6, v4
    v_lshl_add_u32 v20, v6, 4, v5
    v_xor_b32 v90, 0x1000, v20
    v_add_u32 v6, 6, v3
    v_xor_b32 v6, v6, v4
    v_lshl_add_u32 v21, v6, 4, v5
    v_xor_b32 v91, 0x1000, v21
    v_lshrrev_b32 v4, 2, v1
    v_and_b32 v4, 3, v4
    v_lshl_add_u32 v5, v3, 3, v4
    v_lshlrev_b32 v5, 8, v5
    v_lshrrev_b32 v6, 4, v1
    v_and_b32 v6, 1, v6
    v_lshl_add_u32 v5, v6, 5, v5
    v_and_b32 v6, 3, v1
    v_lshl_add_u32 v5, v6, 3, v5
    s_lshl_b32 s3, s33, 1
    s_add_u32 s3, s3, s32
    v_xor_b32 v6, s3, v4
    v_lshl_add_u32 v22, v6, 6, v5
    v_add_u32 v22, 49152, v22
    v_xor_b32 v23, 64, v22
    v_add_u32 v24, 49152, v22
    v_add_u32 v25, 49152, v23
    s_lshl_b32 s3, s3, 7
    v_lshl_add_u32 v31, v2, 2, s3
    v_mov_b32 v26, 0
    v_mov_b32 v27, 0
    v_mov_b32 v28, 0
    v_mov_b32 v29, 0
    s_mul_i32 s56, s30, 10
    s_add_u32 s56, s56, s59
    s_lshl_b32 s56, s56, 10
    s_mul_i32 s57, s31, 10
    s_add_u32 s57, s57, s59
    s_lshl_b32 s57, s57, 10
    s_add_u32 s57, s57, 163840
    s_add_u32 s27, s27, 128
    s_cmp_eq_u32 s27, 1280
    s_cselect_b32 s27, 0, s27
    s_mul_i32 s28, s27, 1536
    s_add_u32 m0, s25, 16384
    s_nop 0
    buffer_load_dwordx4 v10, s[8:11], s27 offen lds
    s_add_u32 m0, s25, 17408
    s_nop 0
    buffer_load_dwordx4 v11, s[8:11], s27 offen lds
    s_add_u32 m0, s25, 18432
    s_nop 0
    buffer_load_dwordx4 v12, s[8:11], s27 offen lds
    s_add_u32 m0, s25, 19456
    s_nop 0
    buffer_load_dwordx4 v13, s[8:11], s27 offen lds
    s_add_u32 m0, s26, 16384
    s_nop 0
    buffer_load_dwordx4 v14, s[12:15], s28 offen lds
    s_add_u32 m0, s26, 65536
    s_nop 0
    buffer_load_dwordx4 v14, s[16:19], s28 offen lds
    s_add_u32 m0, s26, 17408
    s_nop 0
    buffer_load_dwordx4 v15, s[12:15], s28 offen lds
    s_add_u32 m0, s26, 66560
    s_nop 0
    buffer_load_dwordx4 v15, s[16:19], s28 offen lds
    s_add_u32 m0, s26, 18432
    s_nop 0
    buffer_load_dwordx4 v16, s[12:15], s28 offen lds
    s_add_u32 m0, s26, 67584
    s_nop 0
    buffer_load_dwordx4 v16, s[16:19], s28 offen lds
    s_add_u32 m0, s26, 19456
    s_nop 0
    buffer_load_dwordx4 v17, s[12:15], s28 offen lds
    s_add_u32 m0, s26, 68608
    s_nop 0
    buffer_load_dwordx4 v17, s[16:19], s28 offen lds
    s_waitcnt vmcnt(12)
    s_barrier
    s_add_u32 s84, s54, 14155776
    s_addc_u32 s85, s55, 0
    s_and_b32 s85, s85, 0xffff
    s_mov_b32 s86, 1986560
    s_mov_b32 s87, 0x00020000
    s_lshr_b32 s3, s2, 3
    s_lshl_b32 s3, s3, 2
    s_add_u32 s3, s3, s24
    s_mul_i32 s80, s3, 24576
    v_lshlrev_b32 v126, 7, v1
    s_mov_b32 s79, 0
    ds_read_b128 v[48:51], v18 offset:0
    ds_read_b128 v[52:55], v88 offset:0
    ds_read_b64_tr_b16 v[32:33], v22 offset:0
    ds_read_b64_tr_b16 v[34:35], v22 offset:1024
    ds_read_b64_tr_b16 v[36:37], v23 offset:0
    ds_read_b64_tr_b16 v[38:39], v23 offset:1024
    ds_read_b64_tr_b16 v[40:41], v24 offset:0
    ds_read_b64_tr_b16 v[42:43], v24 offset:1024
    ds_read_b64_tr_b16 v[44:45], v25 offset:0
    ds_read_b64_tr_b16 v[46:47], v25 offset:1024
    s_waitcnt lgkmcnt(0)
    v_mfma_f32_32x32x16_bf16 v[128:143], v[32:35], v[48:51], 0
    ds_read_b128 v[80:83], v19 offset:0
    ds_read_b128 v[84:87], v89 offset:0
    ds_read_b64_tr_b16 v[64:65], v22 offset:4096
    v_mfma_f32_32x32x16_bf16 v[144:159], v[32:35], v[52:55], 0
    ds_read_b64_tr_b16 v[66:67], v22 offset:5120
    ds_read_b64_tr_b16 v[68:69], v23 offset:4096
    ds_read_b64_tr_b16 v[70:71], v23 offset:5120
    ds_read_b64_tr_b16 v[72:73], v24 offset:4096
    v_mfma_f32_32x32x16_bf16 v[160:175], v[36:39], v[48:51], 0
    ds_read_b64_tr_b16 v[74:75], v24 offset:5120
    ds_read_b64_tr_b16 v[76:77], v25 offset:4096
    ds_read_b64_tr_b16 v[78:79], v25 offset:5120
    v_dot2_f32_bf16 v26, v48, s29, v26
    v_mfma_f32_32x32x16_bf16 v[176:191], v[36:39], v[52:55], 0
    v_dot2_f32_bf16 v27, v48, v48, v27
    v_dot2_f32_bf16 v26, v49, s29, v26
    s_add_u32 s27, s27, 128
    s_cmp_eq_u32 s27, 1280
    s_cselect_b32 s27, 0, s27
    s_mul_i32 s28, s27, 1536
    v_dot2_f32_bf16 v27, v49, v49, v27
    v_mfma_f32_32x32x16_bf16 v[192:207], v[40:43], v[48:51], 0
    v_dot2_f32_bf16 v26, v50, s29, v26
    v_dot2_f32_bf16 v27, v50, v50, v27
    s_add_u32 m0, s25, 32768
    s_nop 0
    buffer_load_dwordx4 v10, s[8:11], s27 offen lds
    v_dot2_f32_bf16 v26, v51, s29, v26
    v_mfma_f32_32x32x16_bf16 v[208:223], v[40:43], v[52:55], 0
    v_dot2_f32_bf16 v27, v51, v51, v27
    v_dot2_f32_bf16 v28, v32, s29, v28
    s_add_u32 m0, s25, 33792
    s_nop 0
    buffer_load_dwordx4 v11, s[8:11], s27 offen lds
    v_dot2_f32_bf16 v28, v33, s29, v28
    v_mfma_f32_32x32x16_bf16 v[224:239], v[44:47], v[48:51], 0
    v_dot2_f32_bf16 v28, v34, s29, v28
    v_dot2_f32_bf16 v28, v35, s29, v28
    s_add_u32 m0, s25, 34816
    s_nop 0
    buffer_load_dwordx4 v12, s[8:11], s27 offen lds
    v_dot2_f32_bf16 v29, v40, s29, v29
    v_mfma_f32_32x32x16_bf16 v[240:255], v[44:47], v[52:55], 0
    v_dot2_f32_bf16 v29, v41, s29, v29
    v_dot2_f32_bf16 v29, v42, s29, v29
    s_add_u32 m0, s25, 35840
    s_nop 0
    buffer_load_dwordx4 v13, s[8:11], s27 offen lds
    v_dot2_f32_bf16 v29, v43, s29, v29
    s_waitcnt lgkmcnt(0)
    v_mfma_f32_32x32x16_bf16 v[128:143], v[64:67], v[80:83], v[128:143]
    ds_read_b128 v[48:51], v20 offset:0
    ds_read_b128 v[52:55], v90 offset:0
    ds_read_b64_tr_b16 v[32:33], v22 offset:8192
    v_mfma_f32_32x32x16_bf16 v[144:159], v[64:67], v[84:87], v[144:159]
    ds_read_b64_tr_b16 v[34:35], v22 offset:9216
    ds_read_b64_tr_b16 v[36:37], v23 offset:8192
    ds_read_b64_tr_b16 v[38:39], v23 offset:9216
    ds_read_b64_tr_b16 v[40:41], v24 offset:8192
    v_mfma_f32_32x32x16_bf16 v[160:175], v[68:71], v[80:83], v[160:175]
    ds_read_b64_tr_b16 v[42:43], v24 offset:9216
    ds_read_b64_tr_b16 v[44:45], v25 offset:8192
    ds_read_b64_tr_b16 v[46:47], v25 offset:9216
    v_dot2_f32_bf16 v26, v80, s29, v26
    v_mfma_f32_32x32x16_bf16 v[176:191], v[68:71], v[84:87], v[176:191]
    v_dot2_f32_bf16 v27, v80, v80, v27
    v_dot2_f32_bf16 v26, v81, s29, v26
    s_add_u32 m0, s26, 32768
    s_nop 0
    buffer_load_dwordx4 v14, s[12:15], s28 offen lds
    v_dot2_f32_bf16 v27, v81, v81, v27
    v_mfma_f32_32x32x16_bf16 v[192:207], v[72:75], v[80:83], v[192:207]
    v_dot2_f32_bf16 v26, v82, s29, v26
    v_dot2_f32_bf16 v27, v82, v82, v27
    s_add_u32 m0, s26, 81920
    s_nop 0
    buffer_load_dwordx4 v14, s[16:19], s28 offen lds
    v_dot2_f32_bf16 v26, v83, s29, v26
    v_mfma_f32_32x32x16_bf16 v[208:223], v[72:75], v[84:87], v[208:223]
    v_dot2_f32_bf16 v27, v83, v83, v27
    v_dot2_f32_bf16 v28, v64, s29, v28
    s_add_u32 m0, s26, 33792
    s_nop 0
    buffer_load_dwordx4 v15, s[12:15], s28 offen lds
    v_dot2_f32_bf16 v28, v65, s29, v28
    v_mfma_f32_32x32x16_bf16 v[224:239], v[76:79], v[80:83], v[224:239]
    v_dot2_f32_bf16 v28, v66, s29, v28
    v_dot2_f32_bf16 v28, v67, s29, v28
    s_add_u32 m0, s26, 82944
    s_nop 0
    buffer_load_dwordx4 v15, s[16:19], s28 offen lds
    v_dot2_f32_bf16 v29, v72, s29, v29
    v_mfma_f32_32x32x16_bf16 v[240:255], v[76:79], v[84:87], v[240:255]
    v_dot2_f32_bf16 v29, v73, s29, v29
    v_dot2_f32_bf16 v29, v74, s29, v29
    s_add_u32 m0, s26, 34816
    s_nop 0
    buffer_load_dwordx4 v16, s[12:15], s28 offen lds
    v_dot2_f32_bf16 v29, v75, s29, v29
    s_waitcnt lgkmcnt(0)
    v_mfma_f32_32x32x16_bf16 v[128:143], v[32:35], v[48:51], v[128:143]
    ds_read_b128 v[80:83], v21 offset:0
    ds_read_b128 v[84:87], v91 offset:0
    ds_read_b64_tr_b16 v[64:65], v22 offset:12288
    v_mfma_f32_32x32x16_bf16 v[144:159], v[32:35], v[52:55], v[144:159]
    ds_read_b64_tr_b16 v[66:67], v22 offset:13312
    ds_read_b64_tr_b16 v[68:69], v23 offset:12288
    ds_read_b64_tr_b16 v[70:71], v23 offset:13312
    ds_read_b64_tr_b16 v[72:73], v24 offset:12288
    v_mfma_f32_32x32x16_bf16 v[160:175], v[36:39], v[48:51], v[160:175]
    ds_read_b64_tr_b16 v[74:75], v24 offset:13312
    ds_read_b64_tr_b16 v[76:77], v25 offset:12288
    ds_read_b64_tr_b16 v[78:79], v25 offset:13312
    v_mfma_f32_32x32x16_bf16 v[176:191], v[36:39], v[52:55], v[176:191]
    v_dot2_f32_bf16 v26, v48, s29, v26
    v_dot2_f32_bf16 v27, v48, v48, v27
    v_dot2_f32_bf16 v26, v49, s29, v26
    s_add_u32 m0, s26, 83968
    s_nop 0
    buffer_load_dwordx4 v16, s[16:19], s28 offen lds
    v_mfma_f32_32x32x16_bf16 v[192:207], v[40:43], v[48:51], v[192:207]
    v_dot2_f32_bf16 v27, v49, v49, v27
    v_dot2_f32_bf16 v26, v50, s29, v26
    v_dot2_f32_bf16 v27, v50, v50, v27
    s_add_u32 m0, s26, 35840
    s_nop 0
    buffer_load_dwordx4 v17, s[12:15], s28 offen lds
    v_mfma_f32_32x32x16_bf16 v[208:223], v[40:43], v[52:55], v[208:223]
    v_dot2_f32_bf16 v26, v51, s29, v26
    v_dot2_f32_bf16 v27, v51, v51, v27
    v_dot2_f32_bf16 v28, v32, s29, v28
    v_mfma_f32_32x32x16_bf16 v[224:239], v[44:47], v[48:51], v[224:239]
    s_add_u32 m0, s26, 84992
    s_nop 0
    buffer_load_dwordx4 v17, s[16:19], s28 offen lds
    v_dot2_f32_bf16 v28, v33, s29, v28
    v_dot2_f32_bf16 v28, v34, s29, v28
    v_dot2_f32_bf16 v28, v35, s29, v28
    v_mfma_f32_32x32x16_bf16 v[240:255], v[44:47], v[52:55], v[240:255]
    v_dot2_f32_bf16 v29, v40, s29, v29
    v_dot2_f32_bf16 v29, v41, s29, v29
    v_dot2_f32_bf16 v29, v42, s29, v29
    v_dot2_f32_bf16 v29, v43, s29, v29
    s_waitcnt lgkmcnt(0)
    s_waitcnt vmcnt(12)
    s_barrier
    v_mfma_f32_32x32x16_bf16 v[128:143], v[64:67], v[80:83], v[128:143]
    ds_read_b128 v[48:51], v18 offset:16384
    ds_read_b128 v[52:55], v88 offset:16384
    ds_read_b64_tr_b16 v[32:33], v22 offset:16384
    v_mfma_f32_32x32x16_bf16 v[144:159], v[64:67], v[84:87], v[144:159]
    ds_read_b64_tr_b16 v[34:35], v22 offset:17408
    ds_read_b64_tr_b16 v[36:37], v23 offset:16384
    ds_read_b64_tr_b16 v[38:39], v23 offset:17408
    v_mfma_f32_32x32x16_bf16 v[160:175], v[68:71], v[80:83], v[160:175]
    ds_read_b64_tr_b16 v[40:41], v24 offset:16384
    ds_read_b64_tr_b16 v[42:43], v24 offset:17408
    ds_read_b64_tr_b16 v[44:45], v25 offset:16384
    v_mfma_f32_32x32x16_bf16 v[176:191], v[68:71], v[84:87], v[176:191]
    ds_read_b64_tr_b16 v[46:47], v25 offset:17408
    v_dot2_f32_bf16 v26, v80, s29, v26
    v_dot2_f32_bf16 v27, v80, v80, v27
    v_dot2_f32_bf16 v26, v81, s29, v26
    v_mfma_f32_32x32x16_bf16 v[192:207], v[72:75], v[80:83], v[192:207]
    v_dot2_f32_bf16 v27, v81, v81, v27
    v_dot2_f32_bf16 v26, v82, s29, v26
    v_dot2_f32_bf16 v27, v82, v82, v27
    v_mfma_f32_32x32x16_bf16 v[208:223], v[72:75], v[84:87], v[208:223]
    v_dot2_f32_bf16 v26, v83, s29, v26
    v_dot2_f32_bf16 v27, v83, v83, v27
    v_dot2_f32_bf16 v28, v64, s29, v28
    v_mfma_f32_32x32x16_bf16 v[224:239], v[76:79], v[80:83], v[224:239]
    v_dot2_f32_bf16 v28, v65, s29, v28
    v_dot2_f32_bf16 v28, v66, s29, v28
    v_dot2_f32_bf16 v28, v67, s29, v28
    v_mfma_f32_32x32x16_bf16 v[240:255], v[76:79], v[84:87], v[240:255]
    v_dot2_f32_bf16 v29, v72, s29, v29
    v_dot2_f32_bf16 v29, v73, s29, v29
    v_dot2_f32_bf16 v29, v74, s29, v29
    v_dot2_f32_bf16 v29, v75, s29, v29
    s_waitcnt lgkmcnt(0)
    s_nop 2
    v_mov_b32 v6, v26
    v_mov_b32 v7, v27
    v_mov_b32 v8, v28
    v_mov_b32 v9, v29
    s_nop 1
    v_permlane32_swap_b32 v26, v6
    v_permlane32_swap_b32 v27, v7
    v_permlane32_swap_b32 v28, v8
    v_permlane32_swap_b32 v29, v9
    s_nop 1
    v_add_f32 v26, v26, v6
    v_add_f32 v27, v27, v7
    v_add_f32 v28, v28, v8
    v_add_f32 v29, v29, v9
    buffer_store_dwordx2 v[26:27], v30, s[4:7], s56 offen sc1
    buffer_store_dword v28, v31, s[4:7], s57 offen sc1
    buffer_store_dword v29, v31, s[4:7], s57 offen offset:512 sc1
    v_mfma_f32_32x32x16_bf16 v[128:143], v[32:35], v[48:51], v[128:143]
    ds_read_b128 v[80:83], v19 offset:16384
    v_mfma_f32_32x32x16_bf16 v[144:159], v[32:35], v[52:55], v[144:159]
    ds_read_b128 v[84:87], v89 offset:16384
    ds_read_b64_tr_b16 v[64:65], v22 offset:20480
    v_mfma_f32_32x32x16_bf16 v[160:175], v[36:39], v[48:51], v[160:175]
    ds_read_b64_tr_b16 v[66:67], v22 offset:21504
    ds_read_b64_tr_b16 v[68:69], v23 offset:20480
    v_mfma_f32_32x32x16_bf16 v[176:191], v[36:39], v[52:55], v[176:191]
    ds_read_b64_tr_b16 v[70:71], v23 offset:21504
    ds_read_b64_tr_b16 v[72:73], v24 offset:20480
    v_mfma_f32_32x32x16_bf16 v[192:207], v[40:43], v[48:51], v[192:207]
    ds_read_b64_tr_b16 v[74:75], v24 offset:21504
    ds_read_b64_tr_b16 v[76:77], v25 offset:20480
    v_mfma_f32_32x32x16_bf16 v[208:223], v[40:43], v[52:55], v[208:223]
    ds_read_b64_tr_b16 v[78:79], v25 offset:21504
    s_add_u32 s27, s27, 128
    s_cmp_eq_u32 s27, 1280
    s_cselect_b32 s27, 0, s27
    s_mul_i32 s28, s27, 1536
    v_mfma_f32_32x32x16_bf16 v[224:239], v[44:47], v[48:51], v[224:239]
    s_add_u32 m0, s25, 0
    s_nop 0
    buffer_load_dwordx4 v10, s[8:11], s27 offen lds
    s_add_u32 m0, s25, 1024
    s_nop 0
    buffer_load_dwordx4 v11, s[8:11], s27 offen lds
    v_mfma_f32_32x32x16_bf16 v[240:255], v[44:47], v[52:55], v[240:255]
    s_add_u32 m0, s25, 2048
    s_nop 0
    buffer_load_dwordx4 v12, s[8:11], s27 offen lds
    s_add_u32 m0, s25, 3072
    s_nop 0
    buffer_load_dwordx4 v13, s[8:11], s27 offen lds
    s_waitcnt lgkmcnt(0)
    v_mfma_f32_32x32x16_bf16 v[128:143], v[64:67], v[80:83], v[128:143]
    ds_read_b128 v[48:51], v20 offset:16384
    v_mfma_f32_32x32x16_bf16 v[144:159], v[64:67], v[84:87], v[144:159]
    ds_read_b128 v[52:55], v90 offset:16384
    ds_read_b64_tr_b16 v[32:33], v22 offset:24576
    v_mfma_f32_32x32x16_bf16 v[160:175], v[68:71], v[80:83], v[160:175]
    ds_read_b64_tr_b16 v[34:35], v22 offset:25600
    ds_read_b64_tr_b16 v[36:37], v23 offset:24576
    v_mfma_f32_32x32x16_bf16 v[176:191], v[68:71], v[84:87], v[176:191]
    ds_read_b64_tr_b16 v[38:39], v23 offset:25600
    ds_read_b64_tr_b16 v[40:41], v24 offset:24576
    v_mfma_f32_32x32x16_bf16 v[192:207], v[72:75], v[80:83], v[192:207]
    ds_read_b64_tr_b16 v[42:43], v24 offset:25600
    ds_read_b64_tr_b16 v[44:45], v25 offset:24576
    v_mfma_f32_32x32x16_bf16 v[208:223], v[72:75], v[84:87], v[208:223]
    ds_read_b64_tr_b16 v[46:47], v25 offset:25600
    s_add_u32 m0, s26, 0
    s_nop 0
    buffer_load_dwordx4 v14, s[12:15], s28 offen lds
    v_mfma_f32_32x32x16_bf16 v[224:239], v[76:79], v[80:83], v[224:239]
    s_add_u32 m0, s26, 49152
    s_nop 0
    buffer_load_dwordx4 v14, s[16:19], s28 offen lds
    s_add_u32 m0, s26, 1024
    s_nop 0
    buffer_load_dwordx4 v15, s[12:15], s28 offen lds
    v_mfma_f32_32x32x16_bf16 v[240:255], v[76:79], v[84:87], v[240:255]
    s_add_u32 m0, s26, 50176
    s_nop 0
    buffer_load_dwordx4 v15, s[16:19], s28 offen lds
    s_add_u32 m0, s26, 2048
    s_nop 0
    buffer_load_dwordx4 v16, s[12:15], s28 offen lds
    s_waitcnt lgkmcnt(0)
    v_mfma_f32_32x32x16_bf16 v[128:143], v[32:35], v[48:51], v[128:143]
    ds_read_b128 v[80:83], v21 offset:16384
    v_mfma_f32_32x32x16_bf16 v[144:159], v[32:35], v[52:55], v[144:159]
    ds_read_b128 v[84:87], v91 offset:16384
    ds_read_b64_tr_b16 v[64:65], v22 offset:28672
    v_mfma_f32_32x32x16_bf16 v[160:175], v[36:39], v[48:51], v[160:175]
    ds_read_b64_tr_b16 v[66:67], v22 offset:29696
    v_mfma_f32_32x32x16_bf16 v[176:191], v[36:39], v[52:55], v[176:191]
    ds_read_b64_tr_b16 v[68:69], v23 offset:28672
    ds_read_b64_tr_b16 v[70:71], v23 offset:29696
    v_mfma_f32_32x32x16_bf16 v[192:207], v[40:43], v[48:51], v[192:207]
    ds_read_b64_tr_b16 v[72:73], v24 offset:28672
    ds_read_b64_tr_b16 v[74:75], v24 offset:29696
    v_mfma_f32_32x32x16_bf16 v[208:223], v[40:43], v[52:55], v[208:223]
    ds_read_b64_tr_b16 v[76:77], v25 offset:28672
    v_mfma_f32_32x32x16_bf16 v[224:239], v[44:47], v[48:51], v[224:239]
    ds_read_b64_tr_b16 v[78:79], v25 offset:29696
    s_add_u32 m0, s26, 51200
    s_nop 0
    buffer_load_dwordx4 v16, s[16:19], s28 offen lds
    v_mfma_f32_32x32x16_bf16 v[240:255], v[44:47], v[52:55], v[240:255]
    s_add_u32 m0, s26, 3072
    s_nop 0
    buffer_load_dwordx4 v17, s[12:15], s28 offen lds
    s_add_u32 m0, s26, 52224
    s_nop 0
    buffer_load_dwordx4 v17, s[16:19], s28 offen lds
    s_waitcnt lgkmcnt(0)
    s_waitcnt vmcnt(12)
    s_barrier
    s_cmp_lg_u32 s24, 0
    s_cbranch_scc1 pub_1
    v_cmp_eq_u32 vcc, 0, v1
    s_and_saveexec_b64 s[100:101], vcc
    v_mov_b32 v92, 0
    v_mov_b32 v93, 1
    s_cmp_ge_u32 s31, 10
    s_cbranch_scc1 pub_2
    s_lshl_b32 s3, s30, 2
    buffer_atomic_add v93, v92, s[92:95], s3 offen sc1
pub_2:
    s_cmp_ge_u32 s30, 10
    s_cbranch_scc1 pub_3
    s_lshl_b32 s3, s31, 2
    buffer_atomic_add v93, v92, s[92:95], s3 offen offset:64 sc1
pub_3:
    s_mov_b64 exec, s[100:101]
pub_1:
    v_mfma_f32_32x32x16_bf16 v[128:143], v[64:67], v[80:83], v[128:143]
    ds_read_b128 v[48:51], v18 offset:32768
    v_mfma_f32_32x32x16_bf16 v[144:159], v[64:67], v[84:87], v[144:159]
    ds_read_b128 v[52:55], v88 offset:32768
    ds_read_b64_tr_b16 v[32:33], v22 offset:32768
    v_mfma_f32_32x32x16_bf16 v[160:175], v[68:71], v[80:83], v[160:175]
    ds_read_b64_tr_b16 v[34:35], v22 offset:33792
    ds_read_b64_tr_b16 v[36:37], v23 offset:32768
    v_mfma_f32_32x32x16_bf16 v[176:191], v[68:71], v[84:87], v[176:191]
    ds_read_b64_tr_b16 v[38:39], v23 offset:33792
    ds_read_b64_tr_b16 v[40:41], v24 offset:32768
    v_mfma_f32_32x32x16_bf16 v[192:207], v[72:75], v[80:83], v[192:207]
    ds_read_b64_tr_b16 v[42:43], v24 offset:33792
    ds_read_b64_tr_b16 v[44:45], v25 offset:32768
    v_mfma_f32_32x32x16_bf16 v[208:223], v[72:75], v[84:87], v[208:223]
    ds_read_b64_tr_b16 v[46:47], v25 offset:33792
    s_add_u32 s27, s27, 128
    s_cmp_eq_u32 s27, 1280
    s_cselect_b32 s27, 0, s27
    s_mul_i32 s28, s27, 1536
    v_mfma_f32_32x32x16_bf16 v[224:239], v[76:79], v[80:83], v[224:239]
    s_add_u32 m0, s25, 16384
    s_nop 0
    buffer_load_dwordx4 v10, s[8:11], s27 offen lds
    s_add_u32 m0, s25, 17408
    s_nop 0
    buffer_load_dwordx4 v11, s[8:11], s27 offen lds
    v_mfma_f32_32x32x16_bf16 v[240:255], v[76:79], v[84:87], v[240:255]
    s_add_u32 m0, s25, 18432
    s_nop 0
    buffer_load_dwordx4 v12, s[8:11], s27 offen lds
    s_add_u32 m0, s25, 19456
    s_nop 0
    buffer_load_dwordx4 v13, s[8:11], s27 offen lds
    s_waitcnt lgkmcnt(0)
    v_mfma_f32_32x32x16_bf16 v[128:143], v[32:35], v[48:51], v[128:143]
    ds_read_b128 v[80:83], v19 offset:32768
    v_mfma_f32_32x32x16_bf16 v[144:159], v[32:35], v[52:55], v[144:159]
    ds_read_b128 v[84:87], v89 offset:32768
    ds_read_b64_tr_b16 v[64:65], v22 offset:36864
    v_mfma_f32_32x32x16_bf16 v[160:175], v[36:39], v[48:51], v[160:175]
    ds_read_b64_tr_b16 v[66:67], v22 offset:37888
    ds_read_b64_tr_b16 v[68:69], v23 offset:36864
    v_mfma_f32_32x32x16_bf16 v[176:191], v[36:39], v[52:55], v[176:191]
    ds_read_b64_tr_b16 v[70:71], v23 offset:37888
    ds_read_b64_tr_b16 v[72:73], v24 offset:36864
    v_mfma_f32_32x32x16_bf16 v[192:207], v[40:43], v[48:51], v[192:207]
    ds_read_b64_tr_b16 v[74:75], v24 offset:37888
    v_mfma_f32_32x32x16_bf16 v[208:223], v[40:43], v[52:55], v[208:223]
    ds_read_b64_tr_b16 v[76:77], v25 offset:36864
    ds_read_b64_tr_b16 v[78:79], v25 offset:37888
    v_mfma_f32_32x32x16_bf16 v[224:239], v[44:47], v[48:51], v[224:239]
    s_add_u32 m0, s26, 16384
    s_nop 0
    buffer_load_dwordx4 v14, s[12:15], s28 offen lds
    s_add_u32 m0, s26, 65536
    s_nop 0
    buffer_load_dwordx4 v14, s[16:19], s28 offen lds
    v_mfma_f32_32x32x16_bf16 v[240:255], v[44:47], v[52:55], v[240:255]
    s_add_u32 m0, s26, 17408
    s_nop 0
    buffer_load_dwordx4 v15, s[12:15], s28 offen lds
    s_add_u32 m0, s26, 66560
    s_nop 0
    buffer_load_dwordx4 v15, s[16:19], s28 offen lds
    s_waitcnt lgkmcnt(0)
    v_mfma_f32_32x32x16_bf16 v[128:143], v[64:67], v[80:83], v[128:143]
    ds_read_b128 v[48:51], v20 offset:32768
    v_mfma_f32_32x32x16_bf16 v[144:159], v[64:67], v[84:87], v[144:159]
    ds_read_b128 v[52:55], v90 offset:32768
    ds_read_b64_tr_b16 v[32:33], v22 offset:40960
    v_mfma_f32_32x32x16_bf16 v[160:175], v[68:71], v[80:83], v[160:175]
    ds_read_b64_tr_b16 v[34:35], v22 offset:41984
    ds_read_b64_tr_b16 v[36:37], v23 offset:40960
    v_mfma_f32_32x32x16_bf16 v[176:191], v[68:71], v[84:87], v[176:191]
    ds_read_b64_tr_b16 v[38:39], v23 offset:41984
    ds_read_b64_tr_b16 v[40:41], v24 offset:40960
    v_mfma_f32_32x32x16_bf16 v[192:207], v[72:75], v[80:83], v[192:207]
    ds_read_b64_tr_b16 v[42:43], v24 offset:41984
    v_mfma_f32_32x32x16_bf16 v[208:223], v[72:75], v[84:87], v[208:223]
    ds_read_b64_tr_b16 v[44:45], v25 offset:40960
    ds_read_b64_tr_b16 v[46:47], v25 offset:41984
    v_mfma_f32_32x32x16_bf16 v[224:239], v[76:79], v[80:83], v[224:239]
    s_add_u32 m0, s26, 18432
    s_nop 0
    buffer_load_dwordx4 v16, s[12:15], s28 offen lds
    s_add_u32 m0, s26, 67584
    s_nop 0
    buffer_load_dwordx4 v16, s[16:19], s28 offen lds
    v_mfma_f32_32x32x16_bf16 v[240:255], v[76:79], v[84:87], v[240:255]
    s_add_u32 m0, s26, 19456
    s_nop 0
    buffer_load_dwordx4 v17, s[12:15], s28 offen lds
    s_add_u32 m0, s26, 68608
    s_nop 0
    buffer_load_dwordx4 v17, s[16:19], s28 offen lds
    s_waitcnt lgkmcnt(0)
    v_mfma_f32_32x32x16_bf16 v[128:143], v[32:35], v[48:51], v[128:143]
    ds_read_b128 v[80:83], v21 offset:32768
    v_mfma_f32_32x32x16_bf16 v[144:159], v[32:35], v[52:55], v[144:159]
    ds_read_b128 v[84:87], v91 offset:32768
    v_mfma_f32_32x32x16_bf16 v[160:175], v[36:39], v[48:51], v[160:175]
    ds_read_b64_tr_b16 v[64:65], v22 offset:45056
    v_mfma_f32_32x32x16_bf16 v[176:191], v[36:39], v[52:55], v[176:191]
    ds_read_b64_tr_b16 v[66:67], v22 offset:46080
    ds_read_b64_tr_b16 v[68:69], v23 offset:45056
    v_mfma_f32_32x32x16_bf16 v[192:207], v[40:43], v[48:51], v[192:207]
    ds_read_b64_tr_b16 v[70:71], v23 offset:46080
    v_mfma_f32_32x32x16_bf16 v[208:223], v[40:43], v[52:55], v[208:223]
    ds_read_b64_tr_b16 v[72:73], v24 offset:45056
    v_mfma_f32_32x32x16_bf16 v[224:239], v[44:47], v[48:51], v[224:239]
    ds_read_b64_tr_b16 v[74:75], v24 offset:46080
    v_mfma_f32_32x32x16_bf16 v[240:255], v[44:47], v[52:55], v[240:255]
    ds_read_b64_tr_b16 v[76:77], v25 offset:45056
    ds_read_b64_tr_b16 v[78:79], v25 offset:46080
    s_waitcnt lgkmcnt(0)
    s_waitcnt vmcnt(12)
    s_barrier
    v_mfma_f32_32x32x16_bf16 v[128:143], v[64:67], v[80:83], v[128:143]
    ds_read_b128 v[48:51], v18 offset:0
    v_mfma_f32_32x32x16_bf16 v[144:159], v[64:67], v[84:87], v[144:159]
    ds_read_b128 v[52:55], v88 offset:0
    ds_read_b64_tr_b16 v[32:33], v22 offset:0
    v_mfma_f32_32x32x16_bf16 v[160:175], v[68:71], v[80:83], v[160:175]
    ds_read_b64_tr_b16 v[34:35], v22 offset:1024
    ds_read_b64_tr_b16 v[36:37], v23 offset:0
    v_mfma_f32_32x32x16_bf16 v[176:191], v[68:71], v[84:87], v[176:191]
    ds_read_b64_tr_b16 v[38:39], v23 offset:1024
    ds_read_b64_tr_b16 v[40:41], v24 offset:0
    v_mfma_f32_32x32x16_bf16 v[192:207], v[72:75], v[80:83], v[192:207]
    ds_read_b64_tr_b16 v[42:43], v24 offset:1024
    v_mfma_f32_32x32x16_bf16 v[208:223], v[72:75], v[84:87], v[208:223]
    ds_read_b64_tr_b16 v[44:45], v25 offset:0
    ds_read_b64_tr_b16 v[46:47], v25 offset:1024
    v_mfma_f32_32x32x16_bf16 v[224:239], v[76:79], v[80:83], v[224:239]
    s_add_u32 s27, s27, 128
    s_cmp_eq_u32 s27, 1280
    s_cselect_b32 s27, 0, s27
    s_mul_i32 s28, s27, 1536
    s_add_u32 m0, s25, 32768
    s_nop 0
    buffer_load_dwordx4 v10, s[8:11], s27 offen lds
    v_mfma_f32_32x32x16_bf16 v[240:255], v[76:79], v[84:87], v[240:255]
    s_add_u32 m0, s25, 33792
    s_nop 0
    buffer_load_dwordx4 v11, s[8:11], s27 offen lds
    s_add_u32 m0, s25, 34816
    s_nop 0
    buffer_load_dwordx4 v12, s[8:11], s27 offen lds
    s_waitcnt lgkmcnt(0)
    v_mfma_f32_32x32x16_bf16 v[128:143], v[32:35], v[48:51], v[128:143]
    ds_read_b128 v[80:83], v19 offset:0
    v_mfma_f32_32x32x16_bf16 v[144:159], v[32:35], v[52:55], v[144:159]
    ds_read_b128 v[84:87], v89 offset:0
    ds_read_b64_tr_b16 v[64:65], v22 offset:4096
    v_mfma_f32_32x32x16_bf16 v[160:175], v[36:39], v[48:51], v[160:175]
    ds_read_b64_tr_b16 v[66:67], v22 offset:5120
    ds_read_b64_tr_b16 v[68:69], v23 offset:4096
    v_mfma_f32_32x32x16_bf16 v[176:191], v[36:39], v[52:55], v[176:191]
    ds_read_b64_tr_b16 v[70:71], v23 offset:5120
    ds_read_b64_tr_b16 v[72:73], v24 offset:4096
    v_mfma_f32_32x32x16_bf16 v[192:207], v[40:43], v[48:51], v[192:207]
    ds_read_b64_tr_b16 v[74:75], v24 offset:5120
    v_mfma_f32_32x32x16_bf16 v[208:223], v[40:43], v[52:55], v[208:223]
    ds_read_b64_tr_b16 v[76:77], v25 offset:4096
    ds_read_b64_tr_b16 v[78:79], v25 offset:5120
    v_mfma_f32_32x32x16_bf16 v[224:239], v[44:47], v[48:51], v[224:239]
    s_add_u32 m0, s25, 35840
    s_nop 0
    buffer_load_dwordx4 v13, s[8:11], s27 offen lds
    s_add_u32 m0, s26, 32768
    s_nop 0
    buffer_load_dwordx4 v14, s[12:15], s28 offen lds
    v_mfma_f32_32x32x16_bf16 v[240:255], v[44:47], v[52:55], v[240:255]
    s_add_u32 m0, s26, 81920
    s_nop 0
    buffer_load_dwordx4 v14, s[16:19], s28 offen lds
    s_add_u32 m0, s26, 33792
    s_nop 0
    buffer_load_dwordx4 v15, s[12:15], s28 offen lds
    s_waitcnt lgkmcnt(0)
    v_mfma_f32_32x32x16_bf16 v[128:143], v[64:67], v[80:83], v[128:143]
    ds_read_b128 v[48:51], v20 offset:0
    v_mfma_f32_32x32x16_bf16 v[144:159], v[64:67], v[84:87], v[144:159]
    ds_read_b128 v[52:55], v90 offset:0
    ds_read_b64_tr_b16 v[32:33], v22 offset:8192
    v_mfma_f32_32x32x16_bf16 v[160:175], v[68:71], v[80:83], v[160:175]
    ds_read_b64_tr_b16 v[34:35], v22 offset:9216
    ds_read_b64_tr_b16 v[36:37], v23 offset:8192
    v_mfma_f32_32x32x16_bf16 v[176:191], v[68:71], v[84:87], v[176:191]
    ds_read_b64_tr_b16 v[38:39], v23 offset:9216
    ds_read_b64_tr_b16 v[40:41], v24 offset:8192
    v_mfma_f32_32x32x16_bf16 v[192:207], v[72:75], v[80:83], v[192:207]
    ds_read_b64_tr_b16 v[42:43], v24 offset:9216
    v_mfma_f32_32x32x16_bf16 v[208:223], v[72:75], v[84:87], v[208:223]
    ds_read_b64_tr_b16 v[44:45], v25 offset:8192
    ds_read_b64_tr_b16 v[46:47], v25 offset:9216
    v_mfma_f32_32x32x16_bf16 v[224:239], v[76:79], v[80:83], v[224:239]
    s_add_u32 m0, s26, 82944
    s_nop 0
    buffer_load_dwordx4 v15, s[16:19], s28 offen lds
    s_add_u32 m0, s26, 34816
    s_nop 0
    buffer_load_dwordx4 v16, s[12:15], s28 offen lds
    v_mfma_f32_32x32x16_bf16 v[240:255], v[76:79], v[84:87], v[240:255]
    s_add_u32 m0, s26, 83968
    s_nop 0
    buffer_load_dwordx4 v16, s[16:19], s28 offen lds
    s_add_u32 m0, s26, 35840
    s_nop 0
    buffer_load_dwordx4 v17, s[12:15], s28 offen lds
    s_waitcnt lgkmcnt(0)
    v_mfma_f32_32x32x16_bf16 v[128:143], v[32:35], v[48:51], v[128:143]
    ds_read_b128 v[80:83], v21 offset:0
    v_mfma_f32_32x32x16_bf16 v[144:159], v[32:35], v[52:55], v[144:159]
    ds_read_b128 v[84:87], v91 offset:0
    v_mfma_f32_32x32x16_bf16 v[160:175], v[36:39], v[48:51], v[160:175]
    ds_read_b64_tr_b16 v[64:65], v22 offset:12288
    ds_read_b64_tr_b16 v[66:67], v22 offset:13312
    v_mfma_f32_32x32x16_bf16 v[176:191], v[36:39], v[52:55], v[176:191]
    ds_read_b64_tr_b16 v[68:69], v23 offset:12288
    v_mfma_f32_32x32x16_bf16 v[192:207], v[40:43], v[48:51], v[192:207]
    ds_read_b64_tr_b16 v[70:71], v23 offset:13312
    v_mfma_f32_32x32x16_bf16 v[208:223], v[40:43], v[52:55], v[208:223]
    ds_read_b64_tr_b16 v[72:73], v24 offset:12288
    ds_read_b64_tr_b16 v[74:75], v24 offset:13312
    v_mfma_f32_32x32x16_bf16 v[224:239], v[44:47], v[48:51], v[224:239]
    ds_read_b64_tr_b16 v[76:77], v25 offset:12288
    v_mfma_f32_32x32x16_bf16 v[240:255], v[44:47], v[52:55], v[240:255]
    ds_read_b64_tr_b16 v[78:79], v25 offset:13312
    s_add_u32 m0, s26, 84992
    s_nop 0
    buffer_load_dwordx4 v17, s[16:19], s28 offen lds
    s_waitcnt lgkmcnt(0)
    s_waitcnt vmcnt(12)
    s_barrier
    v_mfma_f32_32x32x16_bf16 v[128:143], v[64:67], v[80:83], v[128:143]
    ds_read_b128 v[48:51], v18 offset:16384
    v_mfma_f32_32x32x16_bf16 v[144:159], v[64:67], v[84:87], v[144:159]
    ds_read_b128 v[52:55], v88 offset:16384
    ds_read_b64_tr_b16 v[32:33], v22 offset:16384
    v_mfma_f32_32x32x16_bf16 v[160:175], v[68:71], v[80:83], v[160:175]
    ds_read_b64_tr_b16 v[34:35], v22 offset:17408
    ds_read_b64_tr_b16 v[36:37], v23 offset:16384
    v_mfma_f32_32x32x16_bf16 v[176:191], v[68:71], v[84:87], v[176:191]
    ds_read_b64_tr_b16 v[38:39], v23 offset:17408
    ds_read_b64_tr_b16 v[40:41], v24 offset:16384
    v_mfma_f32_32x32x16_bf16 v[192:207], v[72:75], v[80:83], v[192:207]
    ds_read_b64_tr_b16 v[42:43], v24 offset:17408
    v_mfma_f32_32x32x16_bf16 v[208:223], v[72:75], v[84:87], v[208:223]
    ds_read_b64_tr_b16 v[44:45], v25 offset:16384
    ds_read_b64_tr_b16 v[46:47], v25 offset:17408
    v_mfma_f32_32x32x16_bf16 v[224:239], v[76:79], v[80:83], v[224:239]
    s_add_u32 s27, s27, 128
    s_cmp_eq_u32 s27, 1280
    s_cselect_b32 s27, 0, s27
    s_mul_i32 s28, s27, 1536
    s_add_u32 m0, s25, 0
    s_nop 0
    buffer_load_dwordx4 v10, s[8:11], s27 offen lds
    v_mfma_f32_32x32x16_bf16 v[240:255], v[76:79], v[84:87], v[240:255]
    s_add_u32 m0, s25, 1024
    s_nop 0
    buffer_load_dwordx4 v11, s[8:11], s27 offen lds
    s_add_u32 m0, s25, 2048
    s_nop 0
    buffer_load_dwordx4 v12, s[8:11], s27 offen lds
    s_waitcnt lgkmcnt(0)
    v_mfma_f32_32x32x16_bf16 v[128:143], v[32:35], v[48:51], v[128:143]
    ds_read_b128 v[80:83], v19 offset:16384
    v_mfma_f32_32x32x16_bf16 v[144:159], v[32:35], v[52:55], v[144:159]
    ds_read_b128 v[84:87], v89 offset:16384
    ds_read_b64_tr_b16 v[64:65], v22 offset:20480
    v_mfma_f32_32x32x16_bf16 v[160:175], v[36:39], v[48:51], v[160:175]
    ds_read_b64_tr_b16 v[66:67], v22 offset:21504
    ds_read_b64_tr_b16 v[68:69], v23 offset:20480
    v_mfma_f32_32x32x16_bf16 v[176:191], v[36:39], v[52:55], v[176:191]
    ds_read_b64_tr_b16 v[70:71], v23 offset:21504
    ds_read_b64_tr_b16 v[72:73], v24 offset:20480
    v_mfma_f32_32x32x16_bf16 v[192:207], v[40:43], v[48:51], v[192:207]
    ds_read_b64_tr_b16 v[74:75], v24 offset:21504
    v_mfma_f32_32x32x16_bf16 v[208:223], v[40:43], v[52:55], v[208:223]
    ds_read_b64_tr_b16 v[76:77], v25 offset:20480
    ds_read_b64_tr_b16 v[78:79], v25 offset:21504
    v_mfma_f32_32x32x16_bf16 v[224:239], v[44:47], v[48:51], v[224:239]
    s_add_u32 m0, s25, 3072
    s_nop 0
    buffer_load_dwordx4 v13, s[8:11], s27 offen lds
    s_add_u32 m0, s26, 0
    s_nop 0
    buffer_load_dwordx4 v14, s[12:15], s28 offen lds
    v_mfma_f32_32x32x16_bf16 v[240:255], v[44:47], v[52:55], v[240:255]
    s_add_u32 m0, s26, 49152
    s_nop 0
    buffer_load_dwordx4 v14, s[16:19], s28 offen lds
    s_add_u32 m0, s26, 1024
    s_nop 0
    buffer_load_dwordx4 v15, s[12:15], s28 offen lds
    s_waitcnt lgkmcnt(0)
    v_mfma_f32_32x32x16_bf16 v[128:143], v[64:67], v[80:83], v[128:143]
    ds_read_b128 v[48:51], v20 offset:16384
    v_mfma_f32_32x32x16_bf16 v[144:159], v[64:67], v[84:87], v[144:159]
    ds_read_b128 v[52:55], v90 offset:16384
    ds_read_b64_tr_b16 v[32:33], v22 offset:24576
    v_mfma_f32_32x32x16_bf16 v[160:175], v[68:71], v[80:83], v[160:175]
    ds_read_b64_tr_b16 v[34:35], v22 offset:25600
    ds_read_b64_tr_b16 v[36:37], v23 offset:24576
    v_mfma_f32_32x32x16_bf16 v[176:191], v[68:71], v[84:87], v[176:191]
    ds_read_b64_tr_b16 v[38:39], v23 offset:25600
    ds_read_b64_tr_b16 v[40:41], v24 offset:24576
    v_mfma_f32_32x32x16_bf16 v[192:207], v[72:75], v[80:83], v[192:207]
    ds_read_b64_tr_b16 v[42:43], v24 offset:25600
    v_mfma_f32_32x32x16_bf16 v[208:223], v[72:75], v[84:87], v[208:223]
    ds_read_b64_tr_b16 v[44:45], v25 offset:24576
    ds_read_b64_tr_b16 v[46:47], v25 offset:25600
    v_mfma_f32_32x32x16_bf16 v[224:239], v[76:79], v[80:83], v[224:239]
    s_add_u32 m0, s26, 50176
    s_nop 0
    buffer_load_dwordx4 v15, s[16:19], s28 offen lds
    s_add_u32 m0, s26, 2048
    s_nop 0
    buffer_load_dwordx4 v16, s[12:15], s28 offen lds
    v_mfma_f32_32x32x16_bf16 v[240:255], v[76:79], v[84:87], v[240:255]
    s_add_u32 m0, s26, 51200
    s_nop 0
    buffer_load_dwordx4 v16, s[16:19], s28 offen lds
    s_add_u32 m0, s26, 3072
    s_nop 0
    buffer_load_dwordx4 v17, s[12:15], s28 offen lds
    s_waitcnt lgkmcnt(0)
    v_mfma_f32_32x32x16_bf16 v[128:143], v[32:35], v[48:51], v[128:143]
    ds_read_b128 v[80:83], v21 offset:16384
    v_mfma_f32_32x32x16_bf16 v[144:159], v[32:35], v[52:55], v[144:159]
    ds_read_b128 v[84:87], v91 offset:16384
    v_mfma_f32_32x32x16_bf16 v[160:175], v[36:39], v[48:51], v[160:175]
    ds_read_b64_tr_b16 v[64:65], v22 offset:28672
    ds_read_b64_tr_b16 v[66:67], v22 offset:29696
    v_mfma_f32_32x32x16_bf16 v[176:191], v[36:39], v[52:55], v[176:191]
    ds_read_b64_tr_b16 v[68:69], v23 offset:28672
    v_mfma_f32_32x32x16_bf16 v[192:207], v[40:43], v[48:51], v[192:207]
    ds_read_b64_tr_b16 v[70:71], v23 offset:29696
    v_mfma_f32_32x32x16_bf16 v[208:223], v[40:43], v[52:55], v[208:223]
    ds_read_b64_tr_b16 v[72:73], v24 offset:28672
    ds_read_b64_tr_b16 v[74:75], v24 offset:29696
    v_mfma_f32_32x32x16_bf16 v[224:239], v[44:47], v[48:51], v[224:239]
    ds_read_b64_tr_b16 v[76:77], v25 offset:28672
    v_mfma_f32_32x32x16_bf16 v[240:255], v[44:47], v[52:55], v[240:255]
    ds_read_b64_tr_b16 v[78:79], v25 offset:29696
    s_add_u32 m0, s26, 52224
    s_nop 0
    buffer_load_dwordx4 v17, s[16:19], s28 offen lds
    s_waitcnt lgkmcnt(0)
    s_waitcnt vmcnt(12)
    s_barrier
    v_mfma_f32_32x32x16_bf16 v[128:143], v[64:67], v[80:83], v[128:143]
    ds_read_b128 v[48:51], v18 offset:32768
    v_mfma_f32_32x32x16_bf16 v[144:159], v[64:67], v[84:87], v[144:159]
    ds_read_b128 v[52:55], v88 offset:32768
    ds_read_b64_tr_b16 v[32:33], v22 offset:32768
    v_mfma_f32_32x32x16_bf16 v[160:175], v[68:71], v[80:83], v[160:175]
    ds_read_b64_tr_b16 v[34:35], v22 offset:33792
    ds_read_b64_tr_b16 v[36:37], v23 offset:32768
    v_mfma_f32_32x32x16_bf16 v[176:191], v[68:71], v[84:87], v[176:191]
    ds_read_b64_tr_b16 v[38:39], v23 offset:33792
    ds_read_b64_tr_b16 v[40:41], v24 offset:32768
    v_mfma_f32_32x32x16_bf16 v[192:207], v[72:75], v[80:83], v[192:207]
    ds_read_b64_tr_b16 v[42:43], v24 offset:33792
    v_mfma_f32_32x32x16_bf16 v[208:223], v[72:75], v[84:87], v[208:223]
    ds_read_b64_tr_b16 v[44:45], v25 offset:32768
    ds_read_b64_tr_b16 v[46:47], v25 offset:33792
    v_mfma_f32_32x32x16_bf16 v[224:239], v[76:79], v[80:83], v[224:239]
    s_add_u32 s27, s27, 128
    s_cmp_eq_u32 s27, 1280
    s_cselect_b32 s27, 0, s27
    s_mul_i32 s28, s27, 1536
    s_add_u32 m0, s25, 16384
    s_nop 0
    buffer_load_dwordx4 v10, s[8:11], s27 offen lds
    v_mfma_f32_32x32x16_bf16 v[240:255], v[76:79], v[84:87], v[240:255]
    s_add_u32 m0, s25, 17408
    s_nop 0
    buffer_load_dwordx4 v11, s[8:11], s27 offen lds
    s_add_u32 m0, s25, 18432
    s_nop 0
    buffer_load_dwordx4 v12, s[8:11], s27 offen lds
    s_waitcnt lgkmcnt(0)
    v_mfma_f32_32x32x16_bf16 v[128:143], v[32:35], v[48:51], v[128:143]
    ds_read_b128 v[80:83], v19 offset:32768
    v_mfma_f32_32x32x16_bf16 v[144:159], v[32:35], v[52:55], v[144:159]
    ds_read_b128 v[84:87], v89 offset:32768
    ds_read_b64_tr_b16 v[64:65], v22 offset:36864
    v_mfma_f32_32x32x16_bf16 v[160:175], v[36:39], v[48:51], v[160:175]
    ds_read_b64_tr_b16 v[66:67], v22 offset:37888
    ds_read_b64_tr_b16 v[68:69], v23 offset:36864
    v_mfma_f32_32x32x16_bf16 v[176:191], v[36:39], v[52:55], v[176:191]
    ds_read_b64_tr_b16 v[70:71], v23 offset:37888
    ds_read_b64_tr_b16 v[72:73], v24 offset:36864
    v_mfma_f32_32x32x16_bf16 v[192:207], v[40:43], v[48:51], v[192:207]
    ds_read_b64_tr_b16 v[74:75], v24 offset:37888
    v_mfma_f32_32x32x16_bf16 v[208:223], v[40:43], v[52:55], v[208:223]
    ds_read_b64_tr_b16 v[76:77], v25 offset:36864
    ds_read_b64_tr_b16 v[78:79], v25 offset:37888
    v_mfma_f32_32x32x16_bf16 v[224:239], v[44:47], v[48:51], v[224:239]
    s_add_u32 m0, s25, 19456
    s_nop 0
    buffer_load_dwordx4 v13, s[8:11], s27 offen lds
    s_add_u32 m0, s26, 16384
    s_nop 0
    buffer_load_dwordx4 v14, s[12:15], s28 offen lds
    v_mfma_f32_32x32x16_bf16 v[240:255], v[44:47], v[52:55], v[240:255]
    s_add_u32 m0, s26, 65536
    s_nop 0
    buffer_load_dwordx4 v14, s[16:19], s28 offen lds
    s_add_u32 m0, s26, 17408
    s_nop 0
    buffer_load_dwordx4 v15, s[12:15], s28 offen lds
    s_waitcnt lgkmcnt(0)
    v_mfma_f32_32x32x16_bf16 v[128:143], v[64:67], v[80:83], v[128:143]
    ds_read_b128 v[48:51], v20 offset:32768
    v_mfma_f32_32x32x16_bf16 v[144:159], v[64:67], v[84:87], v[144:159]
    ds_read_b128 v[52:55], v90 offset:32768
    ds_read_b64_tr_b16 v[32:33], v22 offset:40960
    v_mfma_f32_32x32x16_bf16 v[160:175], v[68:71], v[80:83], v[160:175]
    ds_read_b64_tr_b16 v[34:35], v22 offset:41984
    ds_read_b64_tr_b16 v[36:37], v23 offset:40960
    v_mfma_f32_32x32x16_bf16 v[176:191], v[68:71], v[84:87], v[176:191]
    ds_read_b64_tr_b16 v[38:39], v23 offset:41984
    ds_read_b64_tr_b16 v[40:41], v24 offset:40960
    v_mfma_f32_32x32x16_bf16 v[192:207], v[72:75], v[80:83], v[192:207]
    ds_read_b64_tr_b16 v[42:43], v24 offset:41984
    v_mfma_f32_32x32x16_bf16 v[208:223], v[72:75], v[84:87], v[208:223]
    ds_read_b64_tr_b16 v[44:45], v25 offset:40960
    ds_read_b64_tr_b16 v[46:47], v25 offset:41984
    v_mfma_f32_32x32x16_bf16 v[224:239], v[76:79], v[80:83], v[224:239]
    s_add_u32 m0, s26, 66560
    s_nop 0
    buffer_load_dwordx4 v15, s[16:19], s28 offen lds
    s_add_u32 m0, s26, 18432
    s_nop 0
    buffer_load_dwordx4 v16, s[12:15], s28 offen lds
    v_mfma_f32_32x32x16_bf16 v[240:255], v[76:79], v[84:87], v[240:255]
    s_add_u32 m0, s26, 67584
    s_nop 0
    buffer_load_dwordx4 v16, s[16:19], s28 offen lds
    s_add_u32 m0, s26, 19456
    s_nop 0
    buffer_load_dwordx4 v17, s[12:15], s28 offen lds
    s_waitcnt lgkmcnt(0)
    v_mfma_f32_32x32x16_bf16 v[128:143], v[32:35], v[48:51], v[128:143]
    ds_read_b128 v[80:83], v21 offset:32768
    v_mfma_f32_32x32x16_bf16 v[144:159], v[32:35], v[52:55], v[144:159]
    ds_read_b128 v[84:87], v91 offset:32768
    v_mfma_f32_32x32x16_bf16 v[160:175], v[36:39], v[48:51], v[160:175]
    ds_read_b64_tr_b16 v[64:65], v22 offset:45056
    ds_read_b64_tr_b16 v[66:67], v22 offset:46080
    v_mfma_f32_32x32x16_bf16 v[176:191], v[36:39], v[52:55], v[176:191]
    ds_read_b64_tr_b16 v[68:69], v23 offset:45056
    v_mfma_f32_32x32x16_bf16 v[192:207], v[40:43], v[48:51], v[192:207]
    ds_read_b64_tr_b16 v[70:71], v23 offset:46080
    v_mfma_f32_32x32x16_bf16 v[208:223], v[40:43], v[52:55], v[208:223]
    ds_read_b64_tr_b16 v[72:73], v24 offset:45056
    ds_read_b64_tr_b16 v[74:75], v24 offset:46080
    v_mfma_f32_32x32x16_bf16 v[224:239], v[44:47], v[48:51], v[224:239]
    ds_read_b64_tr_b16 v[76:77], v25 offset:45056
    v_mfma_f32_32x32x16_bf16 v[240:255], v[44:47], v[52:55], v[240:255]
    ds_read_b64_tr_b16 v[78:79], v25 offset:46080
    s_add_u32 m0, s26, 68608
    s_nop 0
    buffer_load_dwordx4 v17, s[16:19], s28 offen lds
    s_waitcnt lgkmcnt(0)
    s_waitcnt vmcnt(12)
    s_barrier
    v_mfma_f32_32x32x16_bf16 v[128:143], v[64:67], v[80:83], v[128:143]
    ds_read_b128 v[48:51], v18 offset:0
    v_mfma_f32_32x32x16_bf16 v[144:159], v[64:67], v[84:87], v[144:159]
    ds_read_b128 v[52:55], v88 offset:0
    ds_read_b64_tr_b16 v[32:33], v22 offset:0
    v_mfma_f32_32x32x16_bf16 v[160:175], v[68:71], v[80:83], v[160:175]
    ds_read_b64_tr_b16 v[34:35], v22 offset:1024
    ds_read_b64_tr_b16 v[36:37], v23 offset:0
    v_mfma_f32_32x32x16_bf16 v[176:191], v[68:71], v[84:87], v[176:191]
    ds_read_b64_tr_b16 v[38:39], v23 offset:1024
    ds_read_b64_tr_b16 v[40:41], v24 offset:0
    v_mfma_f32_32x32x16_bf16 v[192:207], v[72:75], v[80:83], v[192:207]
    ds_read_b64_tr_b16 v[42:43], v24 offset:1024
    v_mfma_f32_32x32x16_bf16 v[208:223], v[72:75], v[84:87], v[208:223]
    ds_read_b64_tr_b16 v[44:45], v25 offset:0
    ds_read_b64_tr_b16 v[46:47], v25 offset:1024
    v_mfma_f32_32x32x16_bf16 v[224:239], v[76:79], v[80:83], v[224:239]
    s_add_u32 s27, s27, 128
    s_cmp_eq_u32 s27, 1280
    s_cselect_b32 s27, 0, s27
    s_mul_i32 s28, s27, 1536
    s_add_u32 m0, s25, 32768
    s_nop 0
    buffer_load_dwordx4 v10, s[8:11], s27 offen lds
    v_mfma_f32_32x32x16_bf16 v[240:255], v[76:79], v[84:87], v[240:255]
    s_add_u32 m0, s25, 33792
    s_nop 0
    buffer_load_dwordx4 v11, s[8:11], s27 offen lds
    s_add_u32 m0, s25, 34816
    s_nop 0
    buffer_load_dwordx4 v12, s[8:11], s27 offen lds
    s_waitcnt lgkmcnt(0)
    v_mfma_f32_32x32x16_bf16 v[128:143], v[32:35], v[48:51], v[128:143]
    ds_read_b128 v[80:83], v19 offset:0
    v_mfma_f32_32x32x16_bf16 v[144:159], v[32:35], v[52:55], v[144:159]
    ds_read_b128 v[84:87], v89 offset:0
    ds_read_b64_tr_b16 v[64:65], v22 offset:4096
    v_mfma_f32_32x32x16_bf16 v[160:175], v[36:39], v[48:51], v[160:175]
    ds_read_b64_tr_b16 v[66:67], v22 offset:5120
    ds_read_b64_tr_b16 v[68:69], v23 offset:4096
    v_mfma_f32_32x32x16_bf16 v[176:191], v[36:39], v[52:55], v[176:191]
    ds_read_b64_tr_b16 v[70:71], v23 offset:5120
    ds_read_b64_tr_b16 v[72:73], v24 offset:4096
    v_mfma_f32_32x32x16_bf16 v[192:207], v[40:43], v[48:51], v[192:207]
    ds_read_b64_tr_b16 v[74:75], v24 offset:5120
    v_mfma_f32_32x32x16_bf16 v[208:223], v[40:43], v[52:55], v[208:223]
    ds_read_b64_tr_b16 v[76:77], v25 offset:4096
    ds_read_b64_tr_b16 v[78:79], v25 offset:5120
    v_mfma_f32_32x32x16_bf16 v[224:239], v[44:47], v[48:51], v[224:239]
    s_add_u32 m0, s25, 35840
    s_nop 0
    buffer_load_dwordx4 v13, s[8:11], s27 offen lds
    s_add_u32 m0, s26, 32768
    s_nop 0
    buffer_load_dwordx4 v14, s[12:15], s28 offen lds
    v_mfma_f32_32x32x16_bf16 v[240:255], v[44:47], v[52:55], v[240:255]
    s_add_u32 m0, s26, 81920
    s_nop 0
    buffer_load_dwordx4 v14, s[16:19], s28 offen lds
    s_add_u32 m0, s26, 33792
    s_nop 0
    buffer_load_dwordx4 v15, s[12:15], s28 offen lds
    s_waitcnt lgkmcnt(0)
    v_mfma_f32_32x32x16_bf16 v[128:143], v[64:67], v[80:83], v[128:143]
    ds_read_b128 v[48:51], v20 offset:0
    v_mfma_f32_32x32x16_bf16 v[144:159], v[64:67], v[84:87], v[144:159]
    ds_read_b128 v[52:55], v90 offset:0
    ds_read_b64_tr_b16 v[32:33], v22 offset:8192
    v_mfma_f32_32x32x16_bf16 v[160:175], v[68:71], v[80:83], v[160:175]
    ds_read_b64_tr_b16 v[34:35], v22 offset:9216
    ds_read_b64_tr_b16 v[36:37], v23 offset:8192
    v_mfma_f32_32x32x16_bf16 v[176:191], v[68:71], v[84:87], v[176:191]
    ds_read_b64_tr_b16 v[38:39], v23 offset:9216
    ds_read_b64_tr_b16 v[40:41], v24 offset:8192
    v_mfma_f32_32x32x16_bf16 v[192:207], v[72:75], v[80:83], v[192:207]
    ds_read_b64_tr_b16 v[42:43], v24 offset:9216
    v_mfma_f32_32x32x16_bf16 v[208:223], v[72:75], v[84:87], v[208:223]
    ds_read_b64_tr_b16 v[44:45], v25 offset:8192
    ds_read_b64_tr_b16 v[46:47], v25 offset:9216
    v_mfma_f32_32x32x16_bf16 v[224:239], v[76:79], v[80:83], v[224:239]
    s_add_u32 m0, s26, 82944
    s_nop 0
    buffer_load_dwordx4 v15, s[16:19], s28 offen lds
    s_add_u32 m0, s26, 34816
    s_nop 0
    buffer_load_dwordx4 v16, s[12:15], s28 offen lds
    v_mfma_f32_32x32x16_bf16 v[240:255], v[76:79], v[84:87], v[240:255]
    s_add_u32 m0, s26, 83968
    s_nop 0
    buffer_load_dwordx4 v16, s[16:19], s28 offen lds
    s_add_u32 m0, s26, 35840
    s_nop 0
    buffer_load_dwordx4 v17, s[12:15], s28 offen lds
    s_waitcnt lgkmcnt(0)
    v_mfma_f32_32x32x16_bf16 v[128:143], v[32:35], v[48:51], v[128:143]
    ds_read_b128 v[80:83], v21 offset:0
    v_mfma_f32_32x32x16_bf16 v[144:159], v[32:35], v[52:55], v[144:159]
    ds_read_b128 v[84:87], v91 offset:0
    v_mfma_f32_32x32x16_bf16 v[160:175], v[36:39], v[48:51], v[160:175]
    ds_read_b64_tr_b16 v[64:65], v22 offset:12288
    ds_read_b64_tr_b16 v[66:67], v22 offset:13312
    v_mfma_f32_32x32x16_bf16 v[176:191], v[36:39], v[52:55], v[176:191]
    ds_read_b64_tr_b16 v[68:69], v23 offset:12288
    v_mfma_f32_32x32x16_bf16 v[192:207], v[40:43], v[48:51], v[192:207]
    ds_read_b64_tr_b16 v[70:71], v23 offset:13312
    v_mfma_f32_32x32x16_bf16 v[208:223], v[40:43], v[52:55], v[208:223]
    ds_read_b64_tr_b16 v[72:73], v24 offset:12288
    ds_read_b64_tr_b16 v[74:75], v24 offset:13312
    v_mfma_f32_32x32x16_bf16 v[224:239], v[44:47], v[48:51], v[224:239]
    ds_read_b64_tr_b16 v[76:77], v25 offset:12288
    v_mfma_f32_32x32x16_bf16 v[240:255], v[44:47], v[52:55], v[240:255]
    ds_read_b64_tr_b16 v[78:79], v25 offset:13312
    s_add_u32 m0, s26, 84992
    s_nop 0
    buffer_load_dwordx4 v17, s[16:19], s28 offen lds
    s_waitcnt lgkmcnt(0)
    s_waitcnt vmcnt(12)
    s_barrier
    v_mfma_f32_32x32x16_bf16 v[128:143], v[64:67], v[80:83], v[128:143]
    ds_read_b128 v[48:51], v18 offset:16384
    v_mfma_f32_32x32x16_bf16 v[144:159], v[64:67], v[84:87], v[144:159]
    ds_read_b128 v[52:55], v88 offset:16384
    ds_read_b64_tr_b16 v[32:33], v22 offset:16384
    v_mfma_f32_32x32x16_bf16 v[160:175], v[68:71], v[80:83], v[160:175]
    ds_read_b64_tr_b16 v[34:35], v22 offset:17408
    ds_read_b64_tr_b16 v[36:37], v23 offset:16384
    v_mfma_f32_32x32x16_bf16 v[176:191], v[68:71], v[84:87], v[176:191]
    ds_read_b64_tr_b16 v[38:39], v23 offset:17408
    ds_read_b64_tr_b16 v[40:41], v24 offset:16384
    v_mfma_f32_32x32x16_bf16 v[192:207], v[72:75], v[80:83], v[192:207]
    ds_read_b64_tr_b16 v[42:43], v24 offset:17408
    v_mfma_f32_32x32x16_bf16 v[208:223], v[72:75], v[84:87], v[208:223]
    ds_read_b64_tr_b16 v[44:45], v25 offset:16384
    ds_read_b64_tr_b16 v[46:47], v25 offset:17408
    v_mfma_f32_32x32x16_bf16 v[224:239], v[76:79], v[80:83], v[224:239]
    s_add_u32 s27, s27, 128
    s_cmp_eq_u32 s27, 1280
    s_cselect_b32 s27, 0, s27
    s_mul_i32 s28, s27, 1536
    s_add_u32 m0, s25, 0
    s_nop 0
    buffer_load_dwordx4 v10, s[8:11], s27 offen lds
    v_mfma_f32_32x32x16_bf16 v[240:255], v[76:79], v[84:87], v[240:255]
    s_add_u32 m0, s25, 1024
    s_nop 0
    buffer_load_dwordx4 v11, s[8:11], s27 offen lds
    s_add_u32 m0, s25, 2048
    s_nop 0
    buffer_load_dwordx4 v12, s[8:11], s27 offen lds
    s_waitcnt lgkmcnt(0)
    v_mfma_f32_32x32x16_bf16 v[128:143], v[32:35], v[48:51], v[128:143]
    ds_read_b128 v[80:83], v19 offset:16384
    v_mfma_f32_32x32x16_bf16 v[144:159], v[32:35], v[52:55], v[144:159]
    ds_read_b128 v[84:87], v89 offset:16384
    ds_read_b64_tr_b16 v[64:65], v22 offset:20480
    v_mfma_f32_32x32x16_bf16 v[160:175], v[36:39], v[48:51], v[160:175]
    ds_read_b64_tr_b16 v[66:67], v22 offset:21504
    ds_read_b64_tr_b16 v[68:69], v23 offset:20480
    v_mfma_f32_32x32x16_bf16 v[176:191], v[36:39], v[52:55], v[176:191]
    ds_read_b64_tr_b16 v[70:71], v23 offset:21504
    ds_read_b64_tr_b16 v[72:73], v24 offset:20480
    v_mfma_f32_32x32x16_bf16 v[192:207], v[40:43], v[48:51], v[192:207]
    ds_read_b64_tr_b16 v[74:75], v24 offset:21504
    v_mfma_f32_32x32x16_bf16 v[208:223], v[40:43], v[52:55], v[208:223]
    ds_read_b64_tr_b16 v[76:77], v25 offset:20480
    ds_read_b64_tr_b16 v[78:79], v25 offset:21504
    v_mfma_f32_32x32x16_bf16 v[224:239], v[44:47], v[48:51], v[224:239]
    s_add_u32 m0, s25, 3072
    s_nop 0
    buffer_load_dwordx4 v13, s[8:11], s27 offen lds
    s_add_u32 m0, s26, 0
    s_nop 0
    buffer_load_dwordx4 v14, s[12:15], s28 offen lds
    v_mfma_f32_32x32x16_bf16 v[240:255], v[44:47], v[52:55], v[240:255]
    s_add_u32 m0, s26, 49152
    s_nop 0
    buffer_load_dwordx4 v14, s[16:19], s28 offen lds
    s_add_u32 m0, s26, 1024
    s_nop 0
    buffer_load_dwordx4 v15, s[12:15], s28 offen lds
    s_waitcnt lgkmcnt(0)
    v_mfma_f32_32x32x16_bf16 v[128:143], v[64:67], v[80:83], v[128:143]
    ds_read_b128 v[48:51], v20 offset:16384
    v_mfma_f32_32x32x16_bf16 v[144:159], v[64:67], v[84:87], v[144:159]
    ds_read_b128 v[52:55], v90 offset:16384
    ds_read_b64_tr_b16 v[32:33], v22 offset:24576
    v_mfma_f32_32x32x16_bf16 v[160:175], v[68:71], v[80:83], v[160:175]
    ds_read_b64_tr_b16 v[34:35], v22 offset:25600
    ds_read_b64_tr_b16 v[36:37], v23 offset:24576
    v_mfma_f32_32x32x16_bf16 v[176:191], v[68:71], v[84:87], v[176:191]
    ds_read_b64_tr_b16 v[38:39], v23 offset:25600
    ds_read_b64_tr_b16 v[40:41], v24 offset:24576
    v_mfma_f32_32x32x16_bf16 v[192:207], v[72:75], v[80:83], v[192:207]
    ds_read_b64_tr_b16 v[42:43], v24 offset:25600
    v_mfma_f32_32x32x16_bf16 v[208:223], v[72:75], v[84:87], v[208:223]
    ds_read_b64_tr_b16 v[44:45], v25 offset:24576
    ds_read_b64_tr_b16 v[46:47], v25 offset:25600
    v_mfma_f32_32x32x16_bf16 v[224:239], v[76:79], v[80:83], v[224:239]
    s_add_u32 m0, s26, 50176
    s_nop 0
    buffer_load_dwordx4 v15, s[16:19], s28 offen lds
    s_add_u32 m0, s26, 2048
    s_nop 0
    buffer_load_dwordx4 v16, s[12:15], s28 offen lds
    v_mfma_f32_32x32x16_bf16 v[240:255], v[76:79], v[84:87], v[240:255]
    s_add_u32 m0, s26, 51200
    s_nop 0
    buffer_load_dwordx4 v16, s[16:19], s28 offen lds
    s_add_u32 m0, s26, 3072
    s_nop 0
    buffer_load_dwordx4 v17, s[12:15], s28 offen lds
    s_waitcnt lgkmcnt(0)
    v_mfma_f32_32x32x16_bf16 v[128:143], v[32:35], v[48:51], v[128:143]
    ds_read_b128 v[80:83], v21 offset:16384
    v_mfma_f32_32x32x16_bf16 v[144:159], v[32:35], v[52:55], v[144:159]
    ds_read_b128 v[84:87], v91 offset:16384
    v_mfma_f32_32x32x16_bf16 v[160:175], v[36:39], v[48:51], v[160:175]
    ds_read_b64_tr_b16 v[64:65], v22 offset:28672
    ds_read_b64_tr_b16 v[66:67], v22 offset:29696
    v_mfma_f32_32x32x16_bf16 v[176:191], v[36:39], v[52:55], v[176:191]
    ds_read_b64_tr_b16 v[68:69], v23 offset:28672
    v_mfma_f32_32x32x16_bf16 v[192:207], v[40:43], v[48:51], v[192:207]
    ds_read_b64_tr_b16 v[70:71], v23 offset:29696
    v_mfma_f32_32x32x16_bf16 v[208:223], v[40:43], v[52:55], v[208:223]
    ds_read_b64_tr_b16 v[72:73], v24 offset:28672
    ds_read_b64_tr_b16 v[74:75], v24 offset:29696
    v_mfma_f32_32x32x16_bf16 v[224:239], v[44:47], v[48:51], v[224:239]
    ds_read_b64_tr_b16 v[76:77], v25 offset:28672
    v_mfma_f32_32x32x16_bf16 v[240:255], v[44:47], v[52:55], v[240:255]
    ds_read_b64_tr_b16 v[78:79], v25 offset:29696
    s_add_u32 m0, s26, 52224
    s_nop 0
    buffer_load_dwordx4 v17, s[16:19], s28 offen lds
    s_waitcnt lgkmcnt(0)
    s_waitcnt vmcnt(12)
    s_barrier
    v_mfma_f32_32x32x16_bf16 v[128:143], v[64:67], v[80:83], v[128:143]
    ds_read_b128 v[48:51], v18 offset:32768
    v_mfma_f32_32x32x16_bf16 v[144:159], v[64:67], v[84:87], v[144:159]
    ds_read_b128 v[52:55], v88 offset:32768
    v_mfma_f32_32x32x16_bf16 v[160:175], v[68:71], v[80:83], v[160:175]
    ds_read_b64_tr_b16 v[32:33], v22 offset:32768
    v_mfma_f32_32x32x16_bf16 v[176:191], v[68:71], v[84:87], v[176:191]
    ds_read_b64_tr_b16 v[34:35], v22 offset:33792
    ds_read_b64_tr_b16 v[36:37], v23 offset:32768
    v_mfma_f32_32x32x16_bf16 v[192:207], v[72:75], v[80:83], v[192:207]
    ds_read_b64_tr_b16 v[38:39], v23 offset:33792
    v_mfma_f32_32x32x16_bf16 v[208:223], v[72:75], v[84:87], v[208:223]
    ds_read_b64_tr_b16 v[40:41], v24 offset:32768
    v_mfma_f32_32x32x16_bf16 v[224:239], v[76:79], v[80:83], v[224:239]
    ds_read_b64_tr_b16 v[42:43], v24 offset:33792
    v_mfma_f32_32x32x16_bf16 v[240:255], v[76:79], v[84:87], v[240:255]
    ds_read_b64_tr_b16 v[44:45], v25 offset:32768
    ds_read_b64_tr_b16 v[46:47], v25 offset:33792
    s_waitcnt lgkmcnt(0)
    v_mfma_f32_32x32x16_bf16 v[128:143], v[32:35], v[48:51], v[128:143]
    ds_read_b128 v[80:83], v19 offset:32768
    v_mfma_f32_32x32x16_bf16 v[144:159], v[32:35], v[52:55], v[144:159]
    ds_read_b128 v[84:87], v89 offset:32768
    v_mfma_f32_32x32x16_bf16 v[160:175], v[36:39], v[48:51], v[160:175]
    ds_read_b64_tr_b16 v[64:65], v22 offset:36864
    v_mfma_f32_32x32x16_bf16 v[176:191], v[36:39], v[52:55], v[176:191]
    ds_read_b64_tr_b16 v[66:67], v22 offset:37888
    ds_read_b64_tr_b16 v[68:69], v23 offset:36864
    v_mfma_f32_32x32x16_bf16 v[192:207], v[40:43], v[48:51], v[192:207]
    ds_read_b64_tr_b16 v[70:71], v23 offset:37888
    v_mfma_f32_32x32x16_bf16 v[208:223], v[40:43], v[52:55], v[208:223]
    ds_read_b64_tr_b16 v[72:73], v24 offset:36864
    v_mfma_f32_32x32x16_bf16 v[224:239], v[44:47], v[48:51], v[224:239]
    ds_read_b64_tr_b16 v[74:75], v24 offset:37888
    v_mfma_f32_32x32x16_bf16 v[240:255], v[44:47], v[52:55], v[240:255]
    ds_read_b64_tr_b16 v[76:77], v25 offset:36864
    ds_read_b64_tr_b16 v[78:79], v25 offset:37888
    s_waitcnt lgkmcnt(0)
    v_mfma_f32_32x32x16_bf16 v[128:143], v[64:67], v[80:83], v[128:143]
    ds_read_b128 v[48:51], v20 offset:32768
    v_mfma_f32_32x32x16_bf16 v[144:159], v[64:67], v[84:87], v[144:159]
    ds_read_b128 v[52:55], v90 offset:32768
    v_mfma_f32_32x32x16_bf16 v[160:175], v[68:71], v[80:83], v[160:175]
    ds_read_b64_tr_b16 v[32:33], v22 offset:40960
    v_mfma_f32_32x32x16_bf16 v[176:191], v[68:71], v[84:87], v[176:191]
    ds_read_b64_tr_b16 v[34:35], v22 offset:41984
    ds_read_b64_tr_b16 v[36:37], v23 offset:40960
    v_mfma_f32_32x32x16_bf16 v[192:207], v[72:75], v[80:83], v[192:207]
    ds_read_b64_tr_b16 v[38:39], v23 offset:41984
    v_mfma_f32_32x32x16_bf16 v[208:223], v[72:75], v[84:87], v[208:223]
    ds_read_b64_tr_b16 v[40:41], v24 offset:40960
    v_mfma_f32_32x32x16_bf16 v[224:239], v[76:79], v[80:83], v[224:239]
    ds_read_b64_tr_b16 v[42:43], v24 offset:41984
    v_mfma_f32_32x32x16_bf16 v[240:255], v[76:79], v[84:87], v[240:255]
    ds_read_b64_tr_b16 v[44:45], v25 offset:40960
    ds_read_b64_tr_b16 v[46:47], v25 offset:41984
    s_waitcnt lgkmcnt(0)
    v_mfma_f32_32x32x16_bf16 v[128:143], v[32:35], v[48:51], v[128:143]
    ds_read_b128 v[80:83], v21 offset:32768
    v_mfma_f32_32x32x16_bf16 v[144:159], v[32:35], v[52:55], v[144:159]
    ds_read_b128 v[84:87], v91 offset:32768
    v_mfma_f32_32x32x16_bf16 v[160:175], v[36:39], v[48:51], v[160:175]
    ds_read_b64_tr_b16 v[64:65], v22 offset:45056
    v_mfma_f32_32x32x16_bf16 v[176:191], v[36:39], v[52:55], v[176:191]
    ds_read_b64_tr_b16 v[66:67], v22 offset:46080
    ds_read_b64_tr_b16 v[68:69], v23 offset:45056
    v_mfma_f32_32x32x16_bf16 v[192:207], v[40:43], v[48:51], v[192:207]
    ds_read_b64_tr_b16 v[70:71], v23 offset:46080
    v_mfma_f32_32x32x16_bf16 v[208:223], v[40:43], v[52:55], v[208:223]
    ds_read_b64_tr_b16 v[72:73], v24 offset:45056
    v_mfma_f32_32x32x16_bf16 v[224:239], v[44:47], v[48:51], v[224:239]
    ds_read_b64_tr_b16 v[74:75], v24 offset:46080
    v_mfma_f32_32x32x16_bf16 v[240:255], v[44:47], v[52:55], v[240:255]
    ds_read_b64_tr_b16 v[76:77], v25 offset:45056
    ds_read_b64_tr_b16 v[78:79], v25 offset:46080
    s_waitcnt lgkmcnt(0)
    s_lshl_b32 s3, s30, 2
    s_lshl_b32 s35, s31, 2
    v_mov_b32 v92, 0
    buffer_load_dword v93, v92, s[92:95], s3 offen sc1
    buffer_load_dword v94, v92, s[92:95], s35 offen offset:64 sc1
    buffer_load_dword v95, v92, s[92:95], 0 offen offset:240 sc1
    s_waitcnt vmcnt(0)
    s_barrier
    s_mov_b32 s58, 0
spin_4:
    v_readfirstlane_b32 s3, v93
    v_readfirstlane_b32 s35, v94
    v_readfirstlane_b32 s34, v95
    s_nop 3
    s_add_u32 s3, s3, s35
    s_add_u32 s3, s3, s34
    s_cmp_ge_u32 s3, 21
    s_cbranch_scc1 spinok_5
    s_add_u32 s58, s58, 1
    s_cmp_ge_u32 s58, 0x4000
    s_cbranch_scc1 spinok_5
    s_sleep 4
    s_lshl_b32 s3, s30, 2
    s_lshl_b32 s35, s31, 2
    buffer_load_dword v93, v92, s[92:95], s3 offen sc1
    buffer_load_dword v94, v92, s[92:95], s35 offen offset:64 sc1
    buffer_load_dword v95, v92, s[92:95], 0 offen offset:240 sc1
    s_waitcnt vmcnt(0)
    s_branch spin_4
spinok_5:
    v_mov_b32 v115, 0
    s_lshl_b32 s34, s30, 7
    v_lshlrev_b32 v92, 2, v0
    s_mul_i32 s3, s31, 10240
    s_add_u32 s3, s3, 163840
    s_add_u32 s35, s3, 4096
    s_add_u32 s58, s3, 8192
    v_and_b32 v93, 127, v0
    v_lshlrev_b32 v93, 3, v93
    v_lshrrev_b32 v104, 7, v0
    v_mul_u32_u24 v104, 5120, v104
    v_add_u32 v93, v93, v104
    s_mul_i32 s56, s30, 10240
    s_add_u32 s57, s56, 4096
    v_mfma_f32_32x32x16_bf16 v[128:143], v[64:67], v[80:83], v[128:143]
    ds_read_b128 v[48:51], v18 offset:0
    ds_read_b128 v[52:55], v88 offset:0
    ds_read_b64_tr_b16 v[32:33], v22 offset:0
    v_mfma_f32_32x32x16_bf16 v[144:159], v[64:67], v[84:87], v[144:159]
    ds_read_b64_tr_b16 v[34:35], v22 offset:1024
    ds_read_b64_tr_b16 v[36:37], v23 offset:0
    ds_read_b64_tr_b16 v[38:39], v23 offset:1024
    v_mfma_f32_32x32x16_bf16 v[160:175], v[68:71], v[80:83], v[160:175]
    ds_read_b64_tr_b16 v[40:41], v24 offset:0
    ds_read_b64_tr_b16 v[42:43], v24 offset:1024
    ds_read_b64_tr_b16 v[44:45], v25 offset:0
    v_mfma_f32_32x32x16_bf16 v[176:191], v[68:71], v[84:87], v[176:191]
    ds_read_b64_tr_b16 v[46:47], v25 offset:1024
    buffer_load_dword v114, v115, s[96:99], s34 offen offset:4 sc1
    buffer_load_dword v94, v92, s[4:7], s3 offen offset:0 sc1
    buffer_load_dword v95, v92, s[4:7], s3 offen offset:1024 sc1
    v_mfma_f32_32x32x16_bf16 v[192:207], v[72:75], v[80:83], v[192:207]
    buffer_load_dword v96, v92, s[4:7], s3 offen offset:2048 sc1
    buffer_load_dword v97, v92, s[4:7], s3 offen offset:3072 sc1
    buffer_load_dword v98, v92, s[4:7], s35 offen offset:0 sc1
    v_mfma_f32_32x32x16_bf16 v[208:223], v[72:75], v[84:87], v[208:223]
    buffer_load_dword v99, v92, s[4:7], s35 offen offset:1024 sc1
    buffer_load_dword v100, v92, s[4:7], s35 offen offset:2048 sc1
    buffer_load_dword v101, v92, s[4:7], s35 offen offset:3072 sc1
    v_mfma_f32_32x32x16_bf16 v[224:239], v[76:79], v[80:83], v[224:239]
    buffer_load_dword v102, v92, s[4:7], s58 offen offset:0 sc1
    buffer_load_dword v103, v92, s[4:7], s58 offen offset:1024 sc1
    buffer_load_dwordx2 v[104:105], v93, s[4:7], s56 offen offset:0 sc1
    v_mfma_f32_32x32x16_bf16 v[240:255], v[76:79], v[84:87], v[240:255]
    buffer_load_dwordx2 v[106:107], v93, s[4:7], s56 offen offset:1024 sc1
    buffer_load_dwordx2 v[108:109], v93, s[4:7], s56 offen offset:2048 sc1
    buffer_load_dwordx2 v[110:111], v93, s[4:7], s56 offen offset:3072 sc1
    buffer_load_dwordx2 v[112:113], v93, s[4:7], s57 offen offset:0 sc1
    s_waitcnt lgkmcnt(0)
    v_mfma_f32_32x32x16_bf16 v[128:143], v[32:35], v[48:51], v[128:143]
    ds_read_b128 v[80:83], v19 offset:0
    v_mfma_f32_32x32x16_bf16 v[144:159], v[32:35], v[52:55], v[144:159]
    ds_read_b128 v[84:87], v89 offset:0
    v_mfma_f32_32x32x16_bf16 v[160:175], v[36:39], v[48:51], v[160:175]
    ds_read_b64_tr_b16 v[64:65], v22 offset:4096
    v_mfma_f32_32x32x16_bf16 v[176:191], v[36:39], v[52:55], v[176:191]
    ds_read_b64_tr_b16 v[66:67], v22 offset:5120
    ds_read_b64_tr_b16 v[68:69], v23 offset:4096
    v_mfma_f32_32x32x16_bf16 v[192:207], v[40:43], v[48:51], v[192:207]
    ds_read_b64_tr_b16 v[70:71], v23 offset:5120
    v_mfma_f32_32x32x16_bf16 v[208:223], v[40:43], v[52:55], v[208:223]
    ds_read_b64_tr_b16 v[72:73], v24 offset:4096
    v_mfma_f32_32x32x16_bf16 v[224:239], v[44:47], v[48:51], v[224:239]
    ds_read_b64_tr_b16 v[74:75], v24 offset:5120
    v_mfma_f32_32x32x16_bf16 v[240:255], v[44:47], v[52:55], v[240:255]
    ds_read_b64_tr_b16 v[76:77], v25 offset:4096
    ds_read_b64_tr_b16 v[78:79], v25 offset:5120
    s_waitcnt lgkmcnt(0)
    v_mfma_f32_32x32x16_bf16 v[128:143], v[64:67], v[80:83], v[128:143]
    ds_read_b128 v[48:51], v20 offset:0
    v_mfma_f32_32x32x16_bf16 v[144:159], v[64:67], v[84:87], v[144:159]
    ds_read_b128 v[52:55], v90 offset:0
    v_mfma_f32_32x32x16_bf16 v[160:175], v[68:71], v[80:83], v[160:175]
    ds_read_b64_tr_b16 v[32:33], v22 offset:8192
    v_mfma_f32_32x32x16_bf16 v[176:191], v[68:71], v[84:87], v[176:191]
    ds_read_b64_tr_b16 v[34:35], v22 offset:9216
    ds_read_b64_tr_b16 v[36:37], v23 offset:8192
    v_mfma_f32_32x32x16_bf16 v[192:207], v[72:75], v[80:83], v[192:207]
    ds_read_b64_tr_b16 v[38:39], v23 offset:9216
    v_mfma_f32_32x32x16_bf16 v[208:223], v[72:75], v[84:87], v[208:223]
    ds_read_b64_tr_b16 v[40:41], v24 offset:8192
    v_mfma_f32_32x32x16_bf16 v[224:239], v[76:79], v[80:83], v[224:239]
    ds_read_b64_tr_b16 v[42:43], v24 offset:9216
    v_mfma_f32_32x32x16_bf16 v[240:255], v[76:79], v[84:87], v[240:255]
    ds_read_b64_tr_b16 v[44:45], v25 offset:8192
    ds_read_b64_tr_b16 v[46:47], v25 offset:9216
    s_waitcnt lgkmcnt(0)
    v_mfma_f32_32x32x16_bf16 v[128:143], v[32:35], v[48:51], v[128:143]
    ds_read_b128 v[80:83], v21 offset:0
    v_mfma_f32_32x32x16_bf16 v[144:159], v[32:35], v[52:55], v[144:159]
    ds_read_b128 v[84:87], v91 offset:0
    v_mfma_f32_32x32x16_bf16 v[160:175], v[36:39], v[48:51], v[160:175]
    ds_read_b64_tr_b16 v[64:65], v22 offset:12288
    v_mfma_f32_32x32x16_bf16 v[176:191], v[36:39], v[52:55], v[176:191]
    ds_read_b64_tr_b16 v[66:67], v22 offset:13312
    ds_read_b64_tr_b16 v[68:69], v23 offset:12288
    v_mfma_f32_32x32x16_bf16 v[192:207], v[40:43], v[48:51], v[192:207]
    ds_read_b64_tr_b16 v[70:71], v23 offset:13312
    v_mfma_f32_32x32x16_bf16 v[208:223], v[40:43], v[52:55], v[208:223]
    ds_read_b64_tr_b16 v[72:73], v24 offset:12288
    v_mfma_f32_32x32x16_bf16 v[224:239], v[44:47], v[48:51], v[224:239]
    ds_read_b64_tr_b16 v[74:75], v24 offset:13312
    v_mfma_f32_32x32x16_bf16 v[240:255], v[44:47], v[52:55], v[240:255]
    ds_read_b64_tr_b16 v[76:77], v25 offset:12288
    ds_read_b64_tr_b16 v[78:79], v25 offset:13312
    s_waitcnt lgkmcnt(0)
    v_mfma_f32_32x32x16_bf16 v[128:143], v[64:67], v[80:83], v[128:143]
    v_mfma_f32_32x32x16_bf16 v[144:159], v[64:67], v[84:87], v[144:159]
    v_mfma_f32_32x32x16_bf16 v[160:175], v[68:71], v[80:83], v[160:175]
    v_mfma_f32_32x32x16_bf16 v[176:191], v[68:71], v[84:87], v[176:191]
    v_mfma_f32_32x32x16_bf16 v[192:207], v[72:75], v[80:83], v[192:207]
    v_mfma_f32_32x32x16_bf16 v[208:223], v[72:75], v[84:87], v[208:223]
    v_mfma_f32_32x32x16_bf16 v[224:239], v[76:79], v[80:83], v[224:239]
    v_mfma_f32_32x32x16_bf16 v[240:255], v[76:79], v[84:87], v[240:255]
    s_waitcnt vmcnt(0)
    v_readfirstlane_b32 s34, v114
    s_lshr_b32 s79, s2, 3
    s_mul_i32 s3, s79, 52
    s_lshr_b32 s3, s3, 8
    s_mul_i32 s77, s3, 5
    s_sub_u32 s79, s79, s77
    s_add_u32 s77, s79, s3
    s_cmp_ge_u32 s77, 6
    s_cselect_b32 s3, 6, 0
    s_sub_u32 s77, s77, s3
    s_mov_b32 s76, s77
    s_mul_i32 s3, s24, 24576
    s_lshl_b32 s80, s77, 12
    s_add_u32 s3, s3, s80
    s_mul_i32 s80, s79, 99328
    s_add_u32 s80, s80, s3
    s_sub_u32 s81, 9, s79
    s_mul_i32 s81, s81, 99328
    s_add_u32 s81, s81, s3
    s_add_u32 s82, s80, 993280
    s_add_u32 s83, s81, 993280
    s_cmp_ge_u32 s34, 32
    s_cselect_b32 s79, 1, 0
    s_cmp_lt_u32 s2, 160
    s_cselect_b32 s79, s79, 0
    v_lshlrev_b32 v13, 4, v1
    s_mul_i32 s78, s24, 36864
    v_add_f32 v94, v94, v95
    v_add_f32 v94, v94, v96
    v_add_f32 v94, v94, v97
    v_add_f32 v94, v94, v98
    v_add_f32 v94, v94, v99
    v_add_f32 v94, v94, v100
    v_add_f32 v94, v94, v101
    v_add_f32 v94, v94, v102
    v_add_f32 v94, v94, v103
    v_pk_add_f32 v[104:105], v[104:105], v[106:107]
    v_pk_add_f32 v[104:105], v[104:105], v[108:109]
    v_pk_add_f32 v[104:105], v[104:105], v[110:111]
    v_pk_add_f32 v[104:105], v[104:105], v[112:113]
    v_add_u32 v92, 149504, v92
    ds_write_b32 v92, v94
    v_lshlrev_b32 v93, 3, v0
    v_add_u32 v93, 147456, v93
    ds_write_b64 v93, v[104:105]
    v_and_b32 v2, 31, v1
    v_lshrrev_b32 v3, 5, v1
    s_waitcnt lgkmcnt(0)
    s_barrier
    v_add_u32 v4, 147456, v30
    v_xor_b32 v8, 0x100, v4
    ds_read_b64 v[6:7], v4
    ds_read_b64 v[14:15], v4 offset:1024
    ds_read_b64 v[16:17], v8 offset:1024
    ds_read_b64 v[8:9], v8
    s_lshl_b32 s3, s33, 1
    s_add_u32 s3, s3, s32
    s_lshl_b32 s3, s3, 7
    s_add_u32 s3, s3, 149504
    v_lshl_add_u32 v5, v3, 4, s3
    v_xor_b32 v10, 0x80, v5
    ds_read_b128 v[32:35], v5 offset:0
    ds_read_b128 v[36:39], v5 offset:32
    ds_read_b128 v[40:43], v5 offset:64
    ds_read_b128 v[44:47], v5 offset:96
    ds_read_b128 v[48:51], v10 offset:0
    ds_read_b128 v[52:55], v10 offset:32
    ds_read_b128 v[56:59], v10 offset:64
    ds_read_b128 v[60:63], v10 offset:96
    ds_read_b128 v[64:67], v5 offset:512
    ds_read_b128 v[68:71], v5 offset:544
    ds_read_b128 v[72:75], v5 offset:576
    ds_read_b128 v[76:79], v5 offset:608
    ds_read_b128 v[80:83], v10 offset:512
    ds_read_b128 v[84:87], v10 offset:544
    ds_read_b128 v[88:91], v10 offset:576
    ds_read_b128 v[92:95], v10 offset:608
    s_waitcnt lgkmcnt(0)
    v_pk_add_f32 v[6:7], v[6:7], v[14:15]
    v_pk_add_f32 v[8:9], v[8:9], v[16:17]
    s_mov_b32 s3, 0x3acccccd
    s_mov_b32 s35, 0x3727c5ac
    v_mul_f32 v6, s3, v6
    v_mul_f32 v7, s3, v7
    v_fma_f32 v7, -v6, v6, v7
    v_max_f32 v7, 0, v7
    v_cvt_pk_bf16_f32 v11, v6, v7
    v_lshlrev_b32 v96, 16, v11
    v_xor_b32 v96, 0x80000000, v96
    v_and_b32 v11, 0xffff0000, v11
    v_add_f32 v11, s35, v11
    v_cvt_pk_bf16_f32 v11, v11, v11
    v_lshlrev_b32 v11, 16, v11
    v_sqrt_f32 v11, v11
    s_nop 0
    v_cvt_pk_bf16_f32 v11, v11, v11
    v_lshlrev_b32 v11, 16, v11
    v_mul_f32 v100, v11, v11
    v_rcp_f32 v11, v11
    s_nop 0
    v_mul_f32 v98, 0xbfb8aa3b, v11
    v_mul_f32 v8, s3, v8
    v_mul_f32 v9, s3, v9
    v_fma_f32 v9, -v8, v8, v9
    v_max_f32 v9, 0, v9
    v_cvt_pk_bf16_f32 v11, v8, v9
    v_lshlrev_b32 v104, 16, v11
    v_xor_b32 v104, 0x80000000, v104
    v_and_b32 v11, 0xffff0000, v11
    v_add_f32 v11, s35, v11
    v_cvt_pk_bf16_f32 v11, v11, v11
    v_lshlrev_b32 v11, 16, v11
    v_sqrt_f32 v11, v11
    s_nop 0
    v_cvt_pk_bf16_f32 v11, v11, v11
    v_lshlrev_b32 v11, 16, v11
    v_mul_f32 v108, v11, v11
    v_rcp_f32 v11, v11
    s_nop 0
    v_mul_f32 v106, 0xbfb8aa3b, v11
    v_lshlrev_b32 v12, 4, v1
    s_lshl_b32 s3, s30, 2
    s_lshl_b32 s35, s32, 1
    s_add_u32 s3, s3, s35
    s_lshl_b32 s56, s31, 2
    s_lshl_b32 s35, s33, 1
    s_add_u32 s56, s56, s35
    s_xor_b32 s57, s33, 0
    s_add_u32 s57, s57, s3
    s_mul_i32 s57, s57, 99328
    s_xor_b32 s58, s32, 0
    s_add_u32 s58, s58, s56
    s_lshl_b32 s58, s58, 11
    s_add_u32 s57, s57, s58
    v_pk_fma_f32 v[128:129], v[32:33], v[96:97], v[128:129] op_sel_hi:[1,0,1]
    v_pk_fma_f32 v[192:193], v[64:65], v[96:97], v[192:193] op_sel_hi:[1,0,1]
    v_pk_mul_f32 v[112:113], v[128:129], v[98:99] op_sel_hi:[1,0]
    v_pk_fma_f32 v[130:131], v[34:35], v[96:97], v[130:131] op_sel_hi:[1,0,1]
    v_pk_fma_f32 v[194:195], v[66:67], v[96:97], v[194:195] op_sel_hi:[1,0,1]
    v_pk_mul_f32 v[114:115], v[130:131], v[98:99] op_sel_hi:[1,0]
    v_pk_fma_f32 v[132:133], v[36:37], v[96:97], v[132:133] op_sel_hi:[1,0,1]
    v_pk_fma_f32 v[196:197], v[68:69], v[96:97], v[196:197] op_sel_hi:[1,0,1]
    v_pk_mul_f32 v[116:117], v[132:133], v[98:99] op_sel_hi:[1,0]
    v_pk_fma_f32 v[134:135], v[38:39], v[96:97], v[134:135] op_sel_hi:[1,0,1]
    s_cmp_eq_u32 s79, 0
    s_cbranch_scc1 pf_6
    buffer_load_dwordx4 a[0:3], v13, s[84:87], s80 offen offset:0
    buffer_load_dwordx4 a[4:7], v13, s[84:87], s81 offen offset:0
    buffer_load_dwordx4 a[8:11], v13, s[84:87], s82 offen offset:0
    buffer_load_dwordx4 a[12:15], v13, s[84:87], s83 offen offset:0
    pf_6:
    v_pk_fma_f32 v[198:199], v[70:71], v[96:97], v[198:199] op_sel_hi:[1,0,1]
    v_pk_mul_f32 v[118:119], v[134:135], v[98:99] op_sel_hi:[1,0]
    v_pk_fma_f32 v[136:137], v[40:41], v[96:97], v[136:137] op_sel_hi:[1,0,1]
    v_pk_fma_f32 v[200:201], v[72:73], v[96:97], v[200:201] op_sel_hi:[1,0,1]
    v_pk_mul_f32 v[120:121], v[136:137], v[98:99] op_sel_hi:[1,0]
    v_pk_fma_f32 v[138:139], v[42:43], v[96:97], v[138:139] op_sel_hi:[1,0,1]
    v_pk_fma_f32 v[202:203], v[74:75], v[96:97], v[202:203] op_sel_hi:[1,0,1]
    v_pk_mul_f32 v[122:123], v[138:139], v[98:99] op_sel_hi:[1,0]
    v_pk_fma_f32 v[140:141], v[44:45], v[96:97], v[140:141] op_sel_hi:[1,0,1]
    v_pk_fma_f32 v[204:205], v[76:77], v[96:97], v[204:205] op_sel_hi:[1,0,1]
    v_pk_mul_f32 v[124:125], v[140:141], v[98:99] op_sel_hi:[1,0]
    v_pk_fma_f32 v[142:143], v[46:47], v[96:97], v[142:143] op_sel_hi:[1,0,1]
    v_pk_fma_f32 v[206:207], v[78:79], v[96:97], v[206:207] op_sel_hi:[1,0,1]
    v_pk_mul_f32 v[126:127], v[142:143], v[98:99] op_sel_hi:[1,0]
    v_exp_f32 v112, v112
    v_exp_f32 v113, v113
    v_exp_f32 v114, v114
    s_cmp_eq_u32 s79, 0
    s_cbranch_scc1 pf_7
    buffer_load_dwordx4 a[16:19], v13, s[84:87], s80 offen offset:1024
    buffer_load_dwordx4 a[20:23], v13, s[84:87], s81 offen offset:1024
    buffer_load_dwordx4 a[24:27], v13, s[84:87], s82 offen offset:1024
    buffer_load_dwordx4 a[28:31], v13, s[84:87], s83 offen offset:1024
    pf_7:
    v_exp_f32 v115, v115
    v_exp_f32 v116, v116
    v_exp_f32 v117, v117
    v_exp_f32 v118, v118
    v_exp_f32 v119, v119
    v_exp_f32 v120, v120
    v_exp_f32 v121, v121
    v_exp_f32 v122, v122
    v_exp_f32 v123, v123
    v_exp_f32 v124, v124
    v_exp_f32 v125, v125
    v_exp_f32 v126, v126
    v_exp_f32 v127, v127
    v_pk_mul_f32 v[128:129], v[128:129], v[192:193]
    v_pk_fma_f32 v[112:113], v[112:113], v[100:101], v[100:101] op_sel_hi:[1,0,0]
    v_pk_mul_f32 v[130:131], v[130:131], v[194:195]
    v_pk_fma_f32 v[114:115], v[114:115], v[100:101], v[100:101] op_sel_hi:[1,0,0]
    s_cmp_eq_u32 s79, 0
    s_cbranch_scc1 pf_8
    buffer_load_dwordx4 a[32:35], v13, s[84:87], s80 offen offset:2048
    buffer_load_dwordx4 a[36:39], v13, s[84:87], s81 offen offset:2048
    buffer_load_dwordx4 a[40:43], v13, s[84:87], s82 offen offset:2048
    buffer_load_dwordx4 a[44:47], v13, s[84:87], s83 offen offset:2048
    pf_8:
    v_pk_mul_f32 v[132:133], v[132:133], v[196:197]
    v_pk_fma_f32 v[116:117], v[116:117], v[100:101], v[100:101] op_sel_hi:[1,0,0]
    v_pk_mul_f32 v[134:135], v[134:135], v[198:199]
    v_pk_fma_f32 v[118:119], v[118:119], v[100:101], v[100:101] op_sel_hi:[1,0,0]
    v_pk_mul_f32 v[136:137], v[136:137], v[200:201]
    v_pk_fma_f32 v[120:121], v[120:121], v[100:101], v[100:101] op_sel_hi:[1,0,0]
    v_pk_mul_f32 v[138:139], v[138:139], v[202:203]
    v_pk_fma_f32 v[122:123], v[122:123], v[100:101], v[100:101] op_sel_hi:[1,0,0]
    v_pk_mul_f32 v[140:141], v[140:141], v[204:205]
    v_pk_fma_f32 v[124:125], v[124:125], v[100:101], v[100:101] op_sel_hi:[1,0,0]
    v_pk_mul_f32 v[142:143], v[142:143], v[206:207]
    v_pk_fma_f32 v[126:127], v[126:127], v[100:101], v[100:101] op_sel_hi:[1,0,0]
    v_rcp_f32 v112, v112
    v_rcp_f32 v113, v113
    v_rcp_f32 v114, v114
    v_rcp_f32 v115, v115
    v_rcp_f32 v116, v116
    s_cmp_eq_u32 s79, 0
    s_cbranch_scc1 pf_9
    buffer_load_dwordx4 a[48:51], v13, s[84:87], s80 offen offset:3072
    buffer_load_dwordx4 a[52:55], v13, s[84:87], s81 offen offset:3072
    buffer_load_dwordx4 a[56:59], v13, s[84:87], s82 offen offset:3072
    buffer_load_dwordx4 a[60:63], v13, s[84:87], s83 offen offset:3072
    s_add_u32 s77, s77, 1
    s_mov_b32 s75, 4096
    s_cmp_eq_u32 s77, 6
    s_cmov_b32 s75, -20480
    s_cselect_b32 s77, 0, s77
    s_add_u32 s80, s80, s75
    s_add_u32 s81, s81, s75
    s_add_u32 s82, s82, s75
    s_add_u32 s83, s83, s75
    pf_9:
    v_rcp_f32 v117, v117
    v_rcp_f32 v118, v118
    v_rcp_f32 v119, v119
    v_rcp_f32 v120, v120
    v_rcp_f32 v121, v121
    v_rcp_f32 v122, v122
    v_rcp_f32 v123, v123
    v_rcp_f32 v124, v124
    v_rcp_f32 v125, v125
    v_rcp_f32 v126, v126
    v_rcp_f32 v127, v127
    s_nop 0
    v_pk_mul_f32 v[128:129], v[128:129], v[112:113]
    v_pk_mul_f32 v[130:131], v[130:131], v[114:115]
    v_pk_mul_f32 v[132:133], v[132:133], v[116:117]
    v_pk_mul_f32 v[134:135], v[134:135], v[118:119]
    v_pk_mul_f32 v[136:137], v[136:137], v[120:121]
    s_cmp_eq_u32 s79, 0
    s_cbranch_scc1 pf_10
    buffer_load_dwordx4 a[64:67], v13, s[84:87], s80 offen offset:0
    buffer_load_dwordx4 a[68:71], v13, s[84:87], s81 offen offset:0
    buffer_load_dwordx4 a[72:75], v13, s[84:87], s82 offen offset:0
    buffer_load_dwordx4 a[76:79], v13, s[84:87], s83 offen offset:0
    pf_10:
    v_pk_mul_f32 v[138:139], v[138:139], v[122:123]
    v_pk_mul_f32 v[140:141], v[140:141], v[124:125]
    v_pk_mul_f32 v[142:143], v[142:143], v[126:127]
    v_cvt_pk_bf16_f32 v192, v128, v129
    v_cvt_pk_bf16_f32 v193, v130, v131
    v_cvt_pk_bf16_f32 v194, v132, v133
    v_cvt_pk_bf16_f32 v195, v134, v135
    v_cvt_pk_bf16_f32 v196, v136, v137
    v_cvt_pk_bf16_f32 v197, v138, v139
    v_cvt_pk_bf16_f32 v198, v140, v141
    v_cvt_pk_bf16_f32 v199, v142, v143
    buffer_store_dwordx4 v[192:195], v12, s[20:23], s57 offen sc1
    buffer_store_dwordx4 v[196:199], v12, s[20:23], s57 offen offset:1024 sc1
    s_xor_b32 s57, s33, 0
    s_add_u32 s57, s57, s3
    s_mul_i32 s57, s57, 99328
    s_xor_b32 s58, s32, 1
    s_cmp_eq_u32 s79, 0
    s_cbranch_scc1 pf_11
    buffer_load_dwordx4 a[80:83], v13, s[84:87], s80 offen offset:1024
    buffer_load_dwordx4 a[84:87], v13, s[84:87], s81 offen offset:1024
    buffer_load_dwordx4 a[88:91], v13, s[84:87], s82 offen offset:1024
    buffer_load_dwordx4 a[92:95], v13, s[84:87], s83 offen offset:1024
    pf_11:
    s_add_u32 s58, s58, s56
    s_lshl_b32 s58, s58, 11
    s_add_u32 s57, s57, s58
    v_pk_fma_f32 v[160:161], v[48:49], v[96:97], v[160:161] op_sel_hi:[1,0,1]
    v_pk_fma_f32 v[224:225], v[80:81], v[96:97], v[224:225] op_sel_hi:[1,0,1]
    v_pk_mul_f32 v[112:113], v[160:161], v[98:99] op_sel_hi:[1,0]
    v_pk_fma_f32 v[162:163], v[50:51], v[96:97], v[162:163] op_sel_hi:[1,0,1]
    v_pk_fma_f32 v[226:227], v[82:83], v[96:97], v[226:227] op_sel_hi:[1,0,1]
    v_pk_mul_f32 v[114:115], v[162:163], v[98:99] op_sel_hi:[1,0]
    v_pk_fma_f32 v[164:165], v[52:53], v[96:97], v[164:165] op_sel_hi:[1,0,1]
    v_pk_fma_f32 v[228:229], v[84:85], v[96:97], v[228:229] op_sel_hi:[1,0,1]
    v_pk_mul_f32 v[116:117], v[164:165], v[98:99] op_sel_hi:[1,0]
    v_pk_fma_f32 v[166:167], v[54:55], v[96:97], v[166:167] op_sel_hi:[1,0,1]
    v_pk_fma_f32 v[230:231], v[86:87], v[96:97], v[230:231] op_sel_hi:[1,0,1]
    v_pk_mul_f32 v[118:119], v[166:167], v[98:99] op_sel_hi:[1,0]
    v_pk_fma_f32 v[168:169], v[56:57], v[96:97], v[168:169] op_sel_hi:[1,0,1]
    v_pk_fma_f32 v[232:233], v[88:89], v[96:97], v[232:233] op_sel_hi:[1,0,1]
    s_cmp_eq_u32 s79, 0
    s_cbranch_scc1 pf_12
    buffer_load_dwordx4 a[96:99], v13, s[84:87], s80 offen offset:2048
    buffer_load_dwordx4 a[100:103], v13, s[84:87], s81 offen offset:2048
    buffer_load_dwordx4 a[104:107], v13, s[84:87], s82 offen offset:2048
    buffer_load_dwordx4 a[108:111], v13, s[84:87], s83 offen offset:2048
    pf_12:
    v_pk_mul_f32 v[120:121], v[168:169], v[98:99] op_sel_hi:[1,0]
    v_pk_fma_f32 v[170:171], v[58:59], v[96:97], v[170:171] op_sel_hi:[1,0,1]
    v_pk_fma_f32 v[234:235], v[90:91], v[96:97], v[234:235] op_sel_hi:[1,0,1]
    v_pk_mul_f32 v[122:123], v[170:171], v[98:99] op_sel_hi:[1,0]
    v_pk_fma_f32 v[172:173], v[60:61], v[96:97], v[172:173] op_sel_hi:[1,0,1]
    v_pk_fma_f32 v[236:237], v[92:93], v[96:97], v[236:237] op_sel_hi:[1,0,1]
    v_pk_mul_f32 v[124:125], v[172:173], v[98:99] op_sel_hi:[1,0]
    v_pk_fma_f32 v[174:175], v[62:63], v[96:97], v[174:175] op_sel_hi:[1,0,1]
    v_pk_fma_f32 v[238:239], v[94:95], v[96:97], v[238:239] op_sel_hi:[1,0,1]
    v_pk_mul_f32 v[126:127], v[174:175], v[98:99] op_sel_hi:[1,0]
    v_exp_f32 v112, v112
    v_exp_f32 v113, v113
    v_exp_f32 v114, v114
    v_exp_f32 v115, v115
    v_exp_f32 v116, v116
    v_exp_f32 v117, v117
    v_exp_f32 v118, v118
    s_cmp_eq_u32 s79, 0
    s_cbranch_scc1 pf_13
    buffer_load_dwordx4 a[112:115], v13, s[84:87], s80 offen offset:3072
    buffer_load_dwordx4 a[116:119], v13, s[84:87], s81 offen offset:3072
    buffer_load_dwordx4 a[120:123], v13, s[84:87], s82 offen offset:3072
    buffer_load_dwordx4 a[124:127], v13, s[84:87], s83 offen offset:3072
    s_add_u32 s77, s77, 1
    s_mov_b32 s75, 4096
    s_cmp_eq_u32 s77, 6
    s_cmov_b32 s75, -20480
    s_cselect_b32 s77, 0, s77
    s_add_u32 s80, s80, s75
    s_add_u32 s81, s81, s75
    s_add_u32 s82, s82, s75
    s_add_u32 s83, s83, s75
    pf_13:
    v_exp_f32 v119, v119
    v_exp_f32 v120, v120
    v_exp_f32 v121, v121
    v_exp_f32 v122, v122
    v_exp_f32 v123, v123
    v_exp_f32 v124, v124
    v_exp_f32 v125, v125
    v_exp_f32 v126, v126
    v_exp_f32 v127, v127
    v_pk_mul_f32 v[160:161], v[160:161], v[224:225]
    v_pk_fma_f32 v[112:113], v[112:113], v[100:101], v[100:101] op_sel_hi:[1,0,0]
    v_pk_mul_f32 v[162:163], v[162:163], v[226:227]
    v_pk_fma_f32 v[114:115], v[114:115], v[100:101], v[100:101] op_sel_hi:[1,0,0]
    v_pk_mul_f32 v[164:165], v[164:165], v[228:229]
    v_pk_fma_f32 v[116:117], v[116:117], v[100:101], v[100:101] op_sel_hi:[1,0,0]
    v_pk_mul_f32 v[166:167], v[166:167], v[230:231]
    v_pk_fma_f32 v[118:119], v[118:119], v[100:101], v[100:101] op_sel_hi:[1,0,0]
    s_cmp_eq_u32 s79, 0
    s_cbranch_scc1 pf_14
    buffer_load_dwordx4 a[128:131], v13, s[84:87], s80 offen offset:0
    buffer_load_dwordx4 a[132:135], v13, s[84:87], s81 offen offset:0
    buffer_load_dwordx4 a[136:139], v13, s[84:87], s82 offen offset:0
    buffer_load_dwordx4 a[140:143], v13, s[84:87], s83 offen offset:0
    pf_14:
    v_pk_mul_f32 v[168:169], v[168:169], v[232:233]
    v_pk_fma_f32 v[120:121], v[120:121], v[100:101], v[100:101] op_sel_hi:[1,0,0]
    v_pk_mul_f32 v[170:171], v[170:171], v[234:235]
    v_pk_fma_f32 v[122:123], v[122:123], v[100:101], v[100:101] op_sel_hi:[1,0,0]
    v_pk_mul_f32 v[172:173], v[172:173], v[236:237]
    v_pk_fma_f32 v[124:125], v[124:125], v[100:101], v[100:101] op_sel_hi:[1,0,0]
    v_pk_mul_f32 v[174:175], v[174:175], v[238:239]
    v_pk_fma_f32 v[126:127], v[126:127], v[100:101], v[100:101] op_sel_hi:[1,0,0]
    v_rcp_f32 v112, v112
    v_rcp_f32 v113, v113
    v_rcp_f32 v114, v114
    v_rcp_f32 v115, v115
    v_rcp_f32 v116, v116
    v_rcp_f32 v117, v117
    v_rcp_f32 v118, v118
    v_rcp_f32 v119, v119
    v_rcp_f32 v120, v120
    s_cmp_eq_u32 s79, 0
    s_cbranch_scc1 pf_15
    buffer_load_dwordx4 a[144:147], v13, s[84:87], s80 offen offset:1024
    buffer_load_dwordx4 a[148:151], v13, s[84:87], s81 offen offset:1024
    buffer_load_dwordx4 a[152:155], v13, s[84:87], s82 offen offset:1024
    buffer_load_dwordx4 a[156:159], v13, s[84:87], s83 offen offset:1024
    pf_15:
    v_rcp_f32 v121, v121
    v_rcp_f32 v122, v122
    v_rcp_f32 v123, v123
    v_rcp_f32 v124, v124
    v_rcp_f32 v125, v125
    v_rcp_f32 v126, v126
    v_rcp_f32 v127, v127
    s_nop 0
    v_pk_mul_f32 v[160:161], v[160:161], v[112:113]
    v_pk_mul_f32 v[162:163], v[162:163], v[114:115]
    v_pk_mul_f32 v[164:165], v[164:165], v[116:117]
    v_pk_mul_f32 v[166:167], v[166:167], v[118:119]
    v_pk_mul_f32 v[168:169], v[168:169], v[120:121]
    v_pk_mul_f32 v[170:171], v[170:171], v[122:123]
    v_pk_mul_f32 v[172:173], v[172:173], v[124:125]
    v_pk_mul_f32 v[174:175], v[174:175], v[126:127]
    v_cvt_pk_bf16_f32 v224, v160, v161
    v_cvt_pk_bf16_f32 v225, v162, v163
    v_cvt_pk_bf16_f32 v226, v164, v165
    v_cvt_pk_bf16_f32 v227, v166, v167
    v_cvt_pk_bf16_f32 v228, v168, v169
    v_cvt_pk_bf16_f32 v229, v170, v171
    v_cvt_pk_bf16_f32 v230, v172, v173
    v_cvt_pk_bf16_f32 v231, v174, v175
    buffer_store_dwordx4 v[224:227], v12, s[20:23], s57 offen sc1
    buffer_store_dwordx4 v[228:231], v12, s[20:23], s57 offen offset:1024 sc1
    s_xor_b32 s57, s33, 1
    s_add_u32 s57, s57, s3
    s_mul_i32 s57, s57, 99328
    s_xor_b32 s58, s32, 0
    s_add_u32 s58, s58, s56
    s_lshl_b32 s58, s58, 11
    s_add_u32 s57, s57, s58
    v_pk_fma_f32 v[144:145], v[32:33], v[104:105], v[144:145] op_sel_hi:[1,0,1]
    v_pk_fma_f32 v[208:209], v[64:65], v[104:105], v[208:209] op_sel_hi:[1,0,1]
    v_pk_mul_f32 v[112:113], v[144:145], v[106:107] op_sel_hi:[1,0]
    v_pk_fma_f32 v[146:147], v[34:35], v[104:105], v[146:147] op_sel_hi:[1,0,1]
    v_pk_fma_f32 v[210:211], v[66:67], v[104:105], v[210:211] op_sel_hi:[1,0,1]
    v_pk_mul_f32 v[114:115], v[146:147], v[106:107] op_sel_hi:[1,0]
    v_pk_fma_f32 v[148:149], v[36:37], v[104:105], v[148:149] op_sel_hi:[1,0,1]
    v_pk_fma_f32 v[212:213], v[68:69], v[104:105], v[212:213] op_sel_hi:[1,0,1]
    v_pk_mul_f32 v[116:117], v[148:149], v[106:107] op_sel_hi:[1,0]
    v_pk_fma_f32 v[150:151], v[38:39], v[104:105], v[150:151] op_sel_hi:[1,0,1]
    v_pk_fma_f32 v[214:215], v[70:71], v[104:105], v[214:215] op_sel_hi:[1,0,1]
    v_pk_mul_f32 v[118:119], v[150:151], v[106:107] op_sel_hi:[1,0]
    v_pk_fma_f32 v[152:153], v[40:41], v[104:105], v[152:153] op_sel_hi:[1,0,1]
    v_pk_fma_f32 v[216:217], v[72:73], v[104:105], v[216:217] op_sel_hi:[1,0,1]
    v_pk_mul_f32 v[120:121], v[152:153], v[106:107] op_sel_hi:[1,0]
    v_pk_fma_f32 v[154:155], v[42:43], v[104:105], v[154:155] op_sel_hi:[1,0,1]
    v_pk_fma_f32 v[218:219], v[74:75], v[104:105], v[218:219] op_sel_hi:[1,0,1]
    v_pk_mul_f32 v[122:123], v[154:155], v[106:107] op_sel_hi:[1,0]
    v_pk_fma_f32 v[156:157], v[44:45], v[104:105], v[156:157] op_sel_hi:[1,0,1]
    v_pk_fma_f32 v[220:221], v[76:77], v[104:105], v[220:221] op_sel_hi:[1,0,1]
    v_pk_mul_f32 v[124:125], v[156:157], v[106:107] op_sel_hi:[1,0]
    v_pk_fma_f32 v[158:159], v[46:47], v[104:105], v[158:159] op_sel_hi:[1,0,1]
    v_pk_fma_f32 v[222:223], v[78:79], v[104:105], v[222:223] op_sel_hi:[1,0,1]
    v_pk_mul_f32 v[126:127], v[158:159], v[106:107] op_sel_hi:[1,0]
    v_exp_f32 v112, v112
    v_exp_f32 v113, v113
    v_exp_f32 v114, v114
    v_exp_f32 v115, v115
    v_exp_f32 v116, v116
    v_exp_f32 v117, v117
    v_exp_f32 v118, v118
    v_exp_f32 v119, v119
    v_exp_f32 v120, v120
    v_exp_f32 v121, v121
    v_exp_f32 v122, v122
    v_exp_f32 v123, v123
    v_exp_f32 v124, v124
    v_exp_f32 v125, v125
    v_exp_f32 v126, v126
    v_exp_f32 v127, v127
    v_pk_mul_f32 v[144:145], v[144:145], v[208:209]
    v_pk_fma_f32 v[112:113], v[112:113], v[108:109], v[108:109] op_sel_hi:[1,0,0]
    v_pk_mul_f32 v[146:147], v[146:147], v[210:211]
    v_pk_fma_f32 v[114:115], v[114:115], v[108:109], v[108:109] op_sel_hi:[1,0,0]
    v_pk_mul_f32 v[148:149], v[148:149], v[212:213]
    v_pk_fma_f32 v[116:117], v[116:117], v[108:109], v[108:109] op_sel_hi:[1,0,0]
    v_pk_mul_f32 v[150:151], v[150:151], v[214:215]
    v_pk_fma_f32 v[118:119], v[118:119], v[108:109], v[108:109] op_sel_hi:[1,0,0]
    v_pk_mul_f32 v[152:153], v[152:153], v[216:217]
    v_pk_fma_f32 v[120:121], v[120:121], v[108:109], v[108:109] op_sel_hi:[1,0,0]
    v_pk_mul_f32 v[154:155], v[154:155], v[218:219]
    v_pk_fma_f32 v[122:123], v[122:123], v[108:109], v[108:109] op_sel_hi:[1,0,0]
    v_pk_mul_f32 v[156:157], v[156:157], v[220:221]
    v_pk_fma_f32 v[124:125], v[124:125], v[108:109], v[108:109] op_sel_hi:[1,0,0]
    v_pk_mul_f32 v[158:159], v[158:159], v[222:223]
    v_pk_fma_f32 v[126:127], v[126:127], v[108:109], v[108:109] op_sel_hi:[1,0,0]
    v_rcp_f32 v112, v112
    v_rcp_f32 v113, v113
    v_rcp_f32 v114, v114
    v_rcp_f32 v115, v115
    v_rcp_f32 v116, v116
    v_rcp_f32 v117, v117
    v_rcp_f32 v118, v118
    v_rcp_f32 v119, v119
    v_rcp_f32 v120, v120
    v_rcp_f32 v121, v121
    v_rcp_f32 v122, v122
    v_rcp_f32 v123, v123
    v_rcp_f32 v124, v124
    v_rcp_f32 v125, v125
    v_rcp_f32 v126, v126
    v_rcp_f32 v127, v127
    s_nop 0
    v_pk_mul_f32 v[144:145], v[144:145], v[112:113]
    v_pk_mul_f32 v[146:147], v[146:147], v[114:115]
    v_pk_mul_f32 v[148:149], v[148:149], v[116:117]
    v_pk_mul_f32 v[150:151], v[150:151], v[118:119]
    v_pk_mul_f32 v[152:153], v[152:153], v[120:121]
    v_pk_mul_f32 v[154:155], v[154:155], v[122:123]
    v_pk_mul_f32 v[156:157], v[156:157], v[124:125]
    v_pk_mul_f32 v[158:159], v[158:159], v[126:127]
    v_cvt_pk_bf16_f32 v208, v144, v145
    v_cvt_pk_bf16_f32 v209, v146, v147
    v_cvt_pk_bf16_f32 v210, v148, v149
    v_cvt_pk_bf16_f32 v211, v150, v151
    v_cvt_pk_bf16_f32 v212, v152, v153
    v_cvt_pk_bf16_f32 v213, v154, v155
    v_cvt_pk_bf16_f32 v214, v156, v157
    v_cvt_pk_bf16_f32 v215, v158, v159
    buffer_store_dwordx4 v[208:211], v12, s[20:23], s57 offen sc1
    buffer_store_dwordx4 v[212:215], v12, s[20:23], s57 offen offset:1024 sc1
    s_xor_b32 s57, s33, 1
    s_add_u32 s57, s57, s3
    s_mul_i32 s57, s57, 99328
    s_xor_b32 s58, s32, 1
    s_add_u32 s58, s58, s56
    s_lshl_b32 s58, s58, 11
    s_add_u32 s57, s57, s58
    v_pk_fma_f32 v[176:177], v[48:49], v[104:105], v[176:177] op_sel_hi:[1,0,1]
    v_pk_fma_f32 v[240:241], v[80:81], v[104:105], v[240:241] op_sel_hi:[1,0,1]
    v_pk_mul_f32 v[112:113], v[176:177], v[106:107] op_sel_hi:[1,0]
    v_pk_fma_f32 v[178:179], v[50:51], v[104:105], v[178:179] op_sel_hi:[1,0,1]
    v_pk_fma_f32 v[242:243], v[82:83], v[104:105], v[242:243] op_sel_hi:[1,0,1]
    v_pk_mul_f32 v[114:115], v[178:179], v[106:107] op_sel_hi:[1,0]
    v_pk_fma_f32 v[180:181], v[52:53], v[104:105], v[180:181] op_sel_hi:[1,0,1]
    v_pk_fma_f32 v[244:245], v[84:85], v[104:105], v[244:245] op_sel_hi:[1,0,1]
    v_pk_mul_f32 v[116:117], v[180:181], v[106:107] op_sel_hi:[1,0]
    v_pk_fma_f32 v[182:183], v[54:55], v[104:105], v[182:183] op_sel_hi:[1,0,1]
    v_pk_fma_f32 v[246:247], v[86:87], v[104:105], v[246:247] op_sel_hi:[1,0,1]
    v_pk_mul_f32 v[118:119], v[182:183], v[106:107] op_sel_hi:[1,0]
    v_pk_fma_f32 v[184:185], v[56:57], v[104:105], v[184:185] op_sel_hi:[1,0,1]
    v_pk_fma_f32 v[248:249], v[88:89], v[104:105], v[248:249] op_sel_hi:[1,0,1]
    v_pk_mul_f32 v[120:121], v[184:185], v[106:107] op_sel_hi:[1,0]
    v_pk_fma_f32 v[186:187], v[58:59], v[104:105], v[186:187] op_sel_hi:[1,0,1]
    v_pk_fma_f32 v[250:251], v[90:91], v[104:105], v[250:251] op_sel_hi:[1,0,1]
    v_pk_mul_f32 v[122:123], v[186:187], v[106:107] op_sel_hi:[1,0]
    v_pk_fma_f32 v[188:189], v[60:61], v[104:105], v[188:189] op_sel_hi:[1,0,1]
    v_pk_fma_f32 v[252:253], v[92:93], v[104:105], v[252:253] op_sel_hi:[1,0,1]
    v_pk_mul_f32 v[124:125], v[188:189], v[106:107] op_sel_hi:[1,0]
    v_pk_fma_f32 v[190:191], v[62:63], v[104:105], v[190:191] op_sel_hi:[1,0,1]
    v_pk_fma_f32 v[254:255], v[94:95], v[104:105], v[254:255] op_sel_hi:[1,0,1]
    v_pk_mul_f32 v[126:127], v[190:191], v[106:107] op_sel_hi:[1,0]
    v_exp_f32 v112, v112
    v_exp_f32 v113, v113
    v_exp_f32 v114, v114
    v_exp_f32 v115, v115
    v_exp_f32 v116, v116
    v_exp_f32 v117, v117
    v_exp_f32 v118, v118
    v_exp_f32 v119, v119
    v_exp_f32 v120, v120
    v_exp_f32 v121, v121
    v_exp_f32 v122, v122
    v_exp_f32 v123, v123
    v_exp_f32 v124, v124
    v_exp_f32 v125, v125
    v_exp_f32 v126, v126
    v_exp_f32 v127, v127
    v_pk_mul_f32 v[176:177], v[176:177], v[240:241]
    v_pk_fma_f32 v[112:113], v[112:113], v[108:109], v[108:109] op_sel_hi:[1,0,0]
    v_pk_mul_f32 v[178:179], v[178:179], v[242:243]
    v_pk_fma_f32 v[114:115], v[114:115], v[108:109], v[108:109] op_sel_hi:[1,0,0]
    v_pk_mul_f32 v[180:181], v[180:181], v[244:245]
    v_pk_fma_f32 v[116:117], v[116:117], v[108:109], v[108:109] op_sel_hi:[1,0,0]
    v_pk_mul_f32 v[182:183], v[182:183], v[246:247]
    v_pk_fma_f32 v[118:119], v[118:119], v[108:109], v[108:109] op_sel_hi:[1,0,0]
    v_pk_mul_f32 v[184:185], v[184:185], v[248:249]
    v_pk_fma_f32 v[120:121], v[120:121], v[108:109], v[108:109] op_sel_hi:[1,0,0]
    v_pk_mul_f32 v[186:187], v[186:187], v[250:251]
    v_pk_fma_f32 v[122:123], v[122:123], v[108:109], v[108:109] op_sel_hi:[1,0,0]
    v_pk_mul_f32 v[188:189], v[188:189], v[252:253]
    v_pk_fma_f32 v[124:125], v[124:125], v[108:109], v[108:109] op_sel_hi:[1,0,0]
    v_pk_mul_f32 v[190:191], v[190:191], v[254:255]
    v_pk_fma_f32 v[126:127], v[126:127], v[108:109], v[108:109] op_sel_hi:[1,0,0]
    v_rcp_f32 v112, v112
    v_rcp_f32 v113, v113
    v_rcp_f32 v114, v114
    v_rcp_f32 v115, v115
    v_rcp_f32 v116, v116
    v_rcp_f32 v117, v117
    v_rcp_f32 v118, v118
    v_rcp_f32 v119, v119
    v_rcp_f32 v120, v120
    v_rcp_f32 v121, v121
    v_rcp_f32 v122, v122
    v_rcp_f32 v123, v123
    v_rcp_f32 v124, v124
    v_rcp_f32 v125, v125
    v_rcp_f32 v126, v126
    v_rcp_f32 v127, v127
    s_nop 0
    v_pk_mul_f32 v[176:177], v[176:177], v[112:113]
    v_pk_mul_f32 v[178:179], v[178:179], v[114:115]
    v_pk_mul_f32 v[180:181], v[180:181], v[116:117]
    v_pk_mul_f32 v[182:183], v[182:183], v[118:119]
    v_pk_mul_f32 v[184:185], v[184:185], v[120:121]
    v_pk_mul_f32 v[186:187], v[186:187], v[122:123]
    v_pk_mul_f32 v[188:189], v[188:189], v[124:125]
    v_pk_mul_f32 v[190:191], v[190:191], v[126:127]
    v_cvt_pk_bf16_f32 v240, v176, v177
    v_cvt_pk_bf16_f32 v241, v178, v179
    v_cvt_pk_bf16_f32 v242, v180, v181
    v_cvt_pk_bf16_f32 v243, v182, v183
    v_cvt_pk_bf16_f32 v244, v184, v185
    v_cvt_pk_bf16_f32 v245, v186, v187
    v_cvt_pk_bf16_f32 v246, v188, v189
    v_cvt_pk_bf16_f32 v247, v190, v191
    buffer_store_dwordx4 v[240:243], v12, s[20:23], s57 offen sc1
    buffer_store_dwordx4 v[244:247], v12, s[20:23], s57 offen offset:1024 sc1
    s_cmp_lt_u32 s2, 160
    s_cbranch_scc1 k_gemm2
    s_barrier
    s_lshr_b32 s31, s2, 3
    s_sub_u32 s31, s31, 20
    s_lshl_b32 s31, s31, 3
    s_and_b32 s3, s2, 7
    s_add_u32 s31, s31, s3
    s_cmp_ge_u32 s31, 17
    s_cbranch_scc1 gx_16
    s_getpc_b64 s[20:21]
    s_add_u32 s20, s20, tab_fft@rel32@lo+4
    s_addc_u32 s21, s21, tab_fft@rel32@hi+12
    s_and_b32 s21, s21, 0xffff
    s_mov_b32 s22, 63488
    s_mov_b32 s23, 0x00020000
    v_lshlrev_b32 v31, 4, v1
    s_lshl_b32 s27, s24, 10
    s_add_u32 m0, s27, 92160
    s_add_u32 s35, s27, 0
    buffer_load_dwordx4 v31, s[20:23], s35 offen lds
    s_add_u32 m0, s27, 96256
    s_add_u32 s35, s27, 4096
    buffer_load_dwordx4 v31, s[20:23], s35 offen lds
    s_add_u32 m0, s27, 100352
    s_add_u32 s35, s27, 8192
    buffer_load_dwordx4 v31, s[20:23], s35 offen lds
    s_add_u32 m0, s27, 104448
    s_add_u32 s35, s27, 12288
    buffer_load_dwordx4 v31, s[20:23], s35 offen lds
    s_add_u32 m0, s27, 108544
    s_add_u32 s35, s27, 24576
    buffer_load_dwordx4 v31, s[20:23], s35 offen lds
    s_add_u32 m0, s27, 112640
    s_add_u32 s35, s27, 28672
    buffer_load_dwordx4 v31, s[20:23], s35 offen lds
    s_add_u32 m0, s27, 116736
    s_add_u32 s35, s27, 32768
    buffer_load_dwordx4 v31, s[20:23], s35 offen lds
    s_add_u32 m0, s27, 120832
    s_add_u32 s35, s27, 36864
    buffer_load_dwordx4 v31, s[20:23], s35 offen lds
    s_add_u32 m0, s27, 124928
    s_add_u32 s35, s27, 40960
    buffer_load_dwordx4 v31, s[20:23], s35 offen lds
    s_add_u32 m0, s27, 129024
    s_add_u32 s35, s27, 45056
    buffer_load_dwordx4 v31, s[20:23], s35 offen lds
    s_add_u32 m0, s27, 133120
    s_add_u32 s35, s27, 49152
    buffer_load_dwordx4 v31, s[20:23], s35 offen lds
    s_add_u32 m0, s27, 137216
    s_add_u32 s35, s27, 53248
    buffer_load_dwordx4 v31, s[20:23], s35 offen lds
    s_add_u32 m0, s27, 141312
    s_add_u32 s35, s27, 57344
    buffer_load_dwordx4 v31, s[20:23], s35 offen lds
    s_cmp_ge_u32 s24, 2
    s_cbranch_scc1 tb_17
    s_add_u32 m0, s27, 145408
    s_add_u32 s35, s27, 61440
    buffer_load_dwordx4 v31, s[20:23], s35 offen lds
    tb_17:
    s_waitcnt vmcnt(13)
    v_cmp_eq_u32 vcc, 0, v1
    s_and_saveexec_b64 s[100:101], vcc
    v_mov_b32 v2, 0
    v_mov_b32 v3, 1
    s_lshl_b32 s3, s30, 7
    buffer_atomic_add v3, v2, s[96:99], s3 offen offset:0 sc1
    s_mov_b64 exec, s[100:101]
    s_waitcnt vmcnt(0)
    s_barrier
    s_add_u32 s31, s31, 64
    s_branch aux_fft
gx_16:
    s_waitcnt vmcnt(0)
    v_cmp_eq_u32 vcc, 0, v1
    s_and_saveexec_b64 s[100:101], vcc
    v_mov_b32 v2, 0
    v_mov_b32 v3, 1
    s_lshl_b32 s3, s30, 7
    buffer_atomic_add v3, v2, s[96:99], s3 offen offset:0 sc1
    s_mov_b64 exec, s[100:101]
    s_endpgm
k_gemm2:
    s_mov_b32 s6, s30
    s_and_b32 s30, s2, 7
    s_lshl_b32 s30, s30, 2
    s_lshr_b32 s31, s2, 3
    s_mul_i32 s3, s31, 52
    s_lshr_b32 s3, s3, 8
    s_add_u32 s30, s30, s3
    s_mul_i32 s3, s3, 5
    s_sub_u32 s31, s31, s3
    s_lshr_b32 s59, s30, 1
    s_add_u32 s8, s54, 0
    s_addc_u32 s9, s55, 0
    s_and_b32 s9, s9, 0xffff
    s_mov_b32 s10, 6356992
    s_mov_b32 s11, 0x00020000
    s_add_u32 s12, s54, 14155776
    s_addc_u32 s13, s55, 0
    s_and_b32 s13, s13, 0xffff
    s_mov_b32 s14, 1986560
    s_mov_b32 s15, 0x00020000
    v_lshlrev_b32 v2, 4, v1
    s_mul_i32 s3, s24, 24576
    s_lshl_b32 s25, s76, 12
    s_add_u32 s3, s3, s25
    s_mul_i32 s25, s30, 198656
    s_add_u32 s25, s25, s3
    s_add_u32 s26, s25, 99328
    s_mul_i32 s27, s31, 99328
    s_add_u32 s27, s27, s3
    s_sub_u32 s56, 9, s31
    s_mul_i32 s28, s56, 99328
    s_add_u32 s28, s28, s3
    s_add_u32 s29, s27, 993280
    s_add_u32 s32, s28, 993280
    s_add_u32 s16, s54, 16252928
    s_addc_u32 s17, s55, 0
    s_and_b32 s17, s17, 0xffff
    s_mov_b32 s18, 2621440
    s_mov_b32 s19, 0x00020000
    v_lshrrev_b32 v3, 3, v1
    v_and_b32 v4, 7, v1
    v_and_b32 v5, 2, v3
    v_lshlrev_b32 v5, 1, v5
    v_xor_b32 v4, v4, v5
    v_lshlrev_b32 v3, 12, v3
    v_and_b32 v5, 1, v4
    v_lshl_add_u32 v3, v5, 10, v3
    v_lshrrev_b32 v5, 1, v4
    v_lshl_add_u32 v3, v5, 4, v3
    s_mul_i32 s33, s24, 655360
    s_lshr_b32 s3, s30, 4
    s_lshl_b32 s3, s3, 11
    s_add_u32 s33, s33, s3
    s_and_b32 s3, s30, 15
    s_lshl_b32 s3, s3, 6
    s_add_u32 s33, s33, s3
    s_mov_b32 s7, s34
    s_mul_i32 s34, s24, 20480
    s_add_u32 s34, s34, 69632
    v_lshrrev_b32 v8, 4, v1
    v_lshlrev_b32 v8, 3, v8
    v_lshrrev_b32 v9, 2, v1
    v_and_b32 v9, 3, v9
    v_add_u32 v9, v8, v9
    s_lshl_b32 s3, s30, 6
    v_add_u32 v8, s3, v9
    s_mov_b32 s3, 1280
    v_mul_lo_u32 v8, v8, s3
    v_and_b32 v14, 3, v1
    v_lshl_add_u32 v8, v14, 4, v8
    s_sub_u32 s56, 9, s31
    s_and_b32 s3, s24, 1
    s_cmp_eq_u32 s3, 1
    s_cselect_b32 s56, s56, s31
    s_lshr_b32 s3, s24, 1
    s_mul_i32 s3, s3, 10
    s_add_u32 s56, s56, s3
    s_lshl_b32 s56, s56, 6
    v_lshrrev_b32 v10, 5, v1
    v_lshrrev_b32 v11, 2, v1
    v_and_b32 v11, 3, v11
    v_lshl_add_u32 v12, v10, 3, v11
    v_lshlrev_b32 v12, 7, v12
    v_lshrrev_b32 v13, 4, v1
    v_and_b32 v13, 1, v13
    v_lshl_add_u32 v12, v13, 5, v12
    v_and_b32 v13, 3, v1
    v_lshl_add_u32 v12, v13, 3, v12
    v_lshrrev_b32 v13, 1, v11
    v_lshl_add_u32 v12, v13, 6, v12
    v_add_u32 v12, s34, v12
    v_xor_b32 v13, 64, v12
    v_lshlrev_b32 v6, 3, v1
    s_mul_i32 s3, s24, 5
    s_add_u32 s3, s3, s31
    s_mul_i32 s57, s3, 10240
    s_waitcnt vmcnt(0)
    v_cmp_eq_u32 vcc, 0, v1
    s_and_saveexec_b64 s[100:101], vcc
    v_mov_b32 v72, 0
    v_mov_b32 v73, 1
    s_lshl_b32 s3, s6, 7
    buffer_atomic_add v73, v72, s[96:99], s3 offen offset:0 sc1
    s_mov_b64 exec, s[100:101]
    s_cmp_lg_u32 s79, 0
    s_cbranch_scc1 w2done_18
    s_mov_b32 s58, 0
    v_mov_b32 v72, 0
    s_lshl_b32 s35, s59, 7
w2s_19:
    buffer_load_dword v73, v72, s[96:99], s35 offen offset:4 sc1
    s_waitcnt vmcnt(0)
    v_readfirstlane_b32 s7, v73
    s_nop 3
    s_cmp_ge_u32 s7, 32
    s_cbranch_scc1 w2ok_20
    s_add_u32 s58, s58, 1
    s_cmp_ge_u32 s58, 65536
    s_cbranch_scc1 w2ok_20
    s_sleep 8
    s_branch w2s_19
w2ok_20:
    buffer_load_dwordx4 a[0:3], v2, s[84:87], s80 offen offset:0
    buffer_load_dwordx4 a[4:7], v2, s[84:87], s81 offen offset:0
    buffer_load_dwordx4 a[8:11], v2, s[84:87], s82 offen offset:0
    buffer_load_dwordx4 a[12:15], v2, s[84:87], s83 offen offset:0
    buffer_load_dwordx4 a[16:19], v2, s[84:87], s80 offen offset:1024
    buffer_load_dwordx4 a[20:23], v2, s[84:87], s81 offen offset:1024
    buffer_load_dwordx4 a[24:27], v2, s[84:87], s82 offen offset:1024
    buffer_load_dwordx4 a[28:31], v2, s[84:87], s83 offen offset:1024
    buffer_load_dwordx4 a[32:35], v2, s[84:87], s80 offen offset:2048
    buffer_load_dwordx4 a[36:39], v2, s[84:87], s81 offen offset:2048
    buffer_load_dwordx4 a[40:43], v2, s[84:87], s82 offen offset:2048
    buffer_load_dwordx4 a[44:47], v2, s[84:87], s83 offen offset:2048
    buffer_load_dwordx4 a[48:51], v2, s[84:87], s80 offen offset:3072
    buffer_load_dwordx4 a[52:55], v2, s[84:87], s81 offen offset:3072
    buffer_load_dwordx4 a[56:59], v2, s[84:87], s82 offen offset:3072
    buffer_load_dwordx4 a[60:63], v2, s[84:87], s83 offen offset:3072
    s_add_u32 s77, s77, 1
    s_mov_b32 s75, 4096
    s_cmp_eq_u32 s77, 6
    s_cmov_b32 s75, -20480
    s_cselect_b32 s77, 0, s77
    s_add_u32 s80, s80, s75
    s_add_u32 s81, s81, s75
    s_add_u32 s82, s82, s75
    s_add_u32 s83, s83, s75
    buffer_load_dwordx4 a[64:67], v2, s[84:87], s80 offen offset:0
    buffer_load_dwordx4 a[68:71], v2, s[84:87], s81 offen offset:0
    buffer_load_dwordx4 a[72:75], v2, s[84:87], s82 offen offset:0
    buffer_load_dwordx4 a[76:79], v2, s[84:87], s83 offen offset:0
    buffer_load_dwordx4 a[80:83], v2, s[84:87], s80 offen offset:1024
    buffer_load_dwordx4 a[84:87], v2, s[84:87], s81 offen offset:1024
    buffer_load_dwordx4 a[88:91], v2, s[84:87], s82 offen offset:1024
    buffer_load_dwordx4 a[92:95], v2, s[84:87], s83 offen offset:1024
    buffer_load_dwordx4 a[96:99], v2, s[84:87], s80 offen offset:2048
    buffer_load_dwordx4 a[100:103], v2, s[84:87], s81 offen offset:2048
    buffer_load_dwordx4 a[104:107], v2, s[84:87], s82 offen offset:2048
    buffer_load_dwordx4 a[108:111], v2, s[84:87], s83 offen offset:2048
    buffer_load_dwordx4 a[112:115], v2, s[84:87], s80 offen offset:3072
    buffer_load_dwordx4 a[116:119], v2, s[84:87], s81 offen offset:3072
    buffer_load_dwordx4 a[120:123], v2, s[84:87], s82 offen offset:3072
    buffer_load_dwordx4 a[124:127], v2, s[84:87], s83 offen offset:3072
    s_add_u32 s77, s77, 1
    s_mov_b32 s75, 4096
    s_cmp_eq_u32 s77, 6
    s_cmov_b32 s75, -20480
    s_cselect_b32 s77, 0, s77
    s_add_u32 s80, s80, s75
    s_add_u32 s81, s81, s75
    s_add_u32 s82, s82, s75
    s_add_u32 s83, s83, s75
    buffer_load_dwordx4 a[128:131], v2, s[84:87], s80 offen offset:0
    buffer_load_dwordx4 a[132:135], v2, s[84:87], s81 offen offset:0
    buffer_load_dwordx4 a[136:139], v2, s[84:87], s82 offen offset:0
    buffer_load_dwordx4 a[140:143], v2, s[84:87], s83 offen offset:0
    buffer_load_dwordx4 a[144:147], v2, s[84:87], s80 offen offset:1024
    buffer_load_dwordx4 a[148:151], v2, s[84:87], s81 offen offset:1024
    buffer_load_dwordx4 a[152:155], v2, s[84:87], s82 offen offset:1024
    buffer_load_dwordx4 a[156:159], v2, s[84:87], s83 offen offset:1024
w2done_18:
    s_add_u32 m0, s78, 2048
    s_nop 0
    buffer_load_dwordx4 v2, s[84:87], s80 offen offset:2048 lds
    s_add_u32 m0, s78, 3072
    s_nop 0
    buffer_load_dwordx4 v2, s[84:87], s81 offen offset:2048 lds
    s_add_u32 m0, s78, 4096
    s_nop 0
    buffer_load_dwordx4 v2, s[84:87], s82 offen offset:2048 lds
    s_add_u32 m0, s78, 5120
    s_nop 0
    buffer_load_dwordx4 v2, s[84:87], s83 offen offset:2048 lds
    s_add_u32 m0, s78, 5120
    s_nop 0
    buffer_load_dwordx4 v2, s[84:87], s80 offen offset:3072 lds
    s_add_u32 m0, s78, 6144
    s_nop 0
    buffer_load_dwordx4 v2, s[84:87], s81 offen offset:3072 lds
    s_add_u32 m0, s78, 7168
    s_nop 0
    buffer_load_dwordx4 v2, s[84:87], s82 offen offset:3072 lds
    s_add_u32 m0, s78, 8192
    s_nop 0
    buffer_load_dwordx4 v2, s[84:87], s83 offen offset:3072 lds
    s_add_u32 s77, s77, 1
    s_mov_b32 s75, 4096
    s_cmp_eq_u32 s77, 6
    s_cmov_b32 s75, -20480
    s_cselect_b32 s77, 0, s77
    s_add_u32 s80, s80, s75
    s_add_u32 s81, s81, s75
    s_add_u32 s82, s82, s75
    s_add_u32 s83, s83, s75
    s_add_u32 m0, s78, 12288
    s_nop 0
    buffer_load_dwordx4 v2, s[84:87], s80 offen offset:0 lds
    s_add_u32 m0, s78, 13312
    s_nop 0
    buffer_load_dwordx4 v2, s[84:87], s81 offen offset:0 lds
    s_add_u32 m0, s78, 14336
    s_nop 0
    buffer_load_dwordx4 v2, s[84:87], s82 offen offset:0 lds
    s_add_u32 m0, s78, 15360
    s_nop 0
    buffer_load_dwordx4 v2, s[84:87], s83 offen offset:0 lds
    s_add_u32 m0, s78, 15360
    s_nop 0
    buffer_load_dwordx4 v2, s[84:87], s80 offen offset:1024 lds
    s_add_u32 m0, s78, 16384
    s_nop 0
    buffer_load_dwordx4 v2, s[84:87], s81 offen offset:1024 lds
    s_add_u32 m0, s78, 17408
    s_nop 0
    buffer_load_dwordx4 v2, s[84:87], s82 offen offset:1024 lds
    s_add_u32 m0, s78, 18432
    s_nop 0
    buffer_load_dwordx4 v2, s[84:87], s83 offen offset:1024 lds
    s_add_u32 m0, s78, 18432
    s_nop 0
    buffer_load_dwordx4 v2, s[84:87], s80 offen offset:2048 lds
    s_add_u32 m0, s78, 19456
    s_nop 0
    buffer_load_dwordx4 v2, s[84:87], s81 offen offset:2048 lds
    s_add_u32 m0, s78, 20480
    s_nop 0
    buffer_load_dwordx4 v2, s[84:87], s82 offen offset:2048 lds
    s_add_u32 m0, s78, 21504
    s_nop 0
    buffer_load_dwordx4 v2, s[84:87], s83 offen offset:2048 lds
    v_add_u32 v79, s78, v2
    v_add_u32 v79, 4096, v79
    s_cmp_lg_u32 s24, 0
    s_cbranch_scc1 pook_22
    s_mov_b32 s58, 0
    v_mov_b32 v72, 0
    s_lshl_b32 s35, s59, 7
po_21:
    buffer_load_dwordx4 v[74:77], v72, s[96:99], s35 offen offset:0 sc1
    s_waitcnt vmcnt(0)
    v_readfirstlane_b32 s3, v74
    s_nop 3
    s_cmp_lt_u32 s3, 48
    s_cbranch_scc1 poag_23
    s_branch pook_22
poag_23:
    s_add_u32 s58, s58, 1
    s_cmp_ge_u32 s58, 65536
    s_cbranch_scc1 pook_22
    s_sleep 2
    s_branch po_21
pook_22:
    s_barrier
    buffer_load_dwordx4 a[160:163], v2, s[8:11], s25 offen offset:0
    buffer_load_dwordx4 a[164:167], v2, s[8:11], s26 offen offset:0
    buffer_load_dwordx4 a[168:171], v2, s[8:11], s25 offen offset:1024
    buffer_load_dwordx4 a[172:175], v2, s[8:11], s26 offen offset:1024
    buffer_load_dwordx4 a[176:179], v2, s[8:11], s25 offen offset:2048
    buffer_load_dwordx4 a[180:183], v2, s[8:11], s26 offen offset:2048
    buffer_load_dwordx4 a[184:187], v2, s[8:11], s25 offen offset:3072
    buffer_load_dwordx4 a[188:191], v2, s[8:11], s26 offen offset:3072
    s_add_u32 s76, s76, 1
    s_mov_b32 s74, 4096
    s_cmp_eq_u32 s76, 6
    s_cmov_b32 s74, -20480
    s_cselect_b32 s76, 0, s76
    s_add_u32 s25, s25, s74
    s_add_u32 s26, s26, s74
    buffer_load_dwordx4 a[192:195], v2, s[8:11], s25 offen offset:0
    buffer_load_dwordx4 a[196:199], v2, s[8:11], s26 offen offset:0
    buffer_load_dwordx4 a[200:203], v2, s[8:11], s25 offen offset:1024
    buffer_load_dwordx4 a[204:207], v2, s[8:11], s26 offen offset:1024
    buffer_load_dwordx4 a[208:211], v2, s[8:11], s25 offen offset:2048
    buffer_load_dwordx4 a[212:215], v2, s[8:11], s26 offen offset:2048
    buffer_load_dwordx4 a[216:219], v2, s[8:11], s25 offen offset:3072
    buffer_load_dwordx4 a[220:223], v2, s[8:11], s26 offen offset:3072
    s_add_u32 s76, s76, 1
    s_mov_b32 s74, 4096
    s_cmp_eq_u32 s76, 6
    s_cmov_b32 s74, -20480
    s_cselect_b32 s76, 0, s76
    s_add_u32 s25, s25, s74
    s_add_u32 s26, s26, s74
    buffer_load_dwordx4 a[224:227], v2, s[8:11], s25 offen offset:0
    buffer_load_dwordx4 a[228:231], v2, s[8:11], s26 offen offset:0
    buffer_load_dwordx4 a[232:235], v2, s[8:11], s25 offen offset:1024
    buffer_load_dwordx4 a[236:239], v2, s[8:11], s26 offen offset:1024
    buffer_load_dwordx4 a[240:243], v2, s[8:11], s25 offen offset:2048
    buffer_load_dwordx4 a[244:247], v2, s[8:11], s26 offen offset:2048
    buffer_load_dwordx4 a[248:251], v2, s[8:11], s25 offen offset:3072
    buffer_load_dwordx4 a[252:255], v2, s[8:11], s26 offen offset:3072
    s_add_u32 s76, s76, 1
    s_mov_b32 s74, 4096
    s_cmp_eq_u32 s76, 6
    s_cmov_b32 s74, -20480
    s_cselect_b32 s76, 0, s76
    s_add_u32 s25, s25, s74
    s_add_u32 s26, s26, s74
    s_and_b32 s3, s24, 1
    s_cmp_eq_u32 s3, 1
    s_cselect_b32 s4, 1.0, -1.0
    s_xor_b32 s3, s24, 1
    s_lshr_b32 s5, s24, 1
    s_xor_b32 s3, s3, s5
    s_and_b32 s3, s3, 1
    s_cmp_eq_u32 s3, 1
    s_cselect_b32 s5, 1.0, -1.0
    s_cmp_ge_u32 s24, 2
    s_cselect_b32 s6, 1.0, -1.0
    s_waitcnt vmcnt(22)
    s_waitcnt vmcnt(63)
    v_mfma_f32_32x32x16_bf16 v[128:143], a[0:3], a[160:163], 0
    v_mfma_f32_32x32x16_bf16 v[144:159], a[0:3], a[164:167], 0
    v_mfma_f32_32x32x16_bf16 v[160:175], a[4:7], a[160:163], 0
    v_mfma_f32_32x32x16_bf16 v[176:191], a[4:7], a[164:167], 0
    v_mfma_f32_32x32x16_bf16 v[192:207], a[8:11], a[160:163], 0
    v_mfma_f32_32x32x16_bf16 v[208:223], a[8:11], a[164:167], 0
    v_mfma_f32_32x32x16_bf16 v[224:239], a[12:15], a[160:163], 0
    v_mfma_f32_32x32x16_bf16 v[240:255], a[12:15], a[164:167], 0
    s_waitcnt vmcnt(20)
    s_waitcnt vmcnt(63)
    v_mfma_f32_32x32x16_bf16 v[128:143], a[16:19], a[168:171], v[128:143]
    v_mfma_f32_32x32x16_bf16 v[144:159], a[16:19], a[172:175], v[144:159]
    s_waitcnt vmcnt(40)
    v_mfma_f32_32x32x16_bf16 v[160:175], a[20:23], a[168:171], v[160:175]
    ds_read_b128 a[0:3], v79 offset:0
    v_mfma_f32_32x32x16_bf16 v[176:191], a[20:23], a[172:175], v[176:191]
    ds_read_b128 a[4:7], v79 offset:1024
    v_mfma_f32_32x32x16_bf16 v[192:207], a[24:27], a[168:171], v[192:207]
    ds_read_b128 a[8:11], v79 offset:2048
    v_mfma_f32_32x32x16_bf16 v[208:223], a[24:27], a[172:175], v[208:223]
    ds_read_b128 a[12:15], v79 offset:3072
    v_mfma_f32_32x32x16_bf16 v[224:239], a[28:31], a[168:171], v[224:239]
    buffer_load_dwordx4 a[160:163], v2, s[8:11], s25 offen offset:0
    v_mfma_f32_32x32x16_bf16 v[240:255], a[28:31], a[172:175], v[240:255]
    buffer_load_dwordx4 a[164:167], v2, s[8:11], s26 offen offset:0
    s_waitcnt vmcnt(20)
    s_waitcnt vmcnt(63)
    v_mfma_f32_32x32x16_bf16 v[128:143], a[32:35], a[176:179], v[128:143]
    v_mfma_f32_32x32x16_bf16 v[144:159], a[32:35], a[180:183], v[144:159]
    s_waitcnt vmcnt(38)
    v_mfma_f32_32x32x16_bf16 v[160:175], a[36:39], a[176:179], v[160:175]
    ds_read_b128 a[16:19], v79 offset:4096
    v_mfma_f32_32x32x16_bf16 v[176:191], a[36:39], a[180:183], v[176:191]
    ds_read_b128 a[20:23], v79 offset:5120
    v_mfma_f32_32x32x16_bf16 v[192:207], a[40:43], a[176:179], v[192:207]
    ds_read_b128 a[24:27], v79 offset:6144
    v_mfma_f32_32x32x16_bf16 v[208:223], a[40:43], a[180:183], v[208:223]
    ds_read_b128 a[28:31], v79 offset:7168
    v_mfma_f32_32x32x16_bf16 v[224:239], a[44:47], a[176:179], v[224:239]
    buffer_load_dwordx4 a[168:171], v2, s[8:11], s25 offen offset:1024
    v_mfma_f32_32x32x16_bf16 v[240:255], a[44:47], a[180:183], v[240:255]
    buffer_load_dwordx4 a[172:175], v2, s[8:11], s26 offen offset:1024
    s_waitcnt vmcnt(20)
    s_waitcnt vmcnt(63)
    v_mfma_f32_32x32x16_bf16 v[128:143], a[48:51], a[184:187], v[128:143]
    v_mfma_f32_32x32x16_bf16 v[144:159], a[48:51], a[188:191], v[144:159]
    s_waitcnt vmcnt(36)
    v_mfma_f32_32x32x16_bf16 v[160:175], a[52:55], a[184:187], v[160:175]
    ds_read_b128 a[32:35], v79 offset:8192
    v_mfma_f32_32x32x16_bf16 v[176:191], a[52:55], a[188:191], v[176:191]
    ds_read_b128 a[36:39], v79 offset:9216
    v_mfma_f32_32x32x16_bf16 v[192:207], a[56:59], a[184:187], v[192:207]
    ds_read_b128 a[40:43], v79 offset:10240
    v_mfma_f32_32x32x16_bf16 v[208:223], a[56:59], a[188:191], v[208:223]
    ds_read_b128 a[44:47], v79 offset:11264
    v_mfma_f32_32x32x16_bf16 v[224:239], a[60:63], a[184:187], v[224:239]
    buffer_load_dwordx4 a[176:179], v2, s[8:11], s25 offen offset:2048
    v_mfma_f32_32x32x16_bf16 v[240:255], a[60:63], a[188:191], v[240:255]
    buffer_load_dwordx4 a[180:183], v2, s[8:11], s26 offen offset:2048
    s_waitcnt vmcnt(20)
    s_waitcnt vmcnt(63)
    v_mfma_f32_32x32x16_bf16 v[128:143], a[64:67], a[192:195], v[128:143]
    s_waitcnt vmcnt(34)
    v_mfma_f32_32x32x16_bf16 v[144:159], a[64:67], a[196:199], v[144:159]
    ds_read_b128 a[48:51], v79 offset:12288
    ds_read_b128 a[52:55], v79 offset:13312
    v_mfma_f32_32x32x16_bf16 v[160:175], a[68:71], a[192:195], v[160:175]
    ds_read_b128 a[56:59], v79 offset:14336
    ds_read_b128 a[60:63], v79 offset:15360
    v_mfma_f32_32x32x16_bf16 v[176:191], a[68:71], a[196:199], v[176:191]
    buffer_load_dwordx4 a[184:187], v2, s[8:11], s25 offen offset:3072
    buffer_load_dwordx4 a[188:191], v2, s[8:11], s26 offen offset:3072
    v_mfma_f32_32x32x16_bf16 v[192:207], a[72:75], a[192:195], v[192:207]
    s_add_u32 s76, s76, 1
    v_mfma_f32_32x32x16_bf16 v[208:223], a[72:75], a[196:199], v[208:223]
    s_mov_b32 s74, 4096
    s_cmp_eq_u32 s76, 6
    v_mfma_f32_32x32x16_bf16 v[224:239], a[76:79], a[192:195], v[224:239]
    s_cmov_b32 s74, -20480
    s_cselect_b32 s76, 0, s76
    v_mfma_f32_32x32x16_bf16 v[240:255], a[76:79], a[196:199], v[240:255]
    s_add_u32 s25, s25, s74
    s_add_u32 s26, s26, s74
    s_waitcnt vmcnt(20)
    s_waitcnt vmcnt(63)
    v_mfma_f32_32x32x16_bf16 v[128:143], a[80:83], a[200:203], v[128:143]
    v_mfma_f32_32x32x16_bf16 v[144:159], a[80:83], a[204:207], v[144:159]
    s_waitcnt vmcnt(32)
    v_mfma_f32_32x32x16_bf16 v[160:175], a[84:87], a[200:203], v[160:175]
    ds_read_b128 a[64:67], v79 offset:16384
    v_mfma_f32_32x32x16_bf16 v[176:191], a[84:87], a[204:207], v[176:191]
    ds_read_b128 a[68:71], v79 offset:17408
    v_mfma_f32_32x32x16_bf16 v[192:207], a[88:91], a[200:203], v[192:207]
    ds_read_b128 a[72:75], v79 offset:18432
    v_mfma_f32_32x32x16_bf16 v[208:223], a[88:91], a[204:207], v[208:223]
    ds_read_b128 a[76:79], v79 offset:19456
    v_mfma_f32_32x32x16_bf16 v[224:239], a[92:95], a[200:203], v[224:239]
    buffer_load_dwordx4 a[192:195], v2, s[8:11], s25 offen offset:0
    v_mfma_f32_32x32x16_bf16 v[240:255], a[92:95], a[204:207], v[240:255]
    buffer_load_dwordx4 a[196:199], v2, s[8:11], s26 offen offset:0
    s_waitcnt vmcnt(20)
    s_waitcnt vmcnt(63)
    v_mfma_f32_32x32x16_bf16 v[128:143], a[96:99], a[208:211], v[128:143]
    buffer_load_dwordx4 a[80:83], v2, s[84:87], s80 offen offset:3072
    v_mfma_f32_32x32x16_bf16 v[144:159], a[96:99], a[212:215], v[144:159]
    buffer_load_dwordx4 a[84:87], v2, s[84:87], s81 offen offset:3072
    buffer_load_dwordx4 a[88:91], v2, s[84:87], s82 offen offset:3072
    v_mfma_f32_32x32x16_bf16 v[160:175], a[100:103], a[208:211], v[160:175]
    buffer_load_dwordx4 a[92:95], v2, s[84:87], s83 offen offset:3072
    s_add_u32 s77, s77, 1
    v_mfma_f32_32x32x16_bf16 v[176:191], a[100:103], a[212:215], v[176:191]
    s_mov_b32 s75, 4096
    s_cmp_eq_u32 s77, 6
    v_mfma_f32_32x32x16_bf16 v[192:207], a[104:107], a[208:211], v[192:207]
    s_cmov_b32 s75, -20480
    s_cselect_b32 s77, 0, s77
    v_mfma_f32_32x32x16_bf16 v[208:223], a[104:107], a[212:215], v[208:223]
    s_add_u32 s80, s80, s75
    s_add_u32 s81, s81, s75
    v_mfma_f32_32x32x16_bf16 v[224:239], a[108:111], a[208:211], v[224:239]
    s_add_u32 s82, s82, s75
    s_add_u32 s83, s83, s75
    v_mfma_f32_32x32x16_bf16 v[240:255], a[108:111], a[212:215], v[240:255]
    buffer_load_dwordx4 a[200:203], v2, s[8:11], s25 offen offset:1024
    buffer_load_dwordx4 a[204:207], v2, s[8:11], s26 offen offset:1024
    s_waitcnt vmcnt(24)
    s_waitcnt vmcnt(63)
    v_mfma_f32_32x32x16_bf16 v[128:143], a[112:115], a[216:219], v[128:143]
    v_mfma_f32_32x32x16_bf16 v[144:159], a[112:115], a[220:223], v[144:159]
    buffer_load_dwordx4 a[96:99], v2, s[84:87], s80 offen offset:0
    v_mfma_f32_32x32x16_bf16 v[160:175], a[116:119], a[216:219], v[160:175]
    buffer_load_dwordx4 a[100:103], v2, s[84:87], s81 offen offset:0
    v_mfma_f32_32x32x16_bf16 v[176:191], a[116:119], a[220:223], v[176:191]
    buffer_load_dwordx4 a[104:107], v2, s[84:87], s82 offen offset:0
    v_mfma_f32_32x32x16_bf16 v[192:207], a[120:123], a[216:219], v[192:207]
    v_mfma_f32_32x32x16_bf16 v[208:223], a[120:123], a[220:223], v[208:223]
    buffer_load_dwordx4 a[108:111], v2, s[84:87], s83 offen offset:0
    v_mfma_f32_32x32x16_bf16 v[224:239], a[124:127], a[216:219], v[224:239]
    buffer_load_dwordx4 a[208:211], v2, s[8:11], s25 offen offset:2048
    v_mfma_f32_32x32x16_bf16 v[240:255], a[124:127], a[220:223], v[240:255]
    buffer_load_dwordx4 a[212:215], v2, s[8:11], s26 offen offset:2048
    s_waitcnt vmcnt(28)
    s_waitcnt vmcnt(63)
    v_mfma_f32_32x32x16_bf16 v[128:143], a[128:131], a[224:227], v[128:143]
    buffer_load_dwordx4 a[112:115], v2, s[84:87], s80 offen offset:1024
    v_mfma_f32_32x32x16_bf16 v[144:159], a[128:131], a[228:231], v[144:159]
    buffer_load_dwordx4 a[116:119], v2, s[84:87], s81 offen offset:1024
    buffer_load_dwordx4 a[120:123], v2, s[84:87], s82 offen offset:1024
    v_mfma_f32_32x32x16_bf16 v[160:175], a[132:135], a[224:227], v[160:175]
    buffer_load_dwordx4 a[124:127], v2, s[84:87], s83 offen offset:1024
    v_mfma_f32_32x32x16_bf16 v[176:191], a[132:135], a[228:231], v[176:191]
    buffer_load_dwordx4 a[216:219], v2, s[8:11], s25 offen offset:3072
    buffer_load_dwordx4 a[220:223], v2, s[8:11], s26 offen offset:3072
    v_mfma_f32_32x32x16_bf16 v[192:207], a[136:139], a[224:227], v[192:207]
    s_add_u32 s76, s76, 1
    s_mov_b32 s74, 4096
    v_mfma_f32_32x32x16_bf16 v[208:223], a[136:139], a[228:231], v[208:223]
    s_cmp_eq_u32 s76, 6
    v_mfma_f32_32x32x16_bf16 v[224:239], a[140:143], a[224:227], v[224:239]
    s_cmov_b32 s74, -20480
    s_cselect_b32 s76, 0, s76
    v_mfma_f32_32x32x16_bf16 v[240:255], a[140:143], a[228:231], v[240:255]
    s_add_u32 s25, s25, s74
    s_add_u32 s26, s26, s74
    s_waitcnt vmcnt(32)
    s_waitcnt vmcnt(63)
    v_mfma_f32_32x32x16_bf16 v[128:143], a[144:147], a[232:235], v[128:143]
    v_mfma_f32_32x32x16_bf16 v[144:159], a[144:147], a[236:239], v[144:159]
    buffer_load_dwordx4 a[128:131], v2, s[84:87], s80 offen offset:2048
    v_mfma_f32_32x32x16_bf16 v[160:175], a[148:151], a[232:235], v[160:175]
    buffer_load_dwordx4 a[132:135], v2, s[84:87], s81 offen offset:2048
    v_mfma_f32_32x32x16_bf16 v[176:191], a[148:151], a[236:239], v[176:191]
    buffer_load_dwordx4 a[136:139], v2, s[84:87], s82 offen offset:2048
    v_mfma_f32_32x32x16_bf16 v[192:207], a[152:155], a[232:235], v[192:207]
    v_mfma_f32_32x32x16_bf16 v[208:223], a[152:155], a[236:239], v[208:223]
    buffer_load_dwordx4 a[140:143], v2, s[84:87], s83 offen offset:2048
    v_mfma_f32_32x32x16_bf16 v[224:239], a[156:159], a[232:235], v[224:239]
    buffer_load_dwordx4 a[224:227], v2, s[8:11], s25 offen offset:0
    v_mfma_f32_32x32x16_bf16 v[240:255], a[156:159], a[236:239], v[240:255]
    buffer_load_dwordx4 a[228:231], v2, s[8:11], s26 offen offset:0
    s_waitcnt vmcnt(36)
    s_waitcnt lgkmcnt(0)
    v_mfma_f32_32x32x16_bf16 v[128:143], a[0:3], a[240:243], v[128:143]
    buffer_load_dwordx4 a[144:147], v2, s[84:87], s80 offen offset:3072
    v_mfma_f32_32x32x16_bf16 v[144:159], a[0:3], a[244:247], v[144:159]
    buffer_load_dwordx4 a[148:151], v2, s[84:87], s81 offen offset:3072
    buffer_load_dwordx4 a[152:155], v2, s[84:87], s82 offen offset:3072
    v_mfma_f32_32x32x16_bf16 v[160:175], a[4:7], a[240:243], v[160:175]
    buffer_load_dwordx4 a[156:159], v2, s[84:87], s83 offen offset:3072
    s_add_u32 s77, s77, 1
    v_mfma_f32_32x32x16_bf16 v[176:191], a[4:7], a[244:247], v[176:191]
    s_mov_b32 s75, 4096
    s_cmp_eq_u32 s77, 6
    v_mfma_f32_32x32x16_bf16 v[192:207], a[8:11], a[240:243], v[192:207]
    s_cmov_b32 s75, -20480
    s_cselect_b32 s77, 0, s77
    v_mfma_f32_32x32x16_bf16 v[208:223], a[8:11], a[244:247], v[208:223]
    s_add_u32 s80, s80, s75
    s_add_u32 s81, s81, s75
    v_mfma_f32_32x32x16_bf16 v[224:239], a[12:15], a[240:243], v[224:239]
    s_add_u32 s82, s82, s75
    s_add_u32 s83, s83, s75
    v_mfma_f32_32x32x16_bf16 v[240:255], a[12:15], a[244:247], v[240:255]
    buffer_load_dwordx4 a[232:235], v2, s[8:11], s25 offen offset:1024
    buffer_load_dwordx4 a[236:239], v2, s[8:11], s26 offen offset:1024
    s_waitcnt vmcnt(40)
    s_waitcnt lgkmcnt(0)
    v_mfma_f32_32x32x16_bf16 v[128:143], a[16:19], a[248:251], v[128:143]
    v_mfma_f32_32x32x16_bf16 v[144:159], a[16:19], a[252:255], v[144:159]
    buffer_load_dwordx4 a[0:3], v2, s[84:87], s80 offen offset:0
    v_mfma_f32_32x32x16_bf16 v[160:175], a[20:23], a[248:251], v[160:175]
    buffer_load_dwordx4 a[4:7], v2, s[84:87], s81 offen offset:0
    v_mfma_f32_32x32x16_bf16 v[176:191], a[20:23], a[252:255], v[176:191]
    buffer_load_dwordx4 a[8:11], v2, s[84:87], s82 offen offset:0
    v_mfma_f32_32x32x16_bf16 v[192:207], a[24:27], a[248:251], v[192:207]
    v_mfma_f32_32x32x16_bf16 v[208:223], a[24:27], a[252:255], v[208:223]
    buffer_load_dwordx4 a[12:15], v2, s[84:87], s83 offen offset:0
    v_mfma_f32_32x32x16_bf16 v[224:239], a[28:31], a[248:251], v[224:239]
    buffer_load_dwordx4 a[240:243], v2, s[8:11], s25 offen offset:2048
    v_mfma_f32_32x32x16_bf16 v[240:255], a[28:31], a[252:255], v[240:255]
    buffer_load_dwordx4 a[244:247], v2, s[8:11], s26 offen offset:2048
    s_waitcnt vmcnt(44)
    s_waitcnt lgkmcnt(0)
    v_mfma_f32_32x32x16_bf16 v[128:143], a[32:35], a[160:163], v[128:143]
    buffer_load_dwordx4 a[16:19], v2, s[84:87], s80 offen offset:1024
    v_mfma_f32_32x32x16_bf16 v[144:159], a[32:35], a[164:167], v[144:159]
    buffer_load_dwordx4 a[20:23], v2, s[84:87], s81 offen offset:1024
    buffer_load_dwordx4 a[24:27], v2, s[84:87], s82 offen offset:1024
    v_mfma_f32_32x32x16_bf16 v[160:175], a[36:39], a[160:163], v[160:175]
    buffer_load_dwordx4 a[28:31], v2, s[84:87], s83 offen offset:1024
    v_mfma_f32_32x32x16_bf16 v[176:191], a[36:39], a[164:167], v[176:191]
    buffer_load_dwordx4 a[248:251], v2, s[8:11], s25 offen offset:3072
    buffer_load_dwordx4 a[252:255], v2, s[8:11], s26 offen offset:3072
    v_mfma_f32_32x32x16_bf16 v[192:207], a[40:43], a[160:163], v[192:207]
    s_add_u32 s76, s76, 1
    s_mov_b32 s74, 4096
    v_mfma_f32_32x32x16_bf16 v[208:223], a[40:43], a[164:167], v[208:223]
    s_cmp_eq_u32 s76, 6
    v_mfma_f32_32x32x16_bf16 v[224:239], a[44:47], a[160:163], v[224:239]
    s_cmov_b32 s74, -20480
    s_cselect_b32 s76, 0, s76
    v_mfma_f32_32x32x16_bf16 v[240:255], a[44:47], a[164:167], v[240:255]
    s_add_u32 s25, s25, s74
    s_add_u32 s26, s26, s74
    s_waitcnt vmcnt(48)
    s_waitcnt lgkmcnt(0)
    v_mfma_f32_32x32x16_bf16 v[128:143], a[48:51], a[168:171], v[128:143]
    v_mfma_f32_32x32x16_bf16 v[144:159], a[48:51], a[172:175], v[144:159]
    buffer_load_dwordx4 a[32:35], v2, s[84:87], s80 offen offset:2048
    v_mfma_f32_32x32x16_bf16 v[160:175], a[52:55], a[168:171], v[160:175]
    v_mfma_f32_32x32x16_bf16 v[176:191], a[52:55], a[172:175], v[176:191]
    buffer_load_dwordx4 a[36:39], v2, s[84:87], s81 offen offset:2048
    v_mfma_f32_32x32x16_bf16 v[192:207], a[56:59], a[168:171], v[192:207]
    v_mfma_f32_32x32x16_bf16 v[208:223], a[56:59], a[172:175], v[208:223]
    buffer_load_dwordx4 a[40:43], v2, s[84:87], s82 offen offset:2048
    v_mfma_f32_32x32x16_bf16 v[224:239], a[60:63], a[168:171], v[224:239]
    v_mfma_f32_32x32x16_bf16 v[240:255], a[60:63], a[172:175], v[240:255]
    buffer_load_dwordx4 a[44:47], v2, s[84:87], s83 offen offset:2048
    s_waitcnt vmcnt(50)
    s_waitcnt lgkmcnt(0)
    v_mfma_f32_32x32x16_bf16 v[128:143], a[64:67], a[176:179], v[128:143]
    buffer_load_dwordx4 a[48:51], v2, s[84:87], s80 offen offset:3072
    v_mfma_f32_32x32x16_bf16 v[144:159], a[64:67], a[180:183], v[144:159]
    buffer_load_dwordx4 a[52:55], v2, s[84:87], s81 offen offset:3072
    buffer_load_dwordx4 a[56:59], v2, s[84:87], s82 offen offset:3072
    v_mfma_f32_32x32x16_bf16 v[160:175], a[68:71], a[176:179], v[160:175]
    buffer_load_dwordx4 a[60:63], v2, s[84:87], s83 offen offset:3072
    v_mfma_f32_32x32x16_bf16 v[176:191], a[68:71], a[180:183], v[176:191]
    s_add_u32 s77, s77, 1
    s_mov_b32 s75, 4096
    v_mfma_f32_32x32x16_bf16 v[192:207], a[72:75], a[176:179], v[192:207]
    s_cmp_eq_u32 s77, 6
    s_cmov_b32 s75, -20480
    v_mfma_f32_32x32x16_bf16 v[208:223], a[72:75], a[180:183], v[208:223]
    s_cselect_b32 s77, 0, s77
    v_mfma_f32_32x32x16_bf16 v[224:239], a[76:79], a[176:179], v[224:239]
    s_add_u32 s80, s80, s75
    s_add_u32 s81, s81, s75
    v_mfma_f32_32x32x16_bf16 v[240:255], a[76:79], a[180:183], v[240:255]
    s_add_u32 s82, s82, s75
    s_add_u32 s83, s83, s75
    s_waitcnt vmcnt(52)
    s_waitcnt vmcnt(46)
    v_mfma_f32_32x32x16_bf16 v[128:143], a[80:83], a[184:187], v[128:143]
    v_mfma_f32_32x32x16_bf16 v[144:159], a[80:83], a[188:191], v[144:159]
    v_mfma_f32_32x32x16_bf16 v[160:175], a[84:87], a[184:187], v[160:175]
    v_mfma_f32_32x32x16_bf16 v[176:191], a[84:87], a[188:191], v[176:191]
    v_mfma_f32_32x32x16_bf16 v[192:207], a[88:91], a[184:187], v[192:207]
    v_mfma_f32_32x32x16_bf16 v[208:223], a[88:91], a[188:191], v[208:223]
    v_mfma_f32_32x32x16_bf16 v[224:239], a[92:95], a[184:187], v[224:239]
    v_mfma_f32_32x32x16_bf16 v[240:255], a[92:95], a[188:191], v[240:255]
    s_waitcnt vmcnt(50)
    s_waitcnt vmcnt(40)
    v_mfma_f32_32x32x16_bf16 v[128:143], a[96:99], a[192:195], v[128:143]
    v_mfma_f32_32x32x16_bf16 v[144:159], a[96:99], a[196:199], v[144:159]
    v_mfma_f32_32x32x16_bf16 v[160:175], a[100:103], a[192:195], v[160:175]
    v_mfma_f32_32x32x16_bf16 v[176:191], a[100:103], a[196:199], v[176:191]
    v_mfma_f32_32x32x16_bf16 v[192:207], a[104:107], a[192:195], v[192:207]
    v_mfma_f32_32x32x16_bf16 v[208:223], a[104:107], a[196:199], v[208:223]
    v_mfma_f32_32x32x16_bf16 v[224:239], a[108:111], a[192:195], v[224:239]
    v_mfma_f32_32x32x16_bf16 v[240:255], a[108:111], a[196:199], v[240:255]
    s_waitcnt vmcnt(44)
    s_waitcnt vmcnt(34)
    v_mfma_f32_32x32x16_bf16 v[128:143], a[112:115], a[200:203], v[128:143]
    s_getpc_b64 s[20:21]
    s_add_u32 s20, s20, tab_it@rel32@lo+4
    s_addc_u32 s21, s21, tab_it@rel32@hi+12
    s_and_b32 s21, s21, 0xffff
    v_mfma_f32_32x32x16_bf16 v[144:159], a[112:115], a[204:207], v[144:159]
    s_mov_b32 s22, 204800
    s_mov_b32 s23, 0x00020000
    buffer_load_dwordx4 v[32:35], v2, s[20:23], s57 offen offset:0
    buffer_load_dwordx4 v[36:39], v2, s[20:23], s57 offen offset:1024
    v_mfma_f32_32x32x16_bf16 v[160:175], a[116:119], a[200:203], v[160:175]
    buffer_load_dwordx4 v[40:43], v2, s[20:23], s57 offen offset:2048
    buffer_load_dwordx4 v[44:47], v2, s[20:23], s57 offen offset:3072
    s_add_u32 s57, s57, 4096
    buffer_load_dwordx4 v[48:51], v2, s[20:23], s57 offen offset:0
    buffer_load_dwordx4 v[52:55], v2, s[20:23], s57 offen offset:1024
    v_mfma_f32_32x32x16_bf16 v[176:191], a[116:119], a[204:207], v[176:191]
    buffer_load_dwordx4 v[56:59], v2, s[20:23], s57 offen offset:2048
    buffer_load_dwordx4 v[60:63], v2, s[20:23], s57 offen offset:3072
    s_add_u32 s57, s57, 4096
    buffer_load_dwordx4 v[64:67], v2, s[20:23], s57 offen offset:0
    v_mfma_f32_32x32x16_bf16 v[192:207], a[120:123], a[200:203], v[192:207]
    buffer_load_dwordx4 v[68:71], v2, s[20:23], s57 offen offset:1024
    s_mov_b32 s20, s36
    s_and_b32 s21, s37, 0xffff
    s_mov_b32 s22, 2621440
    v_mfma_f32_32x32x16_bf16 v[208:223], a[120:123], a[204:207], v[208:223]
    s_mov_b32 s23, 0x00020000
    s_add_u32 s3, s56, 0
    buffer_load_dwordx4 v[96:99], v8, s[20:23], s3 offen
    s_add_u32 s3, s56, 5120
    buffer_load_dwordx4 v[100:103], v8, s[20:23], s3 offen
    v_mfma_f32_32x32x16_bf16 v[224:239], a[124:127], a[200:203], v[224:239]
    s_add_u32 s3, s56, 40960
    buffer_load_dwordx4 v[104:107], v8, s[20:23], s3 offen
    s_add_u32 s3, s56, 46080
    buffer_load_dwordx4 v[108:111], v8, s[20:23], s3 offen
    v_mfma_f32_32x32x16_bf16 v[240:255], a[124:127], a[204:207], v[240:255]
    s_add_u32 s20, s54, 8126464
    s_addc_u32 s21, s55, 0
    s_and_b32 s21, s21, 0xffff
    s_mov_b32 s22, 1024
    s_mov_b32 s23, 0x00020000
    s_waitcnt vmcnt(52)
    s_waitcnt vmcnt(42)
    v_mfma_f32_32x32x16_bf16 v[128:143], a[128:131], a[208:211], v[128:143]
    v_mfma_f32_32x32x16_bf16 v[144:159], a[128:131], a[212:215], v[144:159]
    v_mfma_f32_32x32x16_bf16 v[160:175], a[132:135], a[208:211], v[160:175]
    v_mfma_f32_32x32x16_bf16 v[176:191], a[132:135], a[212:215], v[176:191]
    v_mfma_f32_32x32x16_bf16 v[192:207], a[136:139], a[208:211], v[192:207]
    v_mfma_f32_32x32x16_bf16 v[208:223], a[136:139], a[212:215], v[208:223]
    v_mfma_f32_32x32x16_bf16 v[224:239], a[140:143], a[208:211], v[224:239]
    v_mfma_f32_32x32x16_bf16 v[240:255], a[140:143], a[212:215], v[240:255]
    s_waitcnt vmcnt(46)
    s_waitcnt vmcnt(36)
    v_mfma_f32_32x32x16_bf16 v[128:143], a[144:147], a[216:219], v[128:143]
    v_mfma_f32_32x32x16_bf16 v[144:159], a[144:147], a[220:223], v[144:159]
    v_mfma_f32_32x32x16_bf16 v[160:175], a[148:151], a[216:219], v[160:175]
    v_mfma_f32_32x32x16_bf16 v[176:191], a[148:151], a[220:223], v[176:191]
    v_mfma_f32_32x32x16_bf16 v[192:207], a[152:155], a[216:219], v[192:207]
    v_mfma_f32_32x32x16_bf16 v[208:223], a[152:155], a[220:223], v[208:223]
    v_mfma_f32_32x32x16_bf16 v[224:239], a[156:159], a[216:219], v[224:239]
    v_mfma_f32_32x32x16_bf16 v[240:255], a[156:159], a[220:223], v[240:255]
    s_waitcnt vmcnt(40)
    s_waitcnt vmcnt(30)
    v_mfma_f32_32x32x16_bf16 v[128:143], a[0:3], a[224:227], v[128:143]
    v_mfma_f32_32x32x16_bf16 v[144:159], a[0:3], a[228:231], v[144:159]
    v_mfma_f32_32x32x16_bf16 v[160:175], a[4:7], a[224:227], v[160:175]
    v_mfma_f32_32x32x16_bf16 v[176:191], a[4:7], a[228:231], v[176:191]
    v_mfma_f32_32x32x16_bf16 v[192:207], a[8:11], a[224:227], v[192:207]
    v_mfma_f32_32x32x16_bf16 v[208:223], a[8:11], a[228:231], v[208:223]
    v_mfma_f32_32x32x16_bf16 v[224:239], a[12:15], a[224:227], v[224:239]
    v_mfma_f32_32x32x16_bf16 v[240:255], a[12:15], a[228:231], v[240:255]
    s_waitcnt vmcnt(34)
    s_waitcnt vmcnt(24)
    v_mfma_f32_32x32x16_bf16 v[128:143], a[16:19], a[232:235], v[128:143]
    v_mfma_f32_32x32x16_bf16 v[144:159], a[16:19], a[236:239], v[144:159]
    v_mfma_f32_32x32x16_bf16 v[160:175], a[20:23], a[232:235], v[160:175]
    v_mfma_f32_32x32x16_bf16 v[176:191], a[20:23], a[236:239], v[176:191]
    v_mfma_f32_32x32x16_bf16 v[192:207], a[24:27], a[232:235], v[192:207]
    v_mfma_f32_32x32x16_bf16 v[208:223], a[24:27], a[236:239], v[208:223]
    v_mfma_f32_32x32x16_bf16 v[224:239], a[28:31], a[232:235], v[224:239]
    v_mfma_f32_32x32x16_bf16 v[240:255], a[28:31], a[236:239], v[240:255]
    s_waitcnt vmcnt(28)
    s_waitcnt vmcnt(18)
    v_mfma_f32_32x32x16_bf16 v[128:143], a[32:35], a[240:243], v[128:143]
    v_mfma_f32_32x32x16_bf16 v[144:159], a[32:35], a[244:247], v[144:159]
    v_mfma_f32_32x32x16_bf16 v[160:175], a[36:39], a[240:243], v[160:175]
    v_mfma_f32_32x32x16_bf16 v[176:191], a[36:39], a[244:247], v[176:191]
    v_mfma_f32_32x32x16_bf16 v[192:207], a[40:43], a[240:243], v[192:207]
    v_mfma_f32_32x32x16_bf16 v[208:223], a[40:43], a[244:247], v[208:223]
    v_mfma_f32_32x32x16_bf16 v[224:239], a[44:47], a[240:243], v[224:239]
    v_mfma_f32_32x32x16_bf16 v[240:255], a[44:47], a[244:247], v[240:255]
    s_waitcnt vmcnt(22)
    s_waitcnt vmcnt(14)
    v_mfma_f32_32x32x16_bf16 v[128:143], a[48:51], a[248:251], v[128:143]
    v_mfma_f32_32x32x16_bf16 v[144:159], a[48:51], a[252:255], v[144:159]
    v_mfma_f32_32x32x16_bf16 v[160:175], a[52:55], a[248:251], v[160:175]
    v_mfma_f32_32x32x16_bf16 v[176:191], a[52:55], a[252:255], v[176:191]
    v_mfma_f32_32x32x16_bf16 v[192:207], a[56:59], a[248:251], v[192:207]
    v_mfma_f32_32x32x16_bf16 v[208:223], a[56:59], a[252:255], v[208:223]
    v_mfma_f32_32x32x16_bf16 v[224:239], a[60:63], a[248:251], v[224:239]
    v_mfma_f32_32x32x16_bf16 v[240:255], a[60:63], a[252:255], v[240:255]
    v_mov_b32 v72, 163836
    s_cmp_lg_u32 s24, 0
    s_cbranch_scc1 os_24
    v_mov_b32 v74, 0
    s_lshl_b32 s35, s59, 7
    buffer_load_dword v73, v74, s[96:99], s35 offen offset:8 sc1
    s_waitcnt vmcnt(0)
    ds_write_b32 v72, v73
    s_waitcnt lgkmcnt(0)
os_24:
    s_barrier
    ds_read_b32 v73, v72
    v_and_b32 v4, 31, v1
    v_mul_u32_u24 v5, 528, v4
    v_lshl_add_u32 v5, v10, 4, v5
    s_mul_i32 s3, s24, 16896
    v_add_u32 v5, s3, v5
    v_mul_u32_u24 v6, 528, v9
    s_lshl_b32 s3, s24, 7
    v_add_u32 v6, s3, v6
    v_lshl_add_u32 v6, v14, 5, v6
    s_waitcnt lgkmcnt(0)
    v_readfirstlane_b32 s79, v73
    s_nop 3
    s_cmp_ge_u32 s79, 81
    s_cselect_b32 s79, 1, 0
    ds_write_b128 v5, v[128:131] offset:0
    ds_write_b128 v5, v[132:135] offset:32
    ds_write_b128 v5, v[136:139] offset:64
    s_cmp_eq_u32 s79, 0
    s_cbranch_scc1 nodma_25
    buffer_load_dwordx4 v[76:79], v2, s[20:23], 0 offen sc1
    s_add_u32 m0, s34, 0
    s_nop 0
    buffer_load_dwordx4 v3, s[16:19], s33 offen sc1 lds
    s_add_u32 s33, s33, 32768
    s_add_u32 m0, s34, 1024
    s_nop 0
    buffer_load_dwordx4 v3, s[16:19], s33 offen sc1 lds
    s_add_u32 s33, s33, 32768
    nodma_25:
    ds_write_b128 v5, v[140:143] offset:96
    ds_write_b128 v5, v[160:163] offset:128
    ds_write_b128 v5, v[164:167] offset:160
    s_cmp_eq_u32 s79, 0
    s_cbranch_scc1 nodma_26
    s_add_u32 m0, s34, 2048
    s_nop 0
    buffer_load_dwordx4 v3, s[16:19], s33 offen sc1 lds
    s_add_u32 s33, s33, 32768
    s_add_u32 m0, s34, 3072
    s_nop 0
    buffer_load_dwordx4 v3, s[16:19], s33 offen sc1 lds
    s_add_u32 s33, s33, 32768
    nodma_26:
    ds_write_b128 v5, v[168:171] offset:192
    ds_write_b128 v5, v[172:175] offset:224
    ds_write_b128 v5, v[192:195] offset:256
    s_cmp_eq_u32 s79, 0
    s_cbranch_scc1 nodma_27
    s_add_u32 m0, s34, 4096
    s_nop 0
    buffer_load_dwordx4 v3, s[16:19], s33 offen sc1 lds
    s_add_u32 s33, s33, 32768
    s_add_u32 m0, s34, 5120
    s_nop 0
    buffer_load_dwordx4 v3, s[16:19], s33 offen sc1 lds
    s_add_u32 s33, s33, 32768
    nodma_27:
    ds_write_b128 v5, v[196:199] offset:288
    ds_write_b128 v5, v[200:203] offset:320
    ds_write_b128 v5, v[204:207] offset:352
    s_cmp_eq_u32 s79, 0
    s_cbranch_scc1 nodma_28
    s_add_u32 m0, s34, 6144
    s_nop 0
    buffer_load_dwordx4 v3, s[16:19], s33 offen sc1 lds
    s_add_u32 s33, s33, 32768
    s_add_u32 m0, s34, 7168
    s_nop 0
    buffer_load_dwordx4 v3, s[16:19], s33 offen sc1 lds
    s_add_u32 s33, s33, 32768
    nodma_28:
    ds_write_b128 v5, v[224:227] offset:384
    ds_write_b128 v5, v[228:231] offset:416
    ds_write_b128 v5, v[232:235] offset:448
    s_cmp_eq_u32 s79, 0
    s_cbranch_scc1 nodma_29
    s_add_u32 m0, s34, 8192
    s_nop 0
    buffer_load_dwordx4 v3, s[16:19], s33 offen sc1 lds
    s_add_u32 s33, s33, 32768
    s_add_u32 m0, s34, 9216
    s_nop 0
    buffer_load_dwordx4 v3, s[16:19], s33 offen sc1 lds
    s_add_u32 s33, s33, 32768
    nodma_29:
    ds_write_b128 v5, v[236:239] offset:480
    s_waitcnt lgkmcnt(0)
    s_barrier
    ds_read_b128 a[0:3], v6 offset:0
    ds_read_b128 a[4:7], v6 offset:16
    ds_read_b128 a[8:11], v6 offset:2112
    ds_read_b128 a[12:15], v6 offset:2128
    ds_read_b128 a[32:35], v6 offset:16896
    ds_read_b128 a[36:39], v6 offset:16912
    ds_read_b128 a[40:43], v6 offset:19008
    ds_read_b128 a[44:47], v6 offset:19024
    ds_read_b128 a[64:67], v6 offset:33792
    ds_read_b128 a[68:71], v6 offset:33808
    ds_read_b128 a[72:75], v6 offset:35904
    ds_read_b128 a[76:79], v6 offset:35920
    ds_read_b128 a[96:99], v6 offset:50688
    ds_read_b128 a[100:103], v6 offset:50704
    ds_read_b128 a[104:107], v6 offset:52800
    ds_read_b128 a[108:111], v6 offset:52816
    s_waitcnt lgkmcnt(0)
    s_barrier
    ds_write_b128 v5, v[144:147] offset:0
    ds_write_b128 v5, v[148:151] offset:32
    s_cmp_eq_u32 s79, 0
    s_cbranch_scc1 nodma_30
    s_add_u32 m0, s34, 10240
    s_nop 0
    buffer_load_dwordx4 v3, s[16:19], s33 offen sc1 lds
    s_add_u32 s33, s33, 32768
    s_add_u32 m0, s34, 11264
    s_nop 0
    buffer_load_dwordx4 v3, s[16:19], s33 offen sc1 lds
    s_add_u32 s33, s33, 32768
    nodma_30:
    ds_write_b128 v5, v[152:155] offset:64
    ds_write_b128 v5, v[156:159] offset:96
    ds_write_b128 v5, v[176:179] offset:128
    s_cmp_eq_u32 s79, 0
    s_cbranch_scc1 nodma_31
    s_add_u32 m0, s34, 12288
    s_nop 0
    buffer_load_dwordx4 v3, s[16:19], s33 offen sc1 lds
    s_add_u32 s33, s33, 32768
    s_add_u32 m0, s34, 13312
    s_nop 0
    buffer_load_dwordx4 v3, s[16:19], s33 offen sc1 lds
    s_add_u32 s33, s33, 32768
    nodma_31:
    ds_write_b128 v5, v[180:183] offset:160
    ds_write_b128 v5, v[184:187] offset:192
    ds_write_b128 v5, v[188:191] offset:224
    s_cmp_eq_u32 s79, 0
    s_cbranch_scc1 nodma_32
    s_add_u32 m0, s34, 14336
    s_nop 0
    buffer_load_dwordx4 v3, s[16:19], s33 offen sc1 lds
    s_add_u32 s33, s33, 32768
    s_add_u32 m0, s34, 15360
    s_nop 0
    buffer_load_dwordx4 v3, s[16:19], s33 offen sc1 lds
    s_add_u32 s33, s33, 32768
    nodma_32:
    ds_write_b128 v5, v[208:211] offset:256
    ds_write_b128 v5, v[212:215] offset:288
    ds_write_b128 v5, v[216:219] offset:320
    s_cmp_eq_u32 s79, 0
    s_cbranch_scc1 nodma_33
    s_add_u32 m0, s34, 16384
    s_nop 0
    buffer_load_dwordx4 v3, s[16:19], s33 offen sc1 lds
    s_add_u32 s33, s33, 32768
    s_add_u32 m0, s34, 17408
    s_nop 0
    buffer_load_dwordx4 v3, s[16:19], s33 offen sc1 lds
    s_add_u32 s33, s33, 32768
    nodma_33:
    ds_write_b128 v5, v[220:223] offset:352
    ds_write_b128 v5, v[240:243] offset:384
    ds_write_b128 v5, v[244:247] offset:416
    s_cmp_eq_u32 s79, 0
    s_cbranch_scc1 nodma_34
    s_add_u32 m0, s34, 18432
    s_nop 0
    buffer_load_dwordx4 v3, s[16:19], s33 offen sc1 lds
    s_add_u32 s33, s33, 32768
    s_add_u32 m0, s34, 19456
    s_nop 0
    buffer_load_dwordx4 v3, s[16:19], s33 offen sc1 lds
    s_add_u32 s33, s33, 32768
    nodma_34:
    ds_write_b128 v5, v[248:251] offset:448
    ds_write_b128 v5, v[252:255] offset:480
    s_waitcnt lgkmcnt(0)
    s_barrier
    ds_read_b128 v[144:147], v6 offset:0
    ds_read_b128 v[148:151], v6 offset:16
    ds_read_b128 v[152:155], v6 offset:2112
    ds_read_b128 v[156:159], v6 offset:2128
    ds_read_b128 v[176:179], v6 offset:16896
    ds_read_b128 v[180:183], v6 offset:16912
    ds_read_b128 v[184:187], v6 offset:19008
    ds_read_b128 v[188:191], v6 offset:19024
    ds_read_b128 v[208:211], v6 offset:33792
    ds_read_b128 v[212:215], v6 offset:33808
    ds_read_b128 v[216:219], v6 offset:35904
    ds_read_b128 v[220:223], v6 offset:35920
    ds_read_b128 v[240:243], v6 offset:50688
    ds_read_b128 v[244:247], v6 offset:50704
    ds_read_b128 v[248:251], v6 offset:52800
    ds_read_b128 v[252:255], v6 offset:52816
    s_waitcnt lgkmcnt(0)
    s_barrier
    v_accvgpr_read_b32 v128, a0
    v_accvgpr_read_b32 v129, a1
    v_accvgpr_read_b32 v130, a2
    v_accvgpr_read_b32 v131, a3
    v_accvgpr_read_b32 v132, a4
    v_accvgpr_read_b32 v133, a5
    v_accvgpr_read_b32 v134, a6
    v_accvgpr_read_b32 v135, a7
    v_accvgpr_read_b32 v136, a8
    v_accvgpr_read_b32 v137, a9
    v_accvgpr_read_b32 v138, a10
    v_accvgpr_read_b32 v139, a11
    v_accvgpr_read_b32 v140, a12
    v_accvgpr_read_b32 v141, a13
    v_accvgpr_read_b32 v142, a14
    v_accvgpr_read_b32 v143, a15
    v_accvgpr_read_b32 v160, a32
    v_accvgpr_read_b32 v161, a33
    v_accvgpr_read_b32 v162, a34
    v_accvgpr_read_b32 v163, a35
    v_accvgpr_read_b32 v164, a36
    v_accvgpr_read_b32 v165, a37
    v_accvgpr_read_b32 v166, a38
    v_accvgpr_read_b32 v167, a39
    v_accvgpr_read_b32 v168, a40
    v_accvgpr_read_b32 v169, a41
    v_accvgpr_read_b32 v170, a42
    v_accvgpr_read_b32 v171, a43
    v_accvgpr_read_b32 v172, a44
    v_accvgpr_read_b32 v173, a45
    v_accvgpr_read_b32 v174, a46
    v_accvgpr_read_b32 v175, a47
    v_accvgpr_read_b32 v192, a64
    v_accvgpr_read_b32 v193, a65
    v_accvgpr_read_b32 v194, a66
    v_accvgpr_read_b32 v195, a67
    v_accvgpr_read_b32 v196, a68
    v_accvgpr_read_b32 v197, a69
    v_accvgpr_read_b32 v198, a70
    v_accvgpr_read_b32 v199, a71
    v_accvgpr_read_b32 v200, a72
    v_accvgpr_read_b32 v201, a73
    v_accvgpr_read_b32 v202, a74
    v_accvgpr_read_b32 v203, a75
    v_accvgpr_read_b32 v204, a76
    v_accvgpr_read_b32 v205, a77
    v_accvgpr_read_b32 v206, a78
    v_accvgpr_read_b32 v207, a79
    v_accvgpr_read_b32 v224, a96
    v_accvgpr_read_b32 v225, a97
    v_accvgpr_read_b32 v226, a98
    v_accvgpr_read_b32 v227, a99
    v_accvgpr_read_b32 v228, a100
    v_accvgpr_read_b32 v229, a101
    v_accvgpr_read_b32 v230, a102
    v_accvgpr_read_b32 v231, a103
    v_accvgpr_read_b32 v232, a104
    v_accvgpr_read_b32 v233, a105
    v_accvgpr_read_b32 v234, a106
    v_accvgpr_read_b32 v235, a107
    v_accvgpr_read_b32 v236, a108
    v_accvgpr_read_b32 v237, a109
    v_accvgpr_read_b32 v238, a110
    v_accvgpr_read_b32 v239, a111
    v_pk_add_f32 v[128:129], v[128:129], v[160:161]
    v_pk_add_f32 v[130:131], v[130:131], v[162:163]
    v_pk_add_f32 v[132:133], v[132:133], v[164:165]
    v_pk_add_f32 v[134:135], v[134:135], v[166:167]
    v_pk_add_f32 v[136:137], v[136:137], v[168:169]
    v_pk_add_f32 v[138:139], v[138:139], v[170:171]
    v_pk_add_f32 v[140:141], v[140:141], v[172:173]
    v_pk_add_f32 v[142:143], v[142:143], v[174:175]
    v_pk_add_f32 v[144:145], v[144:145], v[176:177]
    v_pk_add_f32 v[146:147], v[146:147], v[178:179]
    v_pk_add_f32 v[148:149], v[148:149], v[180:181]
    v_pk_add_f32 v[150:151], v[150:151], v[182:183]
    v_pk_add_f32 v[152:153], v[152:153], v[184:185]
    v_pk_add_f32 v[154:155], v[154:155], v[186:187]
    v_pk_add_f32 v[156:157], v[156:157], v[188:189]
    v_pk_add_f32 v[158:159], v[158:159], v[190:191]
    v_pk_add_f32 v[128:129], v[128:129], v[192:193]
    v_pk_add_f32 v[130:131], v[130:131], v[194:195]
    v_pk_add_f32 v[132:133], v[132:133], v[196:197]
    v_pk_add_f32 v[134:135], v[134:135], v[198:199]
    v_pk_add_f32 v[136:137], v[136:137], v[200:201]
    v_pk_add_f32 v[138:139], v[138:139], v[202:203]
    v_pk_add_f32 v[140:141], v[140:141], v[204:205]
    v_pk_add_f32 v[142:143], v[142:143], v[206:207]
    v_pk_add_f32 v[144:145], v[144:145], v[208:209]
    v_pk_add_f32 v[146:147], v[146:147], v[210:211]
    v_pk_add_f32 v[148:149], v[148:149], v[212:213]
    v_pk_add_f32 v[150:151], v[150:151], v[214:215]
    v_pk_add_f32 v[152:153], v[152:153], v[216:217]
    v_pk_add_f32 v[154:155], v[154:155], v[218:219]
    v_pk_add_f32 v[156:157], v[156:157], v[220:221]
    v_pk_add_f32 v[158:159], v[158:159], v[222:223]
    v_pk_add_f32 v[128:129], v[128:129], v[224:225]
    v_pk_add_f32 v[130:131], v[130:131], v[226:227]
    v_pk_add_f32 v[132:133], v[132:133], v[228:229]
    v_pk_add_f32 v[134:135], v[134:135], v[230:231]
    v_pk_add_f32 v[136:137], v[136:137], v[232:233]
    v_pk_add_f32 v[138:139], v[138:139], v[234:235]
    v_pk_add_f32 v[140:141], v[140:141], v[236:237]
    v_pk_add_f32 v[142:143], v[142:143], v[238:239]
    v_pk_add_f32 v[144:145], v[144:145], v[240:241]
    v_pk_add_f32 v[146:147], v[146:147], v[242:243]
    v_pk_add_f32 v[148:149], v[148:149], v[244:245]
    v_pk_add_f32 v[150:151], v[150:151], v[246:247]
    v_pk_add_f32 v[152:153], v[152:153], v[248:249]
    v_pk_add_f32 v[154:155], v[154:155], v[250:251]
    v_pk_add_f32 v[156:157], v[156:157], v[252:253]
    v_pk_add_f32 v[158:159], v[158:159], v[254:255]
    v_cvt_pk_bf16_f32 v11, v128, v129
    v_lshlrev_b32 v128, 16, v11
    v_and_b32 v129, 0xffff0000, v11
    v_cvt_pk_bf16_f32 v11, v130, v131
    v_lshlrev_b32 v130, 16, v11
    v_and_b32 v131, 0xffff0000, v11
    v_cvt_pk_bf16_f32 v11, v132, v133
    v_lshlrev_b32 v132, 16, v11
    v_and_b32 v133, 0xffff0000, v11
    v_cvt_pk_bf16_f32 v11, v134, v135
    v_lshlrev_b32 v134, 16, v11
    v_and_b32 v135, 0xffff0000, v11
    v_cvt_pk_bf16_f32 v11, v136, v137
    v_lshlrev_b32 v136, 16, v11
    v_and_b32 v137, 0xffff0000, v11
    v_cvt_pk_bf16_f32 v11, v138, v139
    v_lshlrev_b32 v138, 16, v11
    v_and_b32 v139, 0xffff0000, v11
    v_cvt_pk_bf16_f32 v11, v140, v141
    v_lshlrev_b32 v140, 16, v11
    v_and_b32 v141, 0xffff0000, v11
    v_cvt_pk_bf16_f32 v11, v142, v143
    v_lshlrev_b32 v142, 16, v11
    v_and_b32 v143, 0xffff0000, v11
    v_cvt_pk_bf16_f32 v11, v144, v145
    v_lshlrev_b32 v144, 16, v11
    v_and_b32 v145, 0xffff0000, v11
    v_cvt_pk_bf16_f32 v11, v146, v147
    v_lshlrev_b32 v146, 16, v11
    v_and_b32 v147, 0xffff0000, v11
    v_cvt_pk_bf16_f32 v11, v148, v149
    v_lshlrev_b32 v148, 16, v11
    v_and_b32 v149, 0xffff0000, v11
    v_cvt_pk_bf16_f32 v11, v150, v151
    v_lshlrev_b32 v150, 16, v11
    v_and_b32 v151, 0xffff0000, v11
    v_cvt_pk_bf16_f32 v11, v152, v153
    v_lshlrev_b32 v152, 16, v11
    v_and_b32 v153, 0xffff0000, v11
    v_cvt_pk_bf16_f32 v11, v154, v155
    v_lshlrev_b32 v154, 16, v11
    v_and_b32 v155, 0xffff0000, v11
    v_cvt_pk_bf16_f32 v11, v156, v157
    v_lshlrev_b32 v156, 16, v11
    v_and_b32 v157, 0xffff0000, v11
    v_cvt_pk_bf16_f32 v11, v158, v159
    v_lshlrev_b32 v158, 16, v11
    v_and_b32 v159, 0xffff0000, v11
    s_mov_b32 s57, 0xbfb8aa3b
    v_mul_f32 v160, s57, v128
    v_mul_f32 v161, s57, v129
    v_mul_f32 v162, s57, v130
    v_mul_f32 v163, s57, v131
    v_mul_f32 v164, s57, v132
    v_mul_f32 v165, s57, v133
    v_mul_f32 v166, s57, v134
    v_mul_f32 v167, s57, v135
    v_mul_f32 v168, s57, v136
    v_mul_f32 v169, s57, v137
    v_mul_f32 v170, s57, v138
    v_mul_f32 v171, s57, v139
    v_mul_f32 v172, s57, v140
    v_mul_f32 v173, s57, v141
    v_mul_f32 v174, s57, v142
    v_mul_f32 v175, s57, v143
    v_mul_f32 v176, s57, v144
    v_mul_f32 v177, s57, v145
    v_mul_f32 v178, s57, v146
    v_mul_f32 v179, s57, v147
    v_mul_f32 v180, s57, v148
    v_mul_f32 v181, s57, v149
    v_mul_f32 v182, s57, v150
    v_mul_f32 v183, s57, v151
    v_mul_f32 v184, s57, v152
    v_mul_f32 v185, s57, v153
    v_mul_f32 v186, s57, v154
    v_mul_f32 v187, s57, v155
    v_mul_f32 v188, s57, v156
    v_mul_f32 v189, s57, v157
    v_mul_f32 v190, s57, v158
    v_mul_f32 v191, s57, v159
    v_exp_f32 v160, v160
    v_exp_f32 v161, v161
    v_exp_f32 v162, v162
    v_exp_f32 v163, v163
    v_exp_f32 v164, v164
    v_exp_f32 v165, v165
    v_exp_f32 v166, v166
    v_exp_f32 v167, v167
    v_exp_f32 v168, v168
    v_exp_f32 v169, v169
    v_exp_f32 v170, v170
    v_exp_f32 v171, v171
    v_exp_f32 v172, v172
    v_exp_f32 v173, v173
    v_exp_f32 v174, v174
    v_exp_f32 v175, v175
    v_exp_f32 v176, v176
    v_exp_f32 v177, v177
    v_exp_f32 v178, v178
    v_exp_f32 v179, v179
    v_exp_f32 v180, v180
    v_exp_f32 v181, v181
    v_exp_f32 v182, v182
    v_exp_f32 v183, v183
    v_exp_f32 v184, v184
    v_exp_f32 v185, v185
    v_exp_f32 v186, v186
    v_exp_f32 v187, v187
    v_exp_f32 v188, v188
    v_exp_f32 v189, v189
    v_exp_f32 v190, v190
    v_exp_f32 v191, v191
    s_cmp_lg_u32 s79, 0
    s_cbranch_scc1 join_35
    s_cmp_lg_u32 s24, 0
    s_cbranch_scc1 pook_37
    s_mov_b32 s58, 0
    v_mov_b32 v72, 0
    s_lshl_b32 s35, s59, 7
po_36:
    buffer_load_dwordx4 v[74:77], v72, s[96:99], s35 offen offset:0 sc1
    s_waitcnt vmcnt(0)
    v_readfirstlane_b32 s3, v76
    s_nop 3
    s_cmp_lt_u32 s3, 81
    s_cbranch_scc1 poag_38
    s_branch pook_37
poag_38:
    s_add_u32 s58, s58, 1
    s_cmp_ge_u32 s58, 65536
    s_cbranch_scc1 pook_37
    s_sleep 2
    s_branch po_36
pook_37:
    s_barrier
    buffer_load_dwordx4 v[76:79], v2, s[20:23], 0 offen sc1
    s_add_u32 m0, s34, 0
    s_nop 0
    buffer_load_dwordx4 v3, s[16:19], s33 offen sc1 lds
    s_add_u32 s33, s33, 32768
    s_add_u32 m0, s34, 1024
    s_nop 0
    buffer_load_dwordx4 v3, s[16:19], s33 offen sc1 lds
    s_add_u32 s33, s33, 32768
    s_add_u32 m0, s34, 2048
    s_nop 0
    buffer_load_dwordx4 v3, s[16:19], s33 offen sc1 lds
    s_add_u32 s33, s33, 32768
    s_add_u32 m0, s34, 3072
    s_nop 0
    buffer_load_dwordx4 v3, s[16:19], s33 offen sc1 lds
    s_add_u32 s33, s33, 32768
    s_add_u32 m0, s34, 4096
    s_nop 0
    buffer_load_dwordx4 v3, s[16:19], s33 offen sc1 lds
    s_add_u32 s33, s33, 32768
    s_add_u32 m0, s34, 5120
    s_nop 0
    buffer_load_dwordx4 v3, s[16:19], s33 offen sc1 lds
    s_add_u32 s33, s33, 32768
    s_add_u32 m0, s34, 6144
    s_nop 0
    buffer_load_dwordx4 v3, s[16:19], s33 offen sc1 lds
    s_add_u32 s33, s33, 32768
    s_add_u32 m0, s34, 7168
    s_nop 0
    buffer_load_dwordx4 v3, s[16:19], s33 offen sc1 lds
    s_add_u32 s33, s33, 32768
    s_add_u32 m0, s34, 8192
    s_nop 0
    buffer_load_dwordx4 v3, s[16:19], s33 offen sc1 lds
    s_add_u32 s33, s33, 32768
    s_add_u32 m0, s34, 9216
    s_nop 0
    buffer_load_dwordx4 v3, s[16:19], s33 offen sc1 lds
    s_add_u32 s33, s33, 32768
    s_add_u32 m0, s34, 10240
    s_nop 0
    buffer_load_dwordx4 v3, s[16:19], s33 offen sc1 lds
    s_add_u32 s33, s33, 32768
    s_add_u32 m0, s34, 11264
    s_nop 0
    buffer_load_dwordx4 v3, s[16:19], s33 offen sc1 lds
    s_add_u32 s33, s33, 32768
    s_add_u32 m0, s34, 12288
    s_nop 0
    buffer_load_dwordx4 v3, s[16:19], s33 offen sc1 lds
    s_add_u32 s33, s33, 32768
    s_add_u32 m0, s34, 13312
    s_nop 0
    buffer_load_dwordx4 v3, s[16:19], s33 offen sc1 lds
    s_add_u32 s33, s33, 32768
    s_add_u32 m0, s34, 14336
    s_nop 0
    buffer_load_dwordx4 v3, s[16:19], s33 offen sc1 lds
    s_add_u32 s33, s33, 32768
    s_add_u32 m0, s34, 15360
    s_nop 0
    buffer_load_dwordx4 v3, s[16:19], s33 offen sc1 lds
    s_add_u32 s33, s33, 32768
    s_add_u32 m0, s34, 16384
    s_nop 0
    buffer_load_dwordx4 v3, s[16:19], s33 offen sc1 lds
    s_add_u32 s33, s33, 32768
    s_add_u32 m0, s34, 17408
    s_nop 0
    buffer_load_dwordx4 v3, s[16:19], s33 offen sc1 lds
    s_add_u32 s33, s33, 32768
    s_add_u32 m0, s34, 18432
    s_nop 0
    buffer_load_dwordx4 v3, s[16:19], s33 offen sc1 lds
    s_add_u32 s33, s33, 32768
    s_add_u32 m0, s34, 19456
    s_nop 0
    buffer_load_dwordx4 v3, s[16:19], s33 offen sc1 lds
    s_add_u32 s33, s33, 32768
join_35:
    s_waitcnt vmcnt(20)
    v_max_u32 v7, v76, v77
    v_max3_u32 v7, v78, v79, v7
    s_nop 1
    v_max_u32_dpp v7, v7, v7 row_shr:1 row_mask:0xf bank_mask:0xf
    s_nop 1
    v_max_u32_dpp v7, v7, v7 row_shr:2 row_mask:0xf bank_mask:0xf
    s_nop 1
    v_max_u32_dpp v7, v7, v7 row_shr:4 row_mask:0xf bank_mask:0xf
    s_nop 1
    v_max_u32_dpp v7, v7, v7 row_shr:8 row_mask:0xf bank_mask:0xf
    s_nop 1
    v_max_u32_dpp v7, v7, v7 row_bcast:15 row_mask:0xa bank_mask:0xf
    s_nop 1
    v_max_u32_dpp v7, v7, v7 row_bcast:31 row_mask:0xc bank_mask:0xf
    s_nop 1
    v_readlane_b32 s7, v7, 63
    s_nop 3
    s_lshr_b32 s7, s7, 7
    s_and_b32 s7, s7, 0xff
    s_min_u32 s7, s7, 249
    s_sub_u32 s7, 250, s7
    s_sub_u32 s7, 254, s7
    s_lshl_b32 s7, s7, 23
    v_mov_b32 v6, s7
    v_mul_f32 v6, 0x3b4ccccd, v6
    v_mul_u32_u24 v5, 144, v4
    v_lshl_add_u32 v5, v10, 4, v5
    s_mul_i32 s3, s24, 9216
    s_add_u32 s3, s3, 0
    v_add_u32 v5, s3, v5
    v_lshrrev_b32 v7, 2, v1
    v_mul_u32_u24 v7, 144, v7
    s_and_b32 s3, s24, 1
    s_mul_i32 s3, s3, 3
    v_xor_b32 v15, s3, v14
    v_lshl_add_u32 v7, v15, 5, v7
    v_add_u32 v7, 0, v7
    s_waitcnt vmcnt(18)
    ds_read_b64_tr_b16 a[0:1], v12 offset:0
    ds_read_b64_tr_b16 a[2:3], v12 offset:512
    ds_read_b64_tr_b16 a[4:5], v13 offset:0
    ds_read_b64_tr_b16 a[6:7], v13 offset:512
    s_waitcnt vmcnt(16)
    ds_read_b64_tr_b16 a[8:9], v12 offset:2048
    ds_read_b64_tr_b16 a[10:11], v12 offset:2560
    ds_read_b64_tr_b16 a[12:13], v13 offset:2048
    ds_read_b64_tr_b16 a[14:15], v13 offset:2560
    s_waitcnt vmcnt(14)
    ds_read_b64_tr_b16 a[16:17], v12 offset:4096
    ds_read_b64_tr_b16 a[18:19], v12 offset:4608
    ds_read_b64_tr_b16 a[20:21], v13 offset:4096
    ds_read_b64_tr_b16 a[22:23], v13 offset:4608
    s_waitcnt vmcnt(12)
    ds_read_b64_tr_b16 a[24:25], v12 offset:6144
    ds_read_b64_tr_b16 a[26:27], v12 offset:6656
    ds_read_b64_tr_b16 a[28:29], v13 offset:6144
    ds_read_b64_tr_b16 a[30:31], v13 offset:6656
    s_waitcnt vmcnt(10)
    ds_read_b64_tr_b16 a[32:33], v12 offset:8192
    ds_read_b64_tr_b16 a[34:35], v12 offset:8704
    ds_read_b64_tr_b16 a[36:37], v13 offset:8192
    ds_read_b64_tr_b16 a[38:39], v13 offset:8704
    s_waitcnt vmcnt(8)
    ds_read_b64_tr_b16 a[40:41], v12 offset:10240
    ds_read_b64_tr_b16 a[42:43], v12 offset:10752
    ds_read_b64_tr_b16 a[44:45], v13 offset:10240
    ds_read_b64_tr_b16 a[46:47], v13 offset:10752
    s_waitcnt vmcnt(6)
    ds_read_b64_tr_b16 a[48:49], v12 offset:12288
    ds_read_b64_tr_b16 a[50:51], v12 offset:12800
    ds_read_b64_tr_b16 a[52:53], v13 offset:12288
    ds_read_b64_tr_b16 a[54:55], v13 offset:12800
    s_waitcnt vmcnt(4)
    ds_read_b64_tr_b16 a[56:57], v12 offset:14336
    ds_read_b64_tr_b16 a[58:59], v12 offset:14848
    ds_read_b64_tr_b16 a[60:61], v13 offset:14336
    ds_read_b64_tr_b16 a[62:63], v13 offset:14848
    s_waitcnt vmcnt(2)
    ds_read_b64_tr_b16 a[64:65], v12 offset:16384
    ds_read_b64_tr_b16 a[66:67], v12 offset:16896
    ds_read_b64_tr_b16 a[68:69], v13 offset:16384
    ds_read_b64_tr_b16 a[70:71], v13 offset:16896
    s_waitcnt vmcnt(0)
    ds_read_b64_tr_b16 a[72:73], v12 offset:18432
    ds_read_b64_tr_b16 a[74:75], v12 offset:18944
    ds_read_b64_tr_b16 a[76:77], v13 offset:18432
    ds_read_b64_tr_b16 a[78:79], v13 offset:18944
    s_waitcnt lgkmcnt(15)
    v_mfma_f32_32x32x16_f16 v[112:127], v[32:35], a[0:3], 0
    v_add_f32 v160, 1.0, v160
    v_add_f32 v161, 1.0, v161
    v_mfma_f32_32x32x16_f16 v[16:31], v[32:35], a[4:7], 0
    v_add_f32 v162, 1.0, v162
    v_add_f32 v163, 1.0, v163
    v_add_f32 v164, 1.0, v164
    s_waitcnt lgkmcnt(15)
    v_mfma_f32_32x32x16_f16 v[112:127], v[36:39], a[8:11], v[112:127]
    v_add_f32 v165, 1.0, v165
    v_add_f32 v166, 1.0, v166
    v_add_f32 v167, 1.0, v167
    v_mfma_f32_32x32x16_f16 v[16:31], v[36:39], a[12:15], v[16:31]
    v_add_f32 v168, 1.0, v168
    v_add_f32 v169, 1.0, v169
    v_add_f32 v170, 1.0, v170
    s_waitcnt lgkmcnt(15)
    v_mfma_f32_32x32x16_f16 v[112:127], v[40:43], a[16:19], v[112:127]
    v_add_f32 v171, 1.0, v171
    v_add_f32 v172, 1.0, v172
    v_add_f32 v173, 1.0, v173
    v_mfma_f32_32x32x16_f16 v[16:31], v[40:43], a[20:23], v[16:31]
    v_add_f32 v174, 1.0, v174
    v_add_f32 v175, 1.0, v175
    v_add_f32 v176, 1.0, v176
    s_waitcnt lgkmcnt(15)
    v_mfma_f32_32x32x16_f16 v[112:127], v[44:47], a[24:27], v[112:127]
    v_add_f32 v177, 1.0, v177
    v_add_f32 v178, 1.0, v178
    v_add_f32 v179, 1.0, v179
    v_mfma_f32_32x32x16_f16 v[16:31], v[44:47], a[28:31], v[16:31]
    v_add_f32 v180, 1.0, v180
    v_add_f32 v181, 1.0, v181
    v_add_f32 v182, 1.0, v182
    s_waitcnt lgkmcnt(15)
    v_mfma_f32_32x32x16_f16 v[112:127], v[48:51], a[32:35], v[112:127]
    v_add_f32 v183, 1.0, v183
    v_add_f32 v184, 1.0, v184
    v_add_f32 v185, 1.0, v185
    v_mfma_f32_32x32x16_f16 v[16:31], v[48:51], a[36:39], v[16:31]
    v_add_f32 v186, 1.0, v186
    v_add_f32 v187, 1.0, v187
    v_add_f32 v188, 1.0, v188
    s_waitcnt lgkmcnt(15)
    v_mfma_f32_32x32x16_f16 v[112:127], v[52:55], a[40:43], v[112:127]
    v_add_f32 v189, 1.0, v189
    v_add_f32 v190, 1.0, v190
    v_add_f32 v191, 1.0, v191
    v_mfma_f32_32x32x16_f16 v[16:31], v[52:55], a[44:47], v[16:31]
    v_rcp_f32 v160, v160
    v_rcp_f32 v161, v161
    s_waitcnt lgkmcnt(12)
    v_mfma_f32_32x32x16_f16 v[112:127], v[56:59], a[48:51], v[112:127]
    v_rcp_f32 v162, v162
    v_rcp_f32 v163, v163
    v_rcp_f32 v164, v164
    v_mfma_f32_32x32x16_f16 v[16:31], v[56:59], a[52:55], v[16:31]
    v_rcp_f32 v165, v165
    v_rcp_f32 v166, v166
    v_rcp_f32 v167, v167
    s_waitcnt lgkmcnt(8)
    v_mfma_f32_32x32x16_f16 v[112:127], v[60:63], a[56:59], v[112:127]
    v_rcp_f32 v168, v168
    v_rcp_f32 v169, v169
    v_rcp_f32 v170, v170
    v_mfma_f32_32x32x16_f16 v[16:31], v[60:63], a[60:63], v[16:31]
    v_rcp_f32 v171, v171
    v_rcp_f32 v172, v172
    v_rcp_f32 v173, v173
    s_waitcnt lgkmcnt(4)
    v_mfma_f32_32x32x16_f16 v[112:127], v[64:67], a[64:67], v[112:127]
    v_rcp_f32 v174, v174
    v_rcp_f32 v175, v175
    v_rcp_f32 v176, v176
    v_mfma_f32_32x32x16_f16 v[16:31], v[64:67], a[68:71], v[16:31]
    v_rcp_f32 v177, v177
    v_rcp_f32 v178, v178
    v_rcp_f32 v179, v179
    s_waitcnt lgkmcnt(0)
    v_mfma_f32_32x32x16_f16 v[112:127], v[68:71], a[72:75], v[112:127]
    v_rcp_f32 v180, v180
    v_rcp_f32 v181, v181
    v_rcp_f32 v182, v182
    v_mfma_f32_32x32x16_f16 v[16:31], v[68:71], a[76:79], v[16:31]
    v_rcp_f32 v183, v183
    v_rcp_f32 v184, v184
    v_rcp_f32 v185, v185
    v_rcp_f32 v186, v186
    v_rcp_f32 v187, v187
    v_rcp_f32 v188, v188
    v_rcp_f32 v189, v189
    v_rcp_f32 v190, v190
    v_rcp_f32 v191, v191
    s_nop 11
    ds_write_b128 v5, v[112:115] offset:0
    ds_write_b128 v5, v[116:119] offset:32
    ds_write_b128 v5, v[120:123] offset:64
    ds_write_b128 v5, v[124:127] offset:96
    ds_write_b128 v5, v[16:19] offset:4608
    ds_write_b128 v5, v[20:23] offset:4640
    ds_write_b128 v5, v[24:27] offset:4672
    ds_write_b128 v5, v[28:31] offset:4704
    v_pk_mul_f32 v[128:129], v[128:129], v[160:161]
    v_pk_mul_f32 v[130:131], v[130:131], v[162:163]
    v_pk_mul_f32 v[132:133], v[132:133], v[164:165]
    v_pk_mul_f32 v[134:135], v[134:135], v[166:167]
    v_pk_mul_f32 v[136:137], v[136:137], v[168:169]
    v_pk_mul_f32 v[138:139], v[138:139], v[170:171]
    v_pk_mul_f32 v[140:141], v[140:141], v[172:173]
    v_pk_mul_f32 v[142:143], v[142:143], v[174:175]
    v_pk_mul_f32 v[144:145], v[144:145], v[176:177]
    v_pk_mul_f32 v[146:147], v[146:147], v[178:179]
    v_pk_mul_f32 v[148:149], v[148:149], v[180:181]
    v_pk_mul_f32 v[150:151], v[150:151], v[182:183]
    v_pk_mul_f32 v[152:153], v[152:153], v[184:185]
    v_pk_mul_f32 v[154:155], v[154:155], v[186:187]
    v_pk_mul_f32 v[156:157], v[156:157], v[188:189]
    v_pk_mul_f32 v[158:159], v[158:159], v[190:191]
    v_cvt_pk_bf16_f32 v80, v128, v129
    v_cvt_pk_bf16_f32 v81, v130, v131
    v_cvt_pk_bf16_f32 v82, v132, v133
    v_cvt_pk_bf16_f32 v83, v134, v135
    v_cvt_pk_bf16_f32 v84, v136, v137
    v_cvt_pk_bf16_f32 v85, v138, v139
    v_cvt_pk_bf16_f32 v86, v140, v141
    v_cvt_pk_bf16_f32 v87, v142, v143
    v_cvt_pk_bf16_f32 v88, v144, v145
    v_cvt_pk_bf16_f32 v89, v146, v147
    v_cvt_pk_bf16_f32 v90, v148, v149
    v_cvt_pk_bf16_f32 v91, v150, v151
    v_cvt_pk_bf16_f32 v92, v152, v153
    v_cvt_pk_bf16_f32 v93, v154, v155
    v_cvt_pk_bf16_f32 v94, v156, v157
    v_cvt_pk_bf16_f32 v95, v158, v159
    s_waitcnt lgkmcnt(0)
    s_barrier
    ds_read_b128 v[128:131], v7 offset:0
    ds_read_b128 v[132:135], v7 offset:16
    ds_read_b128 v[136:139], v7 offset:2304
    ds_read_b128 v[140:143], v7 offset:2320
    ds_read_b128 v[144:147], v7 offset:4608
    ds_read_b128 v[148:151], v7 offset:4624
    ds_read_b128 v[152:155], v7 offset:6912
    ds_read_b128 v[156:159], v7 offset:6928
    ds_read_b128 v[160:163], v7 offset:9216
    ds_read_b128 v[164:167], v7 offset:9232
    ds_read_b128 v[168:171], v7 offset:11520
    ds_read_b128 v[172:175], v7 offset:11536
    ds_read_b128 v[176:179], v7 offset:13824
    ds_read_b128 v[180:183], v7 offset:13840
    ds_read_b128 v[184:187], v7 offset:16128
    ds_read_b128 v[188:191], v7 offset:16144
    ds_read_b128 v[192:195], v7 offset:18432
    ds_read_b128 v[196:199], v7 offset:18448
    ds_read_b128 v[200:203], v7 offset:20736
    ds_read_b128 v[204:207], v7 offset:20752
    ds_read_b128 v[208:211], v7 offset:23040
    ds_read_b128 v[212:215], v7 offset:23056
    ds_read_b128 v[216:219], v7 offset:25344
    ds_read_b128 v[220:223], v7 offset:25360
    ds_read_b128 v[224:227], v7 offset:27648
    ds_read_b128 v[228:231], v7 offset:27664
    ds_read_b128 v[232:235], v7 offset:29952
    ds_read_b128 v[236:239], v7 offset:29968
    ds_read_b128 v[240:243], v7 offset:32256
    ds_read_b128 v[244:247], v7 offset:32272
    ds_read_b128 v[248:251], v7 offset:34560
    ds_read_b128 v[252:255], v7 offset:34576
    v_mul_f32 v16, s4, v6
    v_mul_f32 v18, s5, v6
    v_mul_f32 v20, s6, v6
    s_waitcnt lgkmcnt(0)
    v_pk_mul_f32 v[32:33], v[128:129], v[6:7] op_sel_hi:[1,0]
    v_pk_fma_f32 v[32:33], v[160:161], v[16:17], v[32:33] op_sel_hi:[1,0,1]
    v_pk_fma_f32 v[32:33], v[192:193], v[18:19], v[32:33] op_sel_hi:[1,0,1]
    v_pk_fma_f32 v[32:33], v[224:225], v[20:21], v[32:33] op_sel_hi:[1,0,1]
    v_pk_mul_f32 v[34:35], v[130:131], v[6:7] op_sel_hi:[1,0]
    v_pk_fma_f32 v[34:35], v[162:163], v[16:17], v[34:35] op_sel_hi:[1,0,1]
    v_pk_fma_f32 v[34:35], v[194:195], v[18:19], v[34:35] op_sel_hi:[1,0,1]
    v_pk_fma_f32 v[34:35], v[226:227], v[20:21], v[34:35] op_sel_hi:[1,0,1]
    v_pk_mul_f32 v[36:37], v[132:133], v[6:7] op_sel_hi:[1,0]
    v_pk_fma_f32 v[36:37], v[164:165], v[16:17], v[36:37] op_sel_hi:[1,0,1]
    v_pk_fma_f32 v[36:37], v[196:197], v[18:19], v[36:37] op_sel_hi:[1,0,1]
    v_pk_fma_f32 v[36:37], v[228:229], v[20:21], v[36:37] op_sel_hi:[1,0,1]
    v_pk_mul_f32 v[38:39], v[134:135], v[6:7] op_sel_hi:[1,0]
    v_pk_fma_f32 v[38:39], v[166:167], v[16:17], v[38:39] op_sel_hi:[1,0,1]
    v_pk_fma_f32 v[38:39], v[198:199], v[18:19], v[38:39] op_sel_hi:[1,0,1]
    v_pk_fma_f32 v[38:39], v[230:231], v[20:21], v[38:39] op_sel_hi:[1,0,1]
    v_pk_mul_f32 v[40:41], v[136:137], v[6:7] op_sel_hi:[1,0]
    v_pk_fma_f32 v[40:41], v[168:169], v[16:17], v[40:41] op_sel_hi:[1,0,1]
    v_pk_fma_f32 v[40:41], v[200:201], v[18:19], v[40:41] op_sel_hi:[1,0,1]
    v_pk_fma_f32 v[40:41], v[232:233], v[20:21], v[40:41] op_sel_hi:[1,0,1]
    v_pk_mul_f32 v[42:43], v[138:139], v[6:7] op_sel_hi:[1,0]
    v_pk_fma_f32 v[42:43], v[170:171], v[16:17], v[42:43] op_sel_hi:[1,0,1]
    v_pk_fma_f32 v[42:43], v[202:203], v[18:19], v[42:43] op_sel_hi:[1,0,1]
    v_pk_fma_f32 v[42:43], v[234:235], v[20:21], v[42:43] op_sel_hi:[1,0,1]
    v_pk_mul_f32 v[44:45], v[140:141], v[6:7] op_sel_hi:[1,0]
    v_pk_fma_f32 v[44:45], v[172:173], v[16:17], v[44:45] op_sel_hi:[1,0,1]
    v_pk_fma_f32 v[44:45], v[204:205], v[18:19], v[44:45] op_sel_hi:[1,0,1]
    v_pk_fma_f32 v[44:45], v[236:237], v[20:21], v[44:45] op_sel_hi:[1,0,1]
    v_pk_mul_f32 v[46:47], v[142:143], v[6:7] op_sel_hi:[1,0]
    v_pk_fma_f32 v[46:47], v[174:175], v[16:17], v[46:47] op_sel_hi:[1,0,1]
    v_pk_fma_f32 v[46:47], v[206:207], v[18:19], v[46:47] op_sel_hi:[1,0,1]
    v_pk_fma_f32 v[46:47], v[238:239], v[20:21], v[46:47] op_sel_hi:[1,0,1]
    v_pk_mul_f32 v[48:49], v[144:145], v[6:7] op_sel_hi:[1,0]
    v_pk_fma_f32 v[48:49], v[176:177], v[16:17], v[48:49] op_sel_hi:[1,0,1]
    v_pk_fma_f32 v[48:49], v[208:209], v[18:19], v[48:49] op_sel_hi:[1,0,1]
    v_pk_fma_f32 v[48:49], v[240:241], v[20:21], v[48:49] op_sel_hi:[1,0,1]
    v_pk_mul_f32 v[50:51], v[146:147], v[6:7] op_sel_hi:[1,0]
    v_pk_fma_f32 v[50:51], v[178:179], v[16:17], v[50:51] op_sel_hi:[1,0,1]
    v_pk_fma_f32 v[50:51], v[210:211], v[18:19], v[50:51] op_sel_hi:[1,0,1]
    v_pk_fma_f32 v[50:51], v[242:243], v[20:21], v[50:51] op_sel_hi:[1,0,1]
    v_pk_mul_f32 v[52:53], v[148:149], v[6:7] op_sel_hi:[1,0]
    v_pk_fma_f32 v[52:53], v[180:181], v[16:17], v[52:53] op_sel_hi:[1,0,1]
    v_pk_fma_f32 v[52:53], v[212:213], v[18:19], v[52:53] op_sel_hi:[1,0,1]
    v_pk_fma_f32 v[52:53], v[244:245], v[20:21], v[52:53] op_sel_hi:[1,0,1]
    v_pk_mul_f32 v[54:55], v[150:151], v[6:7] op_sel_hi:[1,0]
    v_pk_fma_f32 v[54:55], v[182:183], v[16:17], v[54:55] op_sel_hi:[1,0,1]
    v_pk_fma_f32 v[54:55], v[214:215], v[18:19], v[54:55] op_sel_hi:[1,0,1]
    v_pk_fma_f32 v[54:55], v[246:247], v[20:21], v[54:55] op_sel_hi:[1,0,1]
    v_pk_mul_f32 v[56:57], v[152:153], v[6:7] op_sel_hi:[1,0]
    v_pk_fma_f32 v[56:57], v[184:185], v[16:17], v[56:57] op_sel_hi:[1,0,1]
    v_pk_fma_f32 v[56:57], v[216:217], v[18:19], v[56:57] op_sel_hi:[1,0,1]
    v_pk_fma_f32 v[56:57], v[248:249], v[20:21], v[56:57] op_sel_hi:[1,0,1]
    v_pk_mul_f32 v[58:59], v[154:155], v[6:7] op_sel_hi:[1,0]
    v_pk_fma_f32 v[58:59], v[186:187], v[16:17], v[58:59] op_sel_hi:[1,0,1]
    v_pk_fma_f32 v[58:59], v[218:219], v[18:19], v[58:59] op_sel_hi:[1,0,1]
    v_pk_fma_f32 v[58:59], v[250:251], v[20:21], v[58:59] op_sel_hi:[1,0,1]
    v_pk_mul_f32 v[60:61], v[156:157], v[6:7] op_sel_hi:[1,0]
    v_pk_fma_f32 v[60:61], v[188:189], v[16:17], v[60:61] op_sel_hi:[1,0,1]
    v_pk_fma_f32 v[60:61], v[220:221], v[18:19], v[60:61] op_sel_hi:[1,0,1]
    v_pk_fma_f32 v[60:61], v[252:253], v[20:21], v[60:61] op_sel_hi:[1,0,1]
    v_pk_mul_f32 v[62:63], v[158:159], v[6:7] op_sel_hi:[1,0]
    v_pk_fma_f32 v[62:63], v[190:191], v[16:17], v[62:63] op_sel_hi:[1,0,1]
    v_pk_fma_f32 v[62:63], v[222:223], v[18:19], v[62:63] op_sel_hi:[1,0,1]
    v_pk_fma_f32 v[62:63], v[254:255], v[20:21], v[62:63] op_sel_hi:[1,0,1]
    s_mov_b32 s16, s50
    s_and_b32 s17, s51, 0xffff
    s_mov_b32 s18, 2621440
    s_mov_b32 s19, 0x00020000
    s_and_b32 s3, s24, 1
    s_cmp_eq_u32 s3, 1
    s_cbranch_scc1 k3_rev
    v_cvt_pk_bf16_f32 v10, v32, v33
    v_lshlrev_b32 v12, 16, v10
    v_and_b32 v13, 0xffff0000, v10
    v_lshlrev_b32 v14, 16, v80
    v_and_b32 v15, 0xffff0000, v80
    v_pk_mul_f32 v[12:13], v[12:13], v[14:15]
    v_cvt_pk_bf16_f32 v10, v12, v13
    v_lshlrev_b32 v12, 16, v10
    v_and_b32 v13, 0xffff0000, v10
    v_lshlrev_b32 v14, 16, v96
    v_and_b32 v15, 0xffff0000, v96
    v_pk_add_f32 v[12:13], v[12:13], v[14:15]
    v_cvt_pk_bf16_f32 v112, v12, v13
    v_cvt_pk_bf16_f32 v10, v34, v35
    v_lshlrev_b32 v12, 16, v10
    v_and_b32 v13, 0xffff0000, v10
    v_lshlrev_b32 v14, 16, v81
    v_and_b32 v15, 0xffff0000, v81
    v_pk_mul_f32 v[12:13], v[12:13], v[14:15]
    v_cvt_pk_bf16_f32 v10, v12, v13
    v_lshlrev_b32 v12, 16, v10
    v_and_b32 v13, 0xffff0000, v10
    v_lshlrev_b32 v14, 16, v97
    v_and_b32 v15, 0xffff0000, v97
    v_pk_add_f32 v[12:13], v[12:13], v[14:15]
    v_cvt_pk_bf16_f32 v113, v12, v13
    v_cvt_pk_bf16_f32 v10, v36, v37
    v_lshlrev_b32 v12, 16, v10
    v_and_b32 v13, 0xffff0000, v10
    v_lshlrev_b32 v14, 16, v82
    v_and_b32 v15, 0xffff0000, v82
    v_pk_mul_f32 v[12:13], v[12:13], v[14:15]
    v_cvt_pk_bf16_f32 v10, v12, v13
    v_lshlrev_b32 v12, 16, v10
    v_and_b32 v13, 0xffff0000, v10
    v_lshlrev_b32 v14, 16, v98
    v_and_b32 v15, 0xffff0000, v98
    v_pk_add_f32 v[12:13], v[12:13], v[14:15]
    v_cvt_pk_bf16_f32 v114, v12, v13
    v_cvt_pk_bf16_f32 v10, v38, v39
    v_lshlrev_b32 v12, 16, v10
    v_and_b32 v13, 0xffff0000, v10
    v_lshlrev_b32 v14, 16, v83
    v_and_b32 v15, 0xffff0000, v83
    v_pk_mul_f32 v[12:13], v[12:13], v[14:15]
    v_cvt_pk_bf16_f32 v10, v12, v13
    v_lshlrev_b32 v12, 16, v10
    v_and_b32 v13, 0xffff0000, v10
    v_lshlrev_b32 v14, 16, v99
    v_and_b32 v15, 0xffff0000, v99
    v_pk_add_f32 v[12:13], v[12:13], v[14:15]
    v_cvt_pk_bf16_f32 v115, v12, v13
    v_cvt_pk_bf16_f32 v10, v40, v41
    v_lshlrev_b32 v12, 16, v10
    v_and_b32 v13, 0xffff0000, v10
    v_lshlrev_b32 v14, 16, v84
    v_and_b32 v15, 0xffff0000, v84
    v_pk_mul_f32 v[12:13], v[12:13], v[14:15]
    v_cvt_pk_bf16_f32 v10, v12, v13
    v_lshlrev_b32 v12, 16, v10
    v_and_b32 v13, 0xffff0000, v10
    v_lshlrev_b32 v14, 16, v100
    v_and_b32 v15, 0xffff0000, v100
    v_pk_add_f32 v[12:13], v[12:13], v[14:15]
    v_cvt_pk_bf16_f32 v116, v12, v13
    v_cvt_pk_bf16_f32 v10, v42, v43
    v_lshlrev_b32 v12, 16, v10
    v_and_b32 v13, 0xffff0000, v10
    v_lshlrev_b32 v14, 16, v85
    v_and_b32 v15, 0xffff0000, v85
    v_pk_mul_f32 v[12:13], v[12:13], v[14:15]
    v_cvt_pk_bf16_f32 v10, v12, v13
    v_lshlrev_b32 v12, 16, v10
    v_and_b32 v13, 0xffff0000, v10
    v_lshlrev_b32 v14, 16, v101
    v_and_b32 v15, 0xffff0000, v101
    v_pk_add_f32 v[12:13], v[12:13], v[14:15]
    v_cvt_pk_bf16_f32 v117, v12, v13
    v_cvt_pk_bf16_f32 v10, v44, v45
    v_lshlrev_b32 v12, 16, v10
    v_and_b32 v13, 0xffff0000, v10
    v_lshlrev_b32 v14, 16, v86
    v_and_b32 v15, 0xffff0000, v86
    v_pk_mul_f32 v[12:13], v[12:13], v[14:15]
    v_cvt_pk_bf16_f32 v10, v12, v13
    v_lshlrev_b32 v12, 16, v10
    v_and_b32 v13, 0xffff0000, v10
    v_lshlrev_b32 v14, 16, v102
    v_and_b32 v15, 0xffff0000, v102
    v_pk_add_f32 v[12:13], v[12:13], v[14:15]
    v_cvt_pk_bf16_f32 v118, v12, v13
    v_cvt_pk_bf16_f32 v10, v46, v47
    v_lshlrev_b32 v12, 16, v10
    v_and_b32 v13, 0xffff0000, v10
    v_lshlrev_b32 v14, 16, v87
    v_and_b32 v15, 0xffff0000, v87
    v_pk_mul_f32 v[12:13], v[12:13], v[14:15]
    v_cvt_pk_bf16_f32 v10, v12, v13
    v_lshlrev_b32 v12, 16, v10
    v_and_b32 v13, 0xffff0000, v10
    v_lshlrev_b32 v14, 16, v103
    v_and_b32 v15, 0xffff0000, v103
    v_pk_add_f32 v[12:13], v[12:13], v[14:15]
    v_cvt_pk_bf16_f32 v119, v12, v13
    v_cvt_pk_bf16_f32 v10, v48, v49
    v_lshlrev_b32 v12, 16, v10
    v_and_b32 v13, 0xffff0000, v10
    v_lshlrev_b32 v14, 16, v88
    v_and_b32 v15, 0xffff0000, v88
    v_pk_mul_f32 v[12:13], v[12:13], v[14:15]
    v_cvt_pk_bf16_f32 v10, v12, v13
    v_lshlrev_b32 v12, 16, v10
    v_and_b32 v13, 0xffff0000, v10
    v_lshlrev_b32 v14, 16, v104
    v_and_b32 v15, 0xffff0000, v104
    v_pk_add_f32 v[12:13], v[12:13], v[14:15]
    v_cvt_pk_bf16_f32 v120, v12, v13
    v_cvt_pk_bf16_f32 v10, v50, v51
    v_lshlrev_b32 v12, 16, v10
    v_and_b32 v13, 0xffff0000, v10
    v_lshlrev_b32 v14, 16, v89
    v_and_b32 v15, 0xffff0000, v89
    v_pk_mul_f32 v[12:13], v[12:13], v[14:15]
    v_cvt_pk_bf16_f32 v10, v12, v13
    v_lshlrev_b32 v12, 16, v10
    v_and_b32 v13, 0xffff0000, v10
    v_lshlrev_b32 v14, 16, v105
    v_and_b32 v15, 0xffff0000, v105
    v_pk_add_f32 v[12:13], v[12:13], v[14:15]
    v_cvt_pk_bf16_f32 v121, v12, v13
    v_cvt_pk_bf16_f32 v10, v52, v53
    v_lshlrev_b32 v12, 16, v10
    v_and_b32 v13, 0xffff0000, v10
    v_lshlrev_b32 v14, 16, v90
    v_and_b32 v15, 0xffff0000, v90
    v_pk_mul_f32 v[12:13], v[12:13], v[14:15]
    v_cvt_pk_bf16_f32 v10, v12, v13
    v_lshlrev_b32 v12, 16, v10
    v_and_b32 v13, 0xffff0000, v10
    v_lshlrev_b32 v14, 16, v106
    v_and_b32 v15, 0xffff0000, v106
    v_pk_add_f32 v[12:13], v[12:13], v[14:15]
    v_cvt_pk_bf16_f32 v122, v12, v13
    v_cvt_pk_bf16_f32 v10, v54, v55
    v_lshlrev_b32 v12, 16, v10
    v_and_b32 v13, 0xffff0000, v10
    v_lshlrev_b32 v14, 16, v91
    v_and_b32 v15, 0xffff0000, v91
    v_pk_mul_f32 v[12:13], v[12:13], v[14:15]
    v_cvt_pk_bf16_f32 v10, v12, v13
    v_lshlrev_b32 v12, 16, v10
    v_and_b32 v13, 0xffff0000, v10
    v_lshlrev_b32 v14, 16, v107
    v_and_b32 v15, 0xffff0000, v107
    v_pk_add_f32 v[12:13], v[12:13], v[14:15]
    v_cvt_pk_bf16_f32 v123, v12, v13
    v_cvt_pk_bf16_f32 v10, v56, v57
    v_lshlrev_b32 v12, 16, v10
    v_and_b32 v13, 0xffff0000, v10
    v_lshlrev_b32 v14, 16, v92
    v_and_b32 v15, 0xffff0000, v92
    v_pk_mul_f32 v[12:13], v[12:13], v[14:15]
    v_cvt_pk_bf16_f32 v10, v12, v13
    v_lshlrev_b32 v12, 16, v10
    v_and_b32 v13, 0xffff0000, v10
    v_lshlrev_b32 v14, 16, v108
    v_and_b32 v15, 0xffff0000, v108
    v_pk_add_f32 v[12:13], v[12:13], v[14:15]
    v_cvt_pk_bf16_f32 v124, v12, v13
    v_cvt_pk_bf16_f32 v10, v58, v59
    v_lshlrev_b32 v12, 16, v10
    v_and_b32 v13, 0xffff0000, v10
    v_lshlrev_b32 v14, 16, v93
    v_and_b32 v15, 0xffff0000, v93
    v_pk_mul_f32 v[12:13], v[12:13], v[14:15]
    v_cvt_pk_bf16_f32 v10, v12, v13
    v_lshlrev_b32 v12, 16, v10
    v_and_b32 v13, 0xffff0000, v10
    v_lshlrev_b32 v14, 16, v109
    v_and_b32 v15, 0xffff0000, v109
    v_pk_add_f32 v[12:13], v[12:13], v[14:15]
    v_cvt_pk_bf16_f32 v125, v12, v13
    v_cvt_pk_bf16_f32 v10, v60, v61
    v_lshlrev_b32 v12, 16, v10
    v_and_b32 v13, 0xffff0000, v10
    v_lshlrev_b32 v14, 16, v94
    v_and_b32 v15, 0xffff0000, v94
    v_pk_mul_f32 v[12:13], v[12:13], v[14:15]
    v_cvt_pk_bf16_f32 v10, v12, v13
    v_lshlrev_b32 v12, 16, v10
    v_and_b32 v13, 0xffff0000, v10
    v_lshlrev_b32 v14, 16, v110
    v_and_b32 v15, 0xffff0000, v110
    v_pk_add_f32 v[12:13], v[12:13], v[14:15]
    v_cvt_pk_bf16_f32 v126, v12, v13
    v_cvt_pk_bf16_f32 v10, v62, v63
    v_lshlrev_b32 v12, 16, v10
    v_and_b32 v13, 0xffff0000, v10
    v_lshlrev_b32 v14, 16, v95
    v_and_b32 v15, 0xffff0000, v95
    v_pk_mul_f32 v[12:13], v[12:13], v[14:15]
    v_cvt_pk_bf16_f32 v10, v12, v13
    v_lshlrev_b32 v12, 16, v10
    v_and_b32 v13, 0xffff0000, v10
    v_lshlrev_b32 v14, 16, v111
    v_and_b32 v15, 0xffff0000, v111
    v_pk_add_f32 v[12:13], v[12:13], v[14:15]
    v_cvt_pk_bf16_f32 v127, v12, v13
    s_branch k3_store
k3_rev:
    v_cvt_pk_bf16_f32 v10, v39, v38
    v_lshlrev_b32 v12, 16, v10
    v_and_b32 v13, 0xffff0000, v10
    v_lshlrev_b32 v14, 16, v80
    v_and_b32 v15, 0xffff0000, v80
    v_pk_mul_f32 v[12:13], v[12:13], v[14:15]
    v_cvt_pk_bf16_f32 v10, v12, v13
    v_lshlrev_b32 v12, 16, v10
    v_and_b32 v13, 0xffff0000, v10
    v_lshlrev_b32 v14, 16, v96
    v_and_b32 v15, 0xffff0000, v96
    v_pk_add_f32 v[12:13], v[12:13], v[14:15]
    v_cvt_pk_bf16_f32 v112, v12, v13
    v_cvt_pk_bf16_f32 v10, v37, v36
    v_lshlrev_b32 v12, 16, v10
    v_and_b32 v13, 0xffff0000, v10
    v_lshlrev_b32 v14, 16, v81
    v_and_b32 v15, 0xffff0000, v81
    v_pk_mul_f32 v[12:13], v[12:13], v[14:15]
    v_cvt_pk_bf16_f32 v10, v12, v13
    v_lshlrev_b32 v12, 16, v10
    v_and_b32 v13, 0xffff0000, v10
    v_lshlrev_b32 v14, 16, v97
    v_and_b32 v15, 0xffff0000, v97
    v_pk_add_f32 v[12:13], v[12:13], v[14:15]
    v_cvt_pk_bf16_f32 v113, v12, v13
    v_cvt_pk_bf16_f32 v10, v35, v34
    v_lshlrev_b32 v12, 16, v10
    v_and_b32 v13, 0xffff0000, v10
    v_lshlrev_b32 v14, 16, v82
    v_and_b32 v15, 0xffff0000, v82
    v_pk_mul_f32 v[12:13], v[12:13], v[14:15]
    v_cvt_pk_bf16_f32 v10, v12, v13
    v_lshlrev_b32 v12, 16, v10
    v_and_b32 v13, 0xffff0000, v10
    v_lshlrev_b32 v14, 16, v98
    v_and_b32 v15, 0xffff0000, v98
    v_pk_add_f32 v[12:13], v[12:13], v[14:15]
    v_cvt_pk_bf16_f32 v114, v12, v13
    v_cvt_pk_bf16_f32 v10, v33, v32
    v_lshlrev_b32 v12, 16, v10
    v_and_b32 v13, 0xffff0000, v10
    v_lshlrev_b32 v14, 16, v83
    v_and_b32 v15, 0xffff0000, v83
    v_pk_mul_f32 v[12:13], v[12:13], v[14:15]
    v_cvt_pk_bf16_f32 v10, v12, v13
    v_lshlrev_b32 v12, 16, v10
    v_and_b32 v13, 0xffff0000, v10
    v_lshlrev_b32 v14, 16, v99
    v_and_b32 v15, 0xffff0000, v99
    v_pk_add_f32 v[12:13], v[12:13], v[14:15]
    v_cvt_pk_bf16_f32 v115, v12, v13
    v_cvt_pk_bf16_f32 v10, v47, v46
    v_lshlrev_b32 v12, 16, v10
    v_and_b32 v13, 0xffff0000, v10
    v_lshlrev_b32 v14, 16, v84
    v_and_b32 v15, 0xffff0000, v84
    v_pk_mul_f32 v[12:13], v[12:13], v[14:15]
    v_cvt_pk_bf16_f32 v10, v12, v13
    v_lshlrev_b32 v12, 16, v10
    v_and_b32 v13, 0xffff0000, v10
    v_lshlrev_b32 v14, 16, v100
    v_and_b32 v15, 0xffff0000, v100
    v_pk_add_f32 v[12:13], v[12:13], v[14:15]
    v_cvt_pk_bf16_f32 v116, v12, v13
    v_cvt_pk_bf16_f32 v10, v45, v44
    v_lshlrev_b32 v12, 16, v10
    v_and_b32 v13, 0xffff0000, v10
    v_lshlrev_b32 v14, 16, v85
    v_and_b32 v15, 0xffff0000, v85
    v_pk_mul_f32 v[12:13], v[12:13], v[14:15]
    v_cvt_pk_bf16_f32 v10, v12, v13
    v_lshlrev_b32 v12, 16, v10
    v_and_b32 v13, 0xffff0000, v10
    v_lshlrev_b32 v14, 16, v101
    v_and_b32 v15, 0xffff0000, v101
    v_pk_add_f32 v[12:13], v[12:13], v[14:15]
    v_cvt_pk_bf16_f32 v117, v12, v13
    v_cvt_pk_bf16_f32 v10, v43, v42
    v_lshlrev_b32 v12, 16, v10
    v_and_b32 v13, 0xffff0000, v10
    v_lshlrev_b32 v14, 16, v86
    v_and_b32 v15, 0xffff0000, v86
    v_pk_mul_f32 v[12:13], v[12:13], v[14:15]
    v_cvt_pk_bf16_f32 v10, v12, v13
    v_lshlrev_b32 v12, 16, v10
    v_and_b32 v13, 0xffff0000, v10
    v_lshlrev_b32 v14, 16, v102
    v_and_b32 v15, 0xffff0000, v102
    v_pk_add_f32 v[12:13], v[12:13], v[14:15]
    v_cvt_pk_bf16_f32 v118, v12, v13
    v_cvt_pk_bf16_f32 v10, v41, v40
    v_lshlrev_b32 v12, 16, v10
    v_and_b32 v13, 0xffff0000, v10
    v_lshlrev_b32 v14, 16, v87
    v_and_b32 v15, 0xffff0000, v87
    v_pk_mul_f32 v[12:13], v[12:13], v[14:15]
    v_cvt_pk_bf16_f32 v10, v12, v13
    v_lshlrev_b32 v12, 16, v10
    v_and_b32 v13, 0xffff0000, v10
    v_lshlrev_b32 v14, 16, v103
    v_and_b32 v15, 0xffff0000, v103
    v_pk_add_f32 v[12:13], v[12:13], v[14:15]
    v_cvt_pk_bf16_f32 v119, v12, v13
    v_cvt_pk_bf16_f32 v10, v55, v54
    v_lshlrev_b32 v12, 16, v10
    v_and_b32 v13, 0xffff0000, v10
    v_lshlrev_b32 v14, 16, v88
    v_and_b32 v15, 0xffff0000, v88
    v_pk_mul_f32 v[12:13], v[12:13], v[14:15]
    v_cvt_pk_bf16_f32 v10, v12, v13
    v_lshlrev_b32 v12, 16, v10
    v_and_b32 v13, 0xffff0000, v10
    v_lshlrev_b32 v14, 16, v104
    v_and_b32 v15, 0xffff0000, v104
    v_pk_add_f32 v[12:13], v[12:13], v[14:15]
    v_cvt_pk_bf16_f32 v120, v12, v13
    v_cvt_pk_bf16_f32 v10, v53, v52
    v_lshlrev_b32 v12, 16, v10
    v_and_b32 v13, 0xffff0000, v10
    v_lshlrev_b32 v14, 16, v89
    v_and_b32 v15, 0xffff0000, v89
    v_pk_mul_f32 v[12:13], v[12:13], v[14:15]
    v_cvt_pk_bf16_f32 v10, v12, v13
    v_lshlrev_b32 v12, 16, v10
    v_and_b32 v13, 0xffff0000, v10
    v_lshlrev_b32 v14, 16, v105
    v_and_b32 v15, 0xffff0000, v105
    v_pk_add_f32 v[12:13], v[12:13], v[14:15]
    v_cvt_pk_bf16_f32 v121, v12, v13
    v_cvt_pk_bf16_f32 v10, v51, v50
    v_lshlrev_b32 v12, 16, v10
    v_and_b32 v13, 0xffff0000, v10
    v_lshlrev_b32 v14, 16, v90
    v_and_b32 v15, 0xffff0000, v90
    v_pk_mul_f32 v[12:13], v[12:13], v[14:15]
    v_cvt_pk_bf16_f32 v10, v12, v13
    v_lshlrev_b32 v12, 16, v10
    v_and_b32 v13, 0xffff0000, v10
    v_lshlrev_b32 v14, 16, v106
    v_and_b32 v15, 0xffff0000, v106
    v_pk_add_f32 v[12:13], v[12:13], v[14:15]
    v_cvt_pk_bf16_f32 v122, v12, v13
    v_cvt_pk_bf16_f32 v10, v49, v48
    v_lshlrev_b32 v12, 16, v10
    v_and_b32 v13, 0xffff0000, v10
    v_lshlrev_b32 v14, 16, v91
    v_and_b32 v15, 0xffff0000, v91
    v_pk_mul_f32 v[12:13], v[12:13], v[14:15]
    v_cvt_pk_bf16_f32 v10, v12, v13
    v_lshlrev_b32 v12, 16, v10
    v_and_b32 v13, 0xffff0000, v10
    v_lshlrev_b32 v14, 16, v107
    v_and_b32 v15, 0xffff0000, v107
    v_pk_add_f32 v[12:13], v[12:13], v[14:15]
    v_cvt_pk_bf16_f32 v123, v12, v13
    v_cvt_pk_bf16_f32 v10, v63, v62
    v_lshlrev_b32 v12, 16, v10
    v_and_b32 v13, 0xffff0000, v10
    v_lshlrev_b32 v14, 16, v92
    v_and_b32 v15, 0xffff0000, v92
    v_pk_mul_f32 v[12:13], v[12:13], v[14:15]
    v_cvt_pk_bf16_f32 v10, v12, v13
    v_lshlrev_b32 v12, 16, v10
    v_and_b32 v13, 0xffff0000, v10
    v_lshlrev_b32 v14, 16, v108
    v_and_b32 v15, 0xffff0000, v108
    v_pk_add_f32 v[12:13], v[12:13], v[14:15]
    v_cvt_pk_bf16_f32 v124, v12, v13
    v_cvt_pk_bf16_f32 v10, v61, v60
    v_lshlrev_b32 v12, 16, v10
    v_and_b32 v13, 0xffff0000, v10
    v_lshlrev_b32 v14, 16, v93
    v_and_b32 v15, 0xffff0000, v93
    v_pk_mul_f32 v[12:13], v[12:13], v[14:15]
    v_cvt_pk_bf16_f32 v10, v12, v13
    v_lshlrev_b32 v12, 16, v10
    v_and_b32 v13, 0xffff0000, v10
    v_lshlrev_b32 v14, 16, v109
    v_and_b32 v15, 0xffff0000, v109
    v_pk_add_f32 v[12:13], v[12:13], v[14:15]
    v_cvt_pk_bf16_f32 v125, v12, v13
    v_cvt_pk_bf16_f32 v10, v59, v58
    v_lshlrev_b32 v12, 16, v10
    v_and_b32 v13, 0xffff0000, v10
    v_lshlrev_b32 v14, 16, v94
    v_and_b32 v15, 0xffff0000, v94
    v_pk_mul_f32 v[12:13], v[12:13], v[14:15]
    v_cvt_pk_bf16_f32 v10, v12, v13
    v_lshlrev_b32 v12, 16, v10
    v_and_b32 v13, 0xffff0000, v10
    v_lshlrev_b32 v14, 16, v110
    v_and_b32 v15, 0xffff0000, v110
    v_pk_add_f32 v[12:13], v[12:13], v[14:15]
    v_cvt_pk_bf16_f32 v126, v12, v13
    v_cvt_pk_bf16_f32 v10, v57, v56
    v_lshlrev_b32 v12, 16, v10
    v_and_b32 v13, 0xffff0000, v10
    v_lshlrev_b32 v14, 16, v95
    v_and_b32 v15, 0xffff0000, v95
    v_pk_mul_f32 v[12:13], v[12:13], v[14:15]
    v_cvt_pk_bf16_f32 v10, v12, v13
    v_lshlrev_b32 v12, 16, v10
    v_and_b32 v13, 0xffff0000, v10
    v_lshlrev_b32 v14, 16, v111
    v_and_b32 v15, 0xffff0000, v111
    v_pk_add_f32 v[12:13], v[12:13], v[14:15]
    v_cvt_pk_bf16_f32 v127, v12, v13
k3_store:
    s_add_u32 s3, s56, 0
    buffer_store_dwordx4 v[112:115], v8, s[16:19], s3 offen
    s_add_u32 s3, s56, 5120
    buffer_store_dwordx4 v[116:119], v8, s[16:19], s3 offen
    s_add_u32 s3, s56, 40960
    buffer_store_dwordx4 v[120:123], v8, s[16:19], s3 offen
    s_add_u32 s3, s56, 46080
    buffer_store_dwordx4 v[124:127], v8, s[16:19], s3 offen
    s_endpgm
k1_aux:
    s_waitcnt lgkmcnt(0)
    s_add_u32 s96, s54, 7864320
    s_addc_u32 s97, s55, 0
    s_and_b32 s97, s97, 0xffff
    s_mov_b32 s98, 3072
    s_mov_b32 s99, 0x00020000
    s_sub_u32 s5, s5, 24
    s_lshl_b32 s5, s5, 3
    s_add_u32 s31, s5, s4
    s_lshr_b32 s30, s31, 1
    v_and_b32 v1, 63, v0
    v_lshrrev_b32 v2, 6, v0
    s_nop 0
    v_readfirstlane_b32 s24, v2
    s_nop 3
    s_cmp_lg_u32 s31, 63
    s_cbranch_scc1 aux_noinit
    v_lshlrev_b32 v2, 4, v0
    v_mov_b32 v4, 0
    v_mov_b32 v5, 0
    v_mov_b32 v6, 0
    v_mov_b32 v7, 0
    buffer_store_dwordx4 v[4:7], v2, s[96:99], 0 offen sc1
    s_waitcnt vmcnt(0)
    s_barrier
    v_cmp_eq_u32 vcc, 0, v0
    s_and_saveexec_b64 s[100:101], vcc
    s_cbranch_execz ini_39
    s_mov_b32 s92, s52
    s_and_b32 s93, s53, 0xffff
    s_mov_b32 s94, 256
    s_mov_b32 s95, 0x00020000
    v_mov_b32 v5, 1
    buffer_store_dword v5, v4, s[92:95], 0 offen offset:240 sc1
ini_39:
    s_mov_b64 exec, s[100:101]
aux_noinit:
    s_mov_b32 s8, s36
    s_and_b32 s9, s37, 0xffff
    s_mov_b32 s10, 2621440
    s_mov_b32 s11, 0x00020000
    s_and_b32 s28, s31, 7
    s_lshr_b32 s29, s31, 3
    v_lshrrev_b32 v2, 3, v0
    v_and_b32 v3, 7, v0
    v_and_b32 v4, 3, v2
    v_and_b32 v5, 4, v2
    v_lshl_add_u32 v4, v5, 1, v4
    s_and_b32 s3, s29, 3
    s_lshl_b32 s3, s3, 4
    s_and_b32 s33, s29, 4
    s_add_u32 s3, s3, s33
    v_add_u32 v4, s3, v4
    v_lshrrev_b32 v5, 3, v2
    v_lshl_add_u32 v4, v4, 5, v5
    s_lshl_b32 s3, s28, 2
    v_add_u32 v4, s3, v4
    s_mov_b32 s3, 1280
    v_mul_lo_u32 v4, v4, s3
    v_lshlrev_b32 v5, 3, v3
    v_add_u32 v6, v4, v5
    v_sub_u32 v7, v4, v5
    buffer_load_dwordx2 v[66:67], v6, s[8:11], 0 offen offset:0
    buffer_load_dwordx2 v[70:71], v7, s[8:11], 0 offen offset:632
    buffer_load_dwordx2 v[74:75], v6, s[8:11], 0 offen offset:640
    buffer_load_dwordx2 v[78:79], v7, s[8:11], 0 offen offset:1272
    buffer_load_dwordx2 v[82:83], v6, s[8:11], 0 offen offset:64
    buffer_load_dwordx2 v[86:87], v7, s[8:11], 0 offen offset:568
    buffer_load_dwordx2 v[90:91], v6, s[8:11], 0 offen offset:704
    buffer_load_dwordx2 v[94:95], v7, s[8:11], 0 offen offset:1208
    buffer_load_dwordx2 v[98:99], v6, s[8:11], 0 offen offset:128
    buffer_load_dwordx2 v[102:103], v7, s[8:11], 0 offen offset:504
    buffer_load_dwordx2 v[106:107], v6, s[8:11], 0 offen offset:768
    buffer_load_dwordx2 v[110:111], v7, s[8:11], 0 offen offset:1144
    buffer_load_dwordx2 v[114:115], v6, s[8:11], 0 offen offset:192
    buffer_load_dwordx2 v[118:119], v7, s[8:11], 0 offen offset:440
    buffer_load_dwordx2 v[122:123], v6, s[8:11], 0 offen offset:832
    buffer_load_dwordx2 v[126:127], v7, s[8:11], 0 offen offset:1080
    buffer_load_dwordx2 v[130:131], v6, s[8:11], 0 offen offset:256
    buffer_load_dwordx2 v[134:135], v7, s[8:11], 0 offen offset:376
    buffer_load_dwordx2 v[138:139], v6, s[8:11], 0 offen offset:896
    buffer_load_dwordx2 v[142:143], v7, s[8:11], 0 offen offset:1016
    s_mov_b32 s84, s38
    s_and_b32 s85, s39, 0xffff
    s_mov_b32 s86, 1314816
    s_mov_b32 s87, 0x00020000
    s_mov_b32 s88, s40
    s_and_b32 s89, s41, 0xffff
    s_mov_b32 s90, 1314816
    s_mov_b32 s91, 0x00020000
    s_and_b32 s25, s31, 1
    s_lshr_b32 s26, s31, 1
    s_and_b32 s26, s26, 3
    s_lshr_b32 s27, s31, 3
    s_and_b32 s27, s27, 1
    s_lshr_b32 s32, s31, 4
    s_lshl_b32 s3, s25, 5
    s_lshl_b32 s33, s26, 9
    s_add_u32 s3, s3, s33
    s_lshl_b32 s33, s27, 8
    s_add_u32 s3, s3, s33
    s_lshl_b32 s33, s32, 3
    s_add_u32 s3, s3, s33
    s_mul_i32 s82, s3, 642
    s_mul_i32 s33, s24, 41088
    s_add_u32 s82, s82, s33
    s_mul_i32 s83, s24, 6144
    s_add_u32 s83, s83, 114688
    s_lshl_b32 s3, s25, 2
    s_add_u32 s3, s3, s26
    s_lshl_b32 s3, s3, 10
    s_lshl_b32 s33, s27, 9
    s_add_u32 s3, s3, s33
    s_lshl_b32 s33, s32, 7
    s_add_u32 s34, s3, s33
    v_lshlrev_b32 v49, 4, v1
    s_bitcmp1_b32 s31, 0
    s_cbranch_scc1 aux_odd
    s_getpc_b64 s[12:13]
    s_add_u32 s12, s12, tab_ft@rel32@lo+4
    s_addc_u32 s13, s13, tab_ft@rel32@hi+12
    s_and_b32 s13, s13, 0xffff
    s_mov_b32 s14, 204800
    s_mov_b32 s15, 0x00020000
    v_lshlrev_b32 v48, 4, v1
    s_mul_i32 s25, s24, 51200
    s_add_u32 s16, s54, 8388608
    s_addc_u32 s17, s55, 0
    s_and_b32 s17, s17, 0xffff
    s_mov_b32 s18, 2621440
    s_mov_b32 s19, 0x00020000
    v_mul_u32_u24 v2, 336, v2
    v_add_u32 v2, v2, v5
    v_mov_b32 v4, 0
    v_mov_b32 v5, 0
    v_mov_b32 v8, 0
    v_mov_b32 v9, 0
    s_waitcnt vmcnt(19)
    v_lshlrev_b32 v64, 16, v66
    v_and_b32 v65, 0xffff0000, v66
    v_lshlrev_b32 v66, 16, v67
    v_and_b32 v67, 0xffff0000, v67
    v_pk_add_f32 v[4:5], v[4:5], v[64:65]
    v_pk_add_f32 v[4:5], v[4:5], v[66:67]
    s_waitcnt vmcnt(18)
    v_lshlrev_b32 v68, 16, v70
    v_and_b32 v69, 0xffff0000, v70
    v_lshlrev_b32 v70, 16, v71
    s_add_u32 m0, s83, 0
    s_add_u32 s35, s82, 0
    buffer_load_dwordx4 v49, s[84:87], s35 offen lds
    v_and_b32 v71, 0xffff0000, v71
    v_pk_add_f32 v[4:5], v[4:5], v[68:69]
    v_pk_add_f32 v[4:5], v[4:5], v[70:71]
    s_waitcnt vmcnt(18)
    v_lshlrev_b32 v72, 16, v74
    v_and_b32 v73, 0xffff0000, v74
    v_lshlrev_b32 v74, 16, v75
    v_and_b32 v75, 0xffff0000, v75
    v_pk_add_f32 v[4:5], v[4:5], v[72:73]
    v_pk_add_f32 v[4:5], v[4:5], v[74:75]
    s_add_u32 m0, s83, 1024
    s_add_u32 s35, s82, 1024
    buffer_load_dwordx4 v49, s[84:87], s35 offen lds
    s_waitcnt vmcnt(18)
    v_lshlrev_b32 v76, 16, v78
    v_and_b32 v77, 0xffff0000, v78
    v_lshlrev_b32 v78, 16, v79
    v_and_b32 v79, 0xffff0000, v79
    v_pk_add_f32 v[4:5], v[4:5], v[76:77]
    v_pk_add_f32 v[4:5], v[4:5], v[78:79]
    s_waitcnt vmcnt(17)
    v_lshlrev_b32 v80, 16, v82
    v_and_b32 v81, 0xffff0000, v82
    v_lshlrev_b32 v82, 16, v83
    s_add_u32 m0, s83, 2048
    s_add_u32 s35, s82, 2048
    buffer_load_dwordx4 v49, s[84:87], s35 offen lds
    v_and_b32 v83, 0xffff0000, v83
    v_pk_add_f32 v[4:5], v[4:5], v[80:81]
    v_pk_add_f32 v[4:5], v[4:5], v[82:83]
    s_waitcnt vmcnt(17)
    v_lshlrev_b32 v84, 16, v86
    v_and_b32 v85, 0xffff0000, v86
    v_lshlrev_b32 v86, 16, v87
    v_and_b32 v87, 0xffff0000, v87
    v_pk_add_f32 v[4:5], v[4:5], v[84:85]
    v_pk_add_f32 v[4:5], v[4:5], v[86:87]
    s_add_u32 m0, s83, 3072
    s_add_u32 s35, s82, 3072
    buffer_load_dwordx4 v49, s[84:87], s35 offen lds
    s_waitcnt vmcnt(17)
    v_lshlrev_b32 v88, 16, v90
    v_and_b32 v89, 0xffff0000, v90
    v_lshlrev_b32 v90, 16, v91
    v_and_b32 v91, 0xffff0000, v91
    v_pk_add_f32 v[4:5], v[4:5], v[88:89]
    v_pk_add_f32 v[4:5], v[4:5], v[90:91]
    s_waitcnt vmcnt(16)
    v_lshlrev_b32 v92, 16, v94
    v_and_b32 v93, 0xffff0000, v94
    v_lshlrev_b32 v94, 16, v95
    s_add_u32 m0, s83, 4096
    s_add_u32 s35, s82, 4096
    buffer_load_dwordx4 v49, s[84:87], s35 offen lds
    v_and_b32 v95, 0xffff0000, v95
    v_pk_add_f32 v[4:5], v[4:5], v[92:93]
    v_pk_add_f32 v[4:5], v[4:5], v[94:95]
    s_waitcnt vmcnt(16)
    v_lshlrev_b32 v96, 16, v98
    v_and_b32 v97, 0xffff0000, v98
    v_lshlrev_b32 v98, 16, v99
    v_and_b32 v99, 0xffff0000, v99
    v_pk_add_f32 v[4:5], v[4:5], v[96:97]
    v_pk_add_f32 v[4:5], v[4:5], v[98:99]
    s_add_u32 m0, s83, 5120
    s_add_u32 s35, s82, 5120
    buffer_load_dwordx4 v49, s[84:87], s35 offen lds
    s_waitcnt vmcnt(16)
    v_lshlrev_b32 v100, 16, v102
    v_and_b32 v101, 0xffff0000, v102
    v_lshlrev_b32 v102, 16, v103
    v_and_b32 v103, 0xffff0000, v103
    v_pk_add_f32 v[4:5], v[4:5], v[100:101]
    v_pk_add_f32 v[4:5], v[4:5], v[102:103]
    s_waitcnt vmcnt(15)
    v_lshlrev_b32 v104, 16, v106
    v_and_b32 v105, 0xffff0000, v106
    v_lshlrev_b32 v106, 16, v107
    s_add_u32 m0, s83, 24576
    s_add_u32 s35, s82, 0
    buffer_load_dwordx4 v49, s[88:91], s35 offen lds
    v_and_b32 v107, 0xffff0000, v107
    v_pk_add_f32 v[4:5], v[4:5], v[104:105]
    v_pk_add_f32 v[4:5], v[4:5], v[106:107]
    s_waitcnt vmcnt(15)
    v_lshlrev_b32 v108, 16, v110
    v_and_b32 v109, 0xffff0000, v110
    v_lshlrev_b32 v110, 16, v111
    v_and_b32 v111, 0xffff0000, v111
    v_pk_add_f32 v[4:5], v[4:5], v[108:109]
    v_pk_add_f32 v[4:5], v[4:5], v[110:111]
    s_add_u32 m0, s83, 25600
    s_add_u32 s35, s82, 1024
    buffer_load_dwordx4 v49, s[88:91], s35 offen lds
    s_waitcnt vmcnt(15)
    v_lshlrev_b32 v112, 16, v114
    v_and_b32 v113, 0xffff0000, v114
    v_lshlrev_b32 v114, 16, v115
    v_and_b32 v115, 0xffff0000, v115
    v_pk_add_f32 v[4:5], v[4:5], v[112:113]
    v_pk_add_f32 v[4:5], v[4:5], v[114:115]
    s_waitcnt vmcnt(14)
    v_lshlrev_b32 v116, 16, v118
    v_and_b32 v117, 0xffff0000, v118
    v_lshlrev_b32 v118, 16, v119
    s_add_u32 m0, s83, 26624
    s_add_u32 s35, s82, 2048
    buffer_load_dwordx4 v49, s[88:91], s35 offen lds
    v_and_b32 v119, 0xffff0000, v119
    v_pk_add_f32 v[4:5], v[4:5], v[116:117]
    v_pk_add_f32 v[4:5], v[4:5], v[118:119]
    s_waitcnt vmcnt(14)
    v_lshlrev_b32 v120, 16, v122
    v_and_b32 v121, 0xffff0000, v122
    v_lshlrev_b32 v122, 16, v123
    v_and_b32 v123, 0xffff0000, v123
    v_pk_add_f32 v[4:5], v[4:5], v[120:121]
    v_pk_add_f32 v[4:5], v[4:5], v[122:123]
    s_add_u32 m0, s83, 27648
    s_add_u32 s35, s82, 3072
    buffer_load_dwordx4 v49, s[88:91], s35 offen lds
    s_waitcnt vmcnt(14)
    v_lshlrev_b32 v124, 16, v126
    v_and_b32 v125, 0xffff0000, v126
    v_lshlrev_b32 v126, 16, v127
    v_and_b32 v127, 0xffff0000, v127
    v_pk_add_f32 v[4:5], v[4:5], v[124:125]
    v_pk_add_f32 v[4:5], v[4:5], v[126:127]
    s_waitcnt vmcnt(13)
    v_lshlrev_b32 v128, 16, v130
    v_and_b32 v129, 0xffff0000, v130
    v_lshlrev_b32 v130, 16, v131
    s_add_u32 m0, s83, 28672
    s_add_u32 s35, s82, 4096
    buffer_load_dwordx4 v49, s[88:91], s35 offen lds
    v_and_b32 v131, 0xffff0000, v131
    v_pk_add_f32 v[4:5], v[4:5], v[128:129]
    v_pk_add_f32 v[4:5], v[4:5], v[130:131]
    s_waitcnt vmcnt(13)
    v_lshlrev_b32 v132, 16, v134
    v_and_b32 v133, 0xffff0000, v134
    v_lshlrev_b32 v134, 16, v135
    v_and_b32 v135, 0xffff0000, v135
    v_pk_add_f32 v[4:5], v[4:5], v[132:133]
    v_pk_add_f32 v[4:5], v[4:5], v[134:135]
    s_add_u32 m0, s83, 29696
    s_add_u32 s35, s82, 5120
    buffer_load_dwordx4 v49, s[88:91], s35 offen lds
    s_waitcnt vmcnt(13)
    v_lshlrev_b32 v136, 16, v138
    v_and_b32 v137, 0xffff0000, v138
    v_lshlrev_b32 v138, 16, v139
    v_and_b32 v139, 0xffff0000, v139
    v_pk_add_f32 v[4:5], v[4:5], v[136:137]
    v_pk_add_f32 v[4:5], v[4:5], v[138:139]
    s_waitcnt vmcnt(12)
    v_lshlrev_b32 v140, 16, v142
    v_and_b32 v141, 0xffff0000, v142
    v_lshlrev_b32 v142, 16, v143
    buffer_load_dwordx4 a[0:3], v48, s[12:15], s25 offen offset:0
    v_and_b32 v143, 0xffff0000, v143
    v_pk_add_f32 v[4:5], v[4:5], v[140:141]
    v_pk_add_f32 v[4:5], v[4:5], v[142:143]
    v_add_f32 v4, v4, v5
    s_nop 1
    v_add_f32_dpp v4, v4, v4 quad_perm:[1,0,3,2] row_mask:0xf bank_mask:0xf
    s_nop 1
    v_add_f32_dpp v4, v4, v4 quad_perm:[2,3,0,1] row_mask:0xf bank_mask:0xf
    s_nop 1
    v_add_f32_dpp v4, v4, v4 row_half_mirror row_mask:0xf bank_mask:0xf
    s_mov_b32 s26, 0x3acccccd
    v_mul_f32 v4, s26, v4
    v_cvt_pk_bf16_f32 v6, v4, v4
    v_lshlrev_b32 v6, 16, v6
    v_sub_f32 v5, v4, v6
    v_xor_b32 v6, 0x80000000, v6
    v_pk_add_f32 v[64:65], v[64:65], v[6:7] op_sel_hi:[1,0]
    v_pk_fma_f32 v[8:9], v[64:65], v[64:65], v[8:9]
    v_pk_add_f32 v[66:67], v[66:67], v[6:7] op_sel_hi:[1,0]
    v_pk_fma_f32 v[8:9], v[66:67], v[66:67], v[8:9]
    v_pk_add_f32 v[68:69], v[68:69], v[6:7] op_sel_hi:[1,0]
    v_pk_fma_f32 v[8:9], v[68:69], v[68:69], v[8:9]
    buffer_load_dwordx4 a[4:7], v48, s[12:15], s25 offen offset:1024
    v_pk_add_f32 v[70:71], v[70:71], v[6:7] op_sel_hi:[1,0]
    v_pk_fma_f32 v[8:9], v[70:71], v[70:71], v[8:9]
    v_pk_add_f32 v[72:73], v[72:73], v[6:7] op_sel_hi:[1,0]
    v_pk_fma_f32 v[8:9], v[72:73], v[72:73], v[8:9]
    v_pk_add_f32 v[74:75], v[74:75], v[6:7] op_sel_hi:[1,0]
    v_pk_fma_f32 v[8:9], v[74:75], v[74:75], v[8:9]
    v_pk_add_f32 v[76:77], v[76:77], v[6:7] op_sel_hi:[1,0]
    v_pk_fma_f32 v[8:9], v[76:77], v[76:77], v[8:9]
    v_pk_add_f32 v[78:79], v[78:79], v[6:7] op_sel_hi:[1,0]
    buffer_load_dwordx4 a[8:11], v48, s[12:15], s25 offen offset:2048
    v_pk_fma_f32 v[8:9], v[78:79], v[78:79], v[8:9]
    v_pk_add_f32 v[80:81], v[80:81], v[6:7] op_sel_hi:[1,0]
    v_pk_fma_f32 v[8:9], v[80:81], v[80:81], v[8:9]
    v_pk_add_f32 v[82:83], v[82:83], v[6:7] op_sel_hi:[1,0]
    v_pk_fma_f32 v[8:9], v[82:83], v[82:83], v[8:9]
    v_pk_add_f32 v[84:85], v[84:85], v[6:7] op_sel_hi:[1,0]
    v_pk_fma_f32 v[8:9], v[84:85], v[84:85], v[8:9]
    v_pk_add_f32 v[86:87], v[86:87], v[6:7] op_sel_hi:[1,0]
    v_pk_fma_f32 v[8:9], v[86:87], v[86:87], v[8:9]
    buffer_load_dwordx4 a[12:15], v48, s[12:15], s25 offen offset:3072
    v_pk_add_f32 v[88:89], v[88:89], v[6:7] op_sel_hi:[1,0]
    v_pk_fma_f32 v[8:9], v[88:89], v[88:89], v[8:9]
    v_pk_add_f32 v[90:91], v[90:91], v[6:7] op_sel_hi:[1,0]
    v_pk_fma_f32 v[8:9], v[90:91], v[90:91], v[8:9]
    v_pk_add_f32 v[92:93], v[92:93], v[6:7] op_sel_hi:[1,0]
    v_pk_fma_f32 v[8:9], v[92:93], v[92:93], v[8:9]
    v_pk_add_f32 v[94:95], v[94:95], v[6:7] op_sel_hi:[1,0]
    v_pk_fma_f32 v[8:9], v[94:95], v[94:95], v[8:9]
    v_pk_add_f32 v[96:97], v[96:97], v[6:7] op_sel_hi:[1,0]
    s_add_u32 s25, s25, 4096
    buffer_load_dwordx4 a[16:19], v48, s[12:15], s25 offen offset:0
    v_pk_fma_f32 v[8:9], v[96:97], v[96:97], v[8:9]
    v_pk_add_f32 v[98:99], v[98:99], v[6:7] op_sel_hi:[1,0]
    v_pk_fma_f32 v[8:9], v[98:99], v[98:99], v[8:9]
    v_pk_add_f32 v[100:101], v[100:101], v[6:7] op_sel_hi:[1,0]
    v_pk_fma_f32 v[8:9], v[100:101], v[100:101], v[8:9]
    v_pk_add_f32 v[102:103], v[102:103], v[6:7] op_sel_hi:[1,0]
    v_pk_fma_f32 v[8:9], v[102:103], v[102:103], v[8:9]
    v_pk_add_f32 v[104:105], v[104:105], v[6:7] op_sel_hi:[1,0]
    v_pk_fma_f32 v[8:9], v[104:105], v[104:105], v[8:9]
    buffer_load_dwordx4 a[20:23], v48, s[12:15], s25 offen offset:1024
    v_pk_add_f32 v[106:107], v[106:107], v[6:7] op_sel_hi:[1,0]
    v_pk_fma_f32 v[8:9], v[106:107], v[106:107], v[8:9]
    v_pk_add_f32 v[108:109], v[108:109], v[6:7] op_sel_hi:[1,0]
    v_pk_fma_f32 v[8:9], v[108:109], v[108:109], v[8:9]
    v_pk_add_f32 v[110:111], v[110:111], v[6:7] op_sel_hi:[1,0]
    v_pk_fma_f32 v[8:9], v[110:111], v[110:111], v[8:9]
    v_pk_add_f32 v[112:113], v[112:113], v[6:7] op_sel_hi:[1,0]
    v_pk_fma_f32 v[8:9], v[112:113], v[112:113], v[8:9]
    v_pk_add_f32 v[114:115], v[114:115], v[6:7] op_sel_hi:[1,0]
    buffer_load_dwordx4 a[24:27], v48, s[12:15], s25 offen offset:2048
    v_pk_fma_f32 v[8:9], v[114:115], v[114:115], v[8:9]
    v_pk_add_f32 v[116:117], v[116:117], v[6:7] op_sel_hi:[1,0]
    v_pk_fma_f32 v[8:9], v[116:117], v[116:117], v[8:9]
    v_pk_add_f32 v[118:119], v[118:119], v[6:7] op_sel_hi:[1,0]
    v_pk_fma_f32 v[8:9], v[118:119], v[118:119], v[8:9]
    v_pk_add_f32 v[120:121], v[120:121], v[6:7] op_sel_hi:[1,0]
    v_pk_fma_f32 v[8:9], v[120:121], v[120:121], v[8:9]
    v_pk_add_f32 v[122:123], v[122:123], v[6:7] op_sel_hi:[1,0]
    v_pk_fma_f32 v[8:9], v[122:123], v[122:123], v[8:9]
    buffer_load_dwordx4 a[28:31], v48, s[12:15], s25 offen offset:3072
    v_pk_add_f32 v[124:125], v[124:125], v[6:7] op_sel_hi:[1,0]
    v_pk_fma_f32 v[8:9], v[124:125], v[124:125], v[8:9]
    v_pk_add_f32 v[126:127], v[126:127], v[6:7] op_sel_hi:[1,0]
    v_pk_fma_f32 v[8:9], v[126:127], v[126:127], v[8:9]
    v_pk_add_f32 v[128:129], v[128:129], v[6:7] op_sel_hi:[1,0]
    v_pk_fma_f32 v[8:9], v[128:129], v[128:129], v[8:9]
    v_pk_add_f32 v[130:131], v[130:131], v[6:7] op_sel_hi:[1,0]
    v_pk_fma_f32 v[8:9], v[130:131], v[130:131], v[8:9]
    v_pk_add_f32 v[132:133], v[132:133], v[6:7] op_sel_hi:[1,0]
    s_add_u32 s25, s25, 4096
    buffer_load_dwordx4 a[32:35], v48, s[12:15], s25 offen offset:0
    v_pk_fma_f32 v[8:9], v[132:133], v[132:133], v[8:9]
    v_pk_add_f32 v[134:135], v[134:135], v[6:7] op_sel_hi:[1,0]
    v_pk_fma_f32 v[8:9], v[134:135], v[134:135], v[8:9]
    v_pk_add_f32 v[136:137], v[136:137], v[6:7] op_sel_hi:[1,0]
    v_pk_fma_f32 v[8:9], v[136:137], v[136:137], v[8:9]
    v_pk_add_f32 v[138:139], v[138:139], v[6:7] op_sel_hi:[1,0]
    v_pk_fma_f32 v[8:9], v[138:139], v[138:139], v[8:9]
    v_pk_add_f32 v[140:141], v[140:141], v[6:7] op_sel_hi:[1,0]
    v_pk_fma_f32 v[8:9], v[140:141], v[140:141], v[8:9]
    buffer_load_dwordx4 a[36:39], v48, s[12:15], s25 offen offset:1024
    v_pk_add_f32 v[142:143], v[142:143], v[6:7] op_sel_hi:[1,0]
    v_pk_fma_f32 v[8:9], v[142:143], v[142:143], v[8:9]
    v_add_f32 v8, v8, v9
    s_nop 1
    v_add_f32_dpp v8, v8, v8 quad_perm:[1,0,3,2] row_mask:0xf bank_mask:0xf
    s_nop 1
    v_add_f32_dpp v8, v8, v8 quad_perm:[2,3,0,1] row_mask:0xf bank_mask:0xf
    s_nop 1
    v_add_f32_dpp v8, v8, v8 row_half_mirror row_mask:0xf bank_mask:0xf
    v_mul_f32 v8, s26, v8
    v_fma_f32 v8, -v5, v5, v8
    v_max_f32 v8, 0, v8
    v_cvt_pk_bf16_f32 v8, v8, v8
    v_lshlrev_b32 v8, 16, v8
    v_add_f32 v8, 0x3727c5ac, v8
    v_cvt_pk_bf16_f32 v8, v8, v8
    v_lshlrev_b32 v8, 16, v8
    v_sqrt_f32 v8, v8
    s_nop 0
    v_cvt_pk_bf16_f32 v8, v8, v8
    v_lshlrev_b32 v8, 16, v8
    v_rcp_f32 v8, v8
    s_nop 0
    v_cvt_pk_bf16_f32 v10, v64, v65
    v_lshlrev_b32 v64, 16, v10
    v_and_b32 v65, 0xffff0000, v10
    v_pk_mul_f32 v[64:65], v[64:65], v[8:9] op_sel_hi:[1,0]
    v_cvt_pk_bf16_f32 v10, v64, v65
    v_lshlrev_b32 v64, 16, v10
    v_and_b32 v65, 0xffff0000, v10
    buffer_load_dwordx4 a[40:43], v48, s[12:15], s25 offen offset:2048
    v_cvt_pk_bf16_f32 v10, v66, v67
    v_lshlrev_b32 v66, 16, v10
    v_and_b32 v67, 0xffff0000, v10
    v_pk_mul_f32 v[66:67], v[66:67], v[8:9] op_sel_hi:[1,0]
    v_cvt_pk_bf16_f32 v10, v66, v67
    v_lshlrev_b32 v66, 16, v10
    v_and_b32 v67, 0xffff0000, v10
    v_cvt_pk_bf16_f32 v10, v68, v69
    v_lshlrev_b32 v68, 16, v10
    buffer_load_dwordx4 a[44:47], v48, s[12:15], s25 offen offset:3072
    v_and_b32 v69, 0xffff0000, v10
    v_pk_mul_f32 v[68:69], v[68:69], v[8:9] op_sel_hi:[1,0]
    v_cvt_pk_bf16_f32 v10, v68, v69
    v_lshlrev_b32 v68, 16, v10
    v_and_b32 v69, 0xffff0000, v10
    v_cvt_pk_bf16_f32 v10, v70, v71
    v_lshlrev_b32 v70, 16, v10
    v_and_b32 v71, 0xffff0000, v10
    v_pk_mul_f32 v[70:71], v[70:71], v[8:9] op_sel_hi:[1,0]
    s_add_u32 s25, s25, 4096
    buffer_load_dwordx4 a[48:51], v48, s[12:15], s25 offen offset:0
    v_cvt_pk_bf16_f32 v10, v70, v71
    v_lshlrev_b32 v70, 16, v10
    v_and_b32 v71, 0xffff0000, v10
    v_cvt_pk_bf16_f32 v10, v72, v73
    v_lshlrev_b32 v72, 16, v10
    v_and_b32 v73, 0xffff0000, v10
    v_pk_mul_f32 v[72:73], v[72:73], v[8:9] op_sel_hi:[1,0]
    v_cvt_pk_bf16_f32 v10, v72, v73
    v_lshlrev_b32 v72, 16, v10
    buffer_load_dwordx4 a[52:55], v48, s[12:15], s25 offen offset:1024
    v_and_b32 v73, 0xffff0000, v10
    v_cvt_pk_bf16_f32 v10, v74, v75
    v_lshlrev_b32 v74, 16, v10
    v_and_b32 v75, 0xffff0000, v10
    v_pk_mul_f32 v[74:75], v[74:75], v[8:9] op_sel_hi:[1,0]
    v_cvt_pk_bf16_f32 v10, v74, v75
    v_lshlrev_b32 v74, 16, v10
    v_and_b32 v75, 0xffff0000, v10
    v_cvt_pk_bf16_f32 v10, v76, v77
    buffer_load_dwordx4 a[56:59], v48, s[12:15], s25 offen offset:2048
    v_lshlrev_b32 v76, 16, v10
    v_and_b32 v77, 0xffff0000, v10
    v_pk_mul_f32 v[76:77], v[76:77], v[8:9] op_sel_hi:[1,0]
    v_cvt_pk_bf16_f32 v10, v76, v77
    v_lshlrev_b32 v76, 16, v10
    v_and_b32 v77, 0xffff0000, v10
    v_cvt_pk_bf16_f32 v10, v78, v79
    v_lshlrev_b32 v78, 16, v10
    v_and_b32 v79, 0xffff0000, v10
    buffer_load_dwordx4 a[60:63], v48, s[12:15], s25 offen offset:3072
    v_pk_mul_f32 v[78:79], v[78:79], v[8:9] op_sel_hi:[1,0]
    v_cvt_pk_bf16_f32 v10, v78, v79
    v_lshlrev_b32 v78, 16, v10
    v_and_b32 v79, 0xffff0000, v10
    v_cvt_pk_bf16_f32 v10, v80, v81
    v_lshlrev_b32 v80, 16, v10
    v_and_b32 v81, 0xffff0000, v10
    v_pk_mul_f32 v[80:81], v[80:81], v[8:9] op_sel_hi:[1,0]
    v_cvt_pk_bf16_f32 v10, v80, v81
    s_add_u32 s25, s25, 4096
    buffer_load_dwordx4 a[64:67], v48, s[12:15], s25 offen offset:0
    v_lshlrev_b32 v80, 16, v10
    v_and_b32 v81, 0xffff0000, v10
    v_cvt_pk_bf16_f32 v10, v82, v83
    v_lshlrev_b32 v82, 16, v10
    v_and_b32 v83, 0xffff0000, v10
    v_pk_mul_f32 v[82:83], v[82:83], v[8:9] op_sel_hi:[1,0]
    v_cvt_pk_bf16_f32 v10, v82, v83
    v_lshlrev_b32 v82, 16, v10
    v_and_b32 v83, 0xffff0000, v10
    buffer_load_dwordx4 a[68:71], v48, s[12:15], s25 offen offset:1024
    v_cvt_pk_bf16_f32 v10, v84, v85
    v_lshlrev_b32 v84, 16, v10
    v_and_b32 v85, 0xffff0000, v10
    v_pk_mul_f32 v[84:85], v[84:85], v[8:9] op_sel_hi:[1,0]
    v_cvt_pk_bf16_f32 v10, v84, v85
    v_lshlrev_b32 v84, 16, v10
    v_and_b32 v85, 0xffff0000, v10
    v_cvt_pk_bf16_f32 v10, v86, v87
    v_lshlrev_b32 v86, 16, v10
    buffer_load_dwordx4 a[72:75], v48, s[12:15], s25 offen offset:2048
    v_and_b32 v87, 0xffff0000, v10
    v_pk_mul_f32 v[86:87], v[86:87], v[8:9] op_sel_hi:[1,0]
    v_cvt_pk_bf16_f32 v10, v86, v87
    v_lshlrev_b32 v86, 16, v10
    v_and_b32 v87, 0xffff0000, v10
    v_cvt_pk_bf16_f32 v10, v88, v89
    v_lshlrev_b32 v88, 16, v10
    v_and_b32 v89, 0xffff0000, v10
    v_pk_mul_f32 v[88:89], v[88:89], v[8:9] op_sel_hi:[1,0]
    buffer_load_dwordx4 a[76:79], v48, s[12:15], s25 offen offset:3072
    v_cvt_pk_bf16_f32 v10, v88, v89
    v_lshlrev_b32 v88, 16, v10
    v_and_b32 v89, 0xffff0000, v10
    v_cvt_pk_bf16_f32 v10, v90, v91
    v_lshlrev_b32 v90, 16, v10
    v_and_b32 v91, 0xffff0000, v10
    v_pk_mul_f32 v[90:91], v[90:91], v[8:9] op_sel_hi:[1,0]
    v_cvt_pk_bf16_f32 v10, v90, v91
    v_lshlrev_b32 v90, 16, v10
    s_add_u32 s25, s25, 4096
    buffer_load_dwordx4 a[80:83], v48, s[12:15], s25 offen offset:0
    v_and_b32 v91, 0xffff0000, v10
    v_cvt_pk_bf16_f32 v10, v92, v93
    v_lshlrev_b32 v92, 16, v10
    v_and_b32 v93, 0xffff0000, v10
    v_pk_mul_f32 v[92:93], v[92:93], v[8:9] op_sel_hi:[1,0]
    v_cvt_pk_bf16_f32 v10, v92, v93
    v_lshlrev_b32 v92, 16, v10
    v_and_b32 v93, 0xffff0000, v10
    v_cvt_pk_bf16_f32 v10, v94, v95
    buffer_load_dwordx4 a[84:87], v48, s[12:15], s25 offen offset:1024
    v_lshlrev_b32 v94, 16, v10
    v_and_b32 v95, 0xffff0000, v10
    v_pk_mul_f32 v[94:95], v[94:95], v[8:9] op_sel_hi:[1,0]
    v_cvt_pk_bf16_f32 v10, v94, v95
    v_lshlrev_b32 v94, 16, v10
    v_and_b32 v95, 0xffff0000, v10
    v_cvt_pk_bf16_f32 v10, v96, v97
    v_lshlrev_b32 v96, 16, v10
    v_and_b32 v97, 0xffff0000, v10
    buffer_load_dwordx4 a[88:91], v48, s[12:15], s25 offen offset:2048
    v_pk_mul_f32 v[96:97], v[96:97], v[8:9] op_sel_hi:[1,0]
    v_cvt_pk_bf16_f32 v10, v96, v97
    v_lshlrev_b32 v96, 16, v10
    v_and_b32 v97, 0xffff0000, v10
    v_cvt_pk_bf16_f32 v10, v98, v99
    v_lshlrev_b32 v98, 16, v10
    v_and_b32 v99, 0xffff0000, v10
    v_pk_mul_f32 v[98:99], v[98:99], v[8:9] op_sel_hi:[1,0]
    v_cvt_pk_bf16_f32 v10, v98, v99
    buffer_load_dwordx4 a[92:95], v48, s[12:15], s25 offen offset:3072
    v_lshlrev_b32 v98, 16, v10
    v_and_b32 v99, 0xffff0000, v10
    v_cvt_pk_bf16_f32 v10, v100, v101
    v_lshlrev_b32 v100, 16, v10
    v_and_b32 v101, 0xffff0000, v10
    v_pk_mul_f32 v[100:101], v[100:101], v[8:9] op_sel_hi:[1,0]
    v_cvt_pk_bf16_f32 v10, v100, v101
    v_lshlrev_b32 v100, 16, v10
    v_and_b32 v101, 0xffff0000, v10
    s_add_u32 s25, s25, 4096
    buffer_load_dwordx4 a[96:99], v48, s[12:15], s25 offen offset:0
    v_cvt_pk_bf16_f32 v10, v102, v103
    v_lshlrev_b32 v102, 16, v10
    v_and_b32 v103, 0xffff0000, v10
    v_pk_mul_f32 v[102:103], v[102:103], v[8:9] op_sel_hi:[1,0]
    v_cvt_pk_bf16_f32 v10, v102, v103
    v_lshlrev_b32 v102, 16, v10
    v_and_b32 v103, 0xffff0000, v10
    v_cvt_pk_bf16_f32 v10, v104, v105
    v_lshlrev_b32 v104, 16, v10
    buffer_load_dwordx4 a[100:103], v48, s[12:15], s25 offen offset:1024
    v_and_b32 v105, 0xffff0000, v10
    v_pk_mul_f32 v[104:105], v[104:105], v[8:9] op_sel_hi:[1,0]
    v_cvt_pk_bf16_f32 v10, v104, v105
    v_lshlrev_b32 v104, 16, v10
    v_and_b32 v105, 0xffff0000, v10
    v_cvt_pk_bf16_f32 v10, v106, v107
    v_lshlrev_b32 v106, 16, v10
    v_and_b32 v107, 0xffff0000, v10
    v_pk_mul_f32 v[106:107], v[106:107], v[8:9] op_sel_hi:[1,0]
    buffer_load_dwordx4 a[104:107], v48, s[12:15], s25 offen offset:2048
    v_cvt_pk_bf16_f32 v10, v106, v107
    v_lshlrev_b32 v106, 16, v10
    v_and_b32 v107, 0xffff0000, v10
    v_cvt_pk_bf16_f32 v10, v108, v109
    v_lshlrev_b32 v108, 16, v10
    v_and_b32 v109, 0xffff0000, v10
    v_pk_mul_f32 v[108:109], v[108:109], v[8:9] op_sel_hi:[1,0]
    v_cvt_pk_bf16_f32 v10, v108, v109
    v_lshlrev_b32 v108, 16, v10
    buffer_load_dwordx4 a[108:111], v48, s[12:15], s25 offen offset:3072
    v_and_b32 v109, 0xffff0000, v10
    v_cvt_pk_bf16_f32 v10, v110, v111
    v_lshlrev_b32 v110, 16, v10
    v_and_b32 v111, 0xffff0000, v10
    v_pk_mul_f32 v[110:111], v[110:111], v[8:9] op_sel_hi:[1,0]
    v_cvt_pk_bf16_f32 v10, v110, v111
    v_lshlrev_b32 v110, 16, v10
    v_and_b32 v111, 0xffff0000, v10
    v_cvt_pk_bf16_f32 v10, v112, v113
    s_add_u32 s25, s25, 4096
    buffer_load_dwordx4 a[112:115], v48, s[12:15], s25 offen offset:0
    v_lshlrev_b32 v112, 16, v10
    v_and_b32 v113, 0xffff0000, v10
    v_pk_mul_f32 v[112:113], v[112:113], v[8:9] op_sel_hi:[1,0]
    v_cvt_pk_bf16_f32 v10, v112, v113
    v_lshlrev_b32 v112, 16, v10
    v_and_b32 v113, 0xffff0000, v10
    v_cvt_pk_bf16_f32 v10, v114, v115
    v_lshlrev_b32 v114, 16, v10
    v_and_b32 v115, 0xffff0000, v10
    buffer_load_dwordx4 a[116:119], v48, s[12:15], s25 offen offset:1024
    v_pk_mul_f32 v[114:115], v[114:115], v[8:9] op_sel_hi:[1,0]
    v_cvt_pk_bf16_f32 v10, v114, v115
    v_lshlrev_b32 v114, 16, v10
    v_and_b32 v115, 0xffff0000, v10
    v_cvt_pk_bf16_f32 v10, v116, v117
    v_lshlrev_b32 v116, 16, v10
    v_and_b32 v117, 0xffff0000, v10
    v_pk_mul_f32 v[116:117], v[116:117], v[8:9] op_sel_hi:[1,0]
    v_cvt_pk_bf16_f32 v10, v116, v117
    buffer_load_dwordx4 a[120:123], v48, s[12:15], s25 offen offset:2048
    v_lshlrev_b32 v116, 16, v10
    v_and_b32 v117, 0xffff0000, v10
    v_cvt_pk_bf16_f32 v10, v118, v119
    v_lshlrev_b32 v118, 16, v10
    v_and_b32 v119, 0xffff0000, v10
    v_pk_mul_f32 v[118:119], v[118:119], v[8:9] op_sel_hi:[1,0]
    v_cvt_pk_bf16_f32 v10, v118, v119
    v_lshlrev_b32 v118, 16, v10
    v_and_b32 v119, 0xffff0000, v10
    buffer_load_dwordx4 a[124:127], v48, s[12:15], s25 offen offset:3072
    v_cvt_pk_bf16_f32 v10, v120, v121
    v_lshlrev_b32 v120, 16, v10
    v_and_b32 v121, 0xffff0000, v10
    v_pk_mul_f32 v[120:121], v[120:121], v[8:9] op_sel_hi:[1,0]
    v_cvt_pk_bf16_f32 v10, v120, v121
    v_lshlrev_b32 v120, 16, v10
    v_and_b32 v121, 0xffff0000, v10
    v_cvt_pk_bf16_f32 v10, v122, v123
    v_lshlrev_b32 v122, 16, v10
    s_add_u32 s25, s25, 4096
    buffer_load_dwordx4 a[128:131], v48, s[12:15], s25 offen offset:0
    v_and_b32 v123, 0xffff0000, v10
    v_pk_mul_f32 v[122:123], v[122:123], v[8:9] op_sel_hi:[1,0]
    v_cvt_pk_bf16_f32 v10, v122, v123
    v_lshlrev_b32 v122, 16, v10
    v_and_b32 v123, 0xffff0000, v10
    v_cvt_pk_bf16_f32 v10, v124, v125
    v_lshlrev_b32 v124, 16, v10
    v_and_b32 v125, 0xffff0000, v10
    v_pk_mul_f32 v[124:125], v[124:125], v[8:9] op_sel_hi:[1,0]
    buffer_load_dwordx4 a[132:135], v48, s[12:15], s25 offen offset:1024
    v_cvt_pk_bf16_f32 v10, v124, v125
    v_lshlrev_b32 v124, 16, v10
    v_and_b32 v125, 0xffff0000, v10
    v_cvt_pk_bf16_f32 v10, v126, v127
    v_lshlrev_b32 v126, 16, v10
    v_and_b32 v127, 0xffff0000, v10
    v_pk_mul_f32 v[126:127], v[126:127], v[8:9] op_sel_hi:[1,0]
    v_cvt_pk_bf16_f32 v10, v126, v127
    v_lshlrev_b32 v126, 16, v10
    buffer_load_dwordx4 a[136:139], v48, s[12:15], s25 offen offset:2048
    v_and_b32 v127, 0xffff0000, v10
    v_cvt_pk_bf16_f32 v10, v128, v129
    v_lshlrev_b32 v128, 16, v10
    v_and_b32 v129, 0xffff0000, v10
    v_pk_mul_f32 v[128:129], v[128:129], v[8:9] op_sel_hi:[1,0]
    v_cvt_pk_bf16_f32 v10, v128, v129
    v_lshlrev_b32 v128, 16, v10
    v_and_b32 v129, 0xffff0000, v10
    v_cvt_pk_bf16_f32 v10, v130, v131
    buffer_load_dwordx4 a[140:143], v48, s[12:15], s25 offen offset:3072
    v_lshlrev_b32 v130, 16, v10
    v_and_b32 v131, 0xffff0000, v10
    v_pk_mul_f32 v[130:131], v[130:131], v[8:9] op_sel_hi:[1,0]
    v_cvt_pk_bf16_f32 v10, v130, v131
    v_lshlrev_b32 v130, 16, v10
    v_and_b32 v131, 0xffff0000, v10
    v_cvt_pk_bf16_f32 v10, v132, v133
    v_lshlrev_b32 v132, 16, v10
    v_and_b32 v133, 0xffff0000, v10
    s_add_u32 s25, s25, 4096
    buffer_load_dwordx4 a[144:147], v48, s[12:15], s25 offen offset:0
    v_pk_mul_f32 v[132:133], v[132:133], v[8:9] op_sel_hi:[1,0]
    v_cvt_pk_bf16_f32 v10, v132, v133
    v_lshlrev_b32 v132, 16, v10
    v_and_b32 v133, 0xffff0000, v10
    v_cvt_pk_bf16_f32 v10, v134, v135
    v_lshlrev_b32 v134, 16, v10
    v_and_b32 v135, 0xffff0000, v10
    v_pk_mul_f32 v[134:135], v[134:135], v[8:9] op_sel_hi:[1,0]
    v_cvt_pk_bf16_f32 v10, v134, v135
    buffer_load_dwordx4 a[148:151], v48, s[12:15], s25 offen offset:1024
    v_lshlrev_b32 v134, 16, v10
    v_and_b32 v135, 0xffff0000, v10
    v_cvt_pk_bf16_f32 v10, v136, v137
    v_lshlrev_b32 v136, 16, v10
    v_and_b32 v137, 0xffff0000, v10
    v_pk_mul_f32 v[136:137], v[136:137], v[8:9] op_sel_hi:[1,0]
    v_cvt_pk_bf16_f32 v10, v136, v137
    v_lshlrev_b32 v136, 16, v10
    v_and_b32 v137, 0xffff0000, v10
    buffer_load_dwordx4 a[152:155], v48, s[12:15], s25 offen offset:2048
    v_cvt_pk_bf16_f32 v10, v138, v139
    v_lshlrev_b32 v138, 16, v10
    v_and_b32 v139, 0xffff0000, v10
    v_pk_mul_f32 v[138:139], v[138:139], v[8:9] op_sel_hi:[1,0]
    v_cvt_pk_bf16_f32 v10, v138, v139
    v_lshlrev_b32 v138, 16, v10
    v_and_b32 v139, 0xffff0000, v10
    v_cvt_pk_bf16_f32 v10, v140, v141
    v_lshlrev_b32 v140, 16, v10
    buffer_load_dwordx4 a[156:159], v48, s[12:15], s25 offen offset:3072
    v_and_b32 v141, 0xffff0000, v10
    v_pk_mul_f32 v[140:141], v[140:141], v[8:9] op_sel_hi:[1,0]
    v_cvt_pk_bf16_f32 v10, v140, v141
    v_lshlrev_b32 v140, 16, v10
    v_and_b32 v141, 0xffff0000, v10
    v_cvt_pk_bf16_f32 v10, v142, v143
    v_lshlrev_b32 v142, 16, v10
    v_and_b32 v143, 0xffff0000, v10
    v_pk_mul_f32 v[142:143], v[142:143], v[8:9] op_sel_hi:[1,0]
    s_add_u32 s25, s25, 4096
    buffer_load_dwordx4 a[160:163], v48, s[12:15], s25 offen offset:0
    v_cvt_pk_bf16_f32 v10, v142, v143
    v_lshlrev_b32 v142, 16, v10
    v_and_b32 v143, 0xffff0000, v10
    v_pk_add_f32 v[10:11], v[64:65], v[78:79] op_sel:[0,1] op_sel_hi:[1,0]
    v_pk_add_f32 v[64:65], v[64:65], v[78:79] op_sel:[0,1] op_sel_hi:[1,0] neg_lo:[0,1] neg_hi:[0,1]
    v_pk_add_f32 v[12:13], v[72:73], v[70:71] op_sel:[0,1] op_sel_hi:[1,0]
    v_pk_add_f32 v[72:73], v[72:73], v[70:71] op_sel:[0,1] op_sel_hi:[1,0] neg_lo:[0,1] neg_hi:[0,1]
    v_pk_add_f32 v[14:15], v[10:11], v[12:13]
    v_cvt_pk_f16_f32 v16, v14, v15
    buffer_load_dwordx4 a[164:167], v48, s[12:15], s25 offen offset:1024
    v_pk_add_f32 v[14:15], v[64:65], v[72:73]
    v_cvt_pk_f16_f32 v18, v14, v15
    v_pk_add_f32 v[14:15], v[10:11], v[12:13] neg_lo:[0,1] neg_hi:[0,1]
    v_cvt_pk_f16_f32 v20, v14, v15
    v_pk_add_f32 v[14:15], v[64:65], v[72:73] neg_lo:[0,1] neg_hi:[0,1]
    v_cvt_pk_f16_f32 v22, v14, v15
    v_pk_add_f32 v[10:11], v[66:67], v[76:77] op_sel:[0,1] op_sel_hi:[1,0]
    v_pk_add_f32 v[66:67], v[66:67], v[76:77] op_sel:[0,1] op_sel_hi:[1,0] neg_lo:[0,1] neg_hi:[0,1]
    v_pk_add_f32 v[12:13], v[74:75], v[68:69] op_sel:[0,1] op_sel_hi:[1,0]
    buffer_load_dwordx4 a[168:171], v48, s[12:15], s25 offen offset:2048
    v_pk_add_f32 v[74:75], v[74:75], v[68:69] op_sel:[0,1] op_sel_hi:[1,0] neg_lo:[0,1] neg_hi:[0,1]
    v_pk_add_f32 v[14:15], v[10:11], v[12:13]
    v_cvt_pk_f16_f32 v17, v14, v15
    v_pk_add_f32 v[14:15], v[66:67], v[74:75]
    v_cvt_pk_f16_f32 v19, v14, v15
    v_pk_add_f32 v[14:15], v[10:11], v[12:13] neg_lo:[0,1] neg_hi:[0,1]
    v_cvt_pk_f16_f32 v21, v14, v15
    v_pk_add_f32 v[14:15], v[66:67], v[74:75] neg_lo:[0,1] neg_hi:[0,1]
    v_cvt_pk_f16_f32 v23, v14, v15
    buffer_load_dwordx4 a[172:175], v48, s[12:15], s25 offen offset:3072
    ds_write_b64 v2, v[16:17] offset:0
    ds_write_b64 v2, v[18:19] offset:10752
    ds_write_b64 v2, v[20:21] offset:21504
    ds_write_b64 v2, v[22:23] offset:32256
    v_pk_add_f32 v[10:11], v[80:81], v[94:95] op_sel:[0,1] op_sel_hi:[1,0]
    v_pk_add_f32 v[80:81], v[80:81], v[94:95] op_sel:[0,1] op_sel_hi:[1,0] neg_lo:[0,1] neg_hi:[0,1]
    v_pk_add_f32 v[12:13], v[88:89], v[86:87] op_sel:[0,1] op_sel_hi:[1,0]
    v_pk_add_f32 v[88:89], v[88:89], v[86:87] op_sel:[0,1] op_sel_hi:[1,0] neg_lo:[0,1] neg_hi:[0,1]
    v_pk_add_f32 v[14:15], v[10:11], v[12:13]
    s_add_u32 s25, s25, 4096
    buffer_load_dwordx4 a[176:179], v48, s[12:15], s25 offen offset:0
    v_cvt_pk_f16_f32 v24, v14, v15
    v_pk_add_f32 v[14:15], v[80:81], v[88:89]
    v_cvt_pk_f16_f32 v26, v14, v15
    v_pk_add_f32 v[14:15], v[10:11], v[12:13] neg_lo:[0,1] neg_hi:[0,1]
    v_cvt_pk_f16_f32 v28, v14, v15
    v_pk_add_f32 v[14:15], v[80:81], v[88:89] neg_lo:[0,1] neg_hi:[0,1]
    v_cvt_pk_f16_f32 v30, v14, v15
    v_pk_add_f32 v[10:11], v[82:83], v[92:93] op_sel:[0,1] op_sel_hi:[1,0]
    v_pk_add_f32 v[82:83], v[82:83], v[92:93] op_sel:[0,1] op_sel_hi:[1,0] neg_lo:[0,1] neg_hi:[0,1]
    buffer_load_dwordx4 a[180:183], v48, s[12:15], s25 offen offset:1024
    v_pk_add_f32 v[12:13], v[90:91], v[84:85] op_sel:[0,1] op_sel_hi:[1,0]
    v_pk_add_f32 v[90:91], v[90:91], v[84:85] op_sel:[0,1] op_sel_hi:[1,0] neg_lo:[0,1] neg_hi:[0,1]
    v_pk_add_f32 v[14:15], v[10:11], v[12:13]
    v_cvt_pk_f16_f32 v25, v14, v15
    v_pk_add_f32 v[14:15], v[82:83], v[90:91]
    v_cvt_pk_f16_f32 v27, v14, v15
    v_pk_add_f32 v[14:15], v[10:11], v[12:13] neg_lo:[0,1] neg_hi:[0,1]
    v_cvt_pk_f16_f32 v29, v14, v15
    v_pk_add_f32 v[14:15], v[82:83], v[90:91] neg_lo:[0,1] neg_hi:[0,1]
    buffer_load_dwordx4 a[184:187], v48, s[12:15], s25 offen offset:2048
    v_cvt_pk_f16_f32 v31, v14, v15
    ds_write_b64 v2, v[24:25] offset:64
    ds_write_b64 v2, v[26:27] offset:10816
    ds_write_b64 v2, v[28:29] offset:21568
    ds_write_b64 v2, v[30:31] offset:32320
    v_pk_add_f32 v[10:11], v[96:97], v[110:111] op_sel:[0,1] op_sel_hi:[1,0]
    v_pk_add_f32 v[96:97], v[96:97], v[110:111] op_sel:[0,1] op_sel_hi:[1,0] neg_lo:[0,1] neg_hi:[0,1]
    v_pk_add_f32 v[12:13], v[104:105], v[102:103] op_sel:[0,1] op_sel_hi:[1,0]
    v_pk_add_f32 v[104:105], v[104:105], v[102:103] op_sel:[0,1] op_sel_hi:[1,0] neg_lo:[0,1] neg_hi:[0,1]
    buffer_load_dwordx4 a[188:191], v48, s[12:15], s25 offen offset:3072
    v_pk_add_f32 v[14:15], v[10:11], v[12:13]
    v_cvt_pk_f16_f32 v16, v14, v15
    v_pk_add_f32 v[14:15], v[96:97], v[104:105]
    v_cvt_pk_f16_f32 v18, v14, v15
    v_pk_add_f32 v[14:15], v[10:11], v[12:13] neg_lo:[0,1] neg_hi:[0,1]
    v_cvt_pk_f16_f32 v20, v14, v15
    v_pk_add_f32 v[14:15], v[96:97], v[104:105] neg_lo:[0,1] neg_hi:[0,1]
    v_cvt_pk_f16_f32 v22, v14, v15
    v_pk_add_f32 v[10:11], v[98:99], v[108:109] op_sel:[0,1] op_sel_hi:[1,0]
    s_add_u32 s25, s25, 4096
    buffer_load_dwordx4 a[192:195], v48, s[12:15], s25 offen offset:0
    v_pk_add_f32 v[98:99], v[98:99], v[108:109] op_sel:[0,1] op_sel_hi:[1,0] neg_lo:[0,1] neg_hi:[0,1]
    v_pk_add_f32 v[12:13], v[106:107], v[100:101] op_sel:[0,1] op_sel_hi:[1,0]
    v_pk_add_f32 v[106:107], v[106:107], v[100:101] op_sel:[0,1] op_sel_hi:[1,0] neg_lo:[0,1] neg_hi:[0,1]
    v_pk_add_f32 v[14:15], v[10:11], v[12:13]
    v_cvt_pk_f16_f32 v17, v14, v15
    v_pk_add_f32 v[14:15], v[98:99], v[106:107]
    v_cvt_pk_f16_f32 v19, v14, v15
    v_pk_add_f32 v[14:15], v[10:11], v[12:13] neg_lo:[0,1] neg_hi:[0,1]
    v_cvt_pk_f16_f32 v21, v14, v15
    buffer_load_dwordx4 a[196:199], v48, s[12:15], s25 offen offset:1024
    v_pk_add_f32 v[14:15], v[98:99], v[106:107] neg_lo:[0,1] neg_hi:[0,1]
    v_cvt_pk_f16_f32 v23, v14, v15
    ds_write_b64 v2, v[16:17] offset:128
    ds_write_b64 v2, v[18:19] offset:10880
    ds_write_b64 v2, v[20:21] offset:21632
    ds_write_b64 v2, v[22:23] offset:32384
    v_pk_add_f32 v[10:11], v[112:113], v[126:127] op_sel:[0,1] op_sel_hi:[1,0]
    v_pk_add_f32 v[112:113], v[112:113], v[126:127] op_sel:[0,1] op_sel_hi:[1,0] neg_lo:[0,1] neg_hi:[0,1]
    v_pk_add_f32 v[12:13], v[120:121], v[118:119] op_sel:[0,1] op_sel_hi:[1,0]
    v_pk_add_f32 v[120:121], v[120:121], v[118:119] op_sel:[0,1] op_sel_hi:[1,0] neg_lo:[0,1] neg_hi:[0,1]
    v_pk_add_f32 v[14:15], v[10:11], v[12:13]
    v_cvt_pk_f16_f32 v24, v14, v15
    v_pk_add_f32 v[14:15], v[112:113], v[120:121]
    v_cvt_pk_f16_f32 v26, v14, v15
    v_pk_add_f32 v[14:15], v[10:11], v[12:13] neg_lo:[0,1] neg_hi:[0,1]
    v_cvt_pk_f16_f32 v28, v14, v15
    v_pk_add_f32 v[14:15], v[112:113], v[120:121] neg_lo:[0,1] neg_hi:[0,1]
    v_cvt_pk_f16_f32 v30, v14, v15
    v_pk_add_f32 v[10:11], v[114:115], v[124:125] op_sel:[0,1] op_sel_hi:[1,0]
    v_pk_add_f32 v[114:115], v[114:115], v[124:125] op_sel:[0,1] op_sel_hi:[1,0] neg_lo:[0,1] neg_hi:[0,1]
    v_pk_add_f32 v[12:13], v[122:123], v[116:117] op_sel:[0,1] op_sel_hi:[1,0]
    v_pk_add_f32 v[122:123], v[122:123], v[116:117] op_sel:[0,1] op_sel_hi:[1,0] neg_lo:[0,1] neg_hi:[0,1]
    v_pk_add_f32 v[14:15], v[10:11], v[12:13]
    v_cvt_pk_f16_f32 v25, v14, v15
    v_pk_add_f32 v[14:15], v[114:115], v[122:123]
    v_cvt_pk_f16_f32 v27, v14, v15
    v_pk_add_f32 v[14:15], v[10:11], v[12:13] neg_lo:[0,1] neg_hi:[0,1]
    v_cvt_pk_f16_f32 v29, v14, v15
    v_pk_add_f32 v[14:15], v[114:115], v[122:123] neg_lo:[0,1] neg_hi:[0,1]
    v_cvt_pk_f16_f32 v31, v14, v15
    ds_write_b64 v2, v[24:25] offset:192
    ds_write_b64 v2, v[26:27] offset:10944
    ds_write_b64 v2, v[28:29] offset:21696
    ds_write_b64 v2, v[30:31] offset:32448
    v_pk_add_f32 v[10:11], v[128:129], v[142:143] op_sel:[0,1] op_sel_hi:[1,0]
    v_pk_add_f32 v[128:129], v[128:129], v[142:143] op_sel:[0,1] op_sel_hi:[1,0] neg_lo:[0,1] neg_hi:[0,1]
    v_pk_add_f32 v[12:13], v[136:137], v[134:135] op_sel:[0,1] op_sel_hi:[1,0]
    v_pk_add_f32 v[136:137], v[136:137], v[134:135] op_sel:[0,1] op_sel_hi:[1,0] neg_lo:[0,1] neg_hi:[0,1]
    v_pk_add_f32 v[14:15], v[10:11], v[12:13]
    v_cvt_pk_f16_f32 v16, v14, v15
    v_pk_add_f32 v[14:15], v[128:129], v[136:137]
    v_cvt_pk_f16_f32 v18, v14, v15
    v_pk_add_f32 v[14:15], v[10:11], v[12:13] neg_lo:[0,1] neg_hi:[0,1]
    v_cvt_pk_f16_f32 v20, v14, v15
    v_pk_add_f32 v[14:15], v[128:129], v[136:137] neg_lo:[0,1] neg_hi:[0,1]
    v_cvt_pk_f16_f32 v22, v14, v15
    v_pk_add_f32 v[10:11], v[130:131], v[140:141] op_sel:[0,1] op_sel_hi:[1,0]
    v_pk_add_f32 v[130:131], v[130:131], v[140:141] op_sel:[0,1] op_sel_hi:[1,0] neg_lo:[0,1] neg_hi:[0,1]
    v_pk_add_f32 v[12:13], v[138:139], v[132:133] op_sel:[0,1] op_sel_hi:[1,0]
    v_pk_add_f32 v[138:139], v[138:139], v[132:133] op_sel:[0,1] op_sel_hi:[1,0] neg_lo:[0,1] neg_hi:[0,1]
    v_pk_add_f32 v[14:15], v[10:11], v[12:13]
    v_cvt_pk_f16_f32 v17, v14, v15
    v_pk_add_f32 v[14:15], v[130:131], v[138:139]
    v_cvt_pk_f16_f32 v19, v14, v15
    v_pk_add_f32 v[14:15], v[10:11], v[12:13] neg_lo:[0,1] neg_hi:[0,1]
    v_cvt_pk_f16_f32 v21, v14, v15
    v_pk_add_f32 v[14:15], v[130:131], v[138:139] neg_lo:[0,1] neg_hi:[0,1]
    v_cvt_pk_f16_f32 v23, v14, v15
    ds_write_b64 v2, v[16:17] offset:256
    ds_write_b64 v2, v[18:19] offset:11008
    ds_write_b64 v2, v[20:21] offset:21760
    ds_write_b64 v2, v[22:23] offset:32512
    v_and_b32 v3, 31, v1
    v_lshrrev_b32 v4, 5, v1
    v_mul_u32_u24 v5, 336, v3
    v_lshl_add_u32 v5, v4, 4, v5
    s_mul_i32 s3, s24, 10752
    v_add_u32 v5, s3, v5
    v_mov_b32 v60, v5
    s_waitcnt vmcnt(50) lgkmcnt(0)
    s_barrier
    s_add_u32 s16, s54, 11272192
    s_addc_u32 s17, s55, 0
    s_and_b32 s17, s17, 0xffff
    s_mov_b32 s18, 2629632
    s_mov_b32 s19, 0x00020000
    s_mov_b32 s58, s34
    v_mov_b32 v10, 0
    s_mul_i32 s3, s24, 1284
    s_add_u32 s3, s3, 114688
    v_lshl_add_u32 v5, v1, 1, s3
    v_mul_u32_u24 v6, 144, v1
    s_lshl_b32 s3, s24, 5
    s_add_u32 s3, s3, 53248
    v_add_u32 v6, s3, v6
    ds_read_u16 v104, v5 offset:0
    ds_read_u16 v105, v5 offset:24576
    ds_read_u16 v106, v5 offset:6144
    ds_read_u16 v107, v5 offset:30720
    ds_read_u16 v108, v5 offset:12288
    ds_read_u16 v109, v5 offset:36864
    ds_read_u16 v110, v5 offset:18432
    ds_read_u16 v111, v5 offset:43008
    ds_read_u16 v112, v5 offset:642
    ds_read_u16 v113, v5 offset:25218
    ds_read_u16 v114, v5 offset:6786
    ds_read_u16 v115, v5 offset:31362
    ds_read_u16 v116, v5 offset:12930
    ds_read_u16 v117, v5 offset:37506
    ds_read_u16 v118, v5 offset:19074
    ds_read_u16 v119, v5 offset:43650
    ds_read_u16 v120, v5 offset:128
    ds_read_u16 v121, v5 offset:24704
    ds_read_u16 v122, v5 offset:6272
    ds_read_u16 v123, v5 offset:30848
    ds_read_u16 v124, v5 offset:12416
    ds_read_u16 v125, v5 offset:36992
    ds_read_u16 v126, v5 offset:18560
    ds_read_u16 v127, v5 offset:43136
    ds_read_u16 v128, v5 offset:770
    ds_read_u16 v129, v5 offset:25346
    ds_read_u16 v130, v5 offset:6914
    ds_read_u16 v131, v5 offset:31490
    ds_read_u16 v132, v5 offset:13058
    ds_read_u16 v133, v5 offset:37634
    ds_read_u16 v134, v5 offset:19202
    ds_read_u16 v135, v5 offset:43778
    ds_read_u16 v136, v5 offset:256
    ds_read_u16 v137, v5 offset:24832
    ds_read_u16 v138, v5 offset:6400
    ds_read_u16 v139, v5 offset:30976
    ds_read_u16 v140, v5 offset:12544
    ds_read_u16 v141, v5 offset:37120
    ds_read_u16 v142, v5 offset:18688
    ds_read_u16 v143, v5 offset:43264
    ds_read_u16 v144, v5 offset:898
    ds_read_u16 v145, v5 offset:25474
    ds_read_u16 v146, v5 offset:7042
    ds_read_u16 v147, v5 offset:31618
    ds_read_u16 v148, v5 offset:13186
    ds_read_u16 v149, v5 offset:37762
    ds_read_u16 v150, v5 offset:19330
    ds_read_u16 v151, v5 offset:43906
    ds_read_u16 v152, v5 offset:384
    ds_read_u16 v153, v5 offset:24960
    ds_read_u16 v154, v5 offset:6528
    ds_read_u16 v155, v5 offset:31104
    ds_read_u16 v156, v5 offset:12672
    ds_read_u16 v157, v5 offset:37248
    ds_read_u16 v158, v5 offset:18816
    ds_read_u16 v159, v5 offset:43392
    ds_read_u16 v160, v5 offset:1026
    ds_read_u16 v161, v5 offset:25602
    ds_read_u16 v162, v5 offset:7170
    ds_read_u16 v163, v5 offset:31746
    ds_read_u16 v164, v5 offset:13314
    ds_read_u16 v165, v5 offset:37890
    ds_read_u16 v166, v5 offset:19458
    ds_read_u16 v167, v5 offset:44034
    ds_read_u16 v168, v5 offset:512
    ds_read_u16 v169, v5 offset:25088
    ds_read_u16 v170, v5 offset:6656
    ds_read_u16 v171, v5 offset:31232
    ds_read_u16 v172, v5 offset:12800
    ds_read_u16 v173, v5 offset:37376
    ds_read_u16 v174, v5 offset:18944
    ds_read_u16 v175, v5 offset:43520
    ds_read_u16 v176, v5 offset:1154
    ds_read_u16 v177, v5 offset:25730
    ds_read_u16 v178, v5 offset:7298
    ds_read_u16 v179, v5 offset:31874
    ds_read_u16 v180, v5 offset:13442
    ds_read_u16 v181, v5 offset:38018
    ds_read_u16 v182, v5 offset:19586
    ds_read_u16 v183, v5 offset:44162
    ds_read_u16 v184, v5 offset:640
    ds_read_u16 v185, v5 offset:25216
    ds_read_u16 v186, v5 offset:6784
    ds_read_u16 v187, v5 offset:31360
    ds_read_u16 v188, v5 offset:12928
    ds_read_u16 v189, v5 offset:37504
    ds_read_u16 v190, v5 offset:19072
    ds_read_u16 v191, v5 offset:43648
    ds_read_u16 v192, v5 offset:1282
    ds_read_u16 v193, v5 offset:25858
    ds_read_u16 v194, v5 offset:7426
    ds_read_u16 v195, v5 offset:32002
    ds_read_u16 v196, v5 offset:13570
    ds_read_u16 v197, v5 offset:38146
    ds_read_u16 v198, v5 offset:19714
    ds_read_u16 v199, v5 offset:44290
    s_waitcnt lgkmcnt(15)
    v_lshl_or_b32 v200, v105, 16, v104
    v_lshl_or_b32 v201, v107, 16, v106
    v_lshl_or_b32 v202, v109, 16, v108
    v_lshl_or_b32 v203, v111, 16, v110
    ds_write_b128 v6, v[200:203] offset:0
    v_and_b32 v11, 0x7fff7fff, v200
    v_pk_max_u16 v10, v10, v11
    v_and_b32 v11, 0x7fff7fff, v201
    v_pk_max_u16 v10, v10, v11
    v_and_b32 v11, 0x7fff7fff, v202
    v_pk_max_u16 v10, v10, v11
    v_and_b32 v11, 0x7fff7fff, v203
    v_pk_max_u16 v10, v10, v11
    s_waitcnt lgkmcnt(15)
    v_lshl_or_b32 v204, v113, 16, v112
    v_lshl_or_b32 v205, v115, 16, v114
    v_lshl_or_b32 v206, v117, 16, v116
    v_lshl_or_b32 v207, v119, 16, v118
    ds_write_b128 v6, v[204:207] offset:16
    v_and_b32 v11, 0x7fff7fff, v204
    v_pk_max_u16 v10, v10, v11
    v_and_b32 v11, 0x7fff7fff, v205
    v_pk_max_u16 v10, v10, v11
    v_and_b32 v11, 0x7fff7fff, v206
    v_pk_max_u16 v10, v10, v11
    v_and_b32 v11, 0x7fff7fff, v207
    v_pk_max_u16 v10, v10, v11
    s_waitcnt lgkmcnt(15)
    v_lshl_or_b32 v208, v121, 16, v120
    v_lshl_or_b32 v209, v123, 16, v122
    v_lshl_or_b32 v210, v125, 16, v124
    v_lshl_or_b32 v211, v127, 16, v126
    ds_write_b128 v6, v[208:211] offset:9216
    v_and_b32 v11, 0x7fff7fff, v208
    v_pk_max_u16 v10, v10, v11
    v_and_b32 v11, 0x7fff7fff, v209
    v_pk_max_u16 v10, v10, v11
    v_and_b32 v11, 0x7fff7fff, v210
    v_pk_max_u16 v10, v10, v11
    v_and_b32 v11, 0x7fff7fff, v211
    v_pk_max_u16 v10, v10, v11
    s_waitcnt lgkmcnt(15)
    v_lshl_or_b32 v212, v129, 16, v128
    v_lshl_or_b32 v213, v131, 16, v130
    v_lshl_or_b32 v214, v133, 16, v132
    v_lshl_or_b32 v215, v135, 16, v134
    ds_write_b128 v6, v[212:215] offset:9232
    v_and_b32 v11, 0x7fff7fff, v212
    v_pk_max_u16 v10, v10, v11
    v_and_b32 v11, 0x7fff7fff, v213
    v_pk_max_u16 v10, v10, v11
    v_and_b32 v11, 0x7fff7fff, v214
    v_pk_max_u16 v10, v10, v11
    v_and_b32 v11, 0x7fff7fff, v215
    v_pk_max_u16 v10, v10, v11
    s_waitcnt lgkmcnt(15)
    v_lshl_or_b32 v216, v137, 16, v136
    v_lshl_or_b32 v217, v139, 16, v138
    v_lshl_or_b32 v218, v141, 16, v140
    v_lshl_or_b32 v219, v143, 16, v142
    ds_write_b128 v6, v[216:219] offset:18432
    v_and_b32 v11, 0x7fff7fff, v216
    v_pk_max_u16 v10, v10, v11
    v_and_b32 v11, 0x7fff7fff, v217
    v_pk_max_u16 v10, v10, v11
    v_and_b32 v11, 0x7fff7fff, v218
    v_pk_max_u16 v10, v10, v11
    v_and_b32 v11, 0x7fff7fff, v219
    v_pk_max_u16 v10, v10, v11
    s_waitcnt lgkmcnt(15)
    v_lshl_or_b32 v220, v145, 16, v144
    v_lshl_or_b32 v221, v147, 16, v146
    v_lshl_or_b32 v222, v149, 16, v148
    v_lshl_or_b32 v223, v151, 16, v150
    ds_write_b128 v6, v[220:223] offset:18448
    v_and_b32 v11, 0x7fff7fff, v220
    v_pk_max_u16 v10, v10, v11
    v_and_b32 v11, 0x7fff7fff, v221
    v_pk_max_u16 v10, v10, v11
    v_and_b32 v11, 0x7fff7fff, v222
    v_pk_max_u16 v10, v10, v11
    v_and_b32 v11, 0x7fff7fff, v223
    v_pk_max_u16 v10, v10, v11
    s_waitcnt lgkmcnt(15)
    v_lshl_or_b32 v224, v153, 16, v152
    v_lshl_or_b32 v225, v155, 16, v154
    v_lshl_or_b32 v226, v157, 16, v156
    v_lshl_or_b32 v227, v159, 16, v158
    ds_write_b128 v6, v[224:227] offset:27648
    v_and_b32 v11, 0x7fff7fff, v224
    v_pk_max_u16 v10, v10, v11
    v_and_b32 v11, 0x7fff7fff, v225
    v_pk_max_u16 v10, v10, v11
    v_and_b32 v11, 0x7fff7fff, v226
    v_pk_max_u16 v10, v10, v11
    v_and_b32 v11, 0x7fff7fff, v227
    v_pk_max_u16 v10, v10, v11
    s_waitcnt lgkmcnt(15)
    v_lshl_or_b32 v228, v161, 16, v160
    v_lshl_or_b32 v229, v163, 16, v162
    v_lshl_or_b32 v230, v165, 16, v164
    v_lshl_or_b32 v231, v167, 16, v166
    ds_write_b128 v6, v[228:231] offset:27664
    v_and_b32 v11, 0x7fff7fff, v228
    v_pk_max_u16 v10, v10, v11
    v_and_b32 v11, 0x7fff7fff, v229
    v_pk_max_u16 v10, v10, v11
    v_and_b32 v11, 0x7fff7fff, v230
    v_pk_max_u16 v10, v10, v11
    v_and_b32 v11, 0x7fff7fff, v231
    v_pk_max_u16 v10, v10, v11
    s_waitcnt lgkmcnt(15)
    v_lshl_or_b32 v232, v169, 16, v168
    v_lshl_or_b32 v233, v171, 16, v170
    v_lshl_or_b32 v234, v173, 16, v172
    v_lshl_or_b32 v235, v175, 16, v174
    ds_write_b128 v6, v[232:235] offset:36864
    v_and_b32 v11, 0x7fff7fff, v232
    v_pk_max_u16 v10, v10, v11
    v_and_b32 v11, 0x7fff7fff, v233
    v_pk_max_u16 v10, v10, v11
    v_and_b32 v11, 0x7fff7fff, v234
    v_pk_max_u16 v10, v10, v11
    v_and_b32 v11, 0x7fff7fff, v235
    v_pk_max_u16 v10, v10, v11
    s_waitcnt lgkmcnt(15)
    v_lshl_or_b32 v236, v177, 16, v176
    v_lshl_or_b32 v237, v179, 16, v178
    v_lshl_or_b32 v238, v181, 16, v180
    v_lshl_or_b32 v239, v183, 16, v182
    ds_write_b128 v6, v[236:239] offset:36880
    v_and_b32 v11, 0x7fff7fff, v236
    v_pk_max_u16 v10, v10, v11
    v_and_b32 v11, 0x7fff7fff, v237
    v_pk_max_u16 v10, v10, v11
    v_and_b32 v11, 0x7fff7fff, v238
    v_pk_max_u16 v10, v10, v11
    v_and_b32 v11, 0x7fff7fff, v239
    v_pk_max_u16 v10, v10, v11
    s_waitcnt lgkmcnt(8)
    v_lshl_or_b32 v240, v185, 16, v184
    v_lshl_or_b32 v241, v187, 16, v186
    v_lshl_or_b32 v242, v189, 16, v188
    v_lshl_or_b32 v243, v191, 16, v190
    v_cmp_gt_u32 vcc, 1, v1
    s_and_saveexec_b64 s[100:101], vcc
    ds_write_b128 v6, v[240:243] offset:46080
    v_and_b32 v11, 0x7fff7fff, v240
    v_pk_max_u16 v10, v10, v11
    v_and_b32 v11, 0x7fff7fff, v241
    v_pk_max_u16 v10, v10, v11
    v_and_b32 v11, 0x7fff7fff, v242
    v_pk_max_u16 v10, v10, v11
    v_and_b32 v11, 0x7fff7fff, v243
    v_pk_max_u16 v10, v10, v11
    s_mov_b64 exec, s[100:101]
    s_waitcnt lgkmcnt(0)
    v_lshl_or_b32 v244, v193, 16, v192
    v_lshl_or_b32 v245, v195, 16, v194
    v_lshl_or_b32 v246, v197, 16, v196
    v_lshl_or_b32 v247, v199, 16, v198
    v_cmp_gt_u32 vcc, 1, v1
    s_and_saveexec_b64 s[100:101], vcc
    ds_write_b128 v6, v[244:247] offset:46096
    v_and_b32 v11, 0x7fff7fff, v244
    v_pk_max_u16 v10, v10, v11
    v_and_b32 v11, 0x7fff7fff, v245
    v_pk_max_u16 v10, v10, v11
    v_and_b32 v11, 0x7fff7fff, v246
    v_pk_max_u16 v10, v10, v11
    v_and_b32 v11, 0x7fff7fff, v247
    v_pk_max_u16 v10, v10, v11
    s_mov_b64 exec, s[100:101]
    v_and_b32 v3, 7, v1
    v_lshrrev_b32 v4, 3, v1
    s_lshl_b32 s3, s24, 3
    v_add_u32 v4, s3, v4
    v_mul_u32_u24 v5, 144, v4
    v_lshl_add_u32 v5, v3, 4, v5
    v_add_u32 v5, 53248, v5
    v_lshlrev_b32 v6, 13, v4
    v_lshl_add_u32 v6, v3, 4, v6
    s_waitcnt lgkmcnt(0)
    s_barrier
    ds_read_b128 v[104:107], v5 offset:0
    ds_read_b128 v[108:111], v5 offset:4608
    ds_read_b128 v[112:115], v5 offset:9216
    ds_read_b128 v[116:119], v5 offset:13824
    ds_read_b128 v[120:123], v5 offset:18432
    ds_read_b128 v[124:127], v5 offset:23040
    ds_read_b128 v[128:131], v5 offset:27648
    ds_read_b128 v[132:135], v5 offset:32256
    ds_read_b128 v[136:139], v5 offset:36864
    ds_read_b128 v[140:143], v5 offset:41472
    ds_read_b128 v[144:147], v5 offset:46080
    s_waitcnt lgkmcnt(10)
    buffer_store_dwordx4 v[104:107], v6, s[16:19], s58 offen sc1
    s_add_u32 s58, s58, 262144
    s_waitcnt lgkmcnt(9)
    buffer_store_dwordx4 v[108:111], v6, s[16:19], s58 offen sc1
    s_add_u32 s58, s58, 262144
    s_waitcnt lgkmcnt(8)
    buffer_store_dwordx4 v[112:115], v6, s[16:19], s58 offen sc1
    s_add_u32 s58, s58, 262144
    s_waitcnt lgkmcnt(7)
    buffer_store_dwordx4 v[116:119], v6, s[16:19], s58 offen sc1
    s_add_u32 s58, s58, 262144
    s_waitcnt lgkmcnt(6)
    buffer_store_dwordx4 v[120:123], v6, s[16:19], s58 offen sc1
    s_add_u32 s58, s58, 262144
    s_waitcnt lgkmcnt(5)
    buffer_store_dwordx4 v[124:127], v6, s[16:19], s58 offen sc1
    s_add_u32 s58, s58, 262144
    s_waitcnt lgkmcnt(4)
    buffer_store_dwordx4 v[128:131], v6, s[16:19], s58 offen sc1
    s_add_u32 s58, s58, 262144
    s_waitcnt lgkmcnt(3)
    buffer_store_dwordx4 v[132:135], v6, s[16:19], s58 offen sc1
    s_add_u32 s58, s58, 262144
    s_waitcnt lgkmcnt(2)
    buffer_store_dwordx4 v[136:139], v6, s[16:19], s58 offen sc1
    s_add_u32 s58, s58, 262144
    s_waitcnt lgkmcnt(1)
    buffer_store_dwordx4 v[140:143], v6, s[16:19], s58 offen sc1
    s_add_u32 s58, s58, 262144
    s_waitcnt lgkmcnt(0)
    v_add_u32 v11, 320, v4
    v_cmp_gt_u32 vcc, 321, v11
    s_and_saveexec_b64 s[100:101], vcc
    buffer_store_dwordx4 v[144:147], v6, s[16:19], s58 offen sc1
    s_mov_b64 exec, s[100:101]
    v_lshrrev_b32 v11, 16, v10
    v_and_b32 v10, 0xffff, v10
    v_max_u32 v10, v10, v11
    s_nop 1
    v_max_u32_dpp v10, v10, v10 row_shr:1 row_mask:0xf bank_mask:0xf
    s_nop 1
    v_max_u32_dpp v10, v10, v10 row_shr:2 row_mask:0xf bank_mask:0xf
    s_nop 1
    v_max_u32_dpp v10, v10, v10 row_shr:4 row_mask:0xf bank_mask:0xf
    s_nop 1
    v_max_u32_dpp v10, v10, v10 row_shr:8 row_mask:0xf bank_mask:0xf
    s_nop 1
    v_max_u32_dpp v10, v10, v10 row_bcast:15 row_mask:0xa bank_mask:0xf
    s_nop 1
    v_max_u32_dpp v10, v10, v10 row_bcast:31 row_mask:0xc bank_mask:0xf
    s_add_u32 s20, s54, 8126464
    s_addc_u32 s21, s55, 0
    s_and_b32 s21, s21, 0xffff
    s_mov_b32 s22, 1024
    s_mov_b32 s23, 0x00020000
    v_cmp_eq_u32 vcc, 63, v1
    s_and_saveexec_b64 s[100:101], vcc
    s_lshl_b32 s3, s31, 4
    s_lshl_b32 s33, s24, 2
    s_add_u32 s3, s3, s33
    v_mov_b32 v11, 0
    buffer_store_dword v10, v11, s[20:23], s3 offen sc1
    s_mov_b64 exec, s[100:101]
    s_barrier
    s_getpc_b64 s[20:21]
    s_add_u32 s20, s20, tab_fft@rel32@lo+4
    s_addc_u32 s21, s21, tab_fft@rel32@hi+12
    s_and_b32 s21, s21, 0xffff
    s_mov_b32 s22, 63488
    s_mov_b32 s23, 0x00020000
    v_lshlrev_b32 v31, 4, v1
    s_lshl_b32 s27, s24, 10
    s_add_u32 m0, s27, 92160
    s_add_u32 s35, s27, 0
    buffer_load_dwordx4 v31, s[20:23], s35 offen lds
    s_add_u32 m0, s27, 96256
    s_add_u32 s35, s27, 4096
    buffer_load_dwordx4 v31, s[20:23], s35 offen lds
    s_add_u32 m0, s27, 100352
    s_add_u32 s35, s27, 8192
    buffer_load_dwordx4 v31, s[20:23], s35 offen lds
    s_add_u32 m0, s27, 104448
    s_add_u32 s35, s27, 12288
    buffer_load_dwordx4 v31, s[20:23], s35 offen lds
    s_add_u32 m0, s27, 108544
    s_add_u32 s35, s27, 24576
    buffer_load_dwordx4 v31, s[20:23], s35 offen lds
    s_add_u32 m0, s27, 112640
    s_add_u32 s35, s27, 28672
    buffer_load_dwordx4 v31, s[20:23], s35 offen lds
    s_add_u32 m0, s27, 116736
    s_add_u32 s35, s27, 32768
    buffer_load_dwordx4 v31, s[20:23], s35 offen lds
    s_add_u32 m0, s27, 120832
    s_add_u32 s35, s27, 36864
    buffer_load_dwordx4 v31, s[20:23], s35 offen lds
    s_add_u32 m0, s27, 124928
    s_add_u32 s35, s27, 40960
    buffer_load_dwordx4 v31, s[20:23], s35 offen lds
    s_add_u32 m0, s27, 129024
    s_add_u32 s35, s27, 45056
    buffer_load_dwordx4 v31, s[20:23], s35 offen lds
    s_add_u32 m0, s27, 133120
    s_add_u32 s35, s27, 49152
    buffer_load_dwordx4 v31, s[20:23], s35 offen lds
    s_add_u32 m0, s27, 137216
    s_add_u32 s35, s27, 53248
    buffer_load_dwordx4 v31, s[20:23], s35 offen lds
    s_add_u32 m0, s27, 141312
    s_add_u32 s35, s27, 57344
    buffer_load_dwordx4 v31, s[20:23], s35 offen lds
    s_cmp_ge_u32 s24, 2
    s_cbranch_scc1 tb_40
    s_add_u32 m0, s27, 145408
    s_add_u32 s35, s27, 61440
    buffer_load_dwordx4 v31, s[20:23], s35 offen lds
    tb_40:
    s_add_u32 s16, s54, 8388608
    s_addc_u32 s17, s55, 0
    s_and_b32 s17, s17, 0xffff
    s_mov_b32 s18, 2621440
    s_mov_b32 s19, 0x00020000
    v_and_b32 v3, 31, v1
    v_lshrrev_b32 v4, 5, v1
    ds_read_b128 v[16:19], v60 offset:0
    ds_read_b128 v[20:23], v60 offset:32
    ds_read_b128 v[24:27], v60 offset:64
    ds_read_b128 v[28:31], v60 offset:96
    ds_read_b128 v[32:35], v60 offset:128
    ds_read_b128 v[36:39], v60 offset:160
    ds_read_b128 v[40:43], v60 offset:192
    ds_read_b128 v[44:47], v60 offset:224
    ds_read_b128 v[48:51], v60 offset:256
    ds_read_b128 v[52:55], v60 offset:288
    s_waitcnt vmcnt(25)
    s_waitcnt lgkmcnt(9)
    v_mfma_f32_32x32x16_f16 v[64:79], v[16:19], a[0:3], 0
    v_mfma_f32_32x32x16_f16 v[80:95], v[16:19], a[40:43], 0
    v_mfma_f32_32x32x16_f16 v[96:111], v[16:19], a[80:83], 0
    v_mfma_f32_32x32x16_f16 v[112:127], v[16:19], a[120:123], 0
    v_mfma_f32_32x32x16_f16 v[128:143], v[16:19], a[160:163], 0
    s_waitcnt lgkmcnt(8)
    v_mfma_f32_32x32x16_f16 v[64:79], v[20:23], a[4:7], v[64:79]
    v_mfma_f32_32x32x16_f16 v[80:95], v[20:23], a[44:47], v[80:95]
    v_mfma_f32_32x32x16_f16 v[96:111], v[20:23], a[84:87], v[96:111]
    v_mfma_f32_32x32x16_f16 v[112:127], v[20:23], a[124:127], v[112:127]
    v_mfma_f32_32x32x16_f16 v[128:143], v[20:23], a[164:167], v[128:143]
    s_waitcnt lgkmcnt(7)
    v_mfma_f32_32x32x16_f16 v[64:79], v[24:27], a[8:11], v[64:79]
    v_mfma_f32_32x32x16_f16 v[80:95], v[24:27], a[48:51], v[80:95]
    v_mfma_f32_32x32x16_f16 v[96:111], v[24:27], a[88:91], v[96:111]
    v_mfma_f32_32x32x16_f16 v[112:127], v[24:27], a[128:131], v[112:127]
    v_mfma_f32_32x32x16_f16 v[128:143], v[24:27], a[168:171], v[128:143]
    s_waitcnt lgkmcnt(6)
    v_mfma_f32_32x32x16_f16 v[64:79], v[28:31], a[12:15], v[64:79]
    v_mfma_f32_32x32x16_f16 v[80:95], v[28:31], a[52:55], v[80:95]
    v_mfma_f32_32x32x16_f16 v[96:111], v[28:31], a[92:95], v[96:111]
    v_mfma_f32_32x32x16_f16 v[112:127], v[28:31], a[132:135], v[112:127]
    v_mfma_f32_32x32x16_f16 v[128:143], v[28:31], a[172:175], v[128:143]
    s_waitcnt lgkmcnt(5)
    v_mfma_f32_32x32x16_f16 v[64:79], v[32:35], a[16:19], v[64:79]
    v_mfma_f32_32x32x16_f16 v[80:95], v[32:35], a[56:59], v[80:95]
    v_mfma_f32_32x32x16_f16 v[96:111], v[32:35], a[96:99], v[96:111]
    v_mfma_f32_32x32x16_f16 v[112:127], v[32:35], a[136:139], v[112:127]
    v_mfma_f32_32x32x16_f16 v[128:143], v[32:35], a[176:179], v[128:143]
    s_waitcnt lgkmcnt(4)
    v_mfma_f32_32x32x16_f16 v[64:79], v[36:39], a[20:23], v[64:79]
    v_mfma_f32_32x32x16_f16 v[80:95], v[36:39], a[60:63], v[80:95]
    v_mfma_f32_32x32x16_f16 v[96:111], v[36:39], a[100:103], v[96:111]
    v_mfma_f32_32x32x16_f16 v[112:127], v[36:39], a[140:143], v[112:127]
    v_mfma_f32_32x32x16_f16 v[128:143], v[36:39], a[180:183], v[128:143]
    s_waitcnt lgkmcnt(3)
    v_mfma_f32_32x32x16_f16 v[64:79], v[40:43], a[24:27], v[64:79]
    v_mfma_f32_32x32x16_f16 v[80:95], v[40:43], a[64:67], v[80:95]
    v_mfma_f32_32x32x16_f16 v[96:111], v[40:43], a[104:107], v[96:111]
    v_mfma_f32_32x32x16_f16 v[112:127], v[40:43], a[144:147], v[112:127]
    v_mfma_f32_32x32x16_f16 v[128:143], v[40:43], a[184:187], v[128:143]
    s_waitcnt lgkmcnt(2)
    v_mfma_f32_32x32x16_f16 v[64:79], v[44:47], a[28:31], v[64:79]
    v_mfma_f32_32x32x16_f16 v[80:95], v[44:47], a[68:71], v[80:95]
    v_mfma_f32_32x32x16_f16 v[96:111], v[44:47], a[108:111], v[96:111]
    v_mfma_f32_32x32x16_f16 v[112:127], v[44:47], a[148:151], v[112:127]
    v_mfma_f32_32x32x16_f16 v[128:143], v[44:47], a[188:191], v[128:143]
    s_waitcnt lgkmcnt(1)
    v_mfma_f32_32x32x16_f16 v[64:79], v[48:51], a[32:35], v[64:79]
    v_mfma_f32_32x32x16_f16 v[80:95], v[48:51], a[72:75], v[80:95]
    v_mfma_f32_32x32x16_f16 v[96:111], v[48:51], a[112:115], v[96:111]
    v_mfma_f32_32x32x16_f16 v[112:127], v[48:51], a[152:155], v[112:127]
    v_mfma_f32_32x32x16_f16 v[128:143], v[48:51], a[192:195], v[128:143]
    s_waitcnt lgkmcnt(0)
    v_mfma_f32_32x32x16_f16 v[64:79], v[52:55], a[36:39], v[64:79]
    v_mfma_f32_32x32x16_f16 v[80:95], v[52:55], a[76:79], v[80:95]
    v_mfma_f32_32x32x16_f16 v[96:111], v[52:55], a[116:119], v[96:111]
    v_mfma_f32_32x32x16_f16 v[112:127], v[52:55], a[156:159], v[112:127]
    v_mfma_f32_32x32x16_f16 v[128:143], v[52:55], a[196:199], v[128:143]
    v_mul_u32_u24 v6, 80, v3
    v_lshl_add_u32 v6, v4, 3, v6
    s_barrier
    s_mul_i32 s3, s24, 12800
    v_add_u32 v6, s3, v6
    v_lshrrev_b32 v7, 2, v1
    v_and_b32 v8, 3, v1
    v_mul_u32_u24 v9, 80, v7
    v_lshl_add_u32 v9, v8, 4, v9
    v_add_u32 v9, s3, v9
    s_mul_i32 s3, s24, 160
    v_add_u32 v7, s3, v7
    v_lshlrev_b32 v7, 12, v7
    v_lshl_add_u32 v7, v8, 4, v7
    s_and_b32 s3, s29, 3
    s_lshl_b32 s3, s3, 10
    s_lshr_b32 s33, s29, 2
    s_lshl_b32 s33, s33, 9
    s_add_u32 s3, s3, s33
    s_lshl_b32 s33, s28, 6
    s_add_u32 s3, s3, s33
    v_add_u32 v7, s3, v7
    s_nop 7
    v_cvt_pk_f16_f32 v16, v64, v65
    v_cvt_pk_f16_f32 v17, v66, v67
    ds_write_b64 v6, v[16:17] offset:0
    v_cvt_pk_f16_f32 v18, v68, v69
    v_cvt_pk_f16_f32 v19, v70, v71
    ds_write_b64 v6, v[18:19] offset:16
    v_cvt_pk_f16_f32 v20, v72, v73
    v_cvt_pk_f16_f32 v21, v74, v75
    ds_write_b64 v6, v[20:21] offset:32
    v_cvt_pk_f16_f32 v22, v76, v77
    v_cvt_pk_f16_f32 v23, v78, v79
    ds_write_b64 v6, v[22:23] offset:48
    v_cvt_pk_f16_f32 v24, v80, v81
    v_cvt_pk_f16_f32 v25, v82, v83
    ds_write_b64 v6, v[24:25] offset:2560
    v_cvt_pk_f16_f32 v26, v84, v85
    v_cvt_pk_f16_f32 v27, v86, v87
    ds_write_b64 v6, v[26:27] offset:2576
    v_cvt_pk_f16_f32 v28, v88, v89
    v_cvt_pk_f16_f32 v29, v90, v91
    ds_write_b64 v6, v[28:29] offset:2592
    v_cvt_pk_f16_f32 v30, v92, v93
    v_cvt_pk_f16_f32 v31, v94, v95
    ds_write_b64 v6, v[30:31] offset:2608
    v_cvt_pk_f16_f32 v32, v96, v97
    v_cvt_pk_f16_f32 v33, v98, v99
    ds_write_b64 v6, v[32:33] offset:5120
    v_cvt_pk_f16_f32 v34, v100, v101
    v_cvt_pk_f16_f32 v35, v102, v103
    ds_write_b64 v6, v[34:35] offset:5136
    v_cvt_pk_f16_f32 v36, v104, v105
    v_cvt_pk_f16_f32 v37, v106, v107
    ds_write_b64 v6, v[36:37] offset:5152
    v_cvt_pk_f16_f32 v38, v108, v109
    v_cvt_pk_f16_f32 v39, v110, v111
    ds_write_b64 v6, v[38:39] offset:5168
    v_cvt_pk_f16_f32 v40, v112, v113
    v_cvt_pk_f16_f32 v41, v114, v115
    ds_write_b64 v6, v[40:41] offset:7680
    v_cvt_pk_f16_f32 v42, v116, v117
    v_cvt_pk_f16_f32 v43, v118, v119
    ds_write_b64 v6, v[42:43] offset:7696
    v_cvt_pk_f16_f32 v44, v120, v121
    v_cvt_pk_f16_f32 v45, v122, v123
    ds_write_b64 v6, v[44:45] offset:7712
    v_cvt_pk_f16_f32 v46, v124, v125
    v_cvt_pk_f16_f32 v47, v126, v127
    ds_write_b64 v6, v[46:47] offset:7728
    v_cvt_pk_f16_f32 v48, v128, v129
    v_cvt_pk_f16_f32 v49, v130, v131
    ds_write_b64 v6, v[48:49] offset:10240
    v_cvt_pk_f16_f32 v50, v132, v133
    v_cvt_pk_f16_f32 v51, v134, v135
    ds_write_b64 v6, v[50:51] offset:10256
    v_cvt_pk_f16_f32 v52, v136, v137
    v_cvt_pk_f16_f32 v53, v138, v139
    ds_write_b64 v6, v[52:53] offset:10272
    v_cvt_pk_f16_f32 v54, v140, v141
    v_cvt_pk_f16_f32 v55, v142, v143
    ds_write_b64 v6, v[54:55] offset:10288
    s_waitcnt lgkmcnt(0)
    ds_read_b128 v[64:67], v9 offset:0
    ds_read_b128 v[68:71], v9 offset:1280
    ds_read_b128 v[72:75], v9 offset:2560
    ds_read_b128 v[76:79], v9 offset:3840
    ds_read_b128 v[80:83], v9 offset:5120
    ds_read_b128 v[84:87], v9 offset:6400
    ds_read_b128 v[88:91], v9 offset:7680
    ds_read_b128 v[92:95], v9 offset:8960
    ds_read_b128 v[96:99], v9 offset:10240
    ds_read_b128 v[100:103], v9 offset:11520
    s_mov_b32 s3, 0
    s_waitcnt lgkmcnt(9)
    buffer_store_dwordx4 v[64:67], v7, s[16:19], s3 offen sc1
    s_add_u32 s3, s3, 65536
    s_waitcnt lgkmcnt(8)
    buffer_store_dwordx4 v[68:71], v7, s[16:19], s3 offen sc1
    s_add_u32 s3, s3, 65536
    s_waitcnt lgkmcnt(7)
    buffer_store_dwordx4 v[72:75], v7, s[16:19], s3 offen sc1
    s_add_u32 s3, s3, 65536
    s_waitcnt lgkmcnt(6)
    buffer_store_dwordx4 v[76:79], v7, s[16:19], s3 offen sc1
    s_add_u32 s3, s3, 65536
    s_waitcnt lgkmcnt(5)
    buffer_store_dwordx4 v[80:83], v7, s[16:19], s3 offen sc1
    s_add_u32 s3, s3, 65536
    s_waitcnt lgkmcnt(4)
    buffer_store_dwordx4 v[84:87], v7, s[16:19], s3 offen sc1
    s_add_u32 s3, s3, 65536
    s_waitcnt lgkmcnt(3)
    buffer_store_dwordx4 v[88:91], v7, s[16:19], s3 offen sc1
    s_add_u32 s3, s3, 65536
    s_waitcnt lgkmcnt(2)
    buffer_store_dwordx4 v[92:95], v7, s[16:19], s3 offen sc1
    s_add_u32 s3, s3, 65536
    s_waitcnt lgkmcnt(1)
    buffer_store_dwordx4 v[96:99], v7, s[16:19], s3 offen sc1
    s_add_u32 s3, s3, 65536
    s_waitcnt lgkmcnt(0)
    buffer_store_dwordx4 v[100:103], v7, s[16:19], s3 offen sc1
    s_add_u32 s3, s3, 65536
    s_waitcnt vmcnt(0)
    s_barrier
    s_cmp_lg_u32 s24, 0
    s_cbranch_scc1 arr_41
    s_mov_b32 s92, s52
    s_and_b32 s93, s53, 0xffff
    s_mov_b32 s94, 256
    s_mov_b32 s95, 0x00020000
    s_mov_b32 s58, 0
    v_mov_b32 v6, 0
wi_42:
    buffer_load_dword v7, v6, s[92:95], 0 offen offset:240 sc1
    s_waitcnt vmcnt(0)
    v_readfirstlane_b32 s3, v7
    s_nop 3
    s_cmp_lg_u32 s3, 0
    s_cbranch_scc1 wiok_43
    s_add_u32 s58, s58, 1
    s_cmp_ge_u32 s58, 65536
    s_cbranch_scc1 wiok_43
    s_sleep 2
    s_branch wi_42
wiok_43:
    v_cmp_gt_u32 vcc, 8, v1
    s_and_saveexec_b64 s[100:101], vcc
    v_lshlrev_b32 v6, 7, v1
    v_mov_b32 v7, 1
    buffer_atomic_add v7, v6, s[96:99], 0 offen offset:2048 sc1
    s_mov_b64 exec, s[100:101]
arr_41:
    s_branch aux_fft
aux_odd:
    s_mov_b32 s4, s48
    s_and_b32 s5, s49, 0xffff
    s_mov_b32 s6, 1966080
    s_mov_b32 s7, 0x00020000
    v_lshlrev_b32 v20, 4, v1
    v_add_u32 v20, 0, v20
    v_mul_u32_u24 v21, 52429, v20
    v_lshrrev_b32 v21, 26, v21
    v_mul_u32_u24 v22, 1280, v21
    v_sub_u32 v22, v20, v22
    v_lshlrev_b32 v23, 6, v21
    v_xor_b32 v22, v22, v23
    v_mul_u32_u24 v21, 1280, v21
    v_add_u32 v50, v21, v22
    v_lshlrev_b32 v20, 4, v1
    v_add_u32 v20, 1024, v20
    v_mul_u32_u24 v21, 52429, v20
    v_lshrrev_b32 v21, 26, v21
    v_mul_u32_u24 v22, 1280, v21
    v_sub_u32 v22, v20, v22
    v_lshlrev_b32 v23, 6, v21
    v_xor_b32 v22, v22, v23
    v_mul_u32_u24 v21, 1280, v21
    v_add_u32 v51, v21, v22
    v_lshlrev_b32 v20, 4, v1
    v_add_u32 v20, 2048, v20
    v_mul_u32_u24 v21, 52429, v20
    v_lshrrev_b32 v21, 26, v21
    v_mul_u32_u24 v22, 1280, v21
    v_sub_u32 v22, v20, v22
    v_lshlrev_b32 v23, 6, v21
    v_xor_b32 v22, v22, v23
    v_mul_u32_u24 v21, 1280, v21
    v_add_u32 v52, v21, v22
    v_lshlrev_b32 v20, 4, v1
    v_add_u32 v20, 3072, v20
    v_mul_u32_u24 v21, 52429, v20
    v_lshrrev_b32 v21, 26, v21
    v_mul_u32_u24 v22, 1280, v21
    v_sub_u32 v22, v20, v22
    v_lshlrev_b32 v23, 6, v21
    v_xor_b32 v22, v22, v23
    v_mul_u32_u24 v21, 1280, v21
    v_add_u32 v53, v21, v22
    v_lshlrev_b32 v20, 4, v1
    v_add_u32 v20, 4096, v20
    v_mul_u32_u24 v21, 52429, v20
    v_lshrrev_b32 v21, 26, v21
    v_mul_u32_u24 v22, 1280, v21
    v_sub_u32 v22, v20, v22
    v_lshlrev_b32 v23, 6, v21
    v_xor_b32 v22, v22, v23
    v_mul_u32_u24 v21, 1280, v21
    v_add_u32 v54, v21, v22
    s_mul_i32 s56, s30, 61440
    s_mul_i32 s3, s24, 15360
    s_add_u32 s56, s56, s3
    s_add_u32 s57, s3, 53248
    s_add_u32 m0, s57, 0
    s_add_u32 s35, s56, 0
    buffer_load_dwordx4 v50, s[4:7], s35 offen lds
    s_add_u32 m0, s57, 1024
    s_add_u32 s35, s56, 0
    buffer_load_dwordx4 v51, s[4:7], s35 offen lds
    s_add_u32 m0, s57, 2048
    s_add_u32 s35, s56, 0
    buffer_load_dwordx4 v52, s[4:7], s35 offen lds
    s_add_u32 m0, s57, 3072
    s_add_u32 s35, s56, 0
    buffer_load_dwordx4 v53, s[4:7], s35 offen lds
    s_add_u32 m0, s57, 4096
    s_add_u32 s35, s56, 0
    buffer_load_dwordx4 v54, s[4:7], s35 offen lds
    s_add_u32 m0, s57, 5120
    s_add_u32 s35, s56, 5120
    buffer_load_dwordx4 v50, s[4:7], s35 offen lds
    s_add_u32 m0, s57, 6144
    s_add_u32 s35, s56, 5120
    buffer_load_dwordx4 v51, s[4:7], s35 offen lds
    s_add_u32 m0, s57, 7168
    s_add_u32 s35, s56, 5120
    buffer_load_dwordx4 v52, s[4:7], s35 offen lds
    s_add_u32 m0, s57, 8192
    s_add_u32 s35, s56, 5120
    buffer_load_dwordx4 v53, s[4:7], s35 offen lds
    s_add_u32 m0, s57, 9216
    s_add_u32 s35, s56, 5120
    buffer_load_dwordx4 v54, s[4:7], s35 offen lds
    s_add_u32 m0, s57, 10240
    s_add_u32 s35, s56, 10240
    buffer_load_dwordx4 v50, s[4:7], s35 offen lds
    s_add_u32 m0, s57, 11264
    s_add_u32 s35, s56, 10240
    buffer_load_dwordx4 v51, s[4:7], s35 offen lds
    s_add_u32 m0, s57, 12288
    s_add_u32 s35, s56, 10240
    buffer_load_dwordx4 v52, s[4:7], s35 offen lds
    s_add_u32 m0, s57, 13312
    s_add_u32 s35, s56, 10240
    buffer_load_dwordx4 v53, s[4:7], s35 offen lds
    s_add_u32 m0, s57, 14336
    s_add_u32 s35, s56, 10240
    buffer_load_dwordx4 v54, s[4:7], s35 offen lds
    s_getpc_b64 s[12:13]
    s_add_u32 s12, s12, tab_ft@rel32@lo+4
    s_addc_u32 s13, s13, tab_ft@rel32@hi+12
    s_and_b32 s13, s13, 0xffff
    s_mov_b32 s14, 204800
    s_mov_b32 s15, 0x00020000
    v_lshlrev_b32 v48, 4, v1
    s_mul_i32 s25, s24, 51200
    s_add_u32 s16, s54, 8388608
    s_addc_u32 s17, s55, 0
    s_and_b32 s17, s17, 0xffff
    s_mov_b32 s18, 2621440
    s_mov_b32 s19, 0x00020000
    v_mul_u32_u24 v2, 336, v2
    v_add_u32 v2, v2, v5
    v_mov_b32 v4, 0
    v_mov_b32 v5, 0
    v_mov_b32 v8, 0
    v_mov_b32 v9, 0
    s_waitcnt vmcnt(34)
    v_lshlrev_b32 v64, 16, v66
    v_and_b32 v65, 0xffff0000, v66
    v_lshlrev_b32 v66, 16, v67
    v_and_b32 v67, 0xffff0000, v67
    v_pk_add_f32 v[4:5], v[4:5], v[64:65]
    v_pk_add_f32 v[4:5], v[4:5], v[66:67]
    s_waitcnt vmcnt(33)
    v_lshlrev_b32 v68, 16, v70
    v_and_b32 v69, 0xffff0000, v70
    v_lshlrev_b32 v70, 16, v71
    v_and_b32 v71, 0xffff0000, v71
    s_add_u32 m0, s83, 0
    s_add_u32 s35, s82, 0
    buffer_load_dwordx4 v49, s[84:87], s35 offen lds
    v_pk_add_f32 v[4:5], v[4:5], v[68:69]
    v_pk_add_f32 v[4:5], v[4:5], v[70:71]
    s_waitcnt vmcnt(33)
    v_lshlrev_b32 v72, 16, v74
    v_and_b32 v73, 0xffff0000, v74
    v_lshlrev_b32 v74, 16, v75
    v_and_b32 v75, 0xffff0000, v75
    v_pk_add_f32 v[4:5], v[4:5], v[72:73]
    v_pk_add_f32 v[4:5], v[4:5], v[74:75]
    s_waitcnt vmcnt(32)
    v_lshlrev_b32 v76, 16, v78
    v_and_b32 v77, 0xffff0000, v78
    s_add_u32 m0, s83, 1024
    s_add_u32 s35, s82, 1024
    buffer_load_dwordx4 v49, s[84:87], s35 offen lds
    v_lshlrev_b32 v78, 16, v79
    v_and_b32 v79, 0xffff0000, v79
    v_pk_add_f32 v[4:5], v[4:5], v[76:77]
    v_pk_add_f32 v[4:5], v[4:5], v[78:79]
    s_waitcnt vmcnt(32)
    v_lshlrev_b32 v80, 16, v82
    v_and_b32 v81, 0xffff0000, v82
    v_lshlrev_b32 v82, 16, v83
    v_and_b32 v83, 0xffff0000, v83
    v_pk_add_f32 v[4:5], v[4:5], v[80:81]
    v_pk_add_f32 v[4:5], v[4:5], v[82:83]
    s_add_u32 m0, s83, 2048
    s_add_u32 s35, s82, 2048
    buffer_load_dwordx4 v49, s[84:87], s35 offen lds
    s_waitcnt vmcnt(32)
    v_lshlrev_b32 v84, 16, v86
    v_and_b32 v85, 0xffff0000, v86
    v_lshlrev_b32 v86, 16, v87
    v_and_b32 v87, 0xffff0000, v87
    v_pk_add_f32 v[4:5], v[4:5], v[84:85]
    v_pk_add_f32 v[4:5], v[4:5], v[86:87]
    s_waitcnt vmcnt(31)
    v_lshlrev_b32 v88, 16, v90
    v_and_b32 v89, 0xffff0000, v90
    v_lshlrev_b32 v90, 16, v91
    v_and_b32 v91, 0xffff0000, v91
    s_add_u32 m0, s83, 3072
    s_add_u32 s35, s82, 3072
    buffer_load_dwordx4 v49, s[84:87], s35 offen lds
    v_pk_add_f32 v[4:5], v[4:5], v[88:89]
    v_pk_add_f32 v[4:5], v[4:5], v[90:91]
    s_waitcnt vmcnt(31)
    v_lshlrev_b32 v92, 16, v94
    v_and_b32 v93, 0xffff0000, v94
    v_lshlrev_b32 v94, 16, v95
    v_and_b32 v95, 0xffff0000, v95
    v_pk_add_f32 v[4:5], v[4:5], v[92:93]
    v_pk_add_f32 v[4:5], v[4:5], v[94:95]
    s_waitcnt vmcnt(30)
    v_lshlrev_b32 v96, 16, v98
    v_and_b32 v97, 0xffff0000, v98
    s_add_u32 m0, s83, 4096
    s_add_u32 s35, s82, 4096
    buffer_load_dwordx4 v49, s[84:87], s35 offen lds
    v_lshlrev_b32 v98, 16, v99
    v_and_b32 v99, 0xffff0000, v99
    v_pk_add_f32 v[4:5], v[4:5], v[96:97]
    v_pk_add_f32 v[4:5], v[4:5], v[98:99]
    s_waitcnt vmcnt(30)
    v_lshlrev_b32 v100, 16, v102
    v_and_b32 v101, 0xffff0000, v102
    v_lshlrev_b32 v102, 16, v103
    v_and_b32 v103, 0xffff0000, v103
    v_pk_add_f32 v[4:5], v[4:5], v[100:101]
    v_pk_add_f32 v[4:5], v[4:5], v[102:103]
    s_add_u32 m0, s83, 5120
    s_add_u32 s35, s82, 5120
    buffer_load_dwordx4 v49, s[84:87], s35 offen lds
    s_waitcnt vmcnt(30)
    v_lshlrev_b32 v104, 16, v106
    v_and_b32 v105, 0xffff0000, v106
    v_lshlrev_b32 v106, 16, v107
    v_and_b32 v107, 0xffff0000, v107
    v_pk_add_f32 v[4:5], v[4:5], v[104:105]
    v_pk_add_f32 v[4:5], v[4:5], v[106:107]
    s_waitcnt vmcnt(29)
    v_lshlrev_b32 v108, 16, v110
    v_and_b32 v109, 0xffff0000, v110
    v_lshlrev_b32 v110, 16, v111
    v_and_b32 v111, 0xffff0000, v111
    s_add_u32 m0, s83, 24576
    s_add_u32 s35, s82, 0
    buffer_load_dwordx4 v49, s[88:91], s35 offen lds
    v_pk_add_f32 v[4:5], v[4:5], v[108:109]
    v_pk_add_f32 v[4:5], v[4:5], v[110:111]
    s_waitcnt vmcnt(29)
    v_lshlrev_b32 v112, 16, v114
    v_and_b32 v113, 0xffff0000, v114
    v_lshlrev_b32 v114, 16, v115
    v_and_b32 v115, 0xffff0000, v115
    v_pk_add_f32 v[4:5], v[4:5], v[112:113]
    v_pk_add_f32 v[4:5], v[4:5], v[114:115]
    s_waitcnt vmcnt(28)
    v_lshlrev_b32 v116, 16, v118
    v_and_b32 v117, 0xffff0000, v118
    s_add_u32 m0, s83, 25600
    s_add_u32 s35, s82, 1024
    buffer_load_dwordx4 v49, s[88:91], s35 offen lds
    v_lshlrev_b32 v118, 16, v119
    v_and_b32 v119, 0xffff0000, v119
    v_pk_add_f32 v[4:5], v[4:5], v[116:117]
    v_pk_add_f32 v[4:5], v[4:5], v[118:119]
    s_waitcnt vmcnt(28)
    v_lshlrev_b32 v120, 16, v122
    v_and_b32 v121, 0xffff0000, v122
    v_lshlrev_b32 v122, 16, v123
    v_and_b32 v123, 0xffff0000, v123
    v_pk_add_f32 v[4:5], v[4:5], v[120:121]
    v_pk_add_f32 v[4:5], v[4:5], v[122:123]
    s_add_u32 m0, s83, 26624
    s_add_u32 s35, s82, 2048
    buffer_load_dwordx4 v49, s[88:91], s35 offen lds
    s_waitcnt vmcnt(28)
    v_lshlrev_b32 v124, 16, v126
    v_and_b32 v125, 0xffff0000, v126
    v_lshlrev_b32 v126, 16, v127
    v_and_b32 v127, 0xffff0000, v127
    v_pk_add_f32 v[4:5], v[4:5], v[124:125]
    v_pk_add_f32 v[4:5], v[4:5], v[126:127]
    s_waitcnt vmcnt(27)
    v_lshlrev_b32 v128, 16, v130
    v_and_b32 v129, 0xffff0000, v130
    v_lshlrev_b32 v130, 16, v131
    v_and_b32 v131, 0xffff0000, v131
    s_add_u32 m0, s83, 27648
    s_add_u32 s35, s82, 3072
    buffer_load_dwordx4 v49, s[88:91], s35 offen lds
    v_pk_add_f32 v[4:5], v[4:5], v[128:129]
    v_pk_add_f32 v[4:5], v[4:5], v[130:131]
    s_waitcnt vmcnt(27)
    v_lshlrev_b32 v132, 16, v134
    v_and_b32 v133, 0xffff0000, v134
    v_lshlrev_b32 v134, 16, v135
    v_and_b32 v135, 0xffff0000, v135
    v_pk_add_f32 v[4:5], v[4:5], v[132:133]
    v_pk_add_f32 v[4:5], v[4:5], v[134:135]
    s_waitcnt vmcnt(26)
    v_lshlrev_b32 v136, 16, v138
    v_and_b32 v137, 0xffff0000, v138
    s_add_u32 m0, s83, 28672
    s_add_u32 s35, s82, 4096
    buffer_load_dwordx4 v49, s[88:91], s35 offen lds
    v_lshlrev_b32 v138, 16, v139
    v_and_b32 v139, 0xffff0000, v139
    v_pk_add_f32 v[4:5], v[4:5], v[136:137]
    v_pk_add_f32 v[4:5], v[4:5], v[138:139]
    s_waitcnt vmcnt(26)
    v_lshlrev_b32 v140, 16, v142
    v_and_b32 v141, 0xffff0000, v142
    v_lshlrev_b32 v142, 16, v143
    v_and_b32 v143, 0xffff0000, v143
    v_pk_add_f32 v[4:5], v[4:5], v[140:141]
    v_pk_add_f32 v[4:5], v[4:5], v[142:143]
    s_add_u32 m0, s83, 29696
    s_add_u32 s35, s82, 5120
    buffer_load_dwordx4 v49, s[88:91], s35 offen lds
    s_waitcnt vmcnt(12)
    s_barrier
    s_add_u32 s16, s54, 14155776
    s_addc_u32 s17, s55, 0
    s_and_b32 s17, s17, 0xffff
    s_mov_b32 s18, 1986560
    s_mov_b32 s19, 0x00020000
    v_lshrrev_b32 v20, 5, v1
    v_lshrrev_b32 v21, 2, v1
    v_and_b32 v21, 3, v21
    v_lshl_add_u32 v22, v20, 2, v21
    v_mul_u32_u24 v22, 1280, v22
    v_lshrrev_b32 v23, 4, v1
    v_and_b32 v23, 1, v23
    v_lshl_add_u32 v22, v23, 5, v22
    v_and_b32 v23, 3, v1
    v_lshl_add_u32 v22, v23, 3, v22
    v_add_u32 v22, 53248, v22
    s_mul_i32 s3, s24, 5
    s_add_u32 s33, s3, 0
    v_xor_b32 v23, s33, v21
    v_lshl_add_u32 v24, v23, 6, v22
    s_add_u32 s33, s3, 1
    v_xor_b32 v23, s33, v21
    v_lshl_add_u32 v25, v23, 6, v22
    s_add_u32 s33, s3, 2
    v_xor_b32 v23, s33, v21
    v_lshl_add_u32 v26, v23, 6, v22
    s_add_u32 s33, s3, 3
    v_xor_b32 v23, s33, v21
    v_lshl_add_u32 v27, v23, 6, v22
    s_add_u32 s33, s3, 4
    v_xor_b32 v23, s33, v21
    v_lshl_add_u32 v28, v23, 6, v22
    v_lshlrev_b32 v18, 4, v1
    s_mul_i32 s58, s24, 5
    s_mul_i32 s58, s58, 99328
    s_mul_i32 s3, s30, 3072
    s_add_u32 s58, s58, s3
    ds_read_b64_tr_b16 v[160:161], v24 offset:0
    ds_read_b64_tr_b16 v[162:163], v24 offset:10240
    ds_read_b64_tr_b16 v[164:165], v24 offset:20480
    ds_read_b64_tr_b16 v[166:167], v24 offset:30720
    ds_read_b64_tr_b16 v[168:169], v24 offset:40960
    ds_read_b64_tr_b16 v[170:171], v24 offset:51200
    ds_read_b64_tr_b16 v[172:173], v25 offset:0
    ds_read_b64_tr_b16 v[174:175], v25 offset:10240
    ds_read_b64_tr_b16 v[176:177], v25 offset:20480
    ds_read_b64_tr_b16 v[178:179], v25 offset:30720
    ds_read_b64_tr_b16 v[180:181], v25 offset:40960
    ds_read_b64_tr_b16 v[182:183], v25 offset:51200
    ds_read_b64_tr_b16 v[184:185], v26 offset:0
    ds_read_b64_tr_b16 v[186:187], v26 offset:10240
    ds_read_b64_tr_b16 v[188:189], v26 offset:20480
    ds_read_b64_tr_b16 v[190:191], v26 offset:30720
    ds_read_b64_tr_b16 v[192:193], v26 offset:40960
    ds_read_b64_tr_b16 v[194:195], v26 offset:51200
    ds_read_b64_tr_b16 v[196:197], v27 offset:0
    ds_read_b64_tr_b16 v[198:199], v27 offset:10240
    ds_read_b64_tr_b16 v[200:201], v27 offset:20480
    ds_read_b64_tr_b16 v[202:203], v27 offset:30720
    ds_read_b64_tr_b16 v[204:205], v27 offset:40960
    ds_read_b64_tr_b16 v[206:207], v27 offset:51200
    ds_read_b64_tr_b16 v[208:209], v28 offset:0
    ds_read_b64_tr_b16 v[210:211], v28 offset:10240
    ds_read_b64_tr_b16 v[212:213], v28 offset:20480
    ds_read_b64_tr_b16 v[214:215], v28 offset:30720
    ds_read_b64_tr_b16 v[216:217], v28 offset:40960
    ds_read_b64_tr_b16 v[218:219], v28 offset:51200
    s_waitcnt lgkmcnt(15)
    buffer_store_dwordx4 v[160:163], v18, s[16:19], s58 offen offset:0 sc1
    s_waitcnt lgkmcnt(15)
    buffer_store_dwordx4 v[164:167], v18, s[16:19], s58 offen offset:1024 sc1
    s_waitcnt lgkmcnt(15)
    buffer_store_dwordx4 v[168:171], v18, s[16:19], s58 offen offset:2048 sc1
    s_add_u32 s58, s58, 99328
    s_waitcnt lgkmcnt(15)
    buffer_store_dwordx4 v[172:175], v18, s[16:19], s58 offen offset:0 sc1
    s_waitcnt lgkmcnt(15)
    buffer_store_dwordx4 v[176:179], v18, s[16:19], s58 offen offset:1024 sc1
    s_waitcnt lgkmcnt(15)
    buffer_store_dwordx4 v[180:183], v18, s[16:19], s58 offen offset:2048 sc1
    s_add_u32 s58, s58, 99328
    s_waitcnt lgkmcnt(15)
    buffer_store_dwordx4 v[184:187], v18, s[16:19], s58 offen offset:0 sc1
    s_waitcnt lgkmcnt(14)
    buffer_store_dwordx4 v[188:191], v18, s[16:19], s58 offen offset:1024 sc1
    s_waitcnt lgkmcnt(12)
    buffer_store_dwordx4 v[192:195], v18, s[16:19], s58 offen offset:2048 sc1
    s_add_u32 s58, s58, 99328
    s_waitcnt lgkmcnt(10)
    buffer_store_dwordx4 v[196:199], v18, s[16:19], s58 offen offset:0 sc1
    s_waitcnt lgkmcnt(8)
    buffer_store_dwordx4 v[200:203], v18, s[16:19], s58 offen offset:1024 sc1
    s_waitcnt lgkmcnt(6)
    buffer_store_dwordx4 v[204:207], v18, s[16:19], s58 offen offset:2048 sc1
    s_add_u32 s58, s58, 99328
    s_waitcnt lgkmcnt(4)
    buffer_store_dwordx4 v[208:211], v18, s[16:19], s58 offen offset:0 sc1
    s_waitcnt lgkmcnt(2)
    buffer_store_dwordx4 v[212:215], v18, s[16:19], s58 offen offset:1024 sc1
    s_waitcnt lgkmcnt(0)
    buffer_store_dwordx4 v[216:219], v18, s[16:19], s58 offen offset:2048 sc1
    s_add_u32 s58, s58, 99328
    s_add_u32 s16, s54, 8388608
    s_addc_u32 s17, s55, 0
    s_and_b32 s17, s17, 0xffff
    s_mov_b32 s18, 2621440
    s_mov_b32 s19, 0x00020000
    v_add_f32 v4, v4, v5
    s_nop 1
    v_add_f32_dpp v4, v4, v4 quad_perm:[1,0,3,2] row_mask:0xf bank_mask:0xf
    s_nop 1
    v_add_f32_dpp v4, v4, v4 quad_perm:[2,3,0,1] row_mask:0xf bank_mask:0xf
    s_nop 1
    v_add_f32_dpp v4, v4, v4 row_half_mirror row_mask:0xf bank_mask:0xf
    s_mov_b32 s26, 0x3acccccd
    v_mul_f32 v4, s26, v4
    v_cvt_pk_bf16_f32 v6, v4, v4
    v_lshlrev_b32 v6, 16, v6
    v_sub_f32 v5, v4, v6
    v_xor_b32 v6, 0x80000000, v6
    v_pk_add_f32 v[64:65], v[64:65], v[6:7] op_sel_hi:[1,0]
    v_pk_fma_f32 v[8:9], v[64:65], v[64:65], v[8:9]
    v_pk_add_f32 v[66:67], v[66:67], v[6:7] op_sel_hi:[1,0]
    v_pk_fma_f32 v[8:9], v[66:67], v[66:67], v[8:9]
    v_pk_add_f32 v[68:69], v[68:69], v[6:7] op_sel_hi:[1,0]
    v_pk_fma_f32 v[8:9], v[68:69], v[68:69], v[8:9]
    v_pk_add_f32 v[70:71], v[70:71], v[6:7] op_sel_hi:[1,0]
    v_pk_fma_f32 v[8:9], v[70:71], v[70:71], v[8:9]
    v_pk_add_f32 v[72:73], v[72:73], v[6:7] op_sel_hi:[1,0]
    v_pk_fma_f32 v[8:9], v[72:73], v[72:73], v[8:9]
    buffer_load_dwordx4 a[0:3], v48, s[12:15], s25 offen offset:0
    v_pk_add_f32 v[74:75], v[74:75], v[6:7] op_sel_hi:[1,0]
    v_pk_fma_f32 v[8:9], v[74:75], v[74:75], v[8:9]
    v_pk_add_f32 v[76:77], v[76:77], v[6:7] op_sel_hi:[1,0]
    v_pk_fma_f32 v[8:9], v[76:77], v[76:77], v[8:9]
    v_pk_add_f32 v[78:79], v[78:79], v[6:7] op_sel_hi:[1,0]
    v_pk_fma_f32 v[8:9], v[78:79], v[78:79], v[8:9]
    v_pk_add_f32 v[80:81], v[80:81], v[6:7] op_sel_hi:[1,0]
    v_pk_fma_f32 v[8:9], v[80:81], v[80:81], v[8:9]
    v_pk_add_f32 v[82:83], v[82:83], v[6:7] op_sel_hi:[1,0]
    v_pk_fma_f32 v[8:9], v[82:83], v[82:83], v[8:9]
    buffer_load_dwordx4 a[4:7], v48, s[12:15], s25 offen offset:1024
    v_pk_add_f32 v[84:85], v[84:85], v[6:7] op_sel_hi:[1,0]
    v_pk_fma_f32 v[8:9], v[84:85], v[84:85], v[8:9]
    v_pk_add_f32 v[86:87], v[86:87], v[6:7] op_sel_hi:[1,0]
    v_pk_fma_f32 v[8:9], v[86:87], v[86:87], v[8:9]
    v_pk_add_f32 v[88:89], v[88:89], v[6:7] op_sel_hi:[1,0]
    v_pk_fma_f32 v[8:9], v[88:89], v[88:89], v[8:9]
    v_pk_add_f32 v[90:91], v[90:91], v[6:7] op_sel_hi:[1,0]
    v_pk_fma_f32 v[8:9], v[90:91], v[90:91], v[8:9]
    v_pk_add_f32 v[92:93], v[92:93], v[6:7] op_sel_hi:[1,0]
    v_pk_fma_f32 v[8:9], v[92:93], v[92:93], v[8:9]
    buffer_load_dwordx4 a[8:11], v48, s[12:15], s25 offen offset:2048
    v_pk_add_f32 v[94:95], v[94:95], v[6:7] op_sel_hi:[1,0]
    v_pk_fma_f32 v[8:9], v[94:95], v[94:95], v[8:9]
    v_pk_add_f32 v[96:97], v[96:97], v[6:7] op_sel_hi:[1,0]
    v_pk_fma_f32 v[8:9], v[96:97], v[96:97], v[8:9]
    v_pk_add_f32 v[98:99], v[98:99], v[6:7] op_sel_hi:[1,0]
    v_pk_fma_f32 v[8:9], v[98:99], v[98:99], v[8:9]
    v_pk_add_f32 v[100:101], v[100:101], v[6:7] op_sel_hi:[1,0]
    v_pk_fma_f32 v[8:9], v[100:101], v[100:101], v[8:9]
    v_pk_add_f32 v[102:103], v[102:103], v[6:7] op_sel_hi:[1,0]
    v_pk_fma_f32 v[8:9], v[102:103], v[102:103], v[8:9]
    buffer_load_dwordx4 a[12:15], v48, s[12:15], s25 offen offset:3072
    v_pk_add_f32 v[104:105], v[104:105], v[6:7] op_sel_hi:[1,0]
    v_pk_fma_f32 v[8:9], v[104:105], v[104:105], v[8:9]
    v_pk_add_f32 v[106:107], v[106:107], v[6:7] op_sel_hi:[1,0]
    v_pk_fma_f32 v[8:9], v[106:107], v[106:107], v[8:9]
    v_pk_add_f32 v[108:109], v[108:109], v[6:7] op_sel_hi:[1,0]
    v_pk_fma_f32 v[8:9], v[108:109], v[108:109], v[8:9]
    v_pk_add_f32 v[110:111], v[110:111], v[6:7] op_sel_hi:[1,0]
    v_pk_fma_f32 v[8:9], v[110:111], v[110:111], v[8:9]
    v_pk_add_f32 v[112:113], v[112:113], v[6:7] op_sel_hi:[1,0]
    v_pk_fma_f32 v[8:9], v[112:113], v[112:113], v[8:9]
    s_add_u32 s25, s25, 4096
    buffer_load_dwordx4 a[16:19], v48, s[12:15], s25 offen offset:0
    v_pk_add_f32 v[114:115], v[114:115], v[6:7] op_sel_hi:[1,0]
    v_pk_fma_f32 v[8:9], v[114:115], v[114:115], v[8:9]
    v_pk_add_f32 v[116:117], v[116:117], v[6:7] op_sel_hi:[1,0]
    v_pk_fma_f32 v[8:9], v[116:117], v[116:117], v[8:9]
    v_pk_add_f32 v[118:119], v[118:119], v[6:7] op_sel_hi:[1,0]
    v_pk_fma_f32 v[8:9], v[118:119], v[118:119], v[8:9]
    v_pk_add_f32 v[120:121], v[120:121], v[6:7] op_sel_hi:[1,0]
    v_pk_fma_f32 v[8:9], v[120:121], v[120:121], v[8:9]
    v_pk_add_f32 v[122:123], v[122:123], v[6:7] op_sel_hi:[1,0]
    v_pk_fma_f32 v[8:9], v[122:123], v[122:123], v[8:9]
    buffer_load_dwordx4 a[20:23], v48, s[12:15], s25 offen offset:1024
    v_pk_add_f32 v[124:125], v[124:125], v[6:7] op_sel_hi:[1,0]
    v_pk_fma_f32 v[8:9], v[124:125], v[124:125], v[8:9]
    v_pk_add_f32 v[126:127], v[126:127], v[6:7] op_sel_hi:[1,0]
    v_pk_fma_f32 v[8:9], v[126:127], v[126:127], v[8:9]
    v_pk_add_f32 v[128:129], v[128:129], v[6:7] op_sel_hi:[1,0]
    v_pk_fma_f32 v[8:9], v[128:129], v[128:129], v[8:9]
    v_pk_add_f32 v[130:131], v[130:131], v[6:7] op_sel_hi:[1,0]
    v_pk_fma_f32 v[8:9], v[130:131], v[130:131], v[8:9]
    v_pk_add_f32 v[132:133], v[132:133], v[6:7] op_sel_hi:[1,0]
    v_pk_fma_f32 v[8:9], v[132:133], v[132:133], v[8:9]
    buffer_load_dwordx4 a[24:27], v48, s[12:15], s25 offen offset:2048
    v_pk_add_f32 v[134:135], v[134:135], v[6:7] op_sel_hi:[1,0]
    v_pk_fma_f32 v[8:9], v[134:135], v[134:135], v[8:9]
    v_pk_add_f32 v[136:137], v[136:137], v[6:7] op_sel_hi:[1,0]
    v_pk_fma_f32 v[8:9], v[136:137], v[136:137], v[8:9]
    v_pk_add_f32 v[138:139], v[138:139], v[6:7] op_sel_hi:[1,0]
    v_pk_fma_f32 v[8:9], v[138:139], v[138:139], v[8:9]
    v_pk_add_f32 v[140:141], v[140:141], v[6:7] op_sel_hi:[1,0]
    v_pk_fma_f32 v[8:9], v[140:141], v[140:141], v[8:9]
    v_pk_add_f32 v[142:143], v[142:143], v[6:7] op_sel_hi:[1,0]
    v_pk_fma_f32 v[8:9], v[142:143], v[142:143], v[8:9]
    buffer_load_dwordx4 a[28:31], v48, s[12:15], s25 offen offset:3072
    s_waitcnt vmcnt(8)
    s_barrier
    s_cmp_lg_u32 s24, 0
    s_cbranch_scc1 arr_44
    s_mov_b32 s92, s52
    s_and_b32 s93, s53, 0xffff
    s_mov_b32 s94, 256
    s_mov_b32 s95, 0x00020000
    s_mov_b32 s58, 0
    v_mov_b32 v10, 0
wi_45:
    buffer_load_dword v11, v10, s[92:95], 0 offen offset:240 sc1
    s_waitcnt vmcnt(0)
    v_readfirstlane_b32 s3, v11
    s_nop 3
    s_cmp_lg_u32 s3, 0
    s_cbranch_scc1 wiok_46
    s_add_u32 s58, s58, 1
    s_cmp_ge_u32 s58, 65536
    s_cbranch_scc1 wiok_46
    s_sleep 2
    s_branch wi_45
wiok_46:
    v_cmp_gt_u32 vcc, 16, v1
    s_and_saveexec_b64 s[100:101], vcc
    v_lshlrev_b32 v10, 7, v1
    v_mov_b32 v11, 1
    buffer_atomic_add v11, v10, s[96:99], 0 offen offset:4 sc1
    s_mov_b64 exec, s[100:101]
arr_44:
    v_add_f32 v8, v8, v9
    s_nop 1
    v_add_f32_dpp v8, v8, v8 quad_perm:[1,0,3,2] row_mask:0xf bank_mask:0xf
    s_nop 1
    v_add_f32_dpp v8, v8, v8 quad_perm:[2,3,0,1] row_mask:0xf bank_mask:0xf
    s_nop 1
    v_add_f32_dpp v8, v8, v8 row_half_mirror row_mask:0xf bank_mask:0xf
    v_mul_f32 v8, s26, v8
    v_fma_f32 v8, -v5, v5, v8
    v_max_f32 v8, 0, v8
    v_cvt_pk_bf16_f32 v8, v8, v8
    v_lshlrev_b32 v8, 16, v8
    v_add_f32 v8, 0x3727c5ac, v8
    v_cvt_pk_bf16_f32 v8, v8, v8
    v_lshlrev_b32 v8, 16, v8
    v_sqrt_f32 v8, v8
    s_nop 0
    v_cvt_pk_bf16_f32 v8, v8, v8
    v_lshlrev_b32 v8, 16, v8
    v_rcp_f32 v8, v8
    s_nop 0
    v_cvt_pk_bf16_f32 v10, v64, v65
    v_lshlrev_b32 v64, 16, v10
    v_and_b32 v65, 0xffff0000, v10
    v_pk_mul_f32 v[64:65], v[64:65], v[8:9] op_sel_hi:[1,0]
    v_cvt_pk_bf16_f32 v10, v64, v65
    v_lshlrev_b32 v64, 16, v10
    v_and_b32 v65, 0xffff0000, v10
    v_cvt_pk_bf16_f32 v10, v66, v67
    v_lshlrev_b32 v66, 16, v10
    v_and_b32 v67, 0xffff0000, v10
    s_add_u32 s25, s25, 4096
    buffer_load_dwordx4 a[32:35], v48, s[12:15], s25 offen offset:0
    v_pk_mul_f32 v[66:67], v[66:67], v[8:9] op_sel_hi:[1,0]
    v_cvt_pk_bf16_f32 v10, v66, v67
    v_lshlrev_b32 v66, 16, v10
    v_and_b32 v67, 0xffff0000, v10
    v_cvt_pk_bf16_f32 v10, v68, v69
    v_lshlrev_b32 v68, 16, v10
    v_and_b32 v69, 0xffff0000, v10
    v_pk_mul_f32 v[68:69], v[68:69], v[8:9] op_sel_hi:[1,0]
    v_cvt_pk_bf16_f32 v10, v68, v69
    v_lshlrev_b32 v68, 16, v10
    buffer_load_dwordx4 a[36:39], v48, s[12:15], s25 offen offset:1024
    v_and_b32 v69, 0xffff0000, v10
    v_cvt_pk_bf16_f32 v10, v70, v71
    v_lshlrev_b32 v70, 16, v10
    v_and_b32 v71, 0xffff0000, v10
    v_pk_mul_f32 v[70:71], v[70:71], v[8:9] op_sel_hi:[1,0]
    v_cvt_pk_bf16_f32 v10, v70, v71
    v_lshlrev_b32 v70, 16, v10
    v_and_b32 v71, 0xffff0000, v10
    v_cvt_pk_bf16_f32 v10, v72, v73
    v_lshlrev_b32 v72, 16, v10
    buffer_load_dwordx4 a[40:43], v48, s[12:15], s25 offen offset:2048
    v_and_b32 v73, 0xffff0000, v10
    v_pk_mul_f32 v[72:73], v[72:73], v[8:9] op_sel_hi:[1,0]
    v_cvt_pk_bf16_f32 v10, v72, v73
    v_lshlrev_b32 v72, 16, v10
    v_and_b32 v73, 0xffff0000, v10
    v_cvt_pk_bf16_f32 v10, v74, v75
    v_lshlrev_b32 v74, 16, v10
    v_and_b32 v75, 0xffff0000, v10
    v_pk_mul_f32 v[74:75], v[74:75], v[8:9] op_sel_hi:[1,0]
    v_cvt_pk_bf16_f32 v10, v74, v75
    buffer_load_dwordx4 a[44:47], v48, s[12:15], s25 offen offset:3072
    v_lshlrev_b32 v74, 16, v10
    v_and_b32 v75, 0xffff0000, v10
    v_cvt_pk_bf16_f32 v10, v76, v77
    v_lshlrev_b32 v76, 16, v10
    v_and_b32 v77, 0xffff0000, v10
    v_pk_mul_f32 v[76:77], v[76:77], v[8:9] op_sel_hi:[1,0]
    v_cvt_pk_bf16_f32 v10, v76, v77
    v_lshlrev_b32 v76, 16, v10
    v_and_b32 v77, 0xffff0000, v10
    v_cvt_pk_bf16_f32 v10, v78, v79
    s_add_u32 s25, s25, 4096
    buffer_load_dwordx4 a[48:51], v48, s[12:15], s25 offen offset:0
    v_lshlrev_b32 v78, 16, v10
    v_and_b32 v79, 0xffff0000, v10
    v_pk_mul_f32 v[78:79], v[78:79], v[8:9] op_sel_hi:[1,0]
    v_cvt_pk_bf16_f32 v10, v78, v79
    v_lshlrev_b32 v78, 16, v10
    v_and_b32 v79, 0xffff0000, v10
    v_cvt_pk_bf16_f32 v10, v80, v81
    v_lshlrev_b32 v80, 16, v10
    v_and_b32 v81, 0xffff0000, v10
    v_pk_mul_f32 v[80:81], v[80:81], v[8:9] op_sel_hi:[1,0]
    buffer_load_dwordx4 a[52:55], v48, s[12:15], s25 offen offset:1024
    v_cvt_pk_bf16_f32 v10, v80, v81
    v_lshlrev_b32 v80, 16, v10
    v_and_b32 v81, 0xffff0000, v10
    v_cvt_pk_bf16_f32 v10, v82, v83
    v_lshlrev_b32 v82, 16, v10
    v_and_b32 v83, 0xffff0000, v10
    v_pk_mul_f32 v[82:83], v[82:83], v[8:9] op_sel_hi:[1,0]
    v_cvt_pk_bf16_f32 v10, v82, v83
    v_lshlrev_b32 v82, 16, v10
    v_and_b32 v83, 0xffff0000, v10
    buffer_load_dwordx4 a[56:59], v48, s[12:15], s25 offen offset:2048
    v_cvt_pk_bf16_f32 v10, v84, v85
    v_lshlrev_b32 v84, 16, v10
    v_and_b32 v85, 0xffff0000, v10
    v_pk_mul_f32 v[84:85], v[84:85], v[8:9] op_sel_hi:[1,0]
    v_cvt_pk_bf16_f32 v10, v84, v85
    v_lshlrev_b32 v84, 16, v10
    v_and_b32 v85, 0xffff0000, v10
    v_cvt_pk_bf16_f32 v10, v86, v87
    v_lshlrev_b32 v86, 16, v10
    v_and_b32 v87, 0xffff0000, v10
    buffer_load_dwordx4 a[60:63], v48, s[12:15], s25 offen offset:3072
    v_pk_mul_f32 v[86:87], v[86:87], v[8:9] op_sel_hi:[1,0]
    v_cvt_pk_bf16_f32 v10, v86, v87
    v_lshlrev_b32 v86, 16, v10
    v_and_b32 v87, 0xffff0000, v10
    v_cvt_pk_bf16_f32 v10, v88, v89
    v_lshlrev_b32 v88, 16, v10
    v_and_b32 v89, 0xffff0000, v10
    v_pk_mul_f32 v[88:89], v[88:89], v[8:9] op_sel_hi:[1,0]
    v_cvt_pk_bf16_f32 v10, v88, v89
    v_lshlrev_b32 v88, 16, v10
    s_add_u32 s25, s25, 4096
    buffer_load_dwordx4 a[64:67], v48, s[12:15], s25 offen offset:0
    v_and_b32 v89, 0xffff0000, v10
    v_cvt_pk_bf16_f32 v10, v90, v91
    v_lshlrev_b32 v90, 16, v10
    v_and_b32 v91, 0xffff0000, v10
    v_pk_mul_f32 v[90:91], v[90:91], v[8:9] op_sel_hi:[1,0]
    v_cvt_pk_bf16_f32 v10, v90, v91
    v_lshlrev_b32 v90, 16, v10
    v_and_b32 v91, 0xffff0000, v10
    v_cvt_pk_bf16_f32 v10, v92, v93
    v_lshlrev_b32 v92, 16, v10
    buffer_load_dwordx4 a[68:71], v48, s[12:15], s25 offen offset:1024
    v_and_b32 v93, 0xffff0000, v10
    v_pk_mul_f32 v[92:93], v[92:93], v[8:9] op_sel_hi:[1,0]
    v_cvt_pk_bf16_f32 v10, v92, v93
    v_lshlrev_b32 v92, 16, v10
    v_and_b32 v93, 0xffff0000, v10
    v_cvt_pk_bf16_f32 v10, v94, v95
    v_lshlrev_b32 v94, 16, v10
    v_and_b32 v95, 0xffff0000, v10
    v_pk_mul_f32 v[94:95], v[94:95], v[8:9] op_sel_hi:[1,0]
    v_cvt_pk_bf16_f32 v10, v94, v95
    buffer_load_dwordx4 a[72:75], v48, s[12:15], s25 offen offset:2048
    v_lshlrev_b32 v94, 16, v10
    v_and_b32 v95, 0xffff0000, v10
    v_cvt_pk_bf16_f32 v10, v96, v97
    v_lshlrev_b32 v96, 16, v10
    v_and_b32 v97, 0xffff0000, v10
    v_pk_mul_f32 v[96:97], v[96:97], v[8:9] op_sel_hi:[1,0]
    v_cvt_pk_bf16_f32 v10, v96, v97
    v_lshlrev_b32 v96, 16, v10
    v_and_b32 v97, 0xffff0000, v10
    v_cvt_pk_bf16_f32 v10, v98, v99
    buffer_load_dwordx4 a[76:79], v48, s[12:15], s25 offen offset:3072
    v_lshlrev_b32 v98, 16, v10
    v_and_b32 v99, 0xffff0000, v10
    v_pk_mul_f32 v[98:99], v[98:99], v[8:9] op_sel_hi:[1,0]
    v_cvt_pk_bf16_f32 v10, v98, v99
    v_lshlrev_b32 v98, 16, v10
    v_and_b32 v99, 0xffff0000, v10
    v_cvt_pk_bf16_f32 v10, v100, v101
    v_lshlrev_b32 v100, 16, v10
    v_and_b32 v101, 0xffff0000, v10
    v_pk_mul_f32 v[100:101], v[100:101], v[8:9] op_sel_hi:[1,0]
    s_add_u32 s25, s25, 4096
    buffer_load_dwordx4 a[80:83], v48, s[12:15], s25 offen offset:0
    v_cvt_pk_bf16_f32 v10, v100, v101
    v_lshlrev_b32 v100, 16, v10
    v_and_b32 v101, 0xffff0000, v10
    v_cvt_pk_bf16_f32 v10, v102, v103
    v_lshlrev_b32 v102, 16, v10
    v_and_b32 v103, 0xffff0000, v10
    v_pk_mul_f32 v[102:103], v[102:103], v[8:9] op_sel_hi:[1,0]
    v_cvt_pk_bf16_f32 v10, v102, v103
    v_lshlrev_b32 v102, 16, v10
    v_and_b32 v103, 0xffff0000, v10
    buffer_load_dwordx4 a[84:87], v48, s[12:15], s25 offen offset:1024
    v_cvt_pk_bf16_f32 v10, v104, v105
    v_lshlrev_b32 v104, 16, v10
    v_and_b32 v105, 0xffff0000, v10
    v_pk_mul_f32 v[104:105], v[104:105], v[8:9] op_sel_hi:[1,0]
    v_cvt_pk_bf16_f32 v10, v104, v105
    v_lshlrev_b32 v104, 16, v10
    v_and_b32 v105, 0xffff0000, v10
    v_cvt_pk_bf16_f32 v10, v106, v107
    v_lshlrev_b32 v106, 16, v10
    v_and_b32 v107, 0xffff0000, v10
    buffer_load_dwordx4 a[88:91], v48, s[12:15], s25 offen offset:2048
    v_pk_mul_f32 v[106:107], v[106:107], v[8:9] op_sel_hi:[1,0]
    v_cvt_pk_bf16_f32 v10, v106, v107
    v_lshlrev_b32 v106, 16, v10
    v_and_b32 v107, 0xffff0000, v10
    v_cvt_pk_bf16_f32 v10, v108, v109
    v_lshlrev_b32 v108, 16, v10
    v_and_b32 v109, 0xffff0000, v10
    v_pk_mul_f32 v[108:109], v[108:109], v[8:9] op_sel_hi:[1,0]
    v_cvt_pk_bf16_f32 v10, v108, v109
    v_lshlrev_b32 v108, 16, v10
    buffer_load_dwordx4 a[92:95], v48, s[12:15], s25 offen offset:3072
    v_and_b32 v109, 0xffff0000, v10
    v_cvt_pk_bf16_f32 v10, v110, v111
    v_lshlrev_b32 v110, 16, v10
    v_and_b32 v111, 0xffff0000, v10
    v_pk_mul_f32 v[110:111], v[110:111], v[8:9] op_sel_hi:[1,0]
    v_cvt_pk_bf16_f32 v10, v110, v111
    v_lshlrev_b32 v110, 16, v10
    v_and_b32 v111, 0xffff0000, v10
    v_cvt_pk_bf16_f32 v10, v112, v113
    v_lshlrev_b32 v112, 16, v10
    s_add_u32 s25, s25, 4096
    buffer_load_dwordx4 a[96:99], v48, s[12:15], s25 offen offset:0
    v_and_b32 v113, 0xffff0000, v10
    v_pk_mul_f32 v[112:113], v[112:113], v[8:9] op_sel_hi:[1,0]
    v_cvt_pk_bf16_f32 v10, v112, v113
    v_lshlrev_b32 v112, 16, v10
    v_and_b32 v113, 0xffff0000, v10
    v_cvt_pk_bf16_f32 v10, v114, v115
    v_lshlrev_b32 v114, 16, v10
    v_and_b32 v115, 0xffff0000, v10
    v_pk_mul_f32 v[114:115], v[114:115], v[8:9] op_sel_hi:[1,0]
    v_cvt_pk_bf16_f32 v10, v114, v115
    buffer_load_dwordx4 a[100:103], v48, s[12:15], s25 offen offset:1024
    v_lshlrev_b32 v114, 16, v10
    v_and_b32 v115, 0xffff0000, v10
    v_cvt_pk_bf16_f32 v10, v116, v117
    v_lshlrev_b32 v116, 16, v10
    v_and_b32 v117, 0xffff0000, v10
    v_pk_mul_f32 v[116:117], v[116:117], v[8:9] op_sel_hi:[1,0]
    v_cvt_pk_bf16_f32 v10, v116, v117
    v_lshlrev_b32 v116, 16, v10
    v_and_b32 v117, 0xffff0000, v10
    v_cvt_pk_bf16_f32 v10, v118, v119
    buffer_load_dwordx4 a[104:107], v48, s[12:15], s25 offen offset:2048
    v_lshlrev_b32 v118, 16, v10
    v_and_b32 v119, 0xffff0000, v10
    v_pk_mul_f32 v[118:119], v[118:119], v[8:9] op_sel_hi:[1,0]
    v_cvt_pk_bf16_f32 v10, v118, v119
    v_lshlrev_b32 v118, 16, v10
    v_and_b32 v119, 0xffff0000, v10
    v_cvt_pk_bf16_f32 v10, v120, v121
    v_lshlrev_b32 v120, 16, v10
    v_and_b32 v121, 0xffff0000, v10
    v_pk_mul_f32 v[120:121], v[120:121], v[8:9] op_sel_hi:[1,0]
    buffer_load_dwordx4 a[108:111], v48, s[12:15], s25 offen offset:3072
    v_cvt_pk_bf16_f32 v10, v120, v121
    v_lshlrev_b32 v120, 16, v10
    v_and_b32 v121, 0xffff0000, v10
    v_cvt_pk_bf16_f32 v10, v122, v123
    v_lshlrev_b32 v122, 16, v10
    v_and_b32 v123, 0xffff0000, v10
    v_pk_mul_f32 v[122:123], v[122:123], v[8:9] op_sel_hi:[1,0]
    v_cvt_pk_bf16_f32 v10, v122, v123
    v_lshlrev_b32 v122, 16, v10
    v_and_b32 v123, 0xffff0000, v10
    s_add_u32 s25, s25, 4096
    buffer_load_dwordx4 a[112:115], v48, s[12:15], s25 offen offset:0
    v_cvt_pk_bf16_f32 v10, v124, v125
    v_lshlrev_b32 v124, 16, v10
    v_and_b32 v125, 0xffff0000, v10
    v_pk_mul_f32 v[124:125], v[124:125], v[8:9] op_sel_hi:[1,0]
    v_cvt_pk_bf16_f32 v10, v124, v125
    v_lshlrev_b32 v124, 16, v10
    v_and_b32 v125, 0xffff0000, v10
    v_cvt_pk_bf16_f32 v10, v126, v127
    v_lshlrev_b32 v126, 16, v10
    v_and_b32 v127, 0xffff0000, v10
    buffer_load_dwordx4 a[116:119], v48, s[12:15], s25 offen offset:1024
    v_pk_mul_f32 v[126:127], v[126:127], v[8:9] op_sel_hi:[1,0]
    v_cvt_pk_bf16_f32 v10, v126, v127
    v_lshlrev_b32 v126, 16, v10
    v_and_b32 v127, 0xffff0000, v10
    v_cvt_pk_bf16_f32 v10, v128, v129
    v_lshlrev_b32 v128, 16, v10
    v_and_b32 v129, 0xffff0000, v10
    v_pk_mul_f32 v[128:129], v[128:129], v[8:9] op_sel_hi:[1,0]
    v_cvt_pk_bf16_f32 v10, v128, v129
    v_lshlrev_b32 v128, 16, v10
    buffer_load_dwordx4 a[120:123], v48, s[12:15], s25 offen offset:2048
    v_and_b32 v129, 0xffff0000, v10
    v_cvt_pk_bf16_f32 v10, v130, v131
    v_lshlrev_b32 v130, 16, v10
    v_and_b32 v131, 0xffff0000, v10
    v_pk_mul_f32 v[130:131], v[130:131], v[8:9] op_sel_hi:[1,0]
    v_cvt_pk_bf16_f32 v10, v130, v131
    v_lshlrev_b32 v130, 16, v10
    v_and_b32 v131, 0xffff0000, v10
    v_cvt_pk_bf16_f32 v10, v132, v133
    v_lshlrev_b32 v132, 16, v10
    buffer_load_dwordx4 a[124:127], v48, s[12:15], s25 offen offset:3072
    v_and_b32 v133, 0xffff0000, v10
    v_pk_mul_f32 v[132:133], v[132:133], v[8:9] op_sel_hi:[1,0]
    v_cvt_pk_bf16_f32 v10, v132, v133
    v_lshlrev_b32 v132, 16, v10
    v_and_b32 v133, 0xffff0000, v10
    v_cvt_pk_bf16_f32 v10, v134, v135
    v_lshlrev_b32 v134, 16, v10
    v_and_b32 v135, 0xffff0000, v10
    v_pk_mul_f32 v[134:135], v[134:135], v[8:9] op_sel_hi:[1,0]
    v_cvt_pk_bf16_f32 v10, v134, v135
    s_add_u32 s25, s25, 4096
    buffer_load_dwordx4 a[128:131], v48, s[12:15], s25 offen offset:0
    v_lshlrev_b32 v134, 16, v10
    v_and_b32 v135, 0xffff0000, v10
    v_cvt_pk_bf16_f32 v10, v136, v137
    v_lshlrev_b32 v136, 16, v10
    v_and_b32 v137, 0xffff0000, v10
    v_pk_mul_f32 v[136:137], v[136:137], v[8:9] op_sel_hi:[1,0]
    v_cvt_pk_bf16_f32 v10, v136, v137
    v_lshlrev_b32 v136, 16, v10
    v_and_b32 v137, 0xffff0000, v10
    v_cvt_pk_bf16_f32 v10, v138, v139
    buffer_load_dwordx4 a[132:135], v48, s[12:15], s25 offen offset:1024
    v_lshlrev_b32 v138, 16, v10
    v_and_b32 v139, 0xffff0000, v10
    v_pk_mul_f32 v[138:139], v[138:139], v[8:9] op_sel_hi:[1,0]
    v_cvt_pk_bf16_f32 v10, v138, v139
    v_lshlrev_b32 v138, 16, v10
    v_and_b32 v139, 0xffff0000, v10
    v_cvt_pk_bf16_f32 v10, v140, v141
    v_lshlrev_b32 v140, 16, v10
    v_and_b32 v141, 0xffff0000, v10
    v_pk_mul_f32 v[140:141], v[140:141], v[8:9] op_sel_hi:[1,0]
    buffer_load_dwordx4 a[136:139], v48, s[12:15], s25 offen offset:2048
    v_cvt_pk_bf16_f32 v10, v140, v141
    v_lshlrev_b32 v140, 16, v10
    v_and_b32 v141, 0xffff0000, v10
    v_cvt_pk_bf16_f32 v10, v142, v143
    v_lshlrev_b32 v142, 16, v10
    v_and_b32 v143, 0xffff0000, v10
    v_pk_mul_f32 v[142:143], v[142:143], v[8:9] op_sel_hi:[1,0]
    v_cvt_pk_bf16_f32 v10, v142, v143
    v_lshlrev_b32 v142, 16, v10
    v_and_b32 v143, 0xffff0000, v10
    buffer_load_dwordx4 a[140:143], v48, s[12:15], s25 offen offset:3072
    v_pk_add_f32 v[10:11], v[64:65], v[78:79] op_sel:[0,1] op_sel_hi:[1,0]
    v_pk_add_f32 v[64:65], v[64:65], v[78:79] op_sel:[0,1] op_sel_hi:[1,0] neg_lo:[0,1] neg_hi:[0,1]
    v_pk_add_f32 v[12:13], v[72:73], v[70:71] op_sel:[0,1] op_sel_hi:[1,0]
    v_pk_add_f32 v[72:73], v[72:73], v[70:71] op_sel:[0,1] op_sel_hi:[1,0] neg_lo:[0,1] neg_hi:[0,1]
    v_pk_add_f32 v[14:15], v[10:11], v[12:13]
    v_cvt_pk_f16_f32 v16, v14, v15
    v_pk_add_f32 v[14:15], v[64:65], v[72:73]
    v_cvt_pk_f16_f32 v18, v14, v15
    v_pk_add_f32 v[14:15], v[10:11], v[12:13] neg_lo:[0,1] neg_hi:[0,1]
    v_cvt_pk_f16_f32 v20, v14, v15
    s_add_u32 s25, s25, 4096
    buffer_load_dwordx4 a[144:147], v48, s[12:15], s25 offen offset:0
    v_pk_add_f32 v[14:15], v[64:65], v[72:73] neg_lo:[0,1] neg_hi:[0,1]
    v_cvt_pk_f16_f32 v22, v14, v15
    v_pk_add_f32 v[10:11], v[66:67], v[76:77] op_sel:[0,1] op_sel_hi:[1,0]
    v_pk_add_f32 v[66:67], v[66:67], v[76:77] op_sel:[0,1] op_sel_hi:[1,0] neg_lo:[0,1] neg_hi:[0,1]
    v_pk_add_f32 v[12:13], v[74:75], v[68:69] op_sel:[0,1] op_sel_hi:[1,0]
    v_pk_add_f32 v[74:75], v[74:75], v[68:69] op_sel:[0,1] op_sel_hi:[1,0] neg_lo:[0,1] neg_hi:[0,1]
    v_pk_add_f32 v[14:15], v[10:11], v[12:13]
    v_cvt_pk_f16_f32 v17, v14, v15
    v_pk_add_f32 v[14:15], v[66:67], v[74:75]
    v_cvt_pk_f16_f32 v19, v14, v15
    buffer_load_dwordx4 a[148:151], v48, s[12:15], s25 offen offset:1024
    v_pk_add_f32 v[14:15], v[10:11], v[12:13] neg_lo:[0,1] neg_hi:[0,1]
    v_cvt_pk_f16_f32 v21, v14, v15
    v_pk_add_f32 v[14:15], v[66:67], v[74:75] neg_lo:[0,1] neg_hi:[0,1]
    v_cvt_pk_f16_f32 v23, v14, v15
    ds_write_b64 v2, v[16:17] offset:0
    ds_write_b64 v2, v[18:19] offset:10752
    ds_write_b64 v2, v[20:21] offset:21504
    ds_write_b64 v2, v[22:23] offset:32256
    v_pk_add_f32 v[10:11], v[80:81], v[94:95] op_sel:[0,1] op_sel_hi:[1,0]
    v_pk_add_f32 v[80:81], v[80:81], v[94:95] op_sel:[0,1] op_sel_hi:[1,0] neg_lo:[0,1] neg_hi:[0,1]
    buffer_load_dwordx4 a[152:155], v48, s[12:15], s25 offen offset:2048
    v_pk_add_f32 v[12:13], v[88:89], v[86:87] op_sel:[0,1] op_sel_hi:[1,0]
    v_pk_add_f32 v[88:89], v[88:89], v[86:87] op_sel:[0,1] op_sel_hi:[1,0] neg_lo:[0,1] neg_hi:[0,1]
    v_pk_add_f32 v[14:15], v[10:11], v[12:13]
    v_cvt_pk_f16_f32 v24, v14, v15
    v_pk_add_f32 v[14:15], v[80:81], v[88:89]
    v_cvt_pk_f16_f32 v26, v14, v15
    v_pk_add_f32 v[14:15], v[10:11], v[12:13] neg_lo:[0,1] neg_hi:[0,1]
    v_cvt_pk_f16_f32 v28, v14, v15
    v_pk_add_f32 v[14:15], v[80:81], v[88:89] neg_lo:[0,1] neg_hi:[0,1]
    v_cvt_pk_f16_f32 v30, v14, v15
    buffer_load_dwordx4 a[156:159], v48, s[12:15], s25 offen offset:3072
    v_pk_add_f32 v[10:11], v[82:83], v[92:93] op_sel:[0,1] op_sel_hi:[1,0]
    v_pk_add_f32 v[82:83], v[82:83], v[92:93] op_sel:[0,1] op_sel_hi:[1,0] neg_lo:[0,1] neg_hi:[0,1]
    v_pk_add_f32 v[12:13], v[90:91], v[84:85] op_sel:[0,1] op_sel_hi:[1,0]
    v_pk_add_f32 v[90:91], v[90:91], v[84:85] op_sel:[0,1] op_sel_hi:[1,0] neg_lo:[0,1] neg_hi:[0,1]
    v_pk_add_f32 v[14:15], v[10:11], v[12:13]
    v_cvt_pk_f16_f32 v25, v14, v15
    v_pk_add_f32 v[14:15], v[82:83], v[90:91]
    v_cvt_pk_f16_f32 v27, v14, v15
    v_pk_add_f32 v[14:15], v[10:11], v[12:13] neg_lo:[0,1] neg_hi:[0,1]
    v_cvt_pk_f16_f32 v29, v14, v15
    s_add_u32 s25, s25, 4096
    buffer_load_dwordx4 a[160:163], v48, s[12:15], s25 offen offset:0
    v_pk_add_f32 v[14:15], v[82:83], v[90:91] neg_lo:[0,1] neg_hi:[0,1]
    v_cvt_pk_f16_f32 v31, v14, v15
    ds_write_b64 v2, v[24:25] offset:64
    ds_write_b64 v2, v[26:27] offset:10816
    ds_write_b64 v2, v[28:29] offset:21568
    ds_write_b64 v2, v[30:31] offset:32320
    v_pk_add_f32 v[10:11], v[96:97], v[110:111] op_sel:[0,1] op_sel_hi:[1,0]
    v_pk_add_f32 v[96:97], v[96:97], v[110:111] op_sel:[0,1] op_sel_hi:[1,0] neg_lo:[0,1] neg_hi:[0,1]
    v_pk_add_f32 v[12:13], v[104:105], v[102:103] op_sel:[0,1] op_sel_hi:[1,0]
    v_pk_add_f32 v[104:105], v[104:105], v[102:103] op_sel:[0,1] op_sel_hi:[1,0] neg_lo:[0,1] neg_hi:[0,1]
    buffer_load_dwordx4 a[164:167], v48, s[12:15], s25 offen offset:1024
    v_pk_add_f32 v[14:15], v[10:11], v[12:13]
    v_cvt_pk_f16_f32 v16, v14, v15
    v_pk_add_f32 v[14:15], v[96:97], v[104:105]
    v_cvt_pk_f16_f32 v18, v14, v15
    v_pk_add_f32 v[14:15], v[10:11], v[12:13] neg_lo:[0,1] neg_hi:[0,1]
    v_cvt_pk_f16_f32 v20, v14, v15
    v_pk_add_f32 v[14:15], v[96:97], v[104:105] neg_lo:[0,1] neg_hi:[0,1]
    v_cvt_pk_f16_f32 v22, v14, v15
    v_pk_add_f32 v[10:11], v[98:99], v[108:109] op_sel:[0,1] op_sel_hi:[1,0]
    v_pk_add_f32 v[98:99], v[98:99], v[108:109] op_sel:[0,1] op_sel_hi:[1,0] neg_lo:[0,1] neg_hi:[0,1]
    buffer_load_dwordx4 a[168:171], v48, s[12:15], s25 offen offset:2048
    v_pk_add_f32 v[12:13], v[106:107], v[100:101] op_sel:[0,1] op_sel_hi:[1,0]
    v_pk_add_f32 v[106:107], v[106:107], v[100:101] op_sel:[0,1] op_sel_hi:[1,0] neg_lo:[0,1] neg_hi:[0,1]
    v_pk_add_f32 v[14:15], v[10:11], v[12:13]
    v_cvt_pk_f16_f32 v17, v14, v15
    v_pk_add_f32 v[14:15], v[98:99], v[106:107]
    v_cvt_pk_f16_f32 v19, v14, v15
    v_pk_add_f32 v[14:15], v[10:11], v[12:13] neg_lo:[0,1] neg_hi:[0,1]
    v_cvt_pk_f16_f32 v21, v14, v15
    v_pk_add_f32 v[14:15], v[98:99], v[106:107] neg_lo:[0,1] neg_hi:[0,1]
    v_cvt_pk_f16_f32 v23, v14, v15
    buffer_load_dwordx4 a[172:175], v48, s[12:15], s25 offen offset:3072
    ds_write_b64 v2, v[16:17] offset:128
    ds_write_b64 v2, v[18:19] offset:10880
    ds_write_b64 v2, v[20:21] offset:21632
    ds_write_b64 v2, v[22:23] offset:32384
    v_pk_add_f32 v[10:11], v[112:113], v[126:127] op_sel:[0,1] op_sel_hi:[1,0]
    v_pk_add_f32 v[112:113], v[112:113], v[126:127] op_sel:[0,1] op_sel_hi:[1,0] neg_lo:[0,1] neg_hi:[0,1]
    v_pk_add_f32 v[12:13], v[120:121], v[118:119] op_sel:[0,1] op_sel_hi:[1,0]
    v_pk_add_f32 v[120:121], v[120:121], v[118:119] op_sel:[0,1] op_sel_hi:[1,0] neg_lo:[0,1] neg_hi:[0,1]
    v_pk_add_f32 v[14:15], v[10:11], v[12:13]
    v_cvt_pk_f16_f32 v24, v14, v15
    s_add_u32 s25, s25, 4096
    buffer_load_dwordx4 a[176:179], v48, s[12:15], s25 offen offset:0
    v_pk_add_f32 v[14:15], v[112:113], v[120:121]
    v_cvt_pk_f16_f32 v26, v14, v15
    v_pk_add_f32 v[14:15], v[10:11], v[12:13] neg_lo:[0,1] neg_hi:[0,1]
    v_cvt_pk_f16_f32 v28, v14, v15
    v_pk_add_f32 v[14:15], v[112:113], v[120:121] neg_lo:[0,1] neg_hi:[0,1]
    v_cvt_pk_f16_f32 v30, v14, v15
    v_pk_add_f32 v[10:11], v[114:115], v[124:125] op_sel:[0,1] op_sel_hi:[1,0]
    v_pk_add_f32 v[114:115], v[114:115], v[124:125] op_sel:[0,1] op_sel_hi:[1,0] neg_lo:[0,1] neg_hi:[0,1]
    v_pk_add_f32 v[12:13], v[122:123], v[116:117] op_sel:[0,1] op_sel_hi:[1,0]
    v_pk_add_f32 v[122:123], v[122:123], v[116:117] op_sel:[0,1] op_sel_hi:[1,0] neg_lo:[0,1] neg_hi:[0,1]
    buffer_load_dwordx4 a[180:183], v48, s[12:15], s25 offen offset:1024
    v_pk_add_f32 v[14:15], v[10:11], v[12:13]
    v_cvt_pk_f16_f32 v25, v14, v15
    v_pk_add_f32 v[14:15], v[114:115], v[122:123]
    v_cvt_pk_f16_f32 v27, v14, v15
    v_pk_add_f32 v[14:15], v[10:11], v[12:13] neg_lo:[0,1] neg_hi:[0,1]
    v_cvt_pk_f16_f32 v29, v14, v15
    v_pk_add_f32 v[14:15], v[114:115], v[122:123] neg_lo:[0,1] neg_hi:[0,1]
    v_cvt_pk_f16_f32 v31, v14, v15
    ds_write_b64 v2, v[24:25] offset:192
    ds_write_b64 v2, v[26:27] offset:10944
    buffer_load_dwordx4 a[184:187], v48, s[12:15], s25 offen offset:2048
    ds_write_b64 v2, v[28:29] offset:21696
    ds_write_b64 v2, v[30:31] offset:32448
    v_pk_add_f32 v[10:11], v[128:129], v[142:143] op_sel:[0,1] op_sel_hi:[1,0]
    v_pk_add_f32 v[128:129], v[128:129], v[142:143] op_sel:[0,1] op_sel_hi:[1,0] neg_lo:[0,1] neg_hi:[0,1]
    v_pk_add_f32 v[12:13], v[136:137], v[134:135] op_sel:[0,1] op_sel_hi:[1,0]
    v_pk_add_f32 v[136:137], v[136:137], v[134:135] op_sel:[0,1] op_sel_hi:[1,0] neg_lo:[0,1] neg_hi:[0,1]
    v_pk_add_f32 v[14:15], v[10:11], v[12:13]
    v_cvt_pk_f16_f32 v16, v14, v15
    v_pk_add_f32 v[14:15], v[128:129], v[136:137]
    v_cvt_pk_f16_f32 v18, v14, v15
    buffer_load_dwordx4 a[188:191], v48, s[12:15], s25 offen offset:3072
    v_pk_add_f32 v[14:15], v[10:11], v[12:13] neg_lo:[0,1] neg_hi:[0,1]
    v_cvt_pk_f16_f32 v20, v14, v15
    v_pk_add_f32 v[14:15], v[128:129], v[136:137] neg_lo:[0,1] neg_hi:[0,1]
    v_cvt_pk_f16_f32 v22, v14, v15
    v_pk_add_f32 v[10:11], v[130:131], v[140:141] op_sel:[0,1] op_sel_hi:[1,0]
    v_pk_add_f32 v[130:131], v[130:131], v[140:141] op_sel:[0,1] op_sel_hi:[1,0] neg_lo:[0,1] neg_hi:[0,1]
    v_pk_add_f32 v[12:13], v[138:139], v[132:133] op_sel:[0,1] op_sel_hi:[1,0]
    v_pk_add_f32 v[138:139], v[138:139], v[132:133] op_sel:[0,1] op_sel_hi:[1,0] neg_lo:[0,1] neg_hi:[0,1]
    v_pk_add_f32 v[14:15], v[10:11], v[12:13]
    v_cvt_pk_f16_f32 v17, v14, v15
    s_add_u32 s25, s25, 4096
    buffer_load_dwordx4 a[192:195], v48, s[12:15], s25 offen offset:0
    v_pk_add_f32 v[14:15], v[130:131], v[138:139]
    v_cvt_pk_f16_f32 v19, v14, v15
    v_pk_add_f32 v[14:15], v[10:11], v[12:13] neg_lo:[0,1] neg_hi:[0,1]
    v_cvt_pk_f16_f32 v21, v14, v15
    v_pk_add_f32 v[14:15], v[130:131], v[138:139] neg_lo:[0,1] neg_hi:[0,1]
    v_cvt_pk_f16_f32 v23, v14, v15
    ds_write_b64 v2, v[16:17] offset:256
    ds_write_b64 v2, v[18:19] offset:11008
    ds_write_b64 v2, v[20:21] offset:21760
    ds_write_b64 v2, v[22:23] offset:32512
    buffer_load_dwordx4 a[196:199], v48, s[12:15], s25 offen offset:1024
    v_and_b32 v3, 31, v1
    v_lshrrev_b32 v4, 5, v1
    v_mul_u32_u24 v5, 336, v3
    v_lshl_add_u32 v5, v4, 4, v5
    s_mul_i32 s3, s24, 10752
    v_add_u32 v5, s3, v5
    v_mov_b32 v60, v5
    s_waitcnt vmcnt(50) lgkmcnt(0)
    s_barrier
    s_add_u32 s16, s54, 11272192
    s_addc_u32 s17, s55, 0
    s_and_b32 s17, s17, 0xffff
    s_mov_b32 s18, 2629632
    s_mov_b32 s19, 0x00020000
    s_mov_b32 s58, s34
    v_mov_b32 v10, 0
    s_mul_i32 s3, s24, 1284
    s_add_u32 s3, s3, 114688
    v_lshl_add_u32 v5, v1, 1, s3
    v_mul_u32_u24 v6, 144, v1
    s_lshl_b32 s3, s24, 5
    s_add_u32 s3, s3, 53248
    v_add_u32 v6, s3, v6
    ds_read_u16 v104, v5 offset:0
    ds_read_u16 v105, v5 offset:24576
    ds_read_u16 v106, v5 offset:6144
    ds_read_u16 v107, v5 offset:30720
    ds_read_u16 v108, v5 offset:12288
    ds_read_u16 v109, v5 offset:36864
    ds_read_u16 v110, v5 offset:18432
    ds_read_u16 v111, v5 offset:43008
    ds_read_u16 v112, v5 offset:642
    ds_read_u16 v113, v5 offset:25218
    ds_read_u16 v114, v5 offset:6786
    ds_read_u16 v115, v5 offset:31362
    ds_read_u16 v116, v5 offset:12930
    ds_read_u16 v117, v5 offset:37506
    ds_read_u16 v118, v5 offset:19074
    ds_read_u16 v119, v5 offset:43650
    ds_read_u16 v120, v5 offset:128
    ds_read_u16 v121, v5 offset:24704
    ds_read_u16 v122, v5 offset:6272
    ds_read_u16 v123, v5 offset:30848
    ds_read_u16 v124, v5 offset:12416
    ds_read_u16 v125, v5 offset:36992
    ds_read_u16 v126, v5 offset:18560
    ds_read_u16 v127, v5 offset:43136
    ds_read_u16 v128, v5 offset:770
    ds_read_u16 v129, v5 offset:25346
    ds_read_u16 v130, v5 offset:6914
    ds_read_u16 v131, v5 offset:31490
    ds_read_u16 v132, v5 offset:13058
    ds_read_u16 v133, v5 offset:37634
    ds_read_u16 v134, v5 offset:19202
    ds_read_u16 v135, v5 offset:43778
    ds_read_u16 v136, v5 offset:256
    ds_read_u16 v137, v5 offset:24832
    ds_read_u16 v138, v5 offset:6400
    ds_read_u16 v139, v5 offset:30976
    ds_read_u16 v140, v5 offset:12544
    ds_read_u16 v141, v5 offset:37120
    ds_read_u16 v142, v5 offset:18688
    ds_read_u16 v143, v5 offset:43264
    ds_read_u16 v144, v5 offset:898
    ds_read_u16 v145, v5 offset:25474
    ds_read_u16 v146, v5 offset:7042
    ds_read_u16 v147, v5 offset:31618
    ds_read_u16 v148, v5 offset:13186
    ds_read_u16 v149, v5 offset:37762
    ds_read_u16 v150, v5 offset:19330
    ds_read_u16 v151, v5 offset:43906
    ds_read_u16 v152, v5 offset:384
    ds_read_u16 v153, v5 offset:24960
    ds_read_u16 v154, v5 offset:6528
    ds_read_u16 v155, v5 offset:31104
    ds_read_u16 v156, v5 offset:12672
    ds_read_u16 v157, v5 offset:37248
    ds_read_u16 v158, v5 offset:18816
    ds_read_u16 v159, v5 offset:43392
    ds_read_u16 v160, v5 offset:1026
    ds_read_u16 v161, v5 offset:25602
    ds_read_u16 v162, v5 offset:7170
    ds_read_u16 v163, v5 offset:31746
    ds_read_u16 v164, v5 offset:13314
    ds_read_u16 v165, v5 offset:37890
    ds_read_u16 v166, v5 offset:19458
    ds_read_u16 v167, v5 offset:44034
    ds_read_u16 v168, v5 offset:512
    ds_read_u16 v169, v5 offset:25088
    ds_read_u16 v170, v5 offset:6656
    ds_read_u16 v171, v5 offset:31232
    ds_read_u16 v172, v5 offset:12800
    ds_read_u16 v173, v5 offset:37376
    ds_read_u16 v174, v5 offset:18944
    ds_read_u16 v175, v5 offset:43520
    ds_read_u16 v176, v5 offset:1154
    ds_read_u16 v177, v5 offset:25730
    ds_read_u16 v178, v5 offset:7298
    ds_read_u16 v179, v5 offset:31874
    ds_read_u16 v180, v5 offset:13442
    ds_read_u16 v181, v5 offset:38018
    ds_read_u16 v182, v5 offset:19586
    ds_read_u16 v183, v5 offset:44162
    ds_read_u16 v184, v5 offset:640
    ds_read_u16 v185, v5 offset:25216
    ds_read_u16 v186, v5 offset:6784
    ds_read_u16 v187, v5 offset:31360
    ds_read_u16 v188, v5 offset:12928
    ds_read_u16 v189, v5 offset:37504
    ds_read_u16 v190, v5 offset:19072
    ds_read_u16 v191, v5 offset:43648
    ds_read_u16 v192, v5 offset:1282
    ds_read_u16 v193, v5 offset:25858
    ds_read_u16 v194, v5 offset:7426
    ds_read_u16 v195, v5 offset:32002
    ds_read_u16 v196, v5 offset:13570
    ds_read_u16 v197, v5 offset:38146
    ds_read_u16 v198, v5 offset:19714
    ds_read_u16 v199, v5 offset:44290
    s_waitcnt lgkmcnt(15)
    v_lshl_or_b32 v200, v105, 16, v104
    v_lshl_or_b32 v201, v107, 16, v106
    v_lshl_or_b32 v202, v109, 16, v108
    v_lshl_or_b32 v203, v111, 16, v110
    ds_write_b128 v6, v[200:203] offset:0
    v_and_b32 v11, 0x7fff7fff, v200
    v_pk_max_u16 v10, v10, v11
    v_and_b32 v11, 0x7fff7fff, v201
    v_pk_max_u16 v10, v10, v11
    v_and_b32 v11, 0x7fff7fff, v202
    v_pk_max_u16 v10, v10, v11
    v_and_b32 v11, 0x7fff7fff, v203
    v_pk_max_u16 v10, v10, v11
    s_waitcnt lgkmcnt(15)
    v_lshl_or_b32 v204, v113, 16, v112
    v_lshl_or_b32 v205, v115, 16, v114
    v_lshl_or_b32 v206, v117, 16, v116
    v_lshl_or_b32 v207, v119, 16, v118
    ds_write_b128 v6, v[204:207] offset:16
    v_and_b32 v11, 0x7fff7fff, v204
    v_pk_max_u16 v10, v10, v11
    v_and_b32 v11, 0x7fff7fff, v205
    v_pk_max_u16 v10, v10, v11
    v_and_b32 v11, 0x7fff7fff, v206
    v_pk_max_u16 v10, v10, v11
    v_and_b32 v11, 0x7fff7fff, v207
    v_pk_max_u16 v10, v10, v11
    s_waitcnt lgkmcnt(15)
    v_lshl_or_b32 v208, v121, 16, v120
    v_lshl_or_b32 v209, v123, 16, v122
    v_lshl_or_b32 v210, v125, 16, v124
    v_lshl_or_b32 v211, v127, 16, v126
    ds_write_b128 v6, v[208:211] offset:9216
    v_and_b32 v11, 0x7fff7fff, v208
    v_pk_max_u16 v10, v10, v11
    v_and_b32 v11, 0x7fff7fff, v209
    v_pk_max_u16 v10, v10, v11
    v_and_b32 v11, 0x7fff7fff, v210
    v_pk_max_u16 v10, v10, v11
    v_and_b32 v11, 0x7fff7fff, v211
    v_pk_max_u16 v10, v10, v11
    s_waitcnt lgkmcnt(15)
    v_lshl_or_b32 v212, v129, 16, v128
    v_lshl_or_b32 v213, v131, 16, v130
    v_lshl_or_b32 v214, v133, 16, v132
    v_lshl_or_b32 v215, v135, 16, v134
    ds_write_b128 v6, v[212:215] offset:9232
    v_and_b32 v11, 0x7fff7fff, v212
    v_pk_max_u16 v10, v10, v11
    v_and_b32 v11, 0x7fff7fff, v213
    v_pk_max_u16 v10, v10, v11
    v_and_b32 v11, 0x7fff7fff, v214
    v_pk_max_u16 v10, v10, v11
    v_and_b32 v11, 0x7fff7fff, v215
    v_pk_max_u16 v10, v10, v11
    s_waitcnt lgkmcnt(15)
    v_lshl_or_b32 v216, v137, 16, v136
    v_lshl_or_b32 v217, v139, 16, v138
    v_lshl_or_b32 v218, v141, 16, v140
    v_lshl_or_b32 v219, v143, 16, v142
    ds_write_b128 v6, v[216:219] offset:18432
    v_and_b32 v11, 0x7fff7fff, v216
    v_pk_max_u16 v10, v10, v11
    v_and_b32 v11, 0x7fff7fff, v217
    v_pk_max_u16 v10, v10, v11
    v_and_b32 v11, 0x7fff7fff, v218
    v_pk_max_u16 v10, v10, v11
    v_and_b32 v11, 0x7fff7fff, v219
    v_pk_max_u16 v10, v10, v11
    s_waitcnt lgkmcnt(15)
    v_lshl_or_b32 v220, v145, 16, v144
    v_lshl_or_b32 v221, v147, 16, v146
    v_lshl_or_b32 v222, v149, 16, v148
    v_lshl_or_b32 v223, v151, 16, v150
    ds_write_b128 v6, v[220:223] offset:18448
    v_and_b32 v11, 0x7fff7fff, v220
    v_pk_max_u16 v10, v10, v11
    v_and_b32 v11, 0x7fff7fff, v221
    v_pk_max_u16 v10, v10, v11
    v_and_b32 v11, 0x7fff7fff, v222
    v_pk_max_u16 v10, v10, v11
    v_and_b32 v11, 0x7fff7fff, v223
    v_pk_max_u16 v10, v10, v11
    s_waitcnt lgkmcnt(15)
    v_lshl_or_b32 v224, v153, 16, v152
    v_lshl_or_b32 v225, v155, 16, v154
    v_lshl_or_b32 v226, v157, 16, v156
    v_lshl_or_b32 v227, v159, 16, v158
    ds_write_b128 v6, v[224:227] offset:27648
    v_and_b32 v11, 0x7fff7fff, v224
    v_pk_max_u16 v10, v10, v11
    v_and_b32 v11, 0x7fff7fff, v225
    v_pk_max_u16 v10, v10, v11
    v_and_b32 v11, 0x7fff7fff, v226
    v_pk_max_u16 v10, v10, v11
    v_and_b32 v11, 0x7fff7fff, v227
    v_pk_max_u16 v10, v10, v11
    s_waitcnt lgkmcnt(15)
    v_lshl_or_b32 v228, v161, 16, v160
    v_lshl_or_b32 v229, v163, 16, v162
    v_lshl_or_b32 v230, v165, 16, v164
    v_lshl_or_b32 v231, v167, 16, v166
    ds_write_b128 v6, v[228:231] offset:27664
    v_and_b32 v11, 0x7fff7fff, v228
    v_pk_max_u16 v10, v10, v11
    v_and_b32 v11, 0x7fff7fff, v229
    v_pk_max_u16 v10, v10, v11
    v_and_b32 v11, 0x7fff7fff, v230
    v_pk_max_u16 v10, v10, v11
    v_and_b32 v11, 0x7fff7fff, v231
    v_pk_max_u16 v10, v10, v11
    s_waitcnt lgkmcnt(15)
    v_lshl_or_b32 v232, v169, 16, v168
    v_lshl_or_b32 v233, v171, 16, v170
    v_lshl_or_b32 v234, v173, 16, v172
    v_lshl_or_b32 v235, v175, 16, v174
    ds_write_b128 v6, v[232:235] offset:36864
    v_and_b32 v11, 0x7fff7fff, v232
    v_pk_max_u16 v10, v10, v11
    v_and_b32 v11, 0x7fff7fff, v233
    v_pk_max_u16 v10, v10, v11
    v_and_b32 v11, 0x7fff7fff, v234
    v_pk_max_u16 v10, v10, v11
    v_and_b32 v11, 0x7fff7fff, v235
    v_pk_max_u16 v10, v10, v11
    s_waitcnt lgkmcnt(15)
    v_lshl_or_b32 v236, v177, 16, v176
    v_lshl_or_b32 v237, v179, 16, v178
    v_lshl_or_b32 v238, v181, 16, v180
    v_lshl_or_b32 v239, v183, 16, v182
    ds_write_b128 v6, v[236:239] offset:36880
    v_and_b32 v11, 0x7fff7fff, v236
    v_pk_max_u16 v10, v10, v11
    v_and_b32 v11, 0x7fff7fff, v237
    v_pk_max_u16 v10, v10, v11
    v_and_b32 v11, 0x7fff7fff, v238
    v_pk_max_u16 v10, v10, v11
    v_and_b32 v11, 0x7fff7fff, v239
    v_pk_max_u16 v10, v10, v11
    s_waitcnt lgkmcnt(8)
    v_lshl_or_b32 v240, v185, 16, v184
    v_lshl_or_b32 v241, v187, 16, v186
    v_lshl_or_b32 v242, v189, 16, v188
    v_lshl_or_b32 v243, v191, 16, v190
    v_cmp_gt_u32 vcc, 1, v1
    s_and_saveexec_b64 s[100:101], vcc
    ds_write_b128 v6, v[240:243] offset:46080
    v_and_b32 v11, 0x7fff7fff, v240
    v_pk_max_u16 v10, v10, v11
    v_and_b32 v11, 0x7fff7fff, v241
    v_pk_max_u16 v10, v10, v11
    v_and_b32 v11, 0x7fff7fff, v242
    v_pk_max_u16 v10, v10, v11
    v_and_b32 v11, 0x7fff7fff, v243
    v_pk_max_u16 v10, v10, v11
    s_mov_b64 exec, s[100:101]
    s_waitcnt lgkmcnt(0)
    v_lshl_or_b32 v244, v193, 16, v192
    v_lshl_or_b32 v245, v195, 16, v194
    v_lshl_or_b32 v246, v197, 16, v196
    v_lshl_or_b32 v247, v199, 16, v198
    v_cmp_gt_u32 vcc, 1, v1
    s_and_saveexec_b64 s[100:101], vcc
    ds_write_b128 v6, v[244:247] offset:46096
    v_and_b32 v11, 0x7fff7fff, v244
    v_pk_max_u16 v10, v10, v11
    v_and_b32 v11, 0x7fff7fff, v245
    v_pk_max_u16 v10, v10, v11
    v_and_b32 v11, 0x7fff7fff, v246
    v_pk_max_u16 v10, v10, v11
    v_and_b32 v11, 0x7fff7fff, v247
    v_pk_max_u16 v10, v10, v11
    s_mov_b64 exec, s[100:101]
    v_and_b32 v3, 7, v1
    v_lshrrev_b32 v4, 3, v1
    s_lshl_b32 s3, s24, 3
    v_add_u32 v4, s3, v4
    v_mul_u32_u24 v5, 144, v4
    v_lshl_add_u32 v5, v3, 4, v5
    v_add_u32 v5, 53248, v5
    v_lshlrev_b32 v6, 13, v4
    v_lshl_add_u32 v6, v3, 4, v6
    s_waitcnt lgkmcnt(0)
    s_barrier
    ds_read_b128 v[104:107], v5 offset:0
    ds_read_b128 v[108:111], v5 offset:4608
    ds_read_b128 v[112:115], v5 offset:9216
    ds_read_b128 v[116:119], v5 offset:13824
    ds_read_b128 v[120:123], v5 offset:18432
    ds_read_b128 v[124:127], v5 offset:23040
    ds_read_b128 v[128:131], v5 offset:27648
    ds_read_b128 v[132:135], v5 offset:32256
    ds_read_b128 v[136:139], v5 offset:36864
    ds_read_b128 v[140:143], v5 offset:41472
    ds_read_b128 v[144:147], v5 offset:46080
    s_waitcnt lgkmcnt(10)
    buffer_store_dwordx4 v[104:107], v6, s[16:19], s58 offen sc1
    s_add_u32 s58, s58, 262144
    s_waitcnt lgkmcnt(9)
    buffer_store_dwordx4 v[108:111], v6, s[16:19], s58 offen sc1
    s_add_u32 s58, s58, 262144
    s_waitcnt lgkmcnt(8)
    buffer_store_dwordx4 v[112:115], v6, s[16:19], s58 offen sc1
    s_add_u32 s58, s58, 262144
    s_waitcnt lgkmcnt(7)
    buffer_store_dwordx4 v[116:119], v6, s[16:19], s58 offen sc1
    s_add_u32 s58, s58, 262144
    s_waitcnt lgkmcnt(6)
    buffer_store_dwordx4 v[120:123], v6, s[16:19], s58 offen sc1
    s_add_u32 s58, s58, 262144
    s_waitcnt lgkmcnt(5)
    buffer_store_dwordx4 v[124:127], v6, s[16:19], s58 offen sc1
    s_add_u32 s58, s58, 262144
    s_waitcnt lgkmcnt(4)
    buffer_store_dwordx4 v[128:131], v6, s[16:19], s58 offen sc1
    s_add_u32 s58, s58, 262144
    s_waitcnt lgkmcnt(3)
    buffer_store_dwordx4 v[132:135], v6, s[16:19], s58 offen sc1
    s_add_u32 s58, s58, 262144
    s_waitcnt lgkmcnt(2)
    buffer_store_dwordx4 v[136:139], v6, s[16:19], s58 offen sc1
    s_add_u32 s58, s58, 262144
    s_waitcnt lgkmcnt(1)
    buffer_store_dwordx4 v[140:143], v6, s[16:19], s58 offen sc1
    s_add_u32 s58, s58, 262144
    s_waitcnt lgkmcnt(0)
    v_add_u32 v11, 320, v4
    v_cmp_gt_u32 vcc, 321, v11
    s_and_saveexec_b64 s[100:101], vcc
    buffer_store_dwordx4 v[144:147], v6, s[16:19], s58 offen sc1
    s_mov_b64 exec, s[100:101]
    v_lshrrev_b32 v11, 16, v10
    v_and_b32 v10, 0xffff, v10
    v_max_u32 v10, v10, v11
    s_nop 1
    v_max_u32_dpp v10, v10, v10 row_shr:1 row_mask:0xf bank_mask:0xf
    s_nop 1
    v_max_u32_dpp v10, v10, v10 row_shr:2 row_mask:0xf bank_mask:0xf
    s_nop 1
    v_max_u32_dpp v10, v10, v10 row_shr:4 row_mask:0xf bank_mask:0xf
    s_nop 1
    v_max_u32_dpp v10, v10, v10 row_shr:8 row_mask:0xf bank_mask:0xf
    s_nop 1
    v_max_u32_dpp v10, v10, v10 row_bcast:15 row_mask:0xa bank_mask:0xf
    s_nop 1
    v_max_u32_dpp v10, v10, v10 row_bcast:31 row_mask:0xc bank_mask:0xf
    s_add_u32 s20, s54, 8126464
    s_addc_u32 s21, s55, 0
    s_and_b32 s21, s21, 0xffff
    s_mov_b32 s22, 1024
    s_mov_b32 s23, 0x00020000
    v_cmp_eq_u32 vcc, 63, v1
    s_and_saveexec_b64 s[100:101], vcc
    s_lshl_b32 s3, s31, 4
    s_lshl_b32 s33, s24, 2
    s_add_u32 s3, s3, s33
    v_mov_b32 v11, 0
    buffer_store_dword v10, v11, s[20:23], s3 offen sc1
    s_mov_b64 exec, s[100:101]
    s_barrier
    s_getpc_b64 s[20:21]
    s_add_u32 s20, s20, tab_fft@rel32@lo+4
    s_addc_u32 s21, s21, tab_fft@rel32@hi+12
    s_and_b32 s21, s21, 0xffff
    s_mov_b32 s22, 63488
    s_mov_b32 s23, 0x00020000
    v_lshlrev_b32 v31, 4, v1
    s_lshl_b32 s27, s24, 10
    s_add_u32 m0, s27, 92160
    s_add_u32 s35, s27, 0
    buffer_load_dwordx4 v31, s[20:23], s35 offen lds
    s_add_u32 m0, s27, 96256
    s_add_u32 s35, s27, 4096
    buffer_load_dwordx4 v31, s[20:23], s35 offen lds
    s_add_u32 m0, s27, 100352
    s_add_u32 s35, s27, 8192
    buffer_load_dwordx4 v31, s[20:23], s35 offen lds
    s_add_u32 m0, s27, 104448
    s_add_u32 s35, s27, 12288
    buffer_load_dwordx4 v31, s[20:23], s35 offen lds
    s_add_u32 m0, s27, 108544
    s_add_u32 s35, s27, 24576
    buffer_load_dwordx4 v31, s[20:23], s35 offen lds
    s_add_u32 m0, s27, 112640
    s_add_u32 s35, s27, 28672
    buffer_load_dwordx4 v31, s[20:23], s35 offen lds
    s_add_u32 m0, s27, 116736
    s_add_u32 s35, s27, 32768
    buffer_load_dwordx4 v31, s[20:23], s35 offen lds
    s_add_u32 m0, s27, 120832
    s_add_u32 s35, s27, 36864
    buffer_load_dwordx4 v31, s[20:23], s35 offen lds
    s_add_u32 m0, s27, 124928
    s_add_u32 s35, s27, 40960
    buffer_load_dwordx4 v31, s[20:23], s35 offen lds
    s_add_u32 m0, s27, 129024
    s_add_u32 s35, s27, 45056
    buffer_load_dwordx4 v31, s[20:23], s35 offen lds
    s_add_u32 m0, s27, 133120
    s_add_u32 s35, s27, 49152
    buffer_load_dwordx4 v31, s[20:23], s35 offen lds
    s_add_u32 m0, s27, 137216
    s_add_u32 s35, s27, 53248
    buffer_load_dwordx4 v31, s[20:23], s35 offen lds
    s_add_u32 m0, s27, 141312
    s_add_u32 s35, s27, 57344
    buffer_load_dwordx4 v31, s[20:23], s35 offen lds
    s_cmp_ge_u32 s24, 2
    s_cbranch_scc1 tb_47
    s_add_u32 m0, s27, 145408
    s_add_u32 s35, s27, 61440
    buffer_load_dwordx4 v31, s[20:23], s35 offen lds
    tb_47:
    s_add_u32 s16, s54, 8388608
    s_addc_u32 s17, s55, 0
    s_and_b32 s17, s17, 0xffff
    s_mov_b32 s18, 2621440
    s_mov_b32 s19, 0x00020000
    v_and_b32 v3, 31, v1
    v_lshrrev_b32 v4, 5, v1
    ds_read_b128 v[16:19], v60 offset:0
    ds_read_b128 v[20:23], v60 offset:32
    ds_read_b128 v[24:27], v60 offset:64
    ds_read_b128 v[28:31], v60 offset:96
    ds_read_b128 v[32:35], v60 offset:128
    ds_read_b128 v[36:39], v60 offset:160
    ds_read_b128 v[40:43], v60 offset:192
    ds_read_b128 v[44:47], v60 offset:224
    ds_read_b128 v[48:51], v60 offset:256
    ds_read_b128 v[52:55], v60 offset:288
    s_waitcnt vmcnt(25)
    s_waitcnt lgkmcnt(9)
    v_mfma_f32_32x32x16_f16 v[64:79], v[16:19], a[0:3], 0
    v_mfma_f32_32x32x16_f16 v[80:95], v[16:19], a[40:43], 0
    v_mfma_f32_32x32x16_f16 v[96:111], v[16:19], a[80:83], 0
    v_mfma_f32_32x32x16_f16 v[112:127], v[16:19], a[120:123], 0
    v_mfma_f32_32x32x16_f16 v[128:143], v[16:19], a[160:163], 0
    s_waitcnt lgkmcnt(8)
    v_mfma_f32_32x32x16_f16 v[64:79], v[20:23], a[4:7], v[64:79]
    v_mfma_f32_32x32x16_f16 v[80:95], v[20:23], a[44:47], v[80:95]
    v_mfma_f32_32x32x16_f16 v[96:111], v[20:23], a[84:87], v[96:111]
    v_mfma_f32_32x32x16_f16 v[112:127], v[20:23], a[124:127], v[112:127]
    v_mfma_f32_32x32x16_f16 v[128:143], v[20:23], a[164:167], v[128:143]
    s_waitcnt lgkmcnt(7)
    v_mfma_f32_32x32x16_f16 v[64:79], v[24:27], a[8:11], v[64:79]
    v_mfma_f32_32x32x16_f16 v[80:95], v[24:27], a[48:51], v[80:95]
    v_mfma_f32_32x32x16_f16 v[96:111], v[24:27], a[88:91], v[96:111]
    v_mfma_f32_32x32x16_f16 v[112:127], v[24:27], a[128:131], v[112:127]
    v_mfma_f32_32x32x16_f16 v[128:143], v[24:27], a[168:171], v[128:143]
    s_waitcnt lgkmcnt(6)
    v_mfma_f32_32x32x16_f16 v[64:79], v[28:31], a[12:15], v[64:79]
    v_mfma_f32_32x32x16_f16 v[80:95], v[28:31], a[52:55], v[80:95]
    v_mfma_f32_32x32x16_f16 v[96:111], v[28:31], a[92:95], v[96:111]
    v_mfma_f32_32x32x16_f16 v[112:127], v[28:31], a[132:135], v[112:127]
    v_mfma_f32_32x32x16_f16 v[128:143], v[28:31], a[172:175], v[128:143]
    s_waitcnt lgkmcnt(5)
    v_mfma_f32_32x32x16_f16 v[64:79], v[32:35], a[16:19], v[64:79]
    v_mfma_f32_32x32x16_f16 v[80:95], v[32:35], a[56:59], v[80:95]
    v_mfma_f32_32x32x16_f16 v[96:111], v[32:35], a[96:99], v[96:111]
    v_mfma_f32_32x32x16_f16 v[112:127], v[32:35], a[136:139], v[112:127]
    v_mfma_f32_32x32x16_f16 v[128:143], v[32:35], a[176:179], v[128:143]
    s_waitcnt lgkmcnt(4)
    v_mfma_f32_32x32x16_f16 v[64:79], v[36:39], a[20:23], v[64:79]
    v_mfma_f32_32x32x16_f16 v[80:95], v[36:39], a[60:63], v[80:95]
    v_mfma_f32_32x32x16_f16 v[96:111], v[36:39], a[100:103], v[96:111]
    v_mfma_f32_32x32x16_f16 v[112:127], v[36:39], a[140:143], v[112:127]
    v_mfma_f32_32x32x16_f16 v[128:143], v[36:39], a[180:183], v[128:143]
    s_waitcnt lgkmcnt(3)
    v_mfma_f32_32x32x16_f16 v[64:79], v[40:43], a[24:27], v[64:79]
    v_mfma_f32_32x32x16_f16 v[80:95], v[40:43], a[64:67], v[80:95]
    v_mfma_f32_32x32x16_f16 v[96:111], v[40:43], a[104:107], v[96:111]
    v_mfma_f32_32x32x16_f16 v[112:127], v[40:43], a[144:147], v[112:127]
    v_mfma_f32_32x32x16_f16 v[128:143], v[40:43], a[184:187], v[128:143]
    s_waitcnt lgkmcnt(2)
    v_mfma_f32_32x32x16_f16 v[64:79], v[44:47], a[28:31], v[64:79]
    v_mfma_f32_32x32x16_f16 v[80:95], v[44:47], a[68:71], v[80:95]
    v_mfma_f32_32x32x16_f16 v[96:111], v[44:47], a[108:111], v[96:111]
    v_mfma_f32_32x32x16_f16 v[112:127], v[44:47], a[148:151], v[112:127]
    v_mfma_f32_32x32x16_f16 v[128:143], v[44:47], a[188:191], v[128:143]
    s_waitcnt lgkmcnt(1)
    v_mfma_f32_32x32x16_f16 v[64:79], v[48:51], a[32:35], v[64:79]
    v_mfma_f32_32x32x16_f16 v[80:95], v[48:51], a[72:75], v[80:95]
    v_mfma_f32_32x32x16_f16 v[96:111], v[48:51], a[112:115], v[96:111]
    v_mfma_f32_32x32x16_f16 v[112:127], v[48:51], a[152:155], v[112:127]
    v_mfma_f32_32x32x16_f16 v[128:143], v[48:51], a[192:195], v[128:143]
    s_waitcnt lgkmcnt(0)
    v_mfma_f32_32x32x16_f16 v[64:79], v[52:55], a[36:39], v[64:79]
    v_mfma_f32_32x32x16_f16 v[80:95], v[52:55], a[76:79], v[80:95]
    v_mfma_f32_32x32x16_f16 v[96:111], v[52:55], a[116:119], v[96:111]
    v_mfma_f32_32x32x16_f16 v[112:127], v[52:55], a[156:159], v[112:127]
    v_mfma_f32_32x32x16_f16 v[128:143], v[52:55], a[196:199], v[128:143]
    v_mul_u32_u24 v6, 80, v3
    v_lshl_add_u32 v6, v4, 3, v6
    s_barrier
    s_mul_i32 s3, s24, 12800
    v_add_u32 v6, s3, v6
    v_lshrrev_b32 v7, 2, v1
    v_and_b32 v8, 3, v1
    v_mul_u32_u24 v9, 80, v7
    v_lshl_add_u32 v9, v8, 4, v9
    v_add_u32 v9, s3, v9
    s_mul_i32 s3, s24, 160
    v_add_u32 v7, s3, v7
    v_lshlrev_b32 v7, 12, v7
    v_lshl_add_u32 v7, v8, 4, v7
    s_and_b32 s3, s29, 3
    s_lshl_b32 s3, s3, 10
    s_lshr_b32 s33, s29, 2
    s_lshl_b32 s33, s33, 9
    s_add_u32 s3, s3, s33
    s_lshl_b32 s33, s28, 6
    s_add_u32 s3, s3, s33
    v_add_u32 v7, s3, v7
    s_nop 7
    v_cvt_pk_f16_f32 v16, v64, v65
    v_cvt_pk_f16_f32 v17, v66, v67
    ds_write_b64 v6, v[16:17] offset:0
    v_cvt_pk_f16_f32 v18, v68, v69
    v_cvt_pk_f16_f32 v19, v70, v71
    ds_write_b64 v6, v[18:19] offset:16
    v_cvt_pk_f16_f32 v20, v72, v73
    v_cvt_pk_f16_f32 v21, v74, v75
    ds_write_b64 v6, v[20:21] offset:32
    v_cvt_pk_f16_f32 v22, v76, v77
    v_cvt_pk_f16_f32 v23, v78, v79
    ds_write_b64 v6, v[22:23] offset:48
    v_cvt_pk_f16_f32 v24, v80, v81
    v_cvt_pk_f16_f32 v25, v82, v83
    ds_write_b64 v6, v[24:25] offset:2560
    v_cvt_pk_f16_f32 v26, v84, v85
    v_cvt_pk_f16_f32 v27, v86, v87
    ds_write_b64 v6, v[26:27] offset:2576
    v_cvt_pk_f16_f32 v28, v88, v89
    v_cvt_pk_f16_f32 v29, v90, v91
    ds_write_b64 v6, v[28:29] offset:2592
    v_cvt_pk_f16_f32 v30, v92, v93
    v_cvt_pk_f16_f32 v31, v94, v95
    ds_write_b64 v6, v[30:31] offset:2608
    v_cvt_pk_f16_f32 v32, v96, v97
    v_cvt_pk_f16_f32 v33, v98, v99
    ds_write_b64 v6, v[32:33] offset:5120
    v_cvt_pk_f16_f32 v34, v100, v101
    v_cvt_pk_f16_f32 v35, v102, v103
    ds_write_b64 v6, v[34:35] offset:5136
    v_cvt_pk_f16_f32 v36, v104, v105
    v_cvt_pk_f16_f32 v37, v106, v107
    ds_write_b64 v6, v[36:37] offset:5152
    v_cvt_pk_f16_f32 v38, v108, v109
    v_cvt_pk_f16_f32 v39, v110, v111
    ds_write_b64 v6, v[38:39] offset:5168
    v_cvt_pk_f16_f32 v40, v112, v113
    v_cvt_pk_f16_f32 v41, v114, v115
    ds_write_b64 v6, v[40:41] offset:7680
    v_cvt_pk_f16_f32 v42, v116, v117
    v_cvt_pk_f16_f32 v43, v118, v119
    ds_write_b64 v6, v[42:43] offset:7696
    v_cvt_pk_f16_f32 v44, v120, v121
    v_cvt_pk_f16_f32 v45, v122, v123
    ds_write_b64 v6, v[44:45] offset:7712
    v_cvt_pk_f16_f32 v46, v124, v125
    v_cvt_pk_f16_f32 v47, v126, v127
    ds_write_b64 v6, v[46:47] offset:7728
    v_cvt_pk_f16_f32 v48, v128, v129
    v_cvt_pk_f16_f32 v49, v130, v131
    ds_write_b64 v6, v[48:49] offset:10240
    v_cvt_pk_f16_f32 v50, v132, v133
    v_cvt_pk_f16_f32 v51, v134, v135
    ds_write_b64 v6, v[50:51] offset:10256
    v_cvt_pk_f16_f32 v52, v136, v137
    v_cvt_pk_f16_f32 v53, v138, v139
    ds_write_b64 v6, v[52:53] offset:10272
    v_cvt_pk_f16_f32 v54, v140, v141
    v_cvt_pk_f16_f32 v55, v142, v143
    ds_write_b64 v6, v[54:55] offset:10288
    s_waitcnt lgkmcnt(0)
    ds_read_b128 v[64:67], v9 offset:0
    ds_read_b128 v[68:71], v9 offset:1280
    ds_read_b128 v[72:75], v9 offset:2560
    ds_read_b128 v[76:79], v9 offset:3840
    ds_read_b128 v[80:83], v9 offset:5120
    ds_read_b128 v[84:87], v9 offset:6400
    ds_read_b128 v[88:91], v9 offset:7680
    ds_read_b128 v[92:95], v9 offset:8960
    ds_read_b128 v[96:99], v9 offset:10240
    ds_read_b128 v[100:103], v9 offset:11520
    s_mov_b32 s3, 0
    s_waitcnt lgkmcnt(9)
    buffer_store_dwordx4 v[64:67], v7, s[16:19], s3 offen sc1
    s_add_u32 s3, s3, 65536
    s_waitcnt lgkmcnt(8)
    buffer_store_dwordx4 v[68:71], v7, s[16:19], s3 offen sc1
    s_add_u32 s3, s3, 65536
    s_waitcnt lgkmcnt(7)
    buffer_store_dwordx4 v[72:75], v7, s[16:19], s3 offen sc1
    s_add_u32 s3, s3, 65536
    s_waitcnt lgkmcnt(6)
    buffer_store_dwordx4 v[76:79], v7, s[16:19], s3 offen sc1
    s_add_u32 s3, s3, 65536
    s_waitcnt lgkmcnt(5)
    buffer_store_dwordx4 v[80:83], v7, s[16:19], s3 offen sc1
    s_add_u32 s3, s3, 65536
    s_waitcnt lgkmcnt(4)
    buffer_store_dwordx4 v[84:87], v7, s[16:19], s3 offen sc1
    s_add_u32 s3, s3, 65536
    s_waitcnt lgkmcnt(3)
    buffer_store_dwordx4 v[88:91], v7, s[16:19], s3 offen sc1
    s_add_u32 s3, s3, 65536
    s_waitcnt lgkmcnt(2)
    buffer_store_dwordx4 v[92:95], v7, s[16:19], s3 offen sc1
    s_add_u32 s3, s3, 65536
    s_waitcnt lgkmcnt(1)
    buffer_store_dwordx4 v[96:99], v7, s[16:19], s3 offen sc1
    s_add_u32 s3, s3, 65536
    s_waitcnt lgkmcnt(0)
    buffer_store_dwordx4 v[100:103], v7, s[16:19], s3 offen sc1
    s_add_u32 s3, s3, 65536
    s_waitcnt vmcnt(0)
    s_barrier
    s_cmp_lg_u32 s24, 0
    s_cbranch_scc1 arr_48
    v_cmp_gt_u32 vcc, 8, v1
    s_and_saveexec_b64 s[100:101], vcc
    v_lshlrev_b32 v6, 7, v1
    v_mov_b32 v7, 1
    buffer_atomic_add v7, v6, s[96:99], 0 offen offset:2048 sc1
    s_mov_b64 exec, s[100:101]
arr_48:
aux_fft:
    v_lshlrev_b32 v5, 4, v1
    v_add_u32 v63, 92160, v5
    ds_read_b128 a[0:3], v63 offset:0
    ds_read_b128 a[4:7], v63 offset:1024
    ds_read_b128 a[8:11], v63 offset:2048
    ds_read_b128 a[12:15], v63 offset:3072
    ds_read_b128 a[16:19], v63 offset:4096
    ds_read_b128 a[20:23], v63 offset:5120
    ds_read_b128 a[24:27], v63 offset:6144
    ds_read_b128 a[28:31], v63 offset:7168
    ds_read_b128 a[32:35], v63 offset:8192
    ds_read_b128 a[36:39], v63 offset:9216
    ds_read_b128 a[40:43], v63 offset:10240
    ds_read_b128 a[44:47], v63 offset:11264
    ds_read_b128 a[48:51], v63 offset:12288
    ds_read_b128 a[52:55], v63 offset:13312
    ds_read_b128 a[56:59], v63 offset:14336
    ds_read_b128 a[60:63], v63 offset:15360
    ds_read_b128 a[96:99], v63 offset:16384
    ds_read_b128 a[100:103], v63 offset:17408
    ds_read_b128 a[104:107], v63 offset:18432
    ds_read_b128 a[108:111], v63 offset:19456
    ds_read_b128 a[112:115], v63 offset:20480
    ds_read_b128 a[116:119], v63 offset:21504
    s_add_u32 s8, s54, 8388608
    s_addc_u32 s9, s55, 0
    s_and_b32 s9, s9, 0xffff
    s_mov_b32 s10, 2621440
    s_mov_b32 s11, 0x00020000
    s_add_u32 s12, s54, 11272192
    s_addc_u32 s13, s55, 0
    s_and_b32 s13, s13, 0xffff
    s_mov_b32 s14, 2629632
    s_mov_b32 s15, 0x00020000
    s_add_u32 s20, s54, 16252928
    s_addc_u32 s21, s55, 0
    s_and_b32 s21, s21, 0xffff
    s_mov_b32 s22, 2621440
    s_mov_b32 s23, 0x00020000
    s_add_u32 s4, s54, 8126464
    s_addc_u32 s5, s55, 0
    s_and_b32 s5, s5, 0xffff
    s_mov_b32 s6, 1024
    s_mov_b32 s7, 0x00020000
    s_and_b32 s30, s31, 7
    s_cmp_lg_u32 s24, 0
    s_cbranch_scc1 pook_50
    s_mov_b32 s58, 0
    v_mov_b32 v8, 0
    s_lshl_b32 s35, s30, 7
po_49:
    buffer_load_dwordx4 v[10:13], v8, s[96:99], s35 offen offset:2048 sc1
    s_waitcnt vmcnt(0)
    v_readfirstlane_b32 s3, v10
    s_nop 3
    s_cmp_lt_u32 s3, 64
    s_cbranch_scc1 poag_51
    s_branch pook_50
poag_51:
    s_add_u32 s58, s58, 1
    s_cmp_ge_u32 s58, 65536
    s_cbranch_scc1 pook_50
    s_sleep 2
    s_branch po_49
pook_50:
    s_barrier
    s_lshl_b32 s25, s31, 2
    s_add_u32 s25, s25, s24
    v_and_b32 v2, 31, v1
    v_lshrrev_b32 v3, 5, v1
    v_lshlrev_b32 v4, 4, v1
    v_lshlrev_b32 v2, 5, v2
    v_lshl_add_u32 v2, v3, 4, v2
    v_mov_b32 v3, v63
    s_cmp_gt_u32 s25, 320
    s_cbranch_scc1 fft_done
    s_and_b32 s26, s25, 1
    s_lshr_b32 s27, s25, 1
    s_mul_i32 s28, s26, 320
    s_add_u32 s28, s28, s27
    s_add_u32 s29, s28, 160
    s_xor_b32 s3, s26, 1
    s_sub_u32 s29, s29, s3
    s_lshl_b32 s28, s28, 12
    s_lshl_b32 s29, s29, 12
    s_cmp_ge_u32 s25, 320
    s_cselect_b32 s28, 0x40000000, s28
    s_cmp_eq_u32 s25, 0
    s_cselect_b32 s29, 0x40000000, s29
    s_cmp_gt_u32 s25, 320
    s_cselect_b32 s29, 0x40000000, s29
    buffer_load_dwordx4 v[8:11], v4, s[8:11], s28 offen offset:0
    buffer_load_dwordx4 v[12:15], v4, s[8:11], s28 offen offset:1024
    buffer_load_dwordx4 v[16:19], v4, s[8:11], s28 offen offset:2048
    buffer_load_dwordx4 v[20:23], v4, s[8:11], s28 offen offset:3072
    buffer_load_dwordx4 v[24:27], v4, s[8:11], s29 offen offset:0
    buffer_load_dwordx4 v[28:31], v4, s[8:11], s29 offen offset:1024
    buffer_load_dwordx4 v[32:35], v4, s[8:11], s29 offen offset:2048
    buffer_load_dwordx4 v[36:39], v4, s[8:11], s29 offen offset:3072
    s_lshl_b32 s32, s25, 13
    s_add_u32 s58, s32, 4096
    buffer_load_dwordx4 v[224:227], v5, s[12:15], s32 offen offset:0
    buffer_load_dwordx4 v[228:231], v5, s[12:15], s32 offen offset:1024
    buffer_load_dwordx4 v[232:235], v5, s[12:15], s32 offen offset:2048
    buffer_load_dwordx4 v[236:239], v5, s[12:15], s32 offen offset:3072
    buffer_load_dwordx4 v[240:243], v5, s[12:15], s58 offen offset:0
    buffer_load_dwordx4 v[244:247], v5, s[12:15], s58 offen offset:1024
    buffer_load_dwordx4 v[248:251], v5, s[12:15], s58 offen offset:2048
    buffer_load_dwordx4 v[252:255], v5, s[12:15], s58 offen offset:3072
    buffer_load_dwordx4 a[124:127], v5, s[4:7], 0 offen sc1
    s_mov_b32 s33, 0
    s_waitcnt vmcnt(9)
fft_loop:
    ds_read_b128 v[40:43], v3 offset:22528
    ds_read_b128 v[44:47], v3 offset:23552
    ds_read_b128 v[48:51], v3 offset:24576
    ds_read_b128 v[52:55], v3 offset:25600
    ds_read_b128 v[56:59], v3 offset:26624
    ds_read_b128 v[60:63], v3 offset:27648
    ds_read_b128 v[64:67], v3 offset:28672
    ds_read_b128 v[68:71], v3 offset:29696
    ds_read_b128 v[72:75], v3 offset:30720
    ds_read_b128 v[76:79], v3 offset:31744
    ds_read_b128 v[80:83], v3 offset:32768
    ds_read_b128 v[84:87], v3 offset:33792
    ds_read_b128 v[88:91], v3 offset:34816
    ds_read_b128 v[92:95], v3 offset:35840
    ds_read_b128 v[96:99], v3 offset:36864
    ds_read_b128 v[100:103], v3 offset:37888
    v_xor_b32 v104, 0x80008000, v8
    v_xor_b32 v105, 0x80008000, v9
    v_xor_b32 v106, 0x80008000, v10
    v_xor_b32 v107, 0x80008000, v11
    v_xor_b32 v108, 0x80008000, v12
    v_xor_b32 v109, 0x80008000, v13
    v_xor_b32 v110, 0x80008000, v14
    v_xor_b32 v111, 0x80008000, v15
    v_xor_b32 v112, 0x80008000, v16
    v_xor_b32 v113, 0x80008000, v17
    v_xor_b32 v114, 0x80008000, v18
    v_xor_b32 v115, 0x80008000, v19
    v_xor_b32 v116, 0x80008000, v20
    v_xor_b32 v117, 0x80008000, v21
    v_xor_b32 v118, 0x80008000, v22
    v_xor_b32 v119, 0x80008000, v23
    s_waitcnt lgkmcnt(0)
    s_nop 1
    v_mfma_f32_32x32x16_f16 v[128:143], v[8:11], a[0:3], 0
    v_mfma_f32_32x32x16_f16 v[160:175], v[24:27], a[0:3], 0
    v_mfma_f32_32x32x16_f16 v[128:143], v[12:15], a[8:11], v[128:143]
    v_mfma_f32_32x32x16_f16 v[160:175], v[28:31], a[8:11], v[160:175]
    v_mfma_f32_32x32x16_f16 v[128:143], v[16:19], a[16:19], v[128:143]
    v_mfma_f32_32x32x16_f16 v[160:175], v[32:35], a[16:19], v[160:175]
    v_mfma_f32_32x32x16_f16 v[128:143], v[20:23], a[24:27], v[128:143]
    v_mfma_f32_32x32x16_f16 v[160:175], v[36:39], a[24:27], v[160:175]
    v_mfma_f32_32x32x16_f16 v[128:143], v[24:27], a[32:35], v[128:143]
    v_mfma_f32_32x32x16_f16 v[160:175], v[104:107], a[32:35], v[160:175]
    v_mfma_f32_32x32x16_f16 v[128:143], v[28:31], a[40:43], v[128:143]
    v_mfma_f32_32x32x16_f16 v[160:175], v[108:111], a[40:43], v[160:175]
    v_mfma_f32_32x32x16_f16 v[128:143], v[32:35], a[48:51], v[128:143]
    v_mfma_f32_32x32x16_f16 v[160:175], v[112:115], a[48:51], v[160:175]
    v_mfma_f32_32x32x16_f16 v[128:143], v[36:39], a[56:59], v[128:143]
    v_mfma_f32_32x32x16_f16 v[160:175], v[116:119], a[56:59], v[160:175]
    v_mfma_f32_32x32x16_f16 v[144:159], v[8:11], a[4:7], 0
    v_mfma_f32_32x32x16_f16 v[176:191], v[24:27], a[4:7], 0
    s_nop 11
    v_pk_mul_f32 v[120:121], v[128:129], v[40:41]
    v_pk_mul_f32 v[122:123], v[128:129], v[72:73]
    v_pk_fma_f32 v[120:121], v[160:161], v[72:73], v[120:121] neg_lo:[1,0,0] neg_hi:[1,0,0]
    v_mfma_f32_32x32x16_f16 v[144:159], v[12:15], a[12:15], v[144:159]
    v_pk_fma_f32 v[122:123], v[160:161], v[40:41], v[122:123]
    v_cvt_pk_f16_f32 v192, v120, v121
    v_cvt_pk_f16_f32 v208, v122, v123
    v_mfma_f32_32x32x16_f16 v[176:191], v[28:31], a[12:15], v[176:191]
    v_pk_mul_f32 v[124:125], v[130:131], v[42:43]
    v_pk_mul_f32 v[126:127], v[130:131], v[74:75]
    v_pk_fma_f32 v[124:125], v[162:163], v[74:75], v[124:125] neg_lo:[1,0,0] neg_hi:[1,0,0]
    v_pk_fma_f32 v[126:127], v[162:163], v[42:43], v[126:127]
    v_mfma_f32_32x32x16_f16 v[144:159], v[16:19], a[20:23], v[144:159]
    v_cvt_pk_f16_f32 v193, v124, v125
    v_cvt_pk_f16_f32 v209, v126, v127
    v_pk_mul_f32 v[120:121], v[132:133], v[44:45]
    v_mfma_f32_32x32x16_f16 v[176:191], v[32:35], a[20:23], v[176:191]
    v_pk_mul_f32 v[122:123], v[132:133], v[76:77]
    v_pk_fma_f32 v[120:121], v[164:165], v[76:77], v[120:121] neg_lo:[1,0,0] neg_hi:[1,0,0]
    v_pk_fma_f32 v[122:123], v[164:165], v[44:45], v[122:123]
    v_cvt_pk_f16_f32 v194, v120, v121
    v_mfma_f32_32x32x16_f16 v[144:159], v[20:23], a[28:31], v[144:159]
    v_cvt_pk_f16_f32 v210, v122, v123
    v_pk_mul_f32 v[124:125], v[134:135], v[46:47]
    v_pk_mul_f32 v[126:127], v[134:135], v[78:79]
    v_mfma_f32_32x32x16_f16 v[176:191], v[36:39], a[28:31], v[176:191]
    v_pk_fma_f32 v[124:125], v[166:167], v[78:79], v[124:125] neg_lo:[1,0,0] neg_hi:[1,0,0]
    v_pk_fma_f32 v[126:127], v[166:167], v[46:47], v[126:127]
    v_cvt_pk_f16_f32 v195, v124, v125
    v_cvt_pk_f16_f32 v211, v126, v127
    v_mfma_f32_32x32x16_f16 v[144:159], v[24:27], a[36:39], v[144:159]
    v_pk_mul_f32 v[120:121], v[136:137], v[48:49]
    v_pk_mul_f32 v[122:123], v[136:137], v[80:81]
    v_pk_fma_f32 v[120:121], v[168:169], v[80:81], v[120:121] neg_lo:[1,0,0] neg_hi:[1,0,0]
    v_mfma_f32_32x32x16_f16 v[176:191], v[104:107], a[36:39], v[176:191]
    v_pk_fma_f32 v[122:123], v[168:169], v[48:49], v[122:123]
    v_cvt_pk_f16_f32 v196, v120, v121
    v_cvt_pk_f16_f32 v212, v122, v123
    v_mfma_f32_32x32x16_f16 v[144:159], v[28:31], a[44:47], v[144:159]
    v_pk_mul_f32 v[124:125], v[138:139], v[50:51]
    v_pk_mul_f32 v[126:127], v[138:139], v[82:83]
    v_pk_fma_f32 v[124:125], v[170:171], v[82:83], v[124:125] neg_lo:[1,0,0] neg_hi:[1,0,0]
    v_pk_fma_f32 v[126:127], v[170:171], v[50:51], v[126:127]
    v_mfma_f32_32x32x16_f16 v[176:191], v[108:111], a[44:47], v[176:191]
    v_cvt_pk_f16_f32 v197, v124, v125
    v_cvt_pk_f16_f32 v213, v126, v127
    v_pk_mul_f32 v[120:121], v[140:141], v[52:53]
    v_mfma_f32_32x32x16_f16 v[144:159], v[32:35], a[52:55], v[144:159]
    v_pk_mul_f32 v[122:123], v[140:141], v[84:85]
    v_pk_fma_f32 v[120:121], v[172:173], v[84:85], v[120:121] neg_lo:[1,0,0] neg_hi:[1,0,0]
    v_pk_fma_f32 v[122:123], v[172:173], v[52:53], v[122:123]
    v_cvt_pk_f16_f32 v198, v120, v121
    v_mfma_f32_32x32x16_f16 v[176:191], v[112:115], a[52:55], v[176:191]
    v_cvt_pk_f16_f32 v214, v122, v123
    v_pk_mul_f32 v[124:125], v[142:143], v[54:55]
    v_pk_mul_f32 v[126:127], v[142:143], v[86:87]
    v_mfma_f32_32x32x16_f16 v[144:159], v[36:39], a[60:63], v[144:159]
    v_pk_fma_f32 v[124:125], v[174:175], v[86:87], v[124:125] neg_lo:[1,0,0] neg_hi:[1,0,0]
    v_pk_fma_f32 v[126:127], v[174:175], v[54:55], v[126:127]
    v_cvt_pk_f16_f32 v199, v124, v125
    v_cvt_pk_f16_f32 v215, v126, v127
    v_mfma_f32_32x32x16_f16 v[176:191], v[116:119], a[60:63], v[176:191]
    ds_read_b128 v[8:11], v3 offset:38912
    ds_read_b128 v[12:15], v3 offset:39936
    ds_read_b128 v[16:19], v3 offset:40960
    ds_read_b128 v[20:23], v3 offset:41984
    ds_read_b128 v[24:27], v3 offset:43008
    ds_read_b128 v[28:31], v3 offset:44032
    ds_read_b128 v[32:35], v3 offset:45056
    ds_read_b128 v[36:39], v3 offset:46080
    s_nop 1
    v_mfma_f32_32x32x16_f16 v[128:143], a[96:99], v[192:195], 0
    s_nop 11
    v_pk_mul_f32 v[120:121], v[144:145], v[56:57]
    v_pk_mul_f32 v[122:123], v[144:145], v[88:89]
    v_pk_fma_f32 v[120:121], v[176:177], v[88:89], v[120:121] neg_lo:[1,0,0] neg_hi:[1,0,0]
    v_pk_fma_f32 v[122:123], v[176:177], v[56:57], v[122:123]
    v_cvt_pk_f16_f32 v200, v120, v121
    v_cvt_pk_f16_f32 v216, v122, v123
    v_mfma_f32_32x32x16_f16 v[160:175], a[96:99], v[208:211], 0
    v_pk_mul_f32 v[124:125], v[146:147], v[58:59]
    v_pk_mul_f32 v[126:127], v[146:147], v[90:91]
    v_pk_fma_f32 v[124:125], v[178:179], v[90:91], v[124:125] neg_lo:[1,0,0] neg_hi:[1,0,0]
    v_pk_fma_f32 v[126:127], v[178:179], v[58:59], v[126:127]
    v_cvt_pk_f16_f32 v201, v124, v125
    v_cvt_pk_f16_f32 v217, v126, v127
    v_pk_mul_f32 v[120:121], v[148:149], v[60:61]
    v_mfma_f32_32x32x16_f16 v[128:143], a[100:103], v[196:199], v[128:143]
    v_pk_mul_f32 v[122:123], v[148:149], v[92:93]
    v_pk_fma_f32 v[120:121], v[180:181], v[92:93], v[120:121] neg_lo:[1,0,0] neg_hi:[1,0,0]
    v_pk_fma_f32 v[122:123], v[180:181], v[60:61], v[122:123]
    v_cvt_pk_f16_f32 v202, v120, v121
    v_cvt_pk_f16_f32 v218, v122, v123
    v_pk_mul_f32 v[124:125], v[150:151], v[62:63]
    v_pk_mul_f32 v[126:127], v[150:151], v[94:95]
    v_mfma_f32_32x32x16_f16 v[160:175], a[100:103], v[212:215], v[160:175]
    v_pk_fma_f32 v[124:125], v[182:183], v[94:95], v[124:125] neg_lo:[1,0,0] neg_hi:[1,0,0]
    v_pk_fma_f32 v[126:127], v[182:183], v[62:63], v[126:127]
    v_cvt_pk_f16_f32 v203, v124, v125
    v_cvt_pk_f16_f32 v219, v126, v127
    v_pk_mul_f32 v[120:121], v[152:153], v[64:65]
    v_pk_mul_f32 v[122:123], v[152:153], v[96:97]
    v_pk_fma_f32 v[120:121], v[184:185], v[96:97], v[120:121] neg_lo:[1,0,0] neg_hi:[1,0,0]
    v_mfma_f32_32x32x16_f16 v[128:143], a[104:107], v[208:211], v[128:143]
    v_pk_fma_f32 v[122:123], v[184:185], v[64:65], v[122:123]
    v_cvt_pk_f16_f32 v204, v120, v121
    v_cvt_pk_f16_f32 v220, v122, v123
    v_pk_mul_f32 v[124:125], v[154:155], v[66:67]
    v_pk_mul_f32 v[126:127], v[154:155], v[98:99]
    v_pk_fma_f32 v[124:125], v[186:187], v[98:99], v[124:125] neg_lo:[1,0,0] neg_hi:[1,0,0]
    v_pk_fma_f32 v[126:127], v[186:187], v[66:67], v[126:127]
    v_mfma_f32_32x32x16_f16 v[160:175], a[112:115], v[192:195], v[160:175]
    v_cvt_pk_f16_f32 v205, v124, v125
    v_cvt_pk_f16_f32 v221, v126, v127
    v_pk_mul_f32 v[120:121], v[156:157], v[68:69]
    v_pk_mul_f32 v[122:123], v[156:157], v[100:101]
    v_pk_fma_f32 v[120:121], v[188:189], v[100:101], v[120:121] neg_lo:[1,0,0] neg_hi:[1,0,0]
    v_pk_fma_f32 v[122:123], v[188:189], v[68:69], v[122:123]
    v_cvt_pk_f16_f32 v206, v120, v121
    v_mfma_f32_32x32x16_f16 v[128:143], a[108:111], v[212:215], v[128:143]
    v_cvt_pk_f16_f32 v222, v122, v123
    v_pk_mul_f32 v[124:125], v[158:159], v[70:71]
    v_pk_mul_f32 v[126:127], v[158:159], v[102:103]
    v_pk_fma_f32 v[124:125], v[190:191], v[102:103], v[124:125] neg_lo:[1,0,0] neg_hi:[1,0,0]
    v_pk_fma_f32 v[126:127], v[190:191], v[70:71], v[126:127]
    v_cvt_pk_f16_f32 v207, v124, v125
    v_cvt_pk_f16_f32 v223, v126, v127
    v_mfma_f32_32x32x16_f16 v[160:175], a[116:119], v[196:199], v[160:175]
    ds_read_b128 v[40:43], v3 offset:47104
    ds_read_b128 v[44:47], v3 offset:48128
    ds_read_b128 v[48:51], v3 offset:49152
    ds_read_b128 v[52:55], v3 offset:50176
    ds_read_b128 v[56:59], v3 offset:51200
    ds_read_b128 v[60:63], v3 offset:52224
    ds_read_b128 v[64:67], v3 offset:53248
    ds_read_b128 v[68:71], v3 offset:54272
    s_waitcnt vmcnt(0)
    v_accvgpr_read_b32 v6, a124
    v_accvgpr_read_b32 v7, a125
    v_max_u32 v6, v6, v7
    v_accvgpr_read_b32 v7, a126
    v_max_u32 v6, v6, v7
    v_accvgpr_read_b32 v7, a127
    v_max_u32 v7, v6, v7
    s_nop 1
    v_max_u32_dpp v7, v7, v7 row_shr:1 row_mask:0xf bank_mask:0xf
    s_nop 1
    v_max_u32_dpp v7, v7, v7 row_shr:2 row_mask:0xf bank_mask:0xf
    s_nop 1
    v_max_u32_dpp v7, v7, v7 row_shr:4 row_mask:0xf bank_mask:0xf
    s_nop 1
    v_max_u32_dpp v7, v7, v7 row_shr:8 row_mask:0xf bank_mask:0xf
    s_nop 1
    v_max_u32_dpp v7, v7, v7 row_bcast:15 row_mask:0xa bank_mask:0xf
    s_nop 1
    v_max_u32_dpp v7, v7, v7 row_bcast:31 row_mask:0xc bank_mask:0xf
    s_nop 1
    v_readlane_b32 s33, v7, 63
    s_nop 3
    s_lshr_b32 s33, s33, 7
    s_and_b32 s33, s33, 0xff
    s_min_u32 s33, s33, 249
    s_sub_u32 s33, 250, s33
    s_cmp_eq_u32 s25, 0
    s_cselect_b32 s3, 0, 1
    s_cmp_eq_u32 s25, 320
    s_cselect_b32 s3, 0, s3
    s_add_u32 s59, s33, s3
    s_lshl_b32 s59, s59, 23
    v_mov_b32 v6, s59
    s_nop 1
    v_mfma_f32_32x32x16_f16 v[144:159], a[96:99], v[200:203], 0
    s_nop 11
    v_lshlrev_b32 v104, 16, v224
    v_lshlrev_b32 v105, 16, v225
    v_and_b32 v106, 0xffff0000, v224
    v_and_b32 v107, 0xffff0000, v225
    v_pk_mul_f32 v[104:105], v[104:105], v[6:7] op_sel_hi:[1,0]
    v_pk_mul_f32 v[106:107], v[106:107], v[6:7] op_sel_hi:[1,0]
    v_pk_mul_f32 v[108:109], v[128:129], v[104:105]
    v_pk_mul_f32 v[110:111], v[128:129], v[106:107]
    v_pk_fma_f32 v[108:109], v[160:161], v[106:107], v[108:109] neg_lo:[1,0,0] neg_hi:[1,0,0]
    v_pk_fma_f32 v[110:111], v[160:161], v[104:105], v[110:111]
    v_cvt_pk_f16_f32 v192, v108, v109
    v_cvt_pk_f16_f32 v208, v110, v111
    v_lshlrev_b32 v112, 16, v226
    v_mfma_f32_32x32x16_f16 v[176:191], a[96:99], v[216:219], 0
    v_lshlrev_b32 v113, 16, v227
    v_and_b32 v114, 0xffff0000, v226
    v_and_b32 v115, 0xffff0000, v227
    v_pk_mul_f32 v[112:113], v[112:113], v[6:7] op_sel_hi:[1,0]
    v_pk_mul_f32 v[114:115], v[114:115], v[6:7] op_sel_hi:[1,0]
    v_pk_mul_f32 v[116:117], v[130:131], v[112:113]
    v_pk_mul_f32 v[118:119], v[130:131], v[114:115]
    v_pk_fma_f32 v[116:117], v[162:163], v[114:115], v[116:117] neg_lo:[1,0,0] neg_hi:[1,0,0]
    v_pk_fma_f32 v[118:119], v[162:163], v[112:113], v[118:119]
    v_cvt_pk_f16_f32 v193, v116, v117
    v_cvt_pk_f16_f32 v209, v118, v119
    v_lshlrev_b32 v104, 16, v228
    v_lshlrev_b32 v105, 16, v229
    v_and_b32 v106, 0xffff0000, v228
    v_mfma_f32_32x32x16_f16 v[144:159], a[100:103], v[204:207], v[144:159]
    v_and_b32 v107, 0xffff0000, v229
    v_pk_mul_f32 v[104:105], v[104:105], v[6:7] op_sel_hi:[1,0]
    v_pk_mul_f32 v[106:107], v[106:107], v[6:7] op_sel_hi:[1,0]
    v_pk_mul_f32 v[108:109], v[132:133], v[104:105]
    v_pk_mul_f32 v[110:111], v[132:133], v[106:107]
    v_pk_fma_f32 v[108:109], v[164:165], v[106:107], v[108:109] neg_lo:[1,0,0] neg_hi:[1,0,0]
    v_pk_fma_f32 v[110:111], v[164:165], v[104:105], v[110:111]
    v_cvt_pk_f16_f32 v194, v108, v109
    v_cvt_pk_f16_f32 v210, v110, v111
    v_lshlrev_b32 v112, 16, v230
    v_lshlrev_b32 v113, 16, v231
    v_and_b32 v114, 0xffff0000, v230
    v_and_b32 v115, 0xffff0000, v231
    v_pk_mul_f32 v[112:113], v[112:113], v[6:7] op_sel_hi:[1,0]
    v_mfma_f32_32x32x16_f16 v[176:191], a[100:103], v[220:223], v[176:191]
    v_pk_mul_f32 v[114:115], v[114:115], v[6:7] op_sel_hi:[1,0]
    v_pk_mul_f32 v[116:117], v[134:135], v[112:113]
    v_pk_mul_f32 v[118:119], v[134:135], v[114:115]
    v_pk_fma_f32 v[116:117], v[166:167], v[114:115], v[116:117] neg_lo:[1,0,0] neg_hi:[1,0,0]
    v_pk_fma_f32 v[118:119], v[166:167], v[112:113], v[118:119]
    v_cvt_pk_f16_f32 v195, v116, v117
    v_cvt_pk_f16_f32 v211, v118, v119
    v_lshlrev_b32 v104, 16, v232
    v_lshlrev_b32 v105, 16, v233
    v_and_b32 v106, 0xffff0000, v232
    v_and_b32 v107, 0xffff0000, v233
    v_pk_mul_f32 v[104:105], v[104:105], v[6:7] op_sel_hi:[1,0]
    v_pk_mul_f32 v[106:107], v[106:107], v[6:7] op_sel_hi:[1,0]
    v_mfma_f32_32x32x16_f16 v[144:159], a[104:107], v[216:219], v[144:159]
    v_pk_mul_f32 v[108:109], v[136:137], v[104:105]
    v_pk_mul_f32 v[110:111], v[136:137], v[106:107]
    v_pk_fma_f32 v[108:109], v[168:169], v[106:107], v[108:109] neg_lo:[1,0,0] neg_hi:[1,0,0]
    v_pk_fma_f32 v[110:111], v[168:169], v[104:105], v[110:111]
    v_cvt_pk_f16_f32 v196, v108, v109
    v_cvt_pk_f16_f32 v212, v110, v111
    v_lshlrev_b32 v112, 16, v234
    v_lshlrev_b32 v113, 16, v235
    v_and_b32 v114, 0xffff0000, v234
    v_and_b32 v115, 0xffff0000, v235
    v_pk_mul_f32 v[112:113], v[112:113], v[6:7] op_sel_hi:[1,0]
    v_pk_mul_f32 v[114:115], v[114:115], v[6:7] op_sel_hi:[1,0]
    v_pk_mul_f32 v[116:117], v[138:139], v[112:113]
    v_pk_mul_f32 v[118:119], v[138:139], v[114:115]
    v_mfma_f32_32x32x16_f16 v[176:191], a[112:115], v[200:203], v[176:191]
    v_pk_fma_f32 v[116:117], v[170:171], v[114:115], v[116:117] neg_lo:[1,0,0] neg_hi:[1,0,0]
    v_pk_fma_f32 v[118:119], v[170:171], v[112:113], v[118:119]
    v_cvt_pk_f16_f32 v197, v116, v117
    v_cvt_pk_f16_f32 v213, v118, v119
    v_lshlrev_b32 v104, 16, v236
    v_lshlrev_b32 v105, 16, v237
    v_and_b32 v106, 0xffff0000, v236
    v_and_b32 v107, 0xffff0000, v237
    v_pk_mul_f32 v[104:105], v[104:105], v[6:7] op_sel_hi:[1,0]
    v_pk_mul_f32 v[106:107], v[106:107], v[6:7] op_sel_hi:[1,0]
    v_pk_mul_f32 v[108:109], v[140:141], v[104:105]
    v_pk_mul_f32 v[110:111], v[140:141], v[106:107]
    v_pk_fma_f32 v[108:109], v[172:173], v[106:107], v[108:109] neg_lo:[1,0,0] neg_hi:[1,0,0]
    v_pk_fma_f32 v[110:111], v[172:173], v[104:105], v[110:111]
    v_mfma_f32_32x32x16_f16 v[144:159], a[108:111], v[220:223], v[144:159]
    v_cvt_pk_f16_f32 v198, v108, v109
    v_cvt_pk_f16_f32 v214, v110, v111
    v_lshlrev_b32 v112, 16, v238
    v_lshlrev_b32 v113, 16, v239
    v_and_b32 v114, 0xffff0000, v238
    v_and_b32 v115, 0xffff0000, v239
    v_pk_mul_f32 v[112:113], v[112:113], v[6:7] op_sel_hi:[1,0]
    v_pk_mul_f32 v[114:115], v[114:115], v[6:7] op_sel_hi:[1,0]
    v_pk_mul_f32 v[116:117], v[142:143], v[112:113]
    v_pk_mul_f32 v[118:119], v[142:143], v[114:115]
    v_pk_fma_f32 v[116:117], v[174:175], v[114:115], v[116:117] neg_lo:[1,0,0] neg_hi:[1,0,0]
    v_pk_fma_f32 v[118:119], v[174:175], v[112:113], v[118:119]
    v_cvt_pk_f16_f32 v199, v116, v117
    v_cvt_pk_f16_f32 v215, v118, v119
    v_mfma_f32_32x32x16_f16 v[176:191], a[116:119], v[204:207], v[176:191]
    s_nop 1
    v_mfma_f32_32x32x16_f16 v[128:143], v[192:195], a[96:99], 0
    s_nop 11
    v_lshlrev_b32 v104, 16, v240
    v_lshlrev_b32 v105, 16, v241
    v_and_b32 v106, 0xffff0000, v240
    v_and_b32 v107, 0xffff0000, v241
    v_pk_mul_f32 v[104:105], v[104:105], v[6:7] op_sel_hi:[1,0]
    v_pk_mul_f32 v[106:107], v[106:107], v[6:7] op_sel_hi:[1,0]
    v_pk_mul_f32 v[108:109], v[144:145], v[104:105]
    v_pk_mul_f32 v[110:111], v[144:145], v[106:107]
    v_pk_fma_f32 v[108:109], v[176:177], v[106:107], v[108:109] neg_lo:[1,0,0] neg_hi:[1,0,0]
    v_pk_fma_f32 v[110:111], v[176:177], v[104:105], v[110:111]
    v_cvt_pk_f16_f32 v200, v108, v109
    v_cvt_pk_f16_f32 v216, v110, v111
    v_lshlrev_b32 v112, 16, v242
    v_mfma_f32_32x32x16_f16 v[160:175], v[208:211], a[96:99], 0
    v_lshlrev_b32 v113, 16, v243
    v_and_b32 v114, 0xffff0000, v242
    v_and_b32 v115, 0xffff0000, v243
    v_pk_mul_f32 v[112:113], v[112:113], v[6:7] op_sel_hi:[1,0]
    v_pk_mul_f32 v[114:115], v[114:115], v[6:7] op_sel_hi:[1,0]
    v_pk_mul_f32 v[116:117], v[146:147], v[112:113]
    v_pk_mul_f32 v[118:119], v[146:147], v[114:115]
    v_pk_fma_f32 v[116:117], v[178:179], v[114:115], v[116:117] neg_lo:[1,0,0] neg_hi:[1,0,0]
    v_pk_fma_f32 v[118:119], v[178:179], v[112:113], v[118:119]
    v_cvt_pk_f16_f32 v201, v116, v117
    v_cvt_pk_f16_f32 v217, v118, v119
    v_lshlrev_b32 v104, 16, v244
    v_lshlrev_b32 v105, 16, v245
    v_and_b32 v106, 0xffff0000, v244
    v_mfma_f32_32x32x16_f16 v[128:143], v[196:199], a[100:103], v[128:143]
    v_and_b32 v107, 0xffff0000, v245
    v_pk_mul_f32 v[104:105], v[104:105], v[6:7] op_sel_hi:[1,0]
    v_pk_mul_f32 v[106:107], v[106:107], v[6:7] op_sel_hi:[1,0]
    v_pk_mul_f32 v[108:109], v[148:149], v[104:105]
    v_pk_mul_f32 v[110:111], v[148:149], v[106:107]
    v_pk_fma_f32 v[108:109], v[180:181], v[106:107], v[108:109] neg_lo:[1,0,0] neg_hi:[1,0,0]
    v_pk_fma_f32 v[110:111], v[180:181], v[104:105], v[110:111]
    v_cvt_pk_f16_f32 v202, v108, v109
    v_cvt_pk_f16_f32 v218, v110, v111
    v_lshlrev_b32 v112, 16, v246
    v_lshlrev_b32 v113, 16, v247
    v_and_b32 v114, 0xffff0000, v246
    v_and_b32 v115, 0xffff0000, v247
    v_pk_mul_f32 v[112:113], v[112:113], v[6:7] op_sel_hi:[1,0]
    v_mfma_f32_32x32x16_f16 v[160:175], v[212:215], a[100:103], v[160:175]
    v_pk_mul_f32 v[114:115], v[114:115], v[6:7] op_sel_hi:[1,0]
    v_pk_mul_f32 v[116:117], v[150:151], v[112:113]
    v_pk_mul_f32 v[118:119], v[150:151], v[114:115]
    v_pk_fma_f32 v[116:117], v[182:183], v[114:115], v[116:117] neg_lo:[1,0,0] neg_hi:[1,0,0]
    v_pk_fma_f32 v[118:119], v[182:183], v[112:113], v[118:119]
    v_cvt_pk_f16_f32 v203, v116, v117
    v_cvt_pk_f16_f32 v219, v118, v119
    v_lshlrev_b32 v104, 16, v248
    v_lshlrev_b32 v105, 16, v249
    v_and_b32 v106, 0xffff0000, v248
    v_and_b32 v107, 0xffff0000, v249
    v_pk_mul_f32 v[104:105], v[104:105], v[6:7] op_sel_hi:[1,0]
    v_pk_mul_f32 v[106:107], v[106:107], v[6:7] op_sel_hi:[1,0]
    v_mfma_f32_32x32x16_f16 v[128:143], v[208:211], a[112:115], v[128:143]
    v_pk_mul_f32 v[108:109], v[152:153], v[104:105]
    v_pk_mul_f32 v[110:111], v[152:153], v[106:107]
    v_pk_fma_f32 v[108:109], v[184:185], v[106:107], v[108:109] neg_lo:[1,0,0] neg_hi:[1,0,0]
    v_pk_fma_f32 v[110:111], v[184:185], v[104:105], v[110:111]
    v_cvt_pk_f16_f32 v204, v108, v109
    v_cvt_pk_f16_f32 v220, v110, v111
    v_lshlrev_b32 v112, 16, v250
    v_lshlrev_b32 v113, 16, v251
    v_and_b32 v114, 0xffff0000, v250
    v_and_b32 v115, 0xffff0000, v251
    v_pk_mul_f32 v[112:113], v[112:113], v[6:7] op_sel_hi:[1,0]
    v_pk_mul_f32 v[114:115], v[114:115], v[6:7] op_sel_hi:[1,0]
    v_pk_mul_f32 v[116:117], v[154:155], v[112:113]
    v_pk_mul_f32 v[118:119], v[154:155], v[114:115]
    v_mfma_f32_32x32x16_f16 v[160:175], v[192:195], a[104:107], v[160:175]
    v_pk_fma_f32 v[116:117], v[186:187], v[114:115], v[116:117] neg_lo:[1,0,0] neg_hi:[1,0,0]
    v_pk_fma_f32 v[118:119], v[186:187], v[112:113], v[118:119]
    v_cvt_pk_f16_f32 v205, v116, v117
    v_cvt_pk_f16_f32 v221, v118, v119
    v_lshlrev_b32 v104, 16, v252
    v_lshlrev_b32 v105, 16, v253
    v_and_b32 v106, 0xffff0000, v252
    v_and_b32 v107, 0xffff0000, v253
    v_pk_mul_f32 v[104:105], v[104:105], v[6:7] op_sel_hi:[1,0]
    v_pk_mul_f32 v[106:107], v[106:107], v[6:7] op_sel_hi:[1,0]
    v_pk_mul_f32 v[108:109], v[156:157], v[104:105]
    v_pk_mul_f32 v[110:111], v[156:157], v[106:107]
    v_pk_fma_f32 v[108:109], v[188:189], v[106:107], v[108:109] neg_lo:[1,0,0] neg_hi:[1,0,0]
    v_pk_fma_f32 v[110:111], v[188:189], v[104:105], v[110:111]
    v_mfma_f32_32x32x16_f16 v[128:143], v[212:215], a[116:119], v[128:143]
    v_cvt_pk_f16_f32 v206, v108, v109
    v_cvt_pk_f16_f32 v222, v110, v111
    v_lshlrev_b32 v112, 16, v254
    v_lshlrev_b32 v113, 16, v255
    v_and_b32 v114, 0xffff0000, v254
    v_and_b32 v115, 0xffff0000, v255
    v_pk_mul_f32 v[112:113], v[112:113], v[6:7] op_sel_hi:[1,0]
    v_pk_mul_f32 v[114:115], v[114:115], v[6:7] op_sel_hi:[1,0]
    v_pk_mul_f32 v[116:117], v[158:159], v[112:113]
    v_pk_mul_f32 v[118:119], v[158:159], v[114:115]
    v_pk_fma_f32 v[116:117], v[190:191], v[114:115], v[116:117] neg_lo:[1,0,0] neg_hi:[1,0,0]
    v_pk_fma_f32 v[118:119], v[190:191], v[112:113], v[118:119]
    v_cvt_pk_f16_f32 v207, v116, v117
    v_cvt_pk_f16_f32 v223, v118, v119
    v_mfma_f32_32x32x16_f16 v[160:175], v[196:199], a[108:111], v[160:175]
    s_waitcnt lgkmcnt(0)
    s_nop 1
    v_mfma_f32_32x32x16_f16 v[144:159], v[200:203], a[96:99], 0
    s_nop 11
    v_pk_mul_f32 v[120:121], v[128:129], v[8:9]
    v_pk_mul_f32 v[122:123], v[128:129], v[40:41]
    v_pk_fma_f32 v[120:121], v[160:161], v[40:41], v[120:121] neg_lo:[1,0,0] neg_hi:[1,0,0]
    v_pk_fma_f32 v[122:123], v[160:161], v[8:9], v[122:123]
    v_cvt_pk_f16_f32 v192, v120, v121
    v_cvt_pk_f16_f32 v208, v122, v123
    v_cvt_pk_f16_f32 v104, -v122, -v123
    v_pk_mul_f32 v[124:125], v[130:131], v[10:11]
    v_mfma_f32_32x32x16_f16 v[176:191], v[216:219], a[96:99], 0
    v_pk_mul_f32 v[126:127], v[130:131], v[42:43]
    v_pk_fma_f32 v[124:125], v[162:163], v[42:43], v[124:125] neg_lo:[1,0,0] neg_hi:[1,0,0]
    v_pk_fma_f32 v[126:127], v[162:163], v[10:11], v[126:127]
    v_cvt_pk_f16_f32 v193, v124, v125
    v_cvt_pk_f16_f32 v209, v126, v127
    v_cvt_pk_f16_f32 v105, -v126, -v127
    v_pk_mul_f32 v[120:121], v[132:133], v[12:13]
    v_pk_mul_f32 v[122:123], v[132:133], v[44:45]
    v_mfma_f32_32x32x16_f16 v[144:159], v[204:207], a[100:103], v[144:159]
    v_pk_fma_f32 v[120:121], v[164:165], v[44:45], v[120:121] neg_lo:[1,0,0] neg_hi:[1,0,0]
    v_pk_fma_f32 v[122:123], v[164:165], v[12:13], v[122:123]
    v_cvt_pk_f16_f32 v194, v120, v121
    v_cvt_pk_f16_f32 v210, v122, v123
    v_cvt_pk_f16_f32 v106, -v122, -v123
    v_pk_mul_f32 v[124:125], v[134:135], v[14:15]
    v_pk_mul_f32 v[126:127], v[134:135], v[46:47]
    v_pk_fma_f32 v[124:125], v[166:167], v[46:47], v[124:125] neg_lo:[1,0,0] neg_hi:[1,0,0]
    v_mfma_f32_32x32x16_f16 v[176:191], v[220:223], a[100:103], v[176:191]
    v_pk_fma_f32 v[126:127], v[166:167], v[14:15], v[126:127]
    v_cvt_pk_f16_f32 v195, v124, v125
    v_cvt_pk_f16_f32 v211, v126, v127
    v_cvt_pk_f16_f32 v107, -v126, -v127
    v_pk_mul_f32 v[120:121], v[136:137], v[16:17]
    v_pk_mul_f32 v[122:123], v[136:137], v[48:49]
    v_pk_fma_f32 v[120:121], v[168:169], v[48:49], v[120:121] neg_lo:[1,0,0] neg_hi:[1,0,0]
    v_pk_fma_f32 v[122:123], v[168:169], v[16:17], v[122:123]
    v_mfma_f32_32x32x16_f16 v[144:159], v[216:219], a[112:115], v[144:159]
    v_cvt_pk_f16_f32 v196, v120, v121
    v_cvt_pk_f16_f32 v212, v122, v123
    v_cvt_pk_f16_f32 v108, -v122, -v123
    v_pk_mul_f32 v[124:125], v[138:139], v[18:19]
    v_pk_mul_f32 v[126:127], v[138:139], v[50:51]
    v_pk_fma_f32 v[124:125], v[170:171], v[50:51], v[124:125] neg_lo:[1,0,0] neg_hi:[1,0,0]
    v_pk_fma_f32 v[126:127], v[170:171], v[18:19], v[126:127]
    v_cvt_pk_f16_f32 v197, v124, v125
    v_mfma_f32_32x32x16_f16 v[176:191], v[200:203], a[104:107], v[176:191]
    v_cvt_pk_f16_f32 v213, v126, v127
    v_cvt_pk_f16_f32 v109, -v126, -v127
    v_pk_mul_f32 v[120:121], v[140:141], v[20:21]
    v_pk_mul_f32 v[122:123], v[140:141], v[52:53]
    v_pk_fma_f32 v[120:121], v[172:173], v[52:53], v[120:121] neg_lo:[1,0,0] neg_hi:[1,0,0]
    v_pk_fma_f32 v[122:123], v[172:173], v[20:21], v[122:123]
    v_cvt_pk_f16_f32 v198, v120, v121
    v_cvt_pk_f16_f32 v214, v122, v123
    v_mfma_f32_32x32x16_f16 v[144:159], v[220:223], a[116:119], v[144:159]
    v_cvt_pk_f16_f32 v110, -v122, -v123
    v_pk_mul_f32 v[124:125], v[142:143], v[22:23]
    v_pk_mul_f32 v[126:127], v[142:143], v[54:55]
    v_pk_fma_f32 v[124:125], v[174:175], v[54:55], v[124:125] neg_lo:[1,0,0] neg_hi:[1,0,0]
    v_pk_fma_f32 v[126:127], v[174:175], v[22:23], v[126:127]
    v_cvt_pk_f16_f32 v199, v124, v125
    v_cvt_pk_f16_f32 v215, v126, v127
    v_cvt_pk_f16_f32 v111, -v126, -v127
    v_mfma_f32_32x32x16_f16 v[176:191], v[204:207], a[108:111], v[176:191]
    s_nop 13
    v_pk_mul_f32 v[120:121], v[144:145], v[24:25]
    v_pk_mul_f32 v[122:123], v[144:145], v[56:57]
    v_pk_fma_f32 v[120:121], v[176:177], v[56:57], v[120:121] neg_lo:[1,0,0] neg_hi:[1,0,0]
    v_pk_fma_f32 v[122:123], v[176:177], v[24:25], v[122:123]
    v_cvt_pk_f16_f32 v200, v120, v121
    v_cvt_pk_f16_f32 v216, v122, v123
    v_cvt_pk_f16_f32 v112, -v122, -v123
    v_pk_mul_f32 v[124:125], v[146:147], v[26:27]
    v_pk_mul_f32 v[126:127], v[146:147], v[58:59]
    v_pk_fma_f32 v[124:125], v[178:179], v[58:59], v[124:125] neg_lo:[1,0,0] neg_hi:[1,0,0]
    v_pk_fma_f32 v[126:127], v[178:179], v[26:27], v[126:127]
    v_cvt_pk_f16_f32 v201, v124, v125
    v_cvt_pk_f16_f32 v217, v126, v127
    v_cvt_pk_f16_f32 v113, -v126, -v127
    v_pk_mul_f32 v[120:121], v[148:149], v[28:29]
    v_pk_mul_f32 v[122:123], v[148:149], v[60:61]
    v_pk_fma_f32 v[120:121], v[180:181], v[60:61], v[120:121] neg_lo:[1,0,0] neg_hi:[1,0,0]
    v_pk_fma_f32 v[122:123], v[180:181], v[28:29], v[122:123]
    v_cvt_pk_f16_f32 v202, v120, v121
    v_cvt_pk_f16_f32 v218, v122, v123
    v_cvt_pk_f16_f32 v114, -v122, -v123
    v_pk_mul_f32 v[124:125], v[150:151], v[30:31]
    v_pk_mul_f32 v[126:127], v[150:151], v[62:63]
    v_pk_fma_f32 v[124:125], v[182:183], v[62:63], v[124:125] neg_lo:[1,0,0] neg_hi:[1,0,0]
    v_pk_fma_f32 v[126:127], v[182:183], v[30:31], v[126:127]
    v_cvt_pk_f16_f32 v203, v124, v125
    v_cvt_pk_f16_f32 v219, v126, v127
    v_cvt_pk_f16_f32 v115, -v126, -v127
    v_pk_mul_f32 v[120:121], v[152:153], v[32:33]
    v_pk_mul_f32 v[122:123], v[152:153], v[64:65]
    v_pk_fma_f32 v[120:121], v[184:185], v[64:65], v[120:121] neg_lo:[1,0,0] neg_hi:[1,0,0]
    v_pk_fma_f32 v[122:123], v[184:185], v[32:33], v[122:123]
    v_cvt_pk_f16_f32 v204, v120, v121
    v_cvt_pk_f16_f32 v220, v122, v123
    v_cvt_pk_f16_f32 v116, -v122, -v123
    v_pk_mul_f32 v[124:125], v[154:155], v[34:35]
    v_pk_mul_f32 v[126:127], v[154:155], v[66:67]
    v_pk_fma_f32 v[124:125], v[186:187], v[66:67], v[124:125] neg_lo:[1,0,0] neg_hi:[1,0,0]
    v_pk_fma_f32 v[126:127], v[186:187], v[34:35], v[126:127]
    v_cvt_pk_f16_f32 v205, v124, v125
    v_cvt_pk_f16_f32 v221, v126, v127
    v_cvt_pk_f16_f32 v117, -v126, -v127
    v_pk_mul_f32 v[120:121], v[156:157], v[36:37]
    v_pk_mul_f32 v[122:123], v[156:157], v[68:69]
    v_pk_fma_f32 v[120:121], v[188:189], v[68:69], v[120:121] neg_lo:[1,0,0] neg_hi:[1,0,0]
    v_pk_fma_f32 v[122:123], v[188:189], v[36:37], v[122:123]
    v_cvt_pk_f16_f32 v206, v120, v121
    v_cvt_pk_f16_f32 v222, v122, v123
    v_cvt_pk_f16_f32 v118, -v122, -v123
    v_pk_mul_f32 v[124:125], v[158:159], v[38:39]
    v_pk_mul_f32 v[126:127], v[158:159], v[70:71]
    v_pk_fma_f32 v[124:125], v[190:191], v[70:71], v[124:125] neg_lo:[1,0,0] neg_hi:[1,0,0]
    v_pk_fma_f32 v[126:127], v[190:191], v[38:39], v[126:127]
    v_cvt_pk_f16_f32 v207, v124, v125
    v_cvt_pk_f16_f32 v223, v126, v127
    v_cvt_pk_f16_f32 v119, -v126, -v127
    s_nop 1
    v_mfma_f32_32x32x16_f16 v[128:143], v[192:195], a[0:3], 0
    v_mfma_f32_32x32x16_f16 v[160:175], v[208:211], a[0:3], 0
    v_mfma_f32_32x32x16_f16 v[128:143], v[196:199], a[8:11], v[128:143]
    v_mfma_f32_32x32x16_f16 v[160:175], v[212:215], a[8:11], v[160:175]
    v_mfma_f32_32x32x16_f16 v[128:143], v[200:203], a[16:19], v[128:143]
    v_mfma_f32_32x32x16_f16 v[160:175], v[216:219], a[16:19], v[160:175]
    v_mfma_f32_32x32x16_f16 v[128:143], v[204:207], a[24:27], v[128:143]
    v_mfma_f32_32x32x16_f16 v[160:175], v[220:223], a[24:27], v[160:175]
    v_mfma_f32_32x32x16_f16 v[128:143], v[104:107], a[32:35], v[128:143]
    v_mfma_f32_32x32x16_f16 v[160:175], v[192:195], a[32:35], v[160:175]
    v_mfma_f32_32x32x16_f16 v[128:143], v[108:111], a[40:43], v[128:143]
    v_mfma_f32_32x32x16_f16 v[160:175], v[196:199], a[40:43], v[160:175]
    v_mfma_f32_32x32x16_f16 v[128:143], v[112:115], a[48:51], v[128:143]
    v_mfma_f32_32x32x16_f16 v[160:175], v[200:203], a[48:51], v[160:175]
    v_mfma_f32_32x32x16_f16 v[128:143], v[116:119], a[56:59], v[128:143]
    v_mfma_f32_32x32x16_f16 v[160:175], v[204:207], a[56:59], v[160:175]
    v_mfma_f32_32x32x16_f16 v[144:159], v[192:195], a[4:7], 0
    v_mfma_f32_32x32x16_f16 v[176:191], v[208:211], a[4:7], 0
    s_nop 11
    v_cvt_pk_f16_f32 v72, v128, v129
    v_mfma_f32_32x32x16_f16 v[144:159], v[196:199], a[12:15], v[144:159]
    v_cvt_pk_f16_f32 v73, v130, v131
    v_mfma_f32_32x32x16_f16 v[176:191], v[212:215], a[12:15], v[176:191]
    v_cvt_pk_f16_f32 v74, v132, v133
    v_cvt_pk_f16_f32 v75, v134, v135
    v_mfma_f32_32x32x16_f16 v[144:159], v[200:203], a[20:23], v[144:159]
    v_cvt_pk_f16_f32 v76, v136, v137
    v_mfma_f32_32x32x16_f16 v[176:191], v[216:219], a[20:23], v[176:191]
    v_cvt_pk_f16_f32 v77, v138, v139
    v_cvt_pk_f16_f32 v78, v140, v141
    v_mfma_f32_32x32x16_f16 v[144:159], v[204:207], a[28:31], v[144:159]
    v_cvt_pk_f16_f32 v79, v142, v143
    v_mfma_f32_32x32x16_f16 v[176:191], v[220:223], a[28:31], v[176:191]
    buffer_store_dwordx4 v[72:75], v2, s[20:23], s28 offen offset:0 sc1
    buffer_store_dwordx4 v[76:79], v2, s[20:23], s28 offen offset:1024 sc1
    v_mfma_f32_32x32x16_f16 v[144:159], v[104:107], a[36:39], v[144:159]
    v_cvt_pk_f16_f32 v88, v160, v161
    v_mfma_f32_32x32x16_f16 v[176:191], v[192:195], a[36:39], v[176:191]
    v_cvt_pk_f16_f32 v89, v162, v163
    v_mfma_f32_32x32x16_f16 v[144:159], v[108:111], a[44:47], v[144:159]
    v_cvt_pk_f16_f32 v90, v164, v165
    v_cvt_pk_f16_f32 v91, v166, v167
    v_mfma_f32_32x32x16_f16 v[176:191], v[196:199], a[44:47], v[176:191]
    v_cvt_pk_f16_f32 v92, v168, v169
    v_mfma_f32_32x32x16_f16 v[144:159], v[112:115], a[52:55], v[144:159]
    v_cvt_pk_f16_f32 v93, v170, v171
    v_cvt_pk_f16_f32 v94, v172, v173
    v_mfma_f32_32x32x16_f16 v[176:191], v[200:203], a[52:55], v[176:191]
    v_cvt_pk_f16_f32 v95, v174, v175
    v_mfma_f32_32x32x16_f16 v[144:159], v[116:119], a[60:63], v[144:159]
    buffer_store_dwordx4 v[88:91], v2, s[20:23], s29 offen offset:0 sc1
    buffer_store_dwordx4 v[92:95], v2, s[20:23], s29 offen offset:1024 sc1
    v_mfma_f32_32x32x16_f16 v[176:191], v[204:207], a[60:63], v[176:191]
    s_nop 13
    v_cvt_pk_f16_f32 v80, v144, v145
    v_cvt_pk_f16_f32 v81, v146, v147
    v_cvt_pk_f16_f32 v82, v148, v149
    v_cvt_pk_f16_f32 v83, v150, v151
    v_cvt_pk_f16_f32 v84, v152, v153
    v_cvt_pk_f16_f32 v85, v154, v155
    v_cvt_pk_f16_f32 v86, v156, v157
    v_cvt_pk_f16_f32 v87, v158, v159
    buffer_store_dwordx4 v[80:83], v2, s[20:23], s28 offen offset:2048 sc1
    buffer_store_dwordx4 v[84:87], v2, s[20:23], s28 offen offset:3072 sc1
    v_cvt_pk_f16_f32 v96, v176, v177
    v_cvt_pk_f16_f32 v97, v178, v179
    v_cvt_pk_f16_f32 v98, v180, v181
    v_cvt_pk_f16_f32 v99, v182, v183
    v_cvt_pk_f16_f32 v100, v184, v185
    v_cvt_pk_f16_f32 v101, v186, v187
    v_cvt_pk_f16_f32 v102, v188, v189
    v_cvt_pk_f16_f32 v103, v190, v191
    buffer_store_dwordx4 v[96:99], v2, s[20:23], s29 offen offset:2048 sc1
    buffer_store_dwordx4 v[100:103], v2, s[20:23], s29 offen offset:3072 sc1
fft_done:
    s_waitcnt vmcnt(0)
    s_barrier
    s_cmp_lg_u32 s24, 0
    s_cbranch_scc1 arr_52
    v_cmp_gt_u32 vcc, 16, v1
    s_and_saveexec_b64 s[100:101], vcc
    v_lshlrev_b32 v2, 7, v1
    v_mov_b32 v3, 1
    buffer_atomic_add v3, v2, s[96:99], 0 offen offset:8 sc1
    s_mov_b64 exec, s[100:101]
arr_52:
    s_endpgm
k_done:
    s_endpgm
k_end:
.section .rodata,"a"
.p2align 6
.amdhsa_kernel recurrent_scan__spectral_gfnet__glu_gated_swiglu__prompt_kernel
  .amdhsa_next_free_vgpr 512
  .amdhsa_next_free_sgpr 102
  .amdhsa_accum_offset 256
  .amdhsa_group_segment_fixed_size 0
  .amdhsa_kernarg_size 80
  .amdhsa_user_sgpr_count 2
  .amdhsa_user_sgpr_kernarg_segment_ptr 1
  .amdhsa_system_sgpr_workgroup_id_x 1
  .amdhsa_float_denorm_mode_32 3
  .amdhsa_float_denorm_mode_16_64 3
.end_amdhsa_kernel
.section .rodata,"a"
.set qa0, 11264
.set qa1, 11264
.set qa2, 11264
.set qa3, 11264
.set qa4, 11264
.set qa5, 11263
.set qa6, 11263
.set qa7, 11263
.set qa8, 11262
.set qa9, 11262
.set qa10, 11262
.set qa11, 11261
.set qa12, 11260
.set qa13, 11260
.set qa14, 11259
.set qa15, 11258
.set qa16, 11258
.set qa17, 11257
.set qa18, 11256
.set qa19, 11255
.set qa20, 11254
.set qa21, 11253
.set qa22, 11252
.set qa23, 11251
.set qa24, 11250
.set qa25, 11249
.set qa26, 11247
.set qa27, 11246
.set qa28, 11245
.set qa29, 11243
.set qa30, 11242
.set qa31, 11240
.set qa32, 11239
.set qa33, 11237
.set qa34, 11236
.set qa35, 11234
.set qa36, 11232
.set qa37, 11230
.set qa38, 11228
.set qa39, 11227
.set qa40, 11225
.set qa41, 11223
.set qa42, 11221
.set qa43, 11219
.set qa44, 11216
.set qa45, 11214
.set qa46, 11212
.set qa47, 11210
.set qa48, 11207
.set qa49, 11205
.set qa50, 11203
.set qa51, 11200
.set qa52, 11198
.set qa53, 11195
.set qa54, 11192
.set qa55, 11190
.set qa56, 11187
.set qa57, 11184
.set qa58, 11182
.set qa59, 11179
.set qa60, 11176
.set qa61, 11173
.set qa62, 11170
.set qa63, 11167
.set qa64, 11164
.set qa65, 11161
.set qa66, 11157
.set qa67, 11154
.set qa68, 11151
.set qa69, 11148
.set qa70, 11144
.set qa71, 11141
.set qa72, 11137
.set qa73, 11134
.set qa74, 11130
.set qa75, 11127
.set qa76, 11123
.set qa77, 11119
.set qa78, 11116
.set qa79, 11112
.set qa80, 11108
.set qa81, 11104
.set qa82, 11100
.set qa83, 11096
.set qa84, 11092
.set qa85, 11088
.set qa86, 11084
.set qa87, 11080
.set qa88, 11076
.set qa89, 11072
.set qa90, 11067
.set qa91, 11063
.set qa92, 11059
.set qa93, 11054
.set qa94, 11050
.set qa95, 11045
.set qa96, 11041
.set qa97, 11036
.set qa98, 11032
.set qa99, 11027
.set qa100, 11022
.set qa101, 11017
.set qa102, 11013
.set qa103, 11008
.set qa104, 11003
.set qa105, 10998
.set qa106, 10993
.set qa107, 10988
.set qa108, 10983
.set qa109, 10978
.set qa110, 10973
.set qa111, 10967
.set qa112, 10962
.set qa113, 10957
.set qa114, 10952
.set qa115, 10946
.set qa116, 10941
.set qa117, 10935
.set qa118, 10930
.set qa119, 10924
.set qa120, 10919
.set qa121, 10913
.set qa122, 10908
.set qa123, 10902
.set qa124, 10896
.set qa125, 10890
.set qa126, 10885
.set qa127, 10879
.set qa128, 10873
.set qa129, 10867
.set qa130, 10861
.set qa131, 10855
.set qa132, 10849
.set qa133, 10843
.set qa134, 10837
.set qa135, 10831
.set qa136, 10824
.set qa137, 10818
.set qa138, 10812
.set qa139, 10805
.set qa140, 10799
.set qa141, 10793
.set qa142, 10786
.set qa143, 10780
.set qa144, 10773
.set qa145, 10767
.set qa146, 10760
.set qa147, 10754
.set qa148, 10747
.set qa149, 10740
.set qa150, 10733
.set qa151, 10727
.set qa152, 10720
.set qa153, 10713
.set qa154, 10706
.set qa155, 10699
.set qa156, 10692
.set qa157, 10685
.set qa158, 10678
.set qa159, 10671
.set qa160, 10664
.set qa161, 10657
.set qa162, 10650
.set qa163, 10643
.set qa164, 10635
.set qa165, 10628
.set qa166, 10621
.set qa167, 10614
.set qa168, 10606
.set qa169, 10599
.set qa170, 10591
.set qa171, 10584
.set qa172, 10576
.set qa173, 10569
.set qa174, 10561
.set qa175, 10554
.set qa176, 10546
.set qa177, 10538
.set qa178, 10531
.set qa179, 10523
.set qa180, 10515
.set qa181, 10507
.set qa182, 10500
.set qa183, 10492
.set qa184, 10484
.set qa185, 10476
.set qa186, 10468
.set qa187, 10460
.set qa188, 10452
.set qa189, 10444
.set qa190, 10436
.set qa191, 10428
.set qa192, 10420
.set qa193, 10412
.set qa194, 10403
.set qa195, 10395
.set qa196, 10387
.set qa197, 10379
.set qa198, 10370
.set qa199, 10362
.set qa200, 10354
.set qa201, 10345
.set qa202, 10337
.set qa203, 10329
.set qa204, 10320
.set qa205, 10312
.set qa206, 10303
.set qa207, 10295
.set qa208, 10286
.set qa209, 10277
.set qa210, 10269
.set qa211, 10260
.set qa212, 10252
.set qa213, 10243
.set qa214, 10228
.set qa215, 10211
.set qa216, 10193
.set qa217, 10176
.set qa218, 10158
.set qa219, 10141
.set qa220, 10123
.set qa221, 10105
.set qa222, 10087
.set qa223, 10069
.set qa224, 10052
.set qa225, 10034
.set qa226, 10016
.set qa227, 9998
.set qa228, 9980
.set qa229, 9961
.set qa230, 9943
.set qa231, 9925
.set qa232, 9907
.set qa233, 9889
.set qa234, 9870
.set qa235, 9852
.set qa236, 9833
.set qa237, 9815
.set qa238, 9797
.set qa239, 9778
.set qa240, 9759
.set qa241, 9741
.set qa242, 9722
.set qa243, 9704
.set qa244, 9685
.set qa245, 9666
.set qa246, 9647
.set qa247, 9629
.set qa248, 9610
.set qa249, 9591
.set qa250, 9572
.set qa251, 9553
.set qa252, 9534
.set qa253, 9515
.set qa254, 9496
.set qa255, 9477
.set qa256, 9458
.set qa257, 9439
.set qa258, 9419
.set qa259, 9400
.set qa260, 9381
.set qa261, 9362
.set qa262, 9342
.set qa263, 9323
.set qa264, 9304
.set qa265, 9284
.set qa266, 9265
.set qa267, 9246
.set qa268, 9226
.set qa269, 9197
.set qa270, 9158
.set qa271, 9119
.set qa272, 9080
.set qa273, 9041
.set qa274, 9002
.set qa275, 8963
.set qa276, 8924
.set qa277, 8884
.set qa278, 8845
.set qa279, 8806
.set qa280, 8766
.set qa281, 8727
.set qa282, 8687
.set qa283, 8648
.set qa284, 8608
.set qa285, 8569
.set qa286, 8529
.set qa287, 8489
.set qa288, 8450
.set qa289, 8410
.set qa290, 8370
.set qa291, 8330
.set qa292, 8290
.set qa293, 8251
.set qa294, 8211
.set qa295, 8150
.set qa296, 8070
.set qa297, 7990
.set qa298, 7910
.set qa299, 7830
.set qa300, 7750
.set qa301, 7670
.set qa302, 7590
.set qa303, 7510
.set qa304, 7429
.set qa305, 7349
.set qa306, 7269
.set qa307, 7189
.set qa308, 7049
.set qa309, 6888
.set qa310, 6728
.set qa311, 6567
.set qa312, 6406
.set qa313, 6246
.set qa314, 6026
.set qa315, 5704
.set qa316, 5383
.set qa317, 5002
.set qa318, 4359
.set qa319, 3335
.set qa320, 0
.set qa321, 36103
.set qa322, 37127
.set qa323, 37770
.set qa324, 38151
.set qa325, 38472
.set qa326, 38794
.set qa327, 39014
.set qa328, 39174
.set qa329, 39335
.set qa330, 39496
.set qa331, 39656
.set qa332, 39817
.set qa333, 39957
.set qa334, 40037
.set qa335, 40117
.set qa336, 40197
.set qa337, 40278
.set qa338, 40358
.set qa339, 40438
.set qa340, 40518
.set qa341, 40598
.set qa342, 40678
.set qa343, 40758
.set qa344, 40838
.set qa345, 40918
.set qa346, 40979
.set qa347, 41019
.set qa348, 41058
.set qa349, 41098
.set qa350, 41138
.set qa351, 41178
.set qa352, 41218
.set qa353, 41257
.set qa354, 41297
.set qa355, 41337
.set qa356, 41376
.set qa357, 41416
.set qa358, 41455
.set qa359, 41495
.set qa360, 41534
.set qa361, 41574
.set qa362, 41613
.set qa363, 41652
.set qa364, 41692
.set qa365, 41731
.set qa366, 41770
.set qa367, 41809
.set qa368, 41848
.set qa369, 41887
.set qa370, 41926
.set qa371, 41965
.set qa372, 41994
.set qa373, 42014
.set qa374, 42033
.set qa375, 42052
.set qa376, 42072
.set qa377, 42091
.set qa378, 42110
.set qa379, 42130
.set qa380, 42149
.set qa381, 42168
.set qa382, 42187
.set qa383, 42207
.set qa384, 42226
.set qa385, 42245
.set qa386, 42264
.set qa387, 42283
.set qa388, 42302
.set qa389, 42321
.set qa390, 42340
.set qa391, 42359
.set qa392, 42378
.set qa393, 42397
.set qa394, 42415
.set qa395, 42434
.set qa396, 42453
.set qa397, 42472
.set qa398, 42490
.set qa399, 42509
.set qa400, 42527
.set qa401, 42546
.set qa402, 42565
.set qa403, 42583
.set qa404, 42601
.set qa405, 42620
.set qa406, 42638
.set qa407, 42657
.set qa408, 42675
.set qa409, 42693
.set qa410, 42711
.set qa411, 42729
.set qa412, 42748
.set qa413, 42766
.set qa414, 42784
.set qa415, 42802
.set qa416, 42820
.set qa417, 42837
.set qa418, 42855
.set qa419, 42873
.set qa420, 42891
.set qa421, 42909
.set qa422, 42926
.set qa423, 42944
.set qa424, 42961
.set qa425, 42979
.set qa426, 42996
.set qa427, 43011
.set qa428, 43020
.set qa429, 43028
.set qa430, 43037
.set qa431, 43045
.set qa432, 43054
.set qa433, 43063
.set qa434, 43071
.set qa435, 43080
.set qa436, 43088
.set qa437, 43097
.set qa438, 43105
.set qa439, 43113
.set qa440, 43122
.set qa441, 43130
.set qa442, 43138
.set qa443, 43147
.set qa444, 43155
.set qa445, 43163
.set qa446, 43171
.set qa447, 43180
.set qa448, 43188
.set qa449, 43196
.set qa450, 43204
.set qa451, 43212
.set qa452, 43220
.set qa453, 43228
.set qa454, 43236
.set qa455, 43244
.set qa456, 43252
.set qa457, 43260
.set qa458, 43268
.set qa459, 43275
.set qa460, 43283
.set qa461, 43291
.set qa462, 43299
.set qa463, 43306
.set qa464, 43314
.set qa465, 43322
.set qa466, 43329
.set qa467, 43337
.set qa468, 43344
.set qa469, 43352
.set qa470, 43359
.set qa471, 43367
.set qa472, 43374
.set qa473, 43382
.set qa474, 43389
.set qa475, 43396
.set qa476, 43403
.set qa477, 43411
.set qa478, 43418
.set qa479, 43425
.set qa480, 43432
.set qa481, 43439
.set qa482, 43446
.set qa483, 43453
.set qa484, 43460
.set qa485, 43467
.set qa486, 43474
.set qa487, 43481
.set qa488, 43488
.set qa489, 43495
.set qa490, 43501
.set qa491, 43508
.set qa492, 43515
.set qa493, 43522
.set qa494, 43528
.set qa495, 43535
.set qa496, 43541
.set qa497, 43548
.set qa498, 43554
.set qa499, 43561
.set qa500, 43567
.set qa501, 43573
.set qa502, 43580
.set qa503, 43586
.set qa504, 43592
.set qa505, 43599
.set qa506, 43605
.set qa507, 43611
.set qa508, 43617
.set qa509, 43623
.set qa510, 43629
.set qa511, 43635
.set qa512, 43641
.set qa513, 43647
.set qa514, 43653
.set qa515, 43658
.set qa516, 43664
.set qa517, 43670
.set qa518, 43676
.set qa519, 43681
.set qa520, 43687
.set qa521, 43692
.set qa522, 43698
.set qa523, 43703
.set qa524, 43709
.set qa525, 43714
.set qa526, 43720
.set qa527, 43725
.set qa528, 43730
.set qa529, 43735
.set qa530, 43741
.set qa531, 43746
.set qa532, 43751
.set qa533, 43756
.set qa534, 43761
.set qa535, 43766
.set qa536, 43771
.set qa537, 43776
.set qa538, 43781
.set qa539, 43785
.set qa540, 43790
.set qa541, 43795
.set qa542, 43800
.set qa543, 43804
.set qa544, 43809
.set qa545, 43813
.set qa546, 43818
.set qa547, 43822
.set qa548, 43827
.set qa549, 43831
.set qa550, 43835
.set qa551, 43840
.set qa552, 43844
.set qa553, 43848
.set qa554, 43852
.set qa555, 43856
.set qa556, 43860
.set qa557, 43864
.set qa558, 43868
.set qa559, 43872
.set qa560, 43876
.set qa561, 43880
.set qa562, 43884
.set qa563, 43887
.set qa564, 43891
.set qa565, 43895
.set qa566, 43898
.set qa567, 43902
.set qa568, 43905
.set qa569, 43909
.set qa570, 43912
.set qa571, 43916
.set qa572, 43919
.set qa573, 43922
.set qa574, 43925
.set qa575, 43929
.set qa576, 43932
.set qa577, 43935
.set qa578, 43938
.set qa579, 43941
.set qa580, 43944
.set qa581, 43947
.set qa582, 43950
.set qa583, 43952
.set qa584, 43955
.set qa585, 43958
.set qa586, 43960
.set qa587, 43963
.set qa588, 43966
.set qa589, 43968
.set qa590, 43971
.set qa591, 43973
.set qa592, 43975
.set qa593, 43978
.set qa594, 43980
.set qa595, 43982
.set qa596, 43984
.set qa597, 43987
.set qa598, 43989
.set qa599, 43991
.set qa600, 43993
.set qa601, 43995
.set qa602, 43996
.set qa603, 43998
.set qa604, 44000
.set qa605, 44002
.set qa606, 44004
.set qa607, 44005
.set qa608, 44007
.set qa609, 44008
.set qa610, 44010
.set qa611, 44011
.set qa612, 44013
.set qa613, 44014
.set qa614, 44015
.set qa615, 44017
.set qa616, 44018
.set qa617, 44019
.set qa618, 44020
.set qa619, 44021
.set qa620, 44022
.set qa621, 44023
.set qa622, 44024
.set qa623, 44025
.set qa624, 44026
.set qa625, 44026
.set qa626, 44027
.set qa627, 44028
.set qa628, 44028
.set qa629, 44029
.set qa630, 44030
.set qa631, 44030
.set qa632, 44030
.set qa633, 44031
.set qa634, 44031
.set qa635, 44031
.set qa636, 44032
.set qa637, 44032
.set qa638, 44032
.set qa639, 44032
.set qa640, 44032
.set qa641, 44032
.set qa642, 44032
.set qa643, 44032
.set qa644, 44032
.set qa645, 44031
.set qa646, 44031
.set qa647, 44031
.set qa648, 44030
.set qa649, 44030
.set qa650, 44030
.set qa651, 44029
.set qa652, 44028
.set qa653, 44028
.set qa654, 44027
.set qa655, 44026
.set qa656, 44026
.set qa657, 44025
.set qa658, 44024
.set qa659, 44023
.set qa660, 44022
.set qa661, 44021
.set qa662, 44020
.set qa663, 44019
.set qa664, 44018
.set qa665, 44017
.set qa666, 44015
.set qa667, 44014
.set qa668, 44013
.set qa669, 44011
.set qa670, 44010
.set qa671, 44008
.set qa672, 44007
.set qa673, 44005
.set qa674, 44004
.set qa675, 44002
.set qa676, 44000
.set qa677, 43998
.set qa678, 43996
.set qa679, 43995
.set qa680, 43993
.set qa681, 43991
.set qa682, 43989
.set qa683, 43987
.set qa684, 43984
.set qa685, 43982
.set qa686, 43980
.set qa687, 43978
.set qa688, 43975
.set qa689, 43973
.set qa690, 43971
.set qa691, 43968
.set qa692, 43966
.set qa693, 43963
.set qa694, 43960
.set qa695, 43958
.set qa696, 43955
.set qa697, 43952
.set qa698, 43950
.set qa699, 43947
.set qa700, 43944
.set qa701, 43941
.set qa702, 43938
.set qa703, 43935
.set qa704, 43932
.set qa705, 43929
.set qa706, 43925
.set qa707, 43922
.set qa708, 43919
.set qa709, 43916
.set qa710, 43912
.set qa711, 43909
.set qa712, 43905
.set qa713, 43902
.set qa714, 43898
.set qa715, 43895
.set qa716, 43891
.set qa717, 43887
.set qa718, 43884
.set qa719, 43880
.set qa720, 43876
.set qa721, 43872
.set qa722, 43868
.set qa723, 43864
.set qa724, 43860
.set qa725, 43856
.set qa726, 43852
.set qa727, 43848
.set qa728, 43844
.set qa729, 43840
.set qa730, 43835
.set qa731, 43831
.set qa732, 43827
.set qa733, 43822
.set qa734, 43818
.set qa735, 43813
.set qa736, 43809
.set qa737, 43804
.set qa738, 43800
.set qa739, 43795
.set qa740, 43790
.set qa741, 43785
.set qa742, 43781
.set qa743, 43776
.set qa744, 43771
.set qa745, 43766
.set qa746, 43761
.set qa747, 43756
.set qa748, 43751
.set qa749, 43746
.set qa750, 43741
.set qa751, 43735
.set qa752, 43730
.set qa753, 43725
.set qa754, 43720
.set qa755, 43714
.set qa756, 43709
.set qa757, 43703
.set qa758, 43698
.set qa759, 43692
.set qa760, 43687
.set qa761, 43681
.set qa762, 43676
.set qa763, 43670
.set qa764, 43664
.set qa765, 43658
.set qa766, 43653
.set qa767, 43647
.set qa768, 43641
.set qa769, 43635
.set qa770, 43629
.set qa771, 43623
.set qa772, 43617
.set qa773, 43611
.set qa774, 43605
.set qa775, 43599
.set qa776, 43592
.set qa777, 43586
.set qa778, 43580
.set qa779, 43573
.set qa780, 43567
.set qa781, 43561
.set qa782, 43554
.set qa783, 43548
.set qa784, 43541
.set qa785, 43535
.set qa786, 43528
.set qa787, 43522
.set qa788, 43515
.set qa789, 43508
.set qa790, 43501
.set qa791, 43495
.set qa792, 43488
.set qa793, 43481
.set qa794, 43474
.set qa795, 43467
.set qa796, 43460
.set qa797, 43453
.set qa798, 43446
.set qa799, 43439
.set qa800, 43432
.set qa801, 43425
.set qa802, 43418
.set qa803, 43411
.set qa804, 43403
.set qa805, 43396
.set qa806, 43389
.set qa807, 43382
.set qa808, 43374
.set qa809, 43367
.set qa810, 43359
.set qa811, 43352
.set qa812, 43344
.set qa813, 43337
.set qa814, 43329
.set qa815, 43322
.set qa816, 43314
.set qa817, 43306
.set qa818, 43299
.set qa819, 43291
.set qa820, 43283
.set qa821, 43275
.set qa822, 43268
.set qa823, 43260
.set qa824, 43252
.set qa825, 43244
.set qa826, 43236
.set qa827, 43228
.set qa828, 43220
.set qa829, 43212
.set qa830, 43204
.set qa831, 43196
.set qa832, 43188
.set qa833, 43180
.set qa834, 43171
.set qa835, 43163
.set qa836, 43155
.set qa837, 43147
.set qa838, 43138
.set qa839, 43130
.set qa840, 43122
.set qa841, 43113
.set qa842, 43105
.set qa843, 43097
.set qa844, 43088
.set qa845, 43080
.set qa846, 43071
.set qa847, 43063
.set qa848, 43054
.set qa849, 43045
.set qa850, 43037
.set qa851, 43028
.set qa852, 43020
.set qa853, 43011
.set qa854, 42996
.set qa855, 42979
.set qa856, 42961
.set qa857, 42944
.set qa858, 42926
.set qa859, 42909
.set qa860, 42891
.set qa861, 42873
.set qa862, 42855
.set qa863, 42837
.set qa864, 42820
.set qa865, 42802
.set qa866, 42784
.set qa867, 42766
.set qa868, 42748
.set qa869, 42729
.set qa870, 42711
.set qa871, 42693
.set qa872, 42675
.set qa873, 42657
.set qa874, 42638
.set qa875, 42620
.set qa876, 42601
.set qa877, 42583
.set qa878, 42565
.set qa879, 42546
.set qa880, 42527
.set qa881, 42509
.set qa882, 42490
.set qa883, 42472
.set qa884, 42453
.set qa885, 42434
.set qa886, 42415
.set qa887, 42397
.set qa888, 42378
.set qa889, 42359
.set qa890, 42340
.set qa891, 42321
.set qa892, 42302
.set qa893, 42283
.set qa894, 42264
.set qa895, 42245
.set qa896, 42226
.set qa897, 42207
.set qa898, 42187
.set qa899, 42168
.set qa900, 42149
.set qa901, 42130
.set qa902, 42110
.set qa903, 42091
.set qa904, 42072
.set qa905, 42052
.set qa906, 42033
.set qa907, 42014
.set qa908, 41994
.set qa909, 41965
.set qa910, 41926
.set qa911, 41887
.set qa912, 41848
.set qa913, 41809
.set qa914, 41770
.set qa915, 41731
.set qa916, 41692
.set qa917, 41652
.set qa918, 41613
.set qa919, 41574
.set qa920, 41534
.set qa921, 41495
.set qa922, 41455
.set qa923, 41416
.set qa924, 41376
.set qa925, 41337
.set qa926, 41297
.set qa927, 41257
.set qa928, 41218
.set qa929, 41178
.set qa930, 41138
.set qa931, 41098
.set qa932, 41058
.set qa933, 41019
.set qa934, 40979
.set qa935, 40918
.set qa936, 40838
.set qa937, 40758
.set qa938, 40678
.set qa939, 40598
.set qa940, 40518
.set qa941, 40438
.set qa942, 40358
.set qa943, 40278
.set qa944, 40197
.set qa945, 40117
.set qa946, 40037
.set qa947, 39957
.set qa948, 39817
.set qa949, 39656
.set qa950, 39496
.set qa951, 39335
.set qa952, 39174
.set qa953, 39014
.set qa954, 38794
.set qa955, 38472
.set qa956, 38151
.set qa957, 37770
.set qa958, 37127
.set qa959, 36103
.set qa960, 32768
.set qa961, 3335
.set qa962, 4359
.set qa963, 5002
.set qa964, 5383
.set qa965, 5704
.set qa966, 6026
.set qa967, 6246
.set qa968, 6406
.set qa969, 6567
.set qa970, 6728
.set qa971, 6888
.set qa972, 7049
.set qa973, 7189
.set qa974, 7269
.set qa975, 7349
.set qa976, 7429
.set qa977, 7510
.set qa978, 7590
.set qa979, 7670
.set qa980, 7750
.set qa981, 7830
.set qa982, 7910
.set qa983, 7990
.set qa984, 8070
.set qa985, 8150
.set qa986, 8211
.set qa987, 8251
.set qa988, 8290
.set qa989, 8330
.set qa990, 8370
.set qa991, 8410
.set qa992, 8450
.set qa993, 8489
.set qa994, 8529
.set qa995, 8569
.set qa996, 8608
.set qa997, 8648
.set qa998, 8687
.set qa999, 8727
.set qa1000, 8766
.set qa1001, 8806
.set qa1002, 8845
.set qa1003, 8884
.set qa1004, 8924
.set qa1005, 8963
.set qa1006, 9002
.set qa1007, 9041
.set qa1008, 9080
.set qa1009, 9119
.set qa1010, 9158
.set qa1011, 9197
.set qa1012, 9226
.set qa1013, 9246
.set qa1014, 9265
.set qa1015, 9284
.set qa1016, 9304
.set qa1017, 9323
.set qa1018, 9342
.set qa1019, 9362
.set qa1020, 9381
.set qa1021, 9400
.set qa1022, 9419
.set qa1023, 9439
.set qa1024, 9458
.set qa1025, 9477
.set qa1026, 9496
.set qa1027, 9515
.set qa1028, 9534
.set qa1029, 9553
.set qa1030, 9572
.set qa1031, 9591
.set qa1032, 9610
.set qa1033, 9629
.set qa1034, 9647
.set qa1035, 9666
.set qa1036, 9685
.set qa1037, 9704
.set qa1038, 9722
.set qa1039, 9741
.set qa1040, 9759
.set qa1041, 9778
.set qa1042, 9797
.set qa1043, 9815
.set qa1044, 9833
.set qa1045, 9852
.set qa1046, 9870
.set qa1047, 9889
.set qa1048, 9907
.set qa1049, 9925
.set qa1050, 9943
.set qa1051, 9961
.set qa1052, 9980
.set qa1053, 9998
.set qa1054, 10016
.set qa1055, 10034
.set qa1056, 10052
.set qa1057, 10069
.set qa1058, 10087
.set qa1059, 10105
.set qa1060, 10123
.set qa1061, 10141
.set qa1062, 10158
.set qa1063, 10176
.set qa1064, 10193
.set qa1065, 10211
.set qa1066, 10228
.set qa1067, 10243
.set qa1068, 10252
.set qa1069, 10260
.set qa1070, 10269
.set qa1071, 10277
.set qa1072, 10286
.set qa1073, 10295
.set qa1074, 10303
.set qa1075, 10312
.set qa1076, 10320
.set qa1077, 10329
.set qa1078, 10337
.set qa1079, 10345
.set qa1080, 10354
.set qa1081, 10362
.set qa1082, 10370
.set qa1083, 10379
.set qa1084, 10387
.set qa1085, 10395
.set qa1086, 10403
.set qa1087, 10412
.set qa1088, 10420
.set qa1089, 10428
.set qa1090, 10436
.set qa1091, 10444
.set qa1092, 10452
.set qa1093, 10460
.set qa1094, 10468
.set qa1095, 10476
.set qa1096, 10484
.set qa1097, 10492
.set qa1098, 10500
.set qa1099, 10507
.set qa1100, 10515
.set qa1101, 10523
.set qa1102, 10531
.set qa1103, 10538
.set qa1104, 10546
.set qa1105, 10554
.set qa1106, 10561
.set qa1107, 10569
.set qa1108, 10576
.set qa1109, 10584
.set qa1110, 10591
.set qa1111, 10599
.set qa1112, 10606
.set qa1113, 10614
.set qa1114, 10621
.set qa1115, 10628
.set qa1116, 10635
.set qa1117, 10643
.set qa1118, 10650
.set qa1119, 10657
.set qa1120, 10664
.set qa1121, 10671
.set qa1122, 10678
.set qa1123, 10685
.set qa1124, 10692
.set qa1125, 10699
.set qa1126, 10706
.set qa1127, 10713
.set qa1128, 10720
.set qa1129, 10727
.set qa1130, 10733
.set qa1131, 10740
.set qa1132, 10747
.set qa1133, 10754
.set qa1134, 10760
.set qa1135, 10767
.set qa1136, 10773
.set qa1137, 10780
.set qa1138, 10786
.set qa1139, 10793
.set qa1140, 10799
.set qa1141, 10805
.set qa1142, 10812
.set qa1143, 10818
.set qa1144, 10824
.set qa1145, 10831
.set qa1146, 10837
.set qa1147, 10843
.set qa1148, 10849
.set qa1149, 10855
.set qa1150, 10861
.set qa1151, 10867
.set qa1152, 10873
.set qa1153, 10879
.set qa1154, 10885
.set qa1155, 10890
.set qa1156, 10896
.set qa1157, 10902
.set qa1158, 10908
.set qa1159, 10913
.set qa1160, 10919
.set qa1161, 10924
.set qa1162, 10930
.set qa1163, 10935
.set qa1164, 10941
.set qa1165, 10946
.set qa1166, 10952
.set qa1167, 10957
.set qa1168, 10962
.set qa1169, 10967
.set qa1170, 10973
.set qa1171, 10978
.set qa1172, 10983
.set qa1173, 10988
.set qa1174, 10993
.set qa1175, 10998
.set qa1176, 11003
.set qa1177, 11008
.set qa1178, 11013
.set qa1179, 11017
.set qa1180, 11022
.set qa1181, 11027
.set qa1182, 11032
.set qa1183, 11036
.set qa1184, 11041
.set qa1185, 11045
.set qa1186, 11050
.set qa1187, 11054
.set qa1188, 11059
.set qa1189, 11063
.set qa1190, 11067
.set qa1191, 11072
.set qa1192, 11076
.set qa1193, 11080
.set qa1194, 11084
.set qa1195, 11088
.set qa1196, 11092
.set qa1197, 11096
.set qa1198, 11100
.set qa1199, 11104
.set qa1200, 11108
.set qa1201, 11112
.set qa1202, 11116
.set qa1203, 11119
.set qa1204, 11123
.set qa1205, 11127
.set qa1206, 11130
.set qa1207, 11134
.set qa1208, 11137
.set qa1209, 11141
.set qa1210, 11144
.set qa1211, 11148
.set qa1212, 11151
.set qa1213, 11154
.set qa1214, 11157
.set qa1215, 11161
.set qa1216, 11164
.set qa1217, 11167
.set qa1218, 11170
.set qa1219, 11173
.set qa1220, 11176
.set qa1221, 11179
.set qa1222, 11182
.set qa1223, 11184
.set qa1224, 11187
.set qa1225, 11190
.set qa1226, 11192
.set qa1227, 11195
.set qa1228, 11198
.set qa1229, 11200
.set qa1230, 11203
.set qa1231, 11205
.set qa1232, 11207
.set qa1233, 11210
.set qa1234, 11212
.set qa1235, 11214
.set qa1236, 11216
.set qa1237, 11219
.set qa1238, 11221
.set qa1239, 11223
.set qa1240, 11225
.set qa1241, 11227
.set qa1242, 11228
.set qa1243, 11230
.set qa1244, 11232
.set qa1245, 11234
.set qa1246, 11236
.set qa1247, 11237
.set qa1248, 11239
.set qa1249, 11240
.set qa1250, 11242
.set qa1251, 11243
.set qa1252, 11245
.set qa1253, 11246
.set qa1254, 11247
.set qa1255, 11249
.set qa1256, 11250
.set qa1257, 11251
.set qa1258, 11252
.set qa1259, 11253
.set qa1260, 11254
.set qa1261, 11255
.set qa1262, 11256
.set qa1263, 11257
.set qa1264, 11258
.set qa1265, 11258
.set qa1266, 11259
.set qa1267, 11260
.set qa1268, 11260
.set qa1269, 11261
.set qa1270, 11262
.set qa1271, 11262
.set qa1272, 11262
.set qa1273, 11263
.set qa1274, 11263
.set qa1275, 11263
.set qa1276, 11264
.set qa1277, 11264
.set qa1278, 11264
.set qa1279, 11264
.set qb0, 15360
.set qb1, 15360
.set qb2, 15360
.set qb3, 15360
.set qb4, 15360
.set qb5, 15359
.set qb6, 15359
.set qb7, 15359
.set qb8, 15358
.set qb9, 15358
.set qb10, 15358
.set qb11, 15357
.set qb12, 15356
.set qb13, 15356
.set qb14, 15355
.set qb15, 15354
.set qb16, 15354
.set qb17, 15353
.set qb18, 15352
.set qb19, 15351
.set qb20, 15350
.set qb21, 15349
.set qb22, 15348
.set qb23, 15347
.set qb24, 15346
.set qb25, 15345
.set qb26, 15343
.set qb27, 15342
.set qb28, 15341
.set qb29, 15339
.set qb30, 15338
.set qb31, 15336
.set qb32, 15335
.set qb33, 15333
.set qb34, 15332
.set qb35, 15330
.set qb36, 15328
.set qb37, 15326
.set qb38, 15324
.set qb39, 15323
.set qb40, 15321
.set qb41, 15319
.set qb42, 15317
.set qb43, 15315
.set qb44, 15312
.set qb45, 15310
.set qb46, 15308
.set qb47, 15306
.set qb48, 15303
.set qb49, 15301
.set qb50, 15299
.set qb51, 15296
.set qb52, 15294
.set qb53, 15291
.set qb54, 15288
.set qb55, 15286
.set qb56, 15283
.set qb57, 15280
.set qb58, 15278
.set qb59, 15275
.set qb60, 15272
.set qb61, 15269
.set qb62, 15266
.set qb63, 15263
.set qb64, 15260
.set qb65, 15257
.set qb66, 15253
.set qb67, 15250
.set qb68, 15247
.set qb69, 15244
.set qb70, 15240
.set qb71, 15237
.set qb72, 15233
.set qb73, 15230
.set qb74, 15226
.set qb75, 15223
.set qb76, 15219
.set qb77, 15215
.set qb78, 15212
.set qb79, 15208
.set qb80, 15204
.set qb81, 15200
.set qb82, 15196
.set qb83, 15192
.set qb84, 15188
.set qb85, 15184
.set qb86, 15180
.set qb87, 15176
.set qb88, 15172
.set qb89, 15168
.set qb90, 15163
.set qb91, 15159
.set qb92, 15155
.set qb93, 15150
.set qb94, 15146
.set qb95, 15141
.set qb96, 15137
.set qb97, 15132
.set qb98, 15128
.set qb99, 15123
.set qb100, 15118
.set qb101, 15113
.set qb102, 15109
.set qb103, 15104
.set qb104, 15099
.set qb105, 15094
.set qb106, 15089
.set qb107, 15084
.set qb108, 15079
.set qb109, 15074
.set qb110, 15069
.set qb111, 15063
.set qb112, 15058
.set qb113, 15053
.set qb114, 15048
.set qb115, 15042
.set qb116, 15037
.set qb117, 15031
.set qb118, 15026
.set qb119, 15020
.set qb120, 15015
.set qb121, 15009
.set qb122, 15004
.set qb123, 14998
.set qb124, 14992
.set qb125, 14986
.set qb126, 14981
.set qb127, 14975
.set qb128, 14969
.set qb129, 14963
.set qb130, 14957
.set qb131, 14951
.set qb132, 14945
.set qb133, 14939
.set qb134, 14933
.set qb135, 14927
.set qb136, 14920
.set qb137, 14914
.set qb138, 14908
.set qb139, 14901
.set qb140, 14895
.set qb141, 14889
.set qb142, 14882
.set qb143, 14876
.set qb144, 14869
.set qb145, 14863
.set qb146, 14856
.set qb147, 14850
.set qb148, 14843
.set qb149, 14836
.set qb150, 14829
.set qb151, 14823
.set qb152, 14816
.set qb153, 14809
.set qb154, 14802
.set qb155, 14795
.set qb156, 14788
.set qb157, 14781
.set qb158, 14774
.set qb159, 14767
.set qb160, 14760
.set qb161, 14753
.set qb162, 14746
.set qb163, 14739
.set qb164, 14731
.set qb165, 14724
.set qb166, 14717
.set qb167, 14710
.set qb168, 14702
.set qb169, 14695
.set qb170, 14687
.set qb171, 14680
.set qb172, 14672
.set qb173, 14665
.set qb174, 14657
.set qb175, 14650
.set qb176, 14642
.set qb177, 14634
.set qb178, 14627
.set qb179, 14619
.set qb180, 14611
.set qb181, 14603
.set qb182, 14596
.set qb183, 14588
.set qb184, 14580
.set qb185, 14572
.set qb186, 14564
.set qb187, 14556
.set qb188, 14548
.set qb189, 14540
.set qb190, 14532
.set qb191, 14524
.set qb192, 14516
.set qb193, 14508
.set qb194, 14499
.set qb195, 14491
.set qb196, 14483
.set qb197, 14475
.set qb198, 14466
.set qb199, 14458
.set qb200, 14450
.set qb201, 14441
.set qb202, 14433
.set qb203, 14425
.set qb204, 14416
.set qb205, 14408
.set qb206, 14399
.set qb207, 14391
.set qb208, 14382
.set qb209, 14373
.set qb210, 14365
.set qb211, 14356
.set qb212, 14348
.set qb213, 14339
.set qb214, 14324
.set qb215, 14307
.set qb216, 14289
.set qb217, 14272
.set qb218, 14254
.set qb219, 14237
.set qb220, 14219
.set qb221, 14201
.set qb222, 14183
.set qb223, 14165
.set qb224, 14148
.set qb225, 14130
.set qb226, 14112
.set qb227, 14094
.set qb228, 14076
.set qb229, 14057
.set qb230, 14039
.set qb231, 14021
.set qb232, 14003
.set qb233, 13985
.set qb234, 13966
.set qb235, 13948
.set qb236, 13929
.set qb237, 13911
.set qb238, 13893
.set qb239, 13874
.set qb240, 13855
.set qb241, 13837
.set qb242, 13818
.set qb243, 13800
.set qb244, 13781
.set qb245, 13762
.set qb246, 13743
.set qb247, 13725
.set qb248, 13706
.set qb249, 13687
.set qb250, 13668
.set qb251, 13649
.set qb252, 13630
.set qb253, 13611
.set qb254, 13592
.set qb255, 13573
.set qb256, 13554
.set qb257, 13535
.set qb258, 13515
.set qb259, 13496
.set qb260, 13477
.set qb261, 13458
.set qb262, 13438
.set qb263, 13419
.set qb264, 13400
.set qb265, 13380
.set qb266, 13361
.set qb267, 13342
.set qb268, 13322
.set qb269, 13293
.set qb270, 13254
.set qb271, 13215
.set qb272, 13176
.set qb273, 13137
.set qb274, 13098
.set qb275, 13059
.set qb276, 13020
.set qb277, 12980
.set qb278, 12941
.set qb279, 12902
.set qb280, 12862
.set qb281, 12823
.set qb282, 12783
.set qb283, 12744
.set qb284, 12704
.set qb285, 12665
.set qb286, 12625
.set qb287, 12585
.set qb288, 12546
.set qb289, 12506
.set qb290, 12466
.set qb291, 12426
.set qb292, 12386
.set qb293, 12347
.set qb294, 12307
.set qb295, 12246
.set qb296, 12166
.set qb297, 12086
.set qb298, 12006
.set qb299, 11926
.set qb300, 11846
.set qb301, 11766
.set qb302, 11686
.set qb303, 11606
.set qb304, 11525
.set qb305, 11445
.set qb306, 11365
.set qb307, 11285
.set qb308, 11145
.set qb309, 10984
.set qb310, 10824
.set qb311, 10663
.set qb312, 10502
.set qb313, 10342
.set qb314, 10122
.set qb315, 9800
.set qb316, 9479
.set qb317, 9098
.set qb318, 8455
.set qb319, 7431
.set qb320, 0
.set qb321, 40199
.set qb322, 41223
.set qb323, 41866
.set qb324, 42247
.set qb325, 42568
.set qb326, 42890
.set qb327, 43110
.set qb328, 43270
.set qb329, 43431
.set qb330, 43592
.set qb331, 43752
.set qb332, 43913
.set qb333, 44053
.set qb334, 44133
.set qb335, 44213
.set qb336, 44293
.set qb337, 44374
.set qb338, 44454
.set qb339, 44534
.set qb340, 44614
.set qb341, 44694
.set qb342, 44774
.set qb343, 44854
.set qb344, 44934
.set qb345, 45014
.set qb346, 45075
.set qb347, 45115
.set qb348, 45154
.set qb349, 45194
.set qb350, 45234
.set qb351, 45274
.set qb352, 45314
.set qb353, 45353
.set qb354, 45393
.set qb355, 45433
.set qb356, 45472
.set qb357, 45512
.set qb358, 45551
.set qb359, 45591
.set qb360, 45630
.set qb361, 45670
.set qb362, 45709
.set qb363, 45748
.set qb364, 45788
.set qb365, 45827
.set qb366, 45866
.set qb367, 45905
.set qb368, 45944
.set qb369, 45983
.set qb370, 46022
.set qb371, 46061
.set qb372, 46090
.set qb373, 46110
.set qb374, 46129
.set qb375, 46148
.set qb376, 46168
.set qb377, 46187
.set qb378, 46206
.set qb379, 46226
.set qb380, 46245
.set qb381, 46264
.set qb382, 46283
.set qb383, 46303
.set qb384, 46322
.set qb385, 46341
.set qb386, 46360
.set qb387, 46379
.set qb388, 46398
.set qb389, 46417
.set qb390, 46436
.set qb391, 46455
.set qb392, 46474
.set qb393, 46493
.set qb394, 46511
.set qb395, 46530
.set qb396, 46549
.set qb397, 46568
.set qb398, 46586
.set qb399, 46605
.set qb400, 46623
.set qb401, 46642
.set qb402, 46661
.set qb403, 46679
.set qb404, 46697
.set qb405, 46716
.set qb406, 46734
.set qb407, 46753
.set qb408, 46771
.set qb409, 46789
.set qb410, 46807
.set qb411, 46825
.set qb412, 46844
.set qb413, 46862
.set qb414, 46880
.set qb415, 46898
.set qb416, 46916
.set qb417, 46933
.set qb418, 46951
.set qb419, 46969
.set qb420, 46987
.set qb421, 47005
.set qb422, 47022
.set qb423, 47040
.set qb424, 47057
.set qb425, 47075
.set qb426, 47092
.set qb427, 47107
.set qb428, 47116
.set qb429, 47124
.set qb430, 47133
.set qb431, 47141
.set qb432, 47150
.set qb433, 47159
.set qb434, 47167
.set qb435, 47176
.set qb436, 47184
.set qb437, 47193
.set qb438, 47201
.set qb439, 47209
.set qb440, 47218
.set qb441, 47226
.set qb442, 47234
.set qb443, 47243
.set qb444, 47251
.set qb445, 47259
.set qb446, 47267
.set qb447, 47276
.set qb448, 47284
.set qb449, 47292
.set qb450, 47300
.set qb451, 47308
.set qb452, 47316
.set qb453, 47324
.set qb454, 47332
.set qb455, 47340
.set qb456, 47348
.set qb457, 47356
.set qb458, 47364
.set qb459, 47371
.set qb460, 47379
.set qb461, 47387
.set qb462, 47395
.set qb463, 47402
.set qb464, 47410
.set qb465, 47418
.set qb466, 47425
.set qb467, 47433
.set qb468, 47440
.set qb469, 47448
.set qb470, 47455
.set qb471, 47463
.set qb472, 47470
.set qb473, 47478
.set qb474, 47485
.set qb475, 47492
.set qb476, 47499
.set qb477, 47507
.set qb478, 47514
.set qb479, 47521
.set qb480, 47528
.set qb481, 47535
.set qb482, 47542
.set qb483, 47549
.set qb484, 47556
.set qb485, 47563
.set qb486, 47570
.set qb487, 47577
.set qb488, 47584
.set qb489, 47591
.set qb490, 47597
.set qb491, 47604
.set qb492, 47611
.set qb493, 47618
.set qb494, 47624
.set qb495, 47631
.set qb496, 47637
.set qb497, 47644
.set qb498, 47650
.set qb499, 47657
.set qb500, 47663
.set qb501, 47669
.set qb502, 47676
.set qb503, 47682
.set qb504, 47688
.set qb505, 47695
.set qb506, 47701
.set qb507, 47707
.set qb508, 47713
.set qb509, 47719
.set qb510, 47725
.set qb511, 47731
.set qb512, 47737
.set qb513, 47743
.set qb514, 47749
.set qb515, 47754
.set qb516, 47760
.set qb517, 47766
.set qb518, 47772
.set qb519, 47777
.set qb520, 47783
.set qb521, 47788
.set qb522, 47794
.set qb523, 47799
.set qb524, 47805
.set qb525, 47810
.set qb526, 47816
.set qb527, 47821
.set qb528, 47826
.set qb529, 47831
.set qb530, 47837
.set qb531, 47842
.set qb532, 47847
.set qb533, 47852
.set qb534, 47857
.set qb535, 47862
.set qb536, 47867
.set qb537, 47872
.set qb538, 47877
.set qb539, 47881
.set qb540, 47886
.set qb541, 47891
.set qb542, 47896
.set qb543, 47900
.set qb544, 47905
.set qb545, 47909
.set qb546, 47914
.set qb547, 47918
.set qb548, 47923
.set qb549, 47927
.set qb550, 47931
.set qb551, 47936
.set qb552, 47940
.set qb553, 47944
.set qb554, 47948
.set qb555, 47952
.set qb556, 47956
.set qb557, 47960
.set qb558, 47964
.set qb559, 47968
.set qb560, 47972
.set qb561, 47976
.set qb562, 47980
.set qb563, 47983
.set qb564, 47987
.set qb565, 47991
.set qb566, 47994
.set qb567, 47998
.set qb568, 48001
.set qb569, 48005
.set qb570, 48008
.set qb571, 48012
.set qb572, 48015
.set qb573, 48018
.set qb574, 48021
.set qb575, 48025
.set qb576, 48028
.set qb577, 48031
.set qb578, 48034
.set qb579, 48037
.set qb580, 48040
.set qb581, 48043
.set qb582, 48046
.set qb583, 48048
.set qb584, 48051
.set qb585, 48054
.set qb586, 48056
.set qb587, 48059
.set qb588, 48062
.set qb589, 48064
.set qb590, 48067
.set qb591, 48069
.set qb592, 48071
.set qb593, 48074
.set qb594, 48076
.set qb595, 48078
.set qb596, 48080
.set qb597, 48083
.set qb598, 48085
.set qb599, 48087
.set qb600, 48089
.set qb601, 48091
.set qb602, 48092
.set qb603, 48094
.set qb604, 48096
.set qb605, 48098
.set qb606, 48100
.set qb607, 48101
.set qb608, 48103
.set qb609, 48104
.set qb610, 48106
.set qb611, 48107
.set qb612, 48109
.set qb613, 48110
.set qb614, 48111
.set qb615, 48113
.set qb616, 48114
.set qb617, 48115
.set qb618, 48116
.set qb619, 48117
.set qb620, 48118
.set qb621, 48119
.set qb622, 48120
.set qb623, 48121
.set qb624, 48122
.set qb625, 48122
.set qb626, 48123
.set qb627, 48124
.set qb628, 48124
.set qb629, 48125
.set qb630, 48126
.set qb631, 48126
.set qb632, 48126
.set qb633, 48127
.set qb634, 48127
.set qb635, 48127
.set qb636, 48128
.set qb637, 48128
.set qb638, 48128
.set qb639, 48128
.set qb640, 48128
.set qb641, 48128
.set qb642, 48128
.set qb643, 48128
.set qb644, 48128
.set qb645, 48127
.set qb646, 48127
.set qb647, 48127
.set qb648, 48126
.set qb649, 48126
.set qb650, 48126
.set qb651, 48125
.set qb652, 48124
.set qb653, 48124
.set qb654, 48123
.set qb655, 48122
.set qb656, 48122
.set qb657, 48121
.set qb658, 48120
.set qb659, 48119
.set qb660, 48118
.set qb661, 48117
.set qb662, 48116
.set qb663, 48115
.set qb664, 48114
.set qb665, 48113
.set qb666, 48111
.set qb667, 48110
.set qb668, 48109
.set qb669, 48107
.set qb670, 48106
.set qb671, 48104
.set qb672, 48103
.set qb673, 48101
.set qb674, 48100
.set qb675, 48098
.set qb676, 48096
.set qb677, 48094
.set qb678, 48092
.set qb679, 48091
.set qb680, 48089
.set qb681, 48087
.set qb682, 48085
.set qb683, 48083
.set qb684, 48080
.set qb685, 48078
.set qb686, 48076
.set qb687, 48074
.set qb688, 48071
.set qb689, 48069
.set qb690, 48067
.set qb691, 48064
.set qb692, 48062
.set qb693, 48059
.set qb694, 48056
.set qb695, 48054
.set qb696, 48051
.set qb697, 48048
.set qb698, 48046
.set qb699, 48043
.set qb700, 48040
.set qb701, 48037
.set qb702, 48034
.set qb703, 48031
.set qb704, 48028
.set qb705, 48025
.set qb706, 48021
.set qb707, 48018
.set qb708, 48015
.set qb709, 48012
.set qb710, 48008
.set qb711, 48005
.set qb712, 48001
.set qb713, 47998
.set qb714, 47994
.set qb715, 47991
.set qb716, 47987
.set qb717, 47983
.set qb718, 47980
.set qb719, 47976
.set qb720, 47972
.set qb721, 47968
.set qb722, 47964
.set qb723, 47960
.set qb724, 47956
.set qb725, 47952
.set qb726, 47948
.set qb727, 47944
.set qb728, 47940
.set qb729, 47936
.set qb730, 47931
.set qb731, 47927
.set qb732, 47923
.set qb733, 47918
.set qb734, 47914
.set qb735, 47909
.set qb736, 47905
.set qb737, 47900
.set qb738, 47896
.set qb739, 47891
.set qb740, 47886
.set qb741, 47881
.set qb742, 47877
.set qb743, 47872
.set qb744, 47867
.set qb745, 47862
.set qb746, 47857
.set qb747, 47852
.set qb748, 47847
.set qb749, 47842
.set qb750, 47837
.set qb751, 47831
.set qb752, 47826
.set qb753, 47821
.set qb754, 47816
.set qb755, 47810
.set qb756, 47805
.set qb757, 47799
.set qb758, 47794
.set qb759, 47788
.set qb760, 47783
.set qb761, 47777
.set qb762, 47772
.set qb763, 47766
.set qb764, 47760
.set qb765, 47754
.set qb766, 47749
.set qb767, 47743
.set qb768, 47737
.set qb769, 47731
.set qb770, 47725
.set qb771, 47719
.set qb772, 47713
.set qb773, 47707
.set qb774, 47701
.set qb775, 47695
.set qb776, 47688
.set qb777, 47682
.set qb778, 47676
.set qb779, 47669
.set qb780, 47663
.set qb781, 47657
.set qb782, 47650
.set qb783, 47644
.set qb784, 47637
.set qb785, 47631
.set qb786, 47624
.set qb787, 47618
.set qb788, 47611
.set qb789, 47604
.set qb790, 47597
.set qb791, 47591
.set qb792, 47584
.set qb793, 47577
.set qb794, 47570
.set qb795, 47563
.set qb796, 47556
.set qb797, 47549
.set qb798, 47542
.set qb799, 47535
.set qb800, 47528
.set qb801, 47521
.set qb802, 47514
.set qb803, 47507
.set qb804, 47499
.set qb805, 47492
.set qb806, 47485
.set qb807, 47478
.set qb808, 47470
.set qb809, 47463
.set qb810, 47455
.set qb811, 47448
.set qb812, 47440
.set qb813, 47433
.set qb814, 47425
.set qb815, 47418
.set qb816, 47410
.set qb817, 47402
.set qb818, 47395
.set qb819, 47387
.set qb820, 47379
.set qb821, 47371
.set qb822, 47364
.set qb823, 47356
.set qb824, 47348
.set qb825, 47340
.set qb826, 47332
.set qb827, 47324
.set qb828, 47316
.set qb829, 47308
.set qb830, 47300
.set qb831, 47292
.set qb832, 47284
.set qb833, 47276
.set qb834, 47267
.set qb835, 47259
.set qb836, 47251
.set qb837, 47243
.set qb838, 47234
.set qb839, 47226
.set qb840, 47218
.set qb841, 47209
.set qb842, 47201
.set qb843, 47193
.set qb844, 47184
.set qb845, 47176
.set qb846, 47167
.set qb847, 47159
.set qb848, 47150
.set qb849, 47141
.set qb850, 47133
.set qb851, 47124
.set qb852, 47116
.set qb853, 47107
.set qb854, 47092
.set qb855, 47075
.set qb856, 47057
.set qb857, 47040
.set qb858, 47022
.set qb859, 47005
.set qb860, 46987
.set qb861, 46969
.set qb862, 46951
.set qb863, 46933
.set qb864, 46916
.set qb865, 46898
.set qb866, 46880
.set qb867, 46862
.set qb868, 46844
.set qb869, 46825
.set qb870, 46807
.set qb871, 46789
.set qb872, 46771
.set qb873, 46753
.set qb874, 46734
.set qb875, 46716
.set qb876, 46697
.set qb877, 46679
.set qb878, 46661
.set qb879, 46642
.set qb880, 46623
.set qb881, 46605
.set qb882, 46586
.set qb883, 46568
.set qb884, 46549
.set qb885, 46530
.set qb886, 46511
.set qb887, 46493
.set qb888, 46474
.set qb889, 46455
.set qb890, 46436
.set qb891, 46417
.set qb892, 46398
.set qb893, 46379
.set qb894, 46360
.set qb895, 46341
.set qb896, 46322
.set qb897, 46303
.set qb898, 46283
.set qb899, 46264
.set qb900, 46245
.set qb901, 46226
.set qb902, 46206
.set qb903, 46187
.set qb904, 46168
.set qb905, 46148
.set qb906, 46129
.set qb907, 46110
.set qb908, 46090
.set qb909, 46061
.set qb910, 46022
.set qb911, 45983
.set qb912, 45944
.set qb913, 45905
.set qb914, 45866
.set qb915, 45827
.set qb916, 45788
.set qb917, 45748
.set qb918, 45709
.set qb919, 45670
.set qb920, 45630
.set qb921, 45591
.set qb922, 45551
.set qb923, 45512
.set qb924, 45472
.set qb925, 45433
.set qb926, 45393
.set qb927, 45353
.set qb928, 45314
.set qb929, 45274
.set qb930, 45234
.set qb931, 45194
.set qb932, 45154
.set qb933, 45115
.set qb934, 45075
.set qb935, 45014
.set qb936, 44934
.set qb937, 44854
.set qb938, 44774
.set qb939, 44694
.set qb940, 44614
.set qb941, 44534
.set qb942, 44454
.set qb943, 44374
.set qb944, 44293
.set qb945, 44213
.set qb946, 44133
.set qb947, 44053
.set qb948, 43913
.set qb949, 43752
.set qb950, 43592
.set qb951, 43431
.set qb952, 43270
.set qb953, 43110
.set qb954, 42890
.set qb955, 42568
.set qb956, 42247
.set qb957, 41866
.set qb958, 41223
.set qb959, 40199
.set qb960, 32768
.set qb961, 7431
.set qb962, 8455
.set qb963, 9098
.set qb964, 9479
.set qb965, 9800
.set qb966, 10122
.set qb967, 10342
.set qb968, 10502
.set qb969, 10663
.set qb970, 10824
.set qb971, 10984
.set qb972, 11145
.set qb973, 11285
.set qb974, 11365
.set qb975, 11445
.set qb976, 11525
.set qb977, 11606
.set qb978, 11686
.set qb979, 11766
.set qb980, 11846
.set qb981, 11926
.set qb982, 12006
.set qb983, 12086
.set qb984, 12166
.set qb985, 12246
.set qb986, 12307
.set qb987, 12347
.set qb988, 12386
.set qb989, 12426
.set qb990, 12466
.set qb991, 12506
.set qb992, 12546
.set qb993, 12585
.set qb994, 12625
.set qb995, 12665
.set qb996, 12704
.set qb997, 12744
.set qb998, 12783
.set qb999, 12823
.set qb1000, 12862
.set qb1001, 12902
.set qb1002, 12941
.set qb1003, 12980
.set qb1004, 13020
.set qb1005, 13059
.set qb1006, 13098
.set qb1007, 13137
.set qb1008, 13176
.set qb1009, 13215
.set qb1010, 13254
.set qb1011, 13293
.set qb1012, 13322
.set qb1013, 13342
.set qb1014, 13361
.set qb1015, 13380
.set qb1016, 13400
.set qb1017, 13419
.set qb1018, 13438
.set qb1019, 13458
.set qb1020, 13477
.set qb1021, 13496
.set qb1022, 13515
.set qb1023, 13535
.set qb1024, 13554
.set qb1025, 13573
.set qb1026, 13592
.set qb1027, 13611
.set qb1028, 13630
.set qb1029, 13649
.set qb1030, 13668
.set qb1031, 13687
.set qb1032, 13706
.set qb1033, 13725
.set qb1034, 13743
.set qb1035, 13762
.set qb1036, 13781
.set qb1037, 13800
.set qb1038, 13818
.set qb1039, 13837
.set qb1040, 13855
.set qb1041, 13874
.set qb1042, 13893
.set qb1043, 13911
.set qb1044, 13929
.set qb1045, 13948
.set qb1046, 13966
.set qb1047, 13985
.set qb1048, 14003
.set qb1049, 14021
.set qb1050, 14039
.set qb1051, 14057
.set qb1052, 14076
.set qb1053, 14094
.set qb1054, 14112
.set qb1055, 14130
.set qb1056, 14148
.set qb1057, 14165
.set qb1058, 14183
.set qb1059, 14201
.set qb1060, 14219
.set qb1061, 14237
.set qb1062, 14254
.set qb1063, 14272
.set qb1064, 14289
.set qb1065, 14307
.set qb1066, 14324
.set qb1067, 14339
.set qb1068, 14348
.set qb1069, 14356
.set qb1070, 14365
.set qb1071, 14373
.set qb1072, 14382
.set qb1073, 14391
.set qb1074, 14399
.set qb1075, 14408
.set qb1076, 14416
.set qb1077, 14425
.set qb1078, 14433
.set qb1079, 14441
.set qb1080, 14450
.set qb1081, 14458
.set qb1082, 14466
.set qb1083, 14475
.set qb1084, 14483
.set qb1085, 14491
.set qb1086, 14499
.set qb1087, 14508
.set qb1088, 14516
.set qb1089, 14524
.set qb1090, 14532
.set qb1091, 14540
.set qb1092, 14548
.set qb1093, 14556
.set qb1094, 14564
.set qb1095, 14572
.set qb1096, 14580
.set qb1097, 14588
.set qb1098, 14596
.set qb1099, 14603
.set qb1100, 14611
.set qb1101, 14619
.set qb1102, 14627
.set qb1103, 14634
.set qb1104, 14642
.set qb1105, 14650
.set qb1106, 14657
.set qb1107, 14665
.set qb1108, 14672
.set qb1109, 14680
.set qb1110, 14687
.set qb1111, 14695
.set qb1112, 14702
.set qb1113, 14710
.set qb1114, 14717
.set qb1115, 14724
.set qb1116, 14731
.set qb1117, 14739
.set qb1118, 14746
.set qb1119, 14753
.set qb1120, 14760
.set qb1121, 14767
.set qb1122, 14774
.set qb1123, 14781
.set qb1124, 14788
.set qb1125, 14795
.set qb1126, 14802
.set qb1127, 14809
.set qb1128, 14816
.set qb1129, 14823
.set qb1130, 14829
.set qb1131, 14836
.set qb1132, 14843
.set qb1133, 14850
.set qb1134, 14856
.set qb1135, 14863
.set qb1136, 14869
.set qb1137, 14876
.set qb1138, 14882
.set qb1139, 14889
.set qb1140, 14895
.set qb1141, 14901
.set qb1142, 14908
.set qb1143, 14914
.set qb1144, 14920
.set qb1145, 14927
.set qb1146, 14933
.set qb1147, 14939
.set qb1148, 14945
.set qb1149, 14951
.set qb1150, 14957
.set qb1151, 14963
.set qb1152, 14969
.set qb1153, 14975
.set qb1154, 14981
.set qb1155, 14986
.set qb1156, 14992
.set qb1157, 14998
.set qb1158, 15004
.set qb1159, 15009
.set qb1160, 15015
.set qb1161, 15020
.set qb1162, 15026
.set qb1163, 15031
.set qb1164, 15037
.set qb1165, 15042
.set qb1166, 15048
.set qb1167, 15053
.set qb1168, 15058
.set qb1169, 15063
.set qb1170, 15069
.set qb1171, 15074
.set qb1172, 15079
.set qb1173, 15084
.set qb1174, 15089
.set qb1175, 15094
.set qb1176, 15099
.set qb1177, 15104
.set qb1178, 15109
.set qb1179, 15113
.set qb1180, 15118
.set qb1181, 15123
.set qb1182, 15128
.set qb1183, 15132
.set qb1184, 15137
.set qb1185, 15141
.set qb1186, 15146
.set qb1187, 15150
.set qb1188, 15155
.set qb1189, 15159
.set qb1190, 15163
.set qb1191, 15168
.set qb1192, 15172
.set qb1193, 15176
.set qb1194, 15180
.set qb1195, 15184
.set qb1196, 15188
.set qb1197, 15192
.set qb1198, 15196
.set qb1199, 15200
.set qb1200, 15204
.set qb1201, 15208
.set qb1202, 15212
.set qb1203, 15215
.set qb1204, 15219
.set qb1205, 15223
.set qb1206, 15226
.set qb1207, 15230
.set qb1208, 15233
.set qb1209, 15237
.set qb1210, 15240
.set qb1211, 15244
.set qb1212, 15247
.set qb1213, 15250
.set qb1214, 15253
.set qb1215, 15257
.set qb1216, 15260
.set qb1217, 15263
.set qb1218, 15266
.set qb1219, 15269
.set qb1220, 15272
.set qb1221, 15275
.set qb1222, 15278
.set qb1223, 15280
.set qb1224, 15283
.set qb1225, 15286
.set qb1226, 15288
.set qb1227, 15291
.set qb1228, 15294
.set qb1229, 15296
.set qb1230, 15299
.set qb1231, 15301
.set qb1232, 15303
.set qb1233, 15306
.set qb1234, 15308
.set qb1235, 15310
.set qb1236, 15312
.set qb1237, 15315
.set qb1238, 15317
.set qb1239, 15319
.set qb1240, 15321
.set qb1241, 15323
.set qb1242, 15324
.set qb1243, 15326
.set qb1244, 15328
.set qb1245, 15330
.set qb1246, 15332
.set qb1247, 15333
.set qb1248, 15335
.set qb1249, 15336
.set qb1250, 15338
.set qb1251, 15339
.set qb1252, 15341
.set qb1253, 15342
.set qb1254, 15343
.set qb1255, 15345
.set qb1256, 15346
.set qb1257, 15347
.set qb1258, 15348
.set qb1259, 15349
.set qb1260, 15350
.set qb1261, 15351
.set qb1262, 15352
.set qb1263, 15353
.set qb1264, 15354
.set qb1265, 15354
.set qb1266, 15355
.set qb1267, 15356
.set qb1268, 15356
.set qb1269, 15357
.set qb1270, 15358
.set qb1271, 15358
.set qb1272, 15358
.set qb1273, 15359
.set qb1274, 15359
.set qb1275, 15359
.set qb1276, 15360
.set qb1277, 15360
.set qb1278, 15360
.set qb1279, 15360
.altmacro
.macro EA i
.short qa\i
.endm
.macro EB i
.short qb\i
.endm
.p2align 8
tab_ft:
.set tn, 0
.rept 5
.set tt, 0
.rept 10
.set tl, 0
.rept 64
.set tj, 0
.rept 8
EA %(((2*(16*tt+8*(tl>>5)+tj)+1)*(2*(32*tn+(tl&31))+0)+0) % 1280)
.set tj, tj+1
.endr
.set tl, tl+1
.endr
.set tt, tt+1
.endr
.set tn, tn+1
.endr
.set tn, 0
.rept 5
.set tt, 0
.rept 10
.set tl, 0
.rept 64
.set tj, 0
.rept 8
EA %(((2*(16*tt+8*(tl>>5)+tj)+1)*(2*(32*tn+(tl&31))+2)+320) % 1280)
.set tj, tj+1
.endr
.set tl, tl+1
.endr
.set tt, tt+1
.endr
.set tn, tn+1
.endr
.set tn, 0
.rept 5
.set tt, 0
.rept 10
.set tl, 0
.rept 64
.set tj, 0
.rept 8
EA %(((2*(16*tt+8*(tl>>5)+tj)+1)*(2*(32*tn+(tl&31))+1)+0) % 1280)
.set tj, tj+1
.endr
.set tl, tl+1
.endr
.set tt, tt+1
.endr
.set tn, tn+1
.endr
.set tn, 0
.rept 5
.set tt, 0
.rept 10
.set tl, 0
.rept 64
.set tj, 0
.rept 8
EA %(((2*(16*tt+8*(tl>>5)+tj)+1)*(2*(32*tn+(tl&31))+1)+320) % 1280)
.set tj, tj+1
.endr
.set tl, tl+1
.endr
.set tt, tt+1
.endr
.set tn, tn+1
.endr
.p2align 8
tab_it:
.set tn, 0
.rept 5
.set tt, 0
.rept 10
.set tl, 0
.rept 64
.set tj, 0
.rept 8
EB %(((2*(32*tn+(tl&31))+1)*(2*(16*tt+8*(tl>>5)+tj)+0)+0) % 1280)
.set tj, tj+1
.endr
.set tl, tl+1
.endr
.set tt, tt+1
.endr
.set tn, tn+1
.endr
.set tn, 0
.rept 5
.set tt, 0
.rept 10
.set tl, 0
.rept 64
.set tj, 0
.rept 8
EB %(((2*(32*tn+(tl&31))+1)*(2*(16*tt+8*(tl>>5)+tj)+2)+960) % 1280)
.set tj, tj+1
.endr
.set tl, tl+1
.endr
.set tt, tt+1
.endr
.set tn, tn+1
.endr
.set tn, 0
.rept 5
.set tt, 0
.rept 10
.set tl, 0
.rept 64
.set tj, 0
.rept 8
EB %(((2*(32*tn+(tl&31))+1)*(2*(16*tt+8*(tl>>5)+tj)+1)+0) % 1280)
.set tj, tj+1
.endr
.set tl, tl+1
.endr
.set tt, tt+1
.endr
.set tn, tn+1
.endr
.set tn, 0
.rept 5
.set tt, 0
.rept 10
.set tl, 0
.rept 64
.set tj, 0
.rept 8
EB %(((2*(32*tn+(tl&31))+1)*(2*(16*tt+8*(tl>>5)+tj)+1)+960) % 1280)
.set tj, tj+1
.endr
.set tl, tl+1
.endr
.set tt, tt+1
.endr
.set tn, tn+1
.endr
.noaltmacro
.p2align 8
tab_fft:
.long 0x3c003c00,0x3c003c00,0x3c003c00,0x3c003c00,0x3bf63c00,0x3ba83bd9,0x391339a8,0x378b3872
.long 0x3bd93c00,0x3aa73b64,0xb23e0000,0xb872b61f,0x3ba83c00,0x39133aa7,0xbb0eb9a8,0xbbf6bbd9
.long 0x3b643c00,0x361f39a8,0xbb64bc00,0xb61fb9a8,0x3b0e3c00,0x2e463872,0xb4a5b9a8,0x3913323e
.long 0x3aa73c00,0xb23e361f,0x38728000,0x3bd93b64,0x3a2f3c00,0xb78b323e,0x3bf639a8,0x34a53aa7
.long 0x39a83c00,0xb9a80000,0x39a83c00,0xb9a80000,0x39133c00,0xbb0eb23e,0xae4639a8,0xbba8baa7
.long 0x38723c00,0xbbd9b61f,0xbaa70000,0xb23ebb64,0x378b3c00,0xbbf6b872,0xbba8b9a8,0x3a2fb23e
.long 0x361f3c00,0xbb64b9a8,0xb61fbc00,0x3b6439a8,0x34a53c00,0xba2fbaa7,0x378bb9a8,0x2e463bd9
.long 0x323e3c00,0xb872bb64,0x3bd98000,0xbaa7361f,0x2e463c00,0xb4a5bbd9,0x3a2f39a8,0xbb0eb872
.long 0x3c00,0x8000bc00,0x3c00,0x8000bc00,0xae463c00,0x34a5bbd9,0xba2f39a8,0x3b0eb872
.long 0xb23e3c00,0x3872bb64,0xbbd90000,0x3aa7361f,0xb4a53c00,0x3a2fbaa7,0xb78bb9a8,0xae463bd9
.long 0xb61f3c00,0x3b64b9a8,0x361fbc00,0xbb6439a8,0xb78b3c00,0x3bf6b872,0x3ba8b9a8,0xba2fb23e
.long 0xb8723c00,0x3bd9b61f,0x3aa78000,0x323ebb64,0xb9133c00,0x3b0eb23e,0x2e4639a8,0x3ba8baa7
.long 0xb9a83c00,0x39a88000,0xb9a83c00,0x39a88000,0xba2f3c00,0x378b323e,0xbbf639a8,0xb4a53aa7
.long 0xbaa73c00,0x323e361f,0xb8720000,0xbbd93b64,0xbb0e3c00,0xae463872,0x34a5b9a8,0xb913323e
.long 0xbb643c00,0xb61f39a8,0x3b64bc00,0x361fb9a8,0xbba83c00,0xb9133aa7,0x3b0eb9a8,0x3bf6bbd9
.long 0xbbd93c00,0xbaa73b64,0x323e8000,0x3872b61f,0xbbf63c00,0xbba83bd9,0xb91339a8,0xb78b3872
.long 0x3c003c00,0x3c003c00,0x3c003c00,0x3c003c00,0x3b0e3b64,0x3a2f3aa7,0x34a5361f,0x2e46323e
.long 0x387239a8,0x323e361f,0xbaa7b9a8,0xbbd9bb64,0x2e46361f,0xb78bb23e,0xba2fbb64,0xb4a5b872
.long 0xb61f0000,0xbb64b9a8,0x361f8000,0x3b6439a8,0xba2fb61f,0xbba8bbd9,0x3bf63b64,0x378b3aa7
.long 0xbbd9b9a8,0xb872bb64,0x323e39a8,0xbaa7b61f,0xbba8bb64,0x2e46b872,0xbb0eb61f,0xb913bbd9
.long 0xb9a8bc00,0x39a88000,0xb9a8bc00,0x39a88000,0xb4a5bb64,0x3bf63872,0x378bb61f,0x3a2f3bd9
.long 0x323eb9a8,0x3aa73b64,0x3bd939a8,0xb872361f,0x3913b61f,0x34a53bd9,0x2e463b64,0xbb0ebaa7
.long 0x3b648000,0xb61f39a8,0xbb640000,0x361fb9a8,0x3bf6361f,0xbb0e323e,0xb913bb64,0x3ba83872
.long 0x3aa739a8,0xbbd9b61f,0x3872b9a8,0xb23e3b64,0x378b3b64,0xb913baa7,0x3ba8361f,0xbbf6b23e
.long 0x3c00,0x8000bc00,0x3c00,0x8000bc00,0xb78b3b64,0x3913baa7,0xbba8361f,0x3bf6b23e
.long 0xbaa739a8,0x3bd9b61f,0xb872b9a8,0x323e3b64,0xbbf6361f,0x3b0e323e,0x3913bb64,0xbba83872
.long 0xbb640000,0x361f39a8,0x3b648000,0xb61fb9a8,0xb913b61f,0xb4a53bd9,0xae463b64,0x3b0ebaa7
.long 0xb23eb9a8,0xbaa73b64,0xbbd939a8,0x3872361f,0x34a5bb64,0xbbf63872,0xb78bb61f,0xba2f3bd9
.long 0x39a8bc00,0xb9a80000,0x39a8bc00,0xb9a80000,0x3ba8bb64,0xae46b872,0x3b0eb61f,0x3913bbd9
.long 0x3bd9b9a8,0x3872bb64,0xb23e39a8,0x3aa7b61f,0x3a2fb61f,0x3ba8bbd9,0xbbf63b64,0xb78b3aa7
.long 0x361f8000,0x3b64b9a8,0xb61f0000,0xbb6439a8,0xae46361f,0x378bb23e,0x3a2fbb64,0x34a5b872
.long 0xb87239a8,0xb23e361f,0x3aa7b9a8,0x3bd9bb64,0xbb0e3b64,0xba2f3aa7,0xb4a5361f,0xae46323e
.long 0xbc003c00,0xbc003c00,0xbc003c00,0xbc003c00,0xbbf63c00,0xbba83bd9,0xb91339a8,0xb78b3872
.long 0xbbd93c00,0xbaa73b64,0x323e0000,0x3872b61f,0xbba83c00,0xb9133aa7,0x3b0eb9a8,0x3bf6bbd9
.long 0xbb643c00,0xb61f39a8,0x3b64bc00,0x361fb9a8,0xbb0e3c00,0xae463872,0x34a5b9a8,0xb913323e
.long 0xbaa73c00,0x323e361f,0xb8728000,0xbbd93b64,0xba2f3c00,0x378b323e,0xbbf639a8,0xb4a53aa7
.long 0xb9a83c00,0x39a80000,0xb9a83c00,0x39a80000,0xb9133c00,0x3b0eb23e,0x2e4639a8,0x3ba8baa7
.long 0xb8723c00,0x3bd9b61f,0x3aa70000,0x323ebb64,0xb78b3c00,0x3bf6b872,0x3ba8b9a8,0xba2fb23e
.long 0xb61f3c00,0x3b64b9a8,0x361fbc00,0xbb6439a8,0xb4a53c00,0x3a2fbaa7,0xb78bb9a8,0xae463bd9
.long 0xb23e3c00,0x3872bb64,0xbbd98000,0x3aa7361f,0xae463c00,0x34a5bbd9,0xba2f39a8,0x3b0eb872
.long 0x80003c00,0xbc00,0x80003c00,0xbc00,0x2e463c00,0xb4a5bbd9,0x3a2f39a8,0xbb0eb872
.long 0x323e3c00,0xb872bb64,0x3bd90000,0xbaa7361f,0x34a53c00,0xba2fbaa7,0x378bb9a8,0x2e463bd9
.long 0x361f3c00,0xbb64b9a8,0xb61fbc00,0x3b6439a8,0x378b3c00,0xbbf6b872,0xbba8b9a8,0x3a2fb23e
.long 0x38723c00,0xbbd9b61f,0xbaa78000,0xb23ebb64,0x39133c00,0xbb0eb23e,0xae4639a8,0xbba8baa7
.long 0x39a83c00,0xb9a88000,0x39a83c00,0xb9a88000,0x3a2f3c00,0xb78b323e,0x3bf639a8,0x34a53aa7
.long 0x3aa73c00,0xb23e361f,0x38720000,0x3bd93b64,0x3b0e3c00,0x2e463872,0xb4a5b9a8,0x3913323e
.long 0x3b643c00,0x361f39a8,0xbb64bc00,0xb61fb9a8,0x3ba83c00,0x39133aa7,0xbb0eb9a8,0xbbf6bbd9
.long 0x3bd93c00,0x3aa73b64,0xb23e8000,0xb872b61f,0x3bf63c00,0x3ba83bd9,0x391339a8,0x378b3872
.long 0xbc003c00,0xbc003c00,0xbc003c00,0xbc003c00,0xbb0e3b64,0xba2f3aa7,0xb4a5361f,0xae46323e
.long 0xb87239a8,0xb23e361f,0x3aa7b9a8,0x3bd9bb64,0xae46361f,0x378bb23e,0x3a2fbb64,0x34a5b872
.long 0x361f0000,0x3b64b9a8,0xb61f8000,0xbb6439a8,0x3a2fb61f,0x3ba8bbd9,0xbbf63b64,0xb78b3aa7
.long 0x3bd9b9a8,0x3872bb64,0xb23e39a8,0x3aa7b61f,0x3ba8bb64,0xae46b872,0x3b0eb61f,0x3913bbd9
.long 0x39a8bc00,0xb9a88000,0x39a8bc00,0xb9a88000,0x34a5bb64,0xbbf63872,0xb78bb61f,0xba2f3bd9
.long 0xb23eb9a8,0xbaa73b64,0xbbd939a8,0x3872361f,0xb913b61f,0xb4a53bd9,0xae463b64,0x3b0ebaa7
.long 0xbb648000,0x361f39a8,0x3b640000,0xb61fb9a8,0xbbf6361f,0x3b0e323e,0x3913bb64,0xbba83872
.long 0xbaa739a8,0x3bd9b61f,0xb872b9a8,0x323e3b64,0xb78b3b64,0x3913baa7,0xbba8361f,0x3bf6b23e
.long 0x80003c00,0xbc00,0x80003c00,0xbc00,0x378b3b64,0xb913baa7,0x3ba8361f,0xbbf6b23e
.long 0x3aa739a8,0xbbd9b61f,0x3872b9a8,0xb23e3b64,0x3bf6361f,0xbb0e323e,0xb913bb64,0x3ba83872
.long 0x3b640000,0xb61f39a8,0xbb648000,0x361fb9a8,0x3913b61f,0x34a53bd9,0x2e463b64,0xbb0ebaa7
.long 0x323eb9a8,0x3aa73b64,0x3bd939a8,0xb872361f,0xb4a5bb64,0x3bf63872,0x378bb61f,0x3a2f3bd9
.long 0xb9a8bc00,0x39a80000,0xb9a8bc00,0x39a80000,0xbba8bb64,0x2e46b872,0xbb0eb61f,0xb913bbd9
.long 0xbbd9b9a8,0xb872bb64,0x323e39a8,0xbaa7b61f,0xba2fb61f,0xbba8bbd9,0x3bf63b64,0x378b3aa7
.long 0xb61f8000,0xbb64b9a8,0x361f0000,0x3b6439a8,0x2e46361f,0xb78bb23e,0xba2fbb64,0xb4a5b872
.long 0x387239a8,0x323e361f,0xbaa7b9a8,0xbbd9bb64,0x3b0e3b64,0x3a2f3aa7,0x34a5361f,0x2e46323e
.long 0x3c003c00,0x3c003c00,0x3c003c00,0x3c003c00,0xae460000,0xb4a5b23e,0xba2fb9a8,0xbb0ebaa7
.long 0xbbd9bc00,0xbaa7bb64,0x323e8000,0x3872361f,0x34a58000,0x3a2f3872,0x378b39a8,0xae46323e
.long 0x3b643c00,0x361f39a8,0xbb64bc00,0xb61fb9a8,0xb78b0000,0xbbf6baa7,0x3ba839a8,0x3a2f3bd9
.long 0xbaa7bc00,0x323eb61f,0xb8720000,0xbbd9bb64,0x39138000,0x3b0e3bd9,0xae46b9a8,0x3ba83872
.long 0x39a83c00,0xb9a80000,0x39a83c00,0xb9a80000,0xba2f0000,0xb78bbbd9,0xbbf6b9a8,0x34a5b872
.long 0xb872bc00,0x3bd9361f,0x3aa78000,0x323e3b64,0x3b0e8000,0xae463aa7,0xb4a539a8,0xb913bbd9
.long 0x361f3c00,0xbb64b9a8,0xb61fbc00,0x3b6439a8,0xbba80000,0x3913b872,0x3b0e39a8,0xbbf6b23e
.long 0xb23ebc00,0x38723b64,0xbbd90000,0x3aa7b61f,0x3bf68000,0xbba8323e,0x3913b9a8,0xb78b3aa7
.long 0x3c00,0x8000bc00,0x3c00,0x8000bc00,0xbbf60000,0x3ba8323e,0xb913b9a8,0x378b3aa7
.long 0x323ebc00,0xb8723b64,0x3bd98000,0xbaa7b61f,0x3ba88000,0xb913b872,0xbb0e39a8,0x3bf6b23e
.long 0xb61f3c00,0x3b64b9a8,0x361fbc00,0xbb6439a8,0xbb0e0000,0x2e463aa7,0x34a539a8,0x3913bbd9
.long 0x3872bc00,0xbbd9361f,0xbaa70000,0xb23e3b64,0x3a2f8000,0x378bbbd9,0x3bf6b9a8,0xb4a5b872
.long 0xb9a83c00,0x39a88000,0xb9a83c00,0x39a88000,0xb9130000,0xbb0e3bd9,0x2e46b9a8,0xbba83872
.long 0x3aa7bc00,0xb23eb61f,0x38728000,0x3bd9bb64,0x378b8000,0x3bf6baa7,0xbba839a8,0xba2f3bd9
.long 0xbb643c00,0xb61f39a8,0x3b64bc00,0x361fb9a8,0xb4a50000,0xba2f3872,0xb78b39a8,0x2e46323e
.long 0x3bd9bc00,0x3aa7bb64,0xb23e0000,0xb872361f,0x2e468000,0x34a5b23e,0x3a2fb9a8,0x3b0ebaa7
.long 0x3c003c00,0x3c003c00,0x3c003c00,0x3c003c00,0xb78bb61f,0xb913b872,0xbba8bb64,0xbbf6bbd9
.long 0xb872b9a8,0xb23eb61f,0x3aa739a8,0x3bd93b64,0x3bf63b64,0x3b0e3bd9,0xb913b61f,0xbba8baa7
.long 0xb61f0000,0xbb64b9a8,0x361f8000,0x3b6439a8,0xb913bb64,0x34a5b23e,0xae46361f,0xbb0eb872
.long 0x3bd939a8,0x38723b64,0xb23eb9a8,0x3aa7361f,0xb4a5361f,0xbbf6baa7,0x378b3b64,0xba2fb23e
.long 0xb9a8bc00,0x39a88000,0xb9a8bc00,0x39a88000,0x3ba8361f,0x2e463aa7,0x3b0e3b64,0xb913323e
.long 0xb23e39a8,0xbaa7bb64,0xbbd9b9a8,0x3872b61f,0xba2fbb64,0x3ba8323e,0x3bf6361f,0xb78b3872
.long 0x3b648000,0xb61f39a8,0xbb640000,0x361fb9a8,0xae463b64,0xb78bbbd9,0x3a2fb61f,0xb4a53aa7
.long 0xbaa7b9a8,0x3bd9361f,0xb87239a8,0x323ebb64,0x3b0eb61f,0xba2f3872,0x34a5bb64,0xae463bd9
.long 0x3c00,0x8000bc00,0x3c00,0x8000bc00,0xbb0eb61f,0x3a2f3872,0xb4a5bb64,0x2e463bd9
.long 0x3aa7b9a8,0xbbd9361f,0x387239a8,0xb23ebb64,0x2e463b64,0x378bbbd9,0xba2fb61f,0x34a53aa7
.long 0xbb640000,0x361f39a8,0x3b648000,0xb61fb9a8,0x3a2fbb64,0xbba8323e,0xbbf6361f,0x378b3872
.long 0x323e39a8,0x3aa7bb64,0x3bd9b9a8,0xb872b61f,0xbba8361f,0xae463aa7,0xbb0e3b64,0x3913323e
.long 0x39a8bc00,0xb9a80000,0x39a8bc00,0xb9a80000,0x34a5361f,0x3bf6baa7,0xb78b3b64,0x3a2fb23e
.long 0xbbd939a8,0xb8723b64,0x323eb9a8,0xbaa7361f,0x3913bb64,0xb4a5b23e,0x2e46361f,0x3b0eb872
.long 0x361f8000,0x3b64b9a8,0xb61f0000,0xbb6439a8,0xbbf63b64,0xbb0e3bd9,0x3913b61f,0x3ba8baa7
.long 0x3872b9a8,0x323eb61f,0xbaa739a8,0xbbd93b64,0x378bb61f,0x3913b872,0x3ba8bb64,0x3bf6bbd9
.long 0xbc003c00,0xbc003c00,0xbc003c00,0xbc003c00,0x2e460000,0x34a5b23e,0x3a2fb9a8,0x3b0ebaa7
.long 0x3bd9bc00,0x3aa7bb64,0xb23e8000,0xb872361f,0xb4a58000,0xba2f3872,0xb78b39a8,0x2e46323e
.long 0xbb643c00,0xb61f39a8,0x3b64bc00,0x361fb9a8,0x378b0000,0x3bf6baa7,0xbba839a8,0xba2f3bd9
.long 0x3aa7bc00,0xb23eb61f,0x38720000,0x3bd9bb64,0xb9138000,0xbb0e3bd9,0x2e46b9a8,0xbba83872
.long 0xb9a83c00,0x39a80000,0xb9a83c00,0x39a80000,0x3a2f0000,0x378bbbd9,0x3bf6b9a8,0xb4a5b872
.long 0x3872bc00,0xbbd9361f,0xbaa78000,0xb23e3b64,0xbb0e8000,0x2e463aa7,0x34a539a8,0x3913bbd9
.long 0xb61f3c00,0x3b64b9a8,0x361fbc00,0xbb6439a8,0x3ba80000,0xb913b872,0xbb0e39a8,0x3bf6b23e
.long 0x323ebc00,0xb8723b64,0x3bd90000,0xbaa7b61f,0xbbf68000,0x3ba8323e,0xb913b9a8,0x378b3aa7
.long 0x80003c00,0xbc00,0x80003c00,0xbc00,0x3bf60000,0xbba8323e,0x3913b9a8,0xb78b3aa7
.long 0xb23ebc00,0x38723b64,0xbbd98000,0x3aa7b61f,0xbba88000,0x3913b872,0x3b0e39a8,0xbbf6b23e
.long 0x361f3c00,0xbb64b9a8,0xb61fbc00,0x3b6439a8,0x3b0e0000,0xae463aa7,0xb4a539a8,0xb913bbd9
.long 0xb872bc00,0x3bd9361f,0x3aa70000,0x323e3b64,0xba2f8000,0xb78bbbd9,0xbbf6b9a8,0x34a5b872
.long 0x39a83c00,0xb9a88000,0x39a83c00,0xb9a88000,0x39130000,0x3b0e3bd9,0xae46b9a8,0x3ba83872
.long 0xbaa7bc00,0x323eb61f,0xb8728000,0xbbd9bb64,0xb78b8000,0xbbf6baa7,0x3ba839a8,0x3a2f3bd9
.long 0x3b643c00,0x361f39a8,0xbb64bc00,0xb61fb9a8,0x34a50000,0x3a2f3872,0x378b39a8,0xae46323e
.long 0xbbd9bc00,0xbaa7bb64,0x323e0000,0x3872361f,0xae468000,0xb4a5b23e,0xba2fb9a8,0xbb0ebaa7
.long 0xbc003c00,0xbc003c00,0xbc003c00,0xbc003c00,0x378bb61f,0x3913b872,0x3ba8bb64,0x3bf6bbd9
.long 0x3872b9a8,0x323eb61f,0xbaa739a8,0xbbd93b64,0xbbf63b64,0xbb0e3bd9,0x3913b61f,0x3ba8baa7
.long 0x361f0000,0x3b64b9a8,0xb61f8000,0xbb6439a8,0x3913bb64,0xb4a5b23e,0x2e46361f,0x3b0eb872
.long 0xbbd939a8,0xb8723b64,0x323eb9a8,0xbaa7361f,0x34a5361f,0x3bf6baa7,0xb78b3b64,0x3a2fb23e
.long 0x39a8bc00,0xb9a88000,0x39a8bc00,0xb9a88000,0xbba8361f,0xae463aa7,0xbb0e3b64,0x3913323e
.long 0x323e39a8,0x3aa7bb64,0x3bd9b9a8,0xb872b61f,0x3a2fbb64,0xbba8323e,0xbbf6361f,0x378b3872
.long 0xbb648000,0x361f39a8,0x3b640000,0xb61fb9a8,0x2e463b64,0x378bbbd9,0xba2fb61f,0x34a53aa7
.long 0x3aa7b9a8,0xbbd9361f,0x387239a8,0xb23ebb64,0xbb0eb61f,0x3a2f3872,0xb4a5bb64,0x2e463bd9
.long 0x80003c00,0xbc00,0x80003c00,0xbc00,0x3b0eb61f,0xba2f3872,0x34a5bb64,0xae463bd9
.long 0xbaa7b9a8,0x3bd9361f,0xb87239a8,0x323ebb64,0xae463b64,0xb78bbbd9,0x3a2fb61f,0xb4a53aa7
.long 0x3b640000,0xb61f39a8,0xbb648000,0x361fb9a8,0xba2fbb64,0x3ba8323e,0x3bf6361f,0xb78b3872
.long 0xb23e39a8,0xbaa7bb64,0xbbd9b9a8,0x3872b61f,0x3ba8361f,0x2e463aa7,0x3b0e3b64,0xb913323e
.long 0xb9a8bc00,0x39a80000,0xb9a8bc00,0x39a80000,0xb4a5361f,0xbbf6baa7,0x378b3b64,0xba2fb23e
.long 0x3bd939a8,0x38723b64,0xb23eb9a8,0x3aa7361f,0xb913bb64,0x34a5b23e,0xae46361f,0xbb0eb872
.long 0xb61f8000,0xbb64b9a8,0x361f0000,0x3b6439a8,0x3bf63b64,0x3b0e3bd9,0xb913b61f,0xbba8baa7
.long 0xb872b9a8,0xb23eb61f,0x3aa739a8,0x3bd93b64,0xb78bb61f,0xb913b872,0xbba8bb64,0xbbf6bbd9
.long 0x3c003c00,0x3c003c00,0x3c003c00,0x3c003c00,0xbbf6bc00,0xbba8bbd9,0xb913b9a8,0xb78bb872
.long 0x3bd93c00,0x3aa73b64,0xb23e0000,0xb872b61f,0xbba8bc00,0xb913baa7,0x3b0e39a8,0x3bf63bd9
.long 0x3b643c00,0x361f39a8,0xbb64bc00,0xb61fb9a8,0xbb0ebc00,0xae46b872,0x34a539a8,0xb913b23e
.long 0x3aa73c00,0xb23e361f,0x38728000,0x3bd93b64,0xba2fbc00,0x378bb23e,0xbbf6b9a8,0xb4a5baa7
.long 0x39a83c00,0xb9a80000,0x39a83c00,0xb9a80000,0xb913bc00,0x3b0e323e,0x2e46b9a8,0x3ba83aa7
.long 0x38723c00,0xbbd9b61f,0xbaa70000,0xb23ebb64,0xb78bbc00,0x3bf63872,0x3ba839a8,0xba2f323e
.long 0x361f3c00,0xbb64b9a8,0xb61fbc00,0x3b6439a8,0xb4a5bc00,0x3a2f3aa7,0xb78b39a8,0xae46bbd9
.long 0x323e3c00,0xb872bb64,0x3bd98000,0xbaa7361f,0xae46bc00,0x34a53bd9,0xba2fb9a8,0x3b0e3872
.long 0x3c00,0x8000bc00,0x3c00,0x8000bc00,0x2e46bc00,0xb4a53bd9,0x3a2fb9a8,0xbb0e3872
.long 0xb23e3c00,0x3872bb64,0xbbd90000,0x3aa7361f,0x34a5bc00,0xba2f3aa7,0x378b39a8,0x2e46bbd9
.long 0xb61f3c00,0x3b64b9a8,0x361fbc00,0xbb6439a8,0x378bbc00,0xbbf63872,0xbba839a8,0x3a2f323e
.long 0xb8723c00,0x3bd9b61f,0x3aa78000,0x323ebb64,0x3913bc00,0xbb0e323e,0xae46b9a8,0xbba83aa7
.long 0xb9a83c00,0x39a88000,0xb9a83c00,0x39a88000,0x3a2fbc00,0xb78bb23e,0x3bf6b9a8,0x34a5baa7
.long 0xbaa73c00,0x323e361f,0xb8720000,0xbbd93b64,0x3b0ebc00,0x2e46b872,0xb4a539a8,0x3913b23e
.long 0xbb643c00,0xb61f39a8,0x3b64bc00,0x361fb9a8,0x3ba8bc00,0x3913baa7,0xbb0e39a8,0xbbf63bd9
.long 0xbbd93c00,0xbaa73b64,0x323e8000,0x3872b61f,0x3bf6bc00,0x3ba8bbd9,0x3913b9a8,0x378bb872
.long 0x3c003c00,0x3c003c00,0x3c003c00,0x3c003c00,0xbb0ebb64,0xba2fbaa7,0xb4a5b61f,0xae46b23e
.long 0x387239a8,0x323e361f,0xbaa7b9a8,0xbbd9bb64,0xae46b61f,0x378b323e,0x3a2f3b64,0x34a53872
.long 0xb61f0000,0xbb64b9a8,0x361f8000,0x3b6439a8,0x3a2f361f,0x3ba83bd9,0xbbf6bb64,0xb78bbaa7
.long 0xbbd9b9a8,0xb872bb64,0x323e39a8,0xbaa7b61f,0x3ba83b64,0xae463872,0x3b0e361f,0x39133bd9
.long 0xb9a8bc00,0x39a88000,0xb9a8bc00,0x39a88000,0x34a53b64,0xbbf6b872,0xb78b361f,0xba2fbbd9
.long 0x323eb9a8,0x3aa73b64,0x3bd939a8,0xb872361f,0xb913361f,0xb4a5bbd9,0xae46bb64,0x3b0e3aa7
.long 0x3b648000,0xb61f39a8,0xbb640000,0x361fb9a8,0xbbf6b61f,0x3b0eb23e,0x39133b64,0xbba8b872
.long 0x3aa739a8,0xbbd9b61f,0x3872b9a8,0xb23e3b64,0xb78bbb64,0x39133aa7,0xbba8b61f,0x3bf6323e
.long 0x3c00,0x8000bc00,0x3c00,0x8000bc00,0x378bbb64,0xb9133aa7,0x3ba8b61f,0xbbf6323e
.long 0xbaa739a8,0x3bd9b61f,0xb872b9a8,0x323e3b64,0x3bf6b61f,0xbb0eb23e,0xb9133b64,0x3ba8b872
.long 0xbb640000,0x361f39a8,0x3b648000,0xb61fb9a8,0x3913361f,0x34a5bbd9,0x2e46bb64,0xbb0e3aa7
.long 0xb23eb9a8,0xbaa73b64,0xbbd939a8,0x3872361f,0xb4a53b64,0x3bf6b872,0x378b361f,0x3a2fbbd9
.long 0x39a8bc00,0xb9a80000,0x39a8bc00,0xb9a80000,0xbba83b64,0x2e463872,0xbb0e361f,0xb9133bd9
.long 0x3bd9b9a8,0x3872bb64,0xb23e39a8,0x3aa7b61f,0xba2f361f,0xbba83bd9,0x3bf6bb64,0x378bbaa7
.long 0x361f8000,0x3b64b9a8,0xb61f0000,0xbb6439a8,0x2e46b61f,0xb78b323e,0xba2f3b64,0xb4a53872
.long 0xb87239a8,0xb23e361f,0x3aa7b9a8,0x3bd9bb64,0x3b0ebb64,0x3a2fbaa7,0x34a5b61f,0x2e46b23e
.long 0xbc003c00,0xbc003c00,0xbc003c00,0xbc003c00,0x3bf6bc00,0x3ba8bbd9,0x3913b9a8,0x378bb872
.long 0xbbd93c00,0xbaa73b64,0x323e0000,0x3872b61f,0x3ba8bc00,0x3913baa7,0xbb0e39a8,0xbbf63bd9
.long 0xbb643c00,0xb61f39a8,0x3b64bc00,0x361fb9a8,0x3b0ebc00,0x2e46b872,0xb4a539a8,0x3913b23e
.long 0xbaa73c00,0x323e361f,0xb8728000,0xbbd93b64,0x3a2fbc00,0xb78bb23e,0x3bf6b9a8,0x34a5baa7
.long 0xb9a83c00,0x39a80000,0xb9a83c00,0x39a80000,0x3913bc00,0xbb0e323e,0xae46b9a8,0xbba83aa7
.long 0xb8723c00,0x3bd9b61f,0x3aa70000,0x323ebb64,0x378bbc00,0xbbf63872,0xbba839a8,0x3a2f323e
.long 0xb61f3c00,0x3b64b9a8,0x361fbc00,0xbb6439a8,0x34a5bc00,0xba2f3aa7,0x378b39a8,0x2e46bbd9
.long 0xb23e3c00,0x3872bb64,0xbbd98000,0x3aa7361f,0x2e46bc00,0xb4a53bd9,0x3a2fb9a8,0xbb0e3872
.long 0x80003c00,0xbc00,0x80003c00,0xbc00,0xae46bc00,0x34a53bd9,0xba2fb9a8,0x3b0e3872
.long 0x323e3c00,0xb872bb64,0x3bd90000,0xbaa7361f,0xb4a5bc00,0x3a2f3aa7,0xb78b39a8,0xae46bbd9
.long 0x361f3c00,0xbb64b9a8,0xb61fbc00,0x3b6439a8,0xb78bbc00,0x3bf63872,0x3ba839a8,0xba2f323e
.long 0x38723c00,0xbbd9b61f,0xbaa78000,0xb23ebb64,0xb913bc00,0x3b0e323e,0x2e46b9a8,0x3ba83aa7
.long 0x39a83c00,0xb9a88000,0x39a83c00,0xb9a88000,0xba2fbc00,0x378bb23e,0xbbf6b9a8,0xb4a5baa7
.long 0x3aa73c00,0xb23e361f,0x38720000,0x3bd93b64,0xbb0ebc00,0xae46b872,0x34a539a8,0xb913b23e
.long 0x3b643c00,0x361f39a8,0xbb64bc00,0xb61fb9a8,0xbba8bc00,0xb913baa7,0x3b0e39a8,0x3bf63bd9
.long 0x3bd93c00,0x3aa73b64,0xb23e8000,0xb872b61f,0xbbf6bc00,0xbba8bbd9,0xb913b9a8,0xb78bb872
.long 0xbc003c00,0xbc003c00,0xbc003c00,0xbc003c00,0x3b0ebb64,0x3a2fbaa7,0x34a5b61f,0x2e46b23e
.long 0xb87239a8,0xb23e361f,0x3aa7b9a8,0x3bd9bb64,0x2e46b61f,0xb78b323e,0xba2f3b64,0xb4a53872
.long 0x361f0000,0x3b64b9a8,0xb61f8000,0xbb6439a8,0xba2f361f,0xbba83bd9,0x3bf6bb64,0x378bbaa7
.long 0x3bd9b9a8,0x3872bb64,0xb23e39a8,0x3aa7b61f,0xbba83b64,0x2e463872,0xbb0e361f,0xb9133bd9
.long 0x39a8bc00,0xb9a88000,0x39a8bc00,0xb9a88000,0xb4a53b64,0x3bf6b872,0x378b361f,0x3a2fbbd9
.long 0xb23eb9a8,0xbaa73b64,0xbbd939a8,0x3872361f,0x3913361f,0x34a5bbd9,0x2e46bb64,0xbb0e3aa7
.long 0xbb648000,0x361f39a8,0x3b640000,0xb61fb9a8,0x3bf6b61f,0xbb0eb23e,0xb9133b64,0x3ba8b872
.long 0xbaa739a8,0x3bd9b61f,0xb872b9a8,0x323e3b64,0x378bbb64,0xb9133aa7,0x3ba8b61f,0xbbf6323e
.long 0x80003c00,0xbc00,0x80003c00,0xbc00,0xb78bbb64,0x39133aa7,0xbba8b61f,0x3bf6323e
.long 0x3aa739a8,0xbbd9b61f,0x3872b9a8,0xb23e3b64,0xbbf6b61f,0x3b0eb23e,0x39133b64,0xbba8b872
.long 0x3b640000,0xb61f39a8,0xbb648000,0x361fb9a8,0xb913361f,0xb4a5bbd9,0xae46bb64,0x3b0e3aa7
.long 0x323eb9a8,0x3aa73b64,0x3bd939a8,0xb872361f,0x34a53b64,0xbbf6b872,0xb78b361f,0xba2fbbd9
.long 0xb9a8bc00,0x39a80000,0xb9a8bc00,0x39a80000,0x3ba83b64,0xae463872,0x3b0e361f,0x39133bd9
.long 0xbbd9b9a8,0xb872bb64,0x323e39a8,0xbaa7b61f,0x3a2f361f,0x3ba83bd9,0xbbf6bb64,0xb78bbaa7
.long 0xb61f8000,0xbb64b9a8,0x361f0000,0x3b6439a8,0xae46b61f,0x378b323e,0x3a2f3b64,0x34a53872
.long 0x387239a8,0x323e361f,0xbaa7b9a8,0xbbd9bb64,0xbb0ebb64,0xba2fbaa7,0xb4a5b61f,0xae46b23e
.long 0x3c003c00,0x3c003c00,0x3c003c00,0x3c003c00,0x2e468000,0x34a5323e,0x3a2f39a8,0x3b0e3aa7
.long 0xbbd9bc00,0xbaa7bb64,0x323e8000,0x3872361f,0xb4a50000,0xba2fb872,0xb78bb9a8,0x2e46b23e
.long 0x3b643c00,0x361f39a8,0xbb64bc00,0xb61fb9a8,0x378b8000,0x3bf63aa7,0xbba8b9a8,0xba2fbbd9
.long 0xbaa7bc00,0x323eb61f,0xb8720000,0xbbd9bb64,0xb9130000,0xbb0ebbd9,0x2e4639a8,0xbba8b872
.long 0x39a83c00,0xb9a80000,0x39a83c00,0xb9a80000,0x3a2f8000,0x378b3bd9,0x3bf639a8,0xb4a53872
.long 0xb872bc00,0x3bd9361f,0x3aa78000,0x323e3b64,0xbb0e0000,0x2e46baa7,0x34a5b9a8,0x39133bd9
.long 0x361f3c00,0xbb64b9a8,0xb61fbc00,0x3b6439a8,0x3ba88000,0xb9133872,0xbb0eb9a8,0x3bf6323e
.long 0xb23ebc00,0x38723b64,0xbbd90000,0x3aa7b61f,0xbbf60000,0x3ba8b23e,0xb91339a8,0x378bbaa7
.long 0x3c00,0x8000bc00,0x3c00,0x8000bc00,0x3bf68000,0xbba8b23e,0x391339a8,0xb78bbaa7
.long 0x323ebc00,0xb8723b64,0x3bd98000,0xbaa7b61f,0xbba80000,0x39133872,0x3b0eb9a8,0xbbf6323e
.long 0xb61f3c00,0x3b64b9a8,0x361fbc00,0xbb6439a8,0x3b0e8000,0xae46baa7,0xb4a5b9a8,0xb9133bd9
.long 0x3872bc00,0xbbd9361f,0xbaa70000,0xb23e3b64,0xba2f0000,0xb78b3bd9,0xbbf639a8,0x34a53872
.long 0xb9a83c00,0x39a88000,0xb9a83c00,0x39a88000,0x39138000,0x3b0ebbd9,0xae4639a8,0x3ba8b872
.long 0x3aa7bc00,0xb23eb61f,0x38728000,0x3bd9bb64,0xb78b0000,0xbbf63aa7,0x3ba8b9a8,0x3a2fbbd9
.long 0xbb643c00,0xb61f39a8,0x3b64bc00,0x361fb9a8,0x34a58000,0x3a2fb872,0x378bb9a8,0xae46b23e
.long 0x3bd9bc00,0x3aa7bb64,0xb23e0000,0xb872361f,0xae460000,0xb4a5323e,0xba2f39a8,0xbb0e3aa7
.long 0x3c003c00,0x3c003c00,0x3c003c00,0x3c003c00,0x378b361f,0x39133872,0x3ba83b64,0x3bf63bd9
.long 0xb872b9a8,0xb23eb61f,0x3aa739a8,0x3bd93b64,0xbbf6bb64,0xbb0ebbd9,0x3913361f,0x3ba83aa7
.long 0xb61f0000,0xbb64b9a8,0x361f8000,0x3b6439a8,0x39133b64,0xb4a5323e,0x2e46b61f,0x3b0e3872
.long 0x3bd939a8,0x38723b64,0xb23eb9a8,0x3aa7361f,0x34a5b61f,0x3bf63aa7,0xb78bbb64,0x3a2f323e
.long 0xb9a8bc00,0x39a88000,0xb9a8bc00,0x39a88000,0xbba8b61f,0xae46baa7,0xbb0ebb64,0x3913b23e
.long 0xb23e39a8,0xbaa7bb64,0xbbd9b9a8,0x3872b61f,0x3a2f3b64,0xbba8b23e,0xbbf6b61f,0x378bb872
.long 0x3b648000,0xb61f39a8,0xbb640000,0x361fb9a8,0x2e46bb64,0x378b3bd9,0xba2f361f,0x34a5baa7
.long 0xbaa7b9a8,0x3bd9361f,0xb87239a8,0x323ebb64,0xbb0e361f,0x3a2fb872,0xb4a53b64,0x2e46bbd9
.long 0x3c00,0x8000bc00,0x3c00,0x8000bc00,0x3b0e361f,0xba2fb872,0x34a53b64,0xae46bbd9
.long 0x3aa7b9a8,0xbbd9361f,0x387239a8,0xb23ebb64,0xae46bb64,0xb78b3bd9,0x3a2f361f,0xb4a5baa7
.long 0xbb640000,0x361f39a8,0x3b648000,0xb61fb9a8,0xba2f3b64,0x3ba8b23e,0x3bf6b61f,0xb78bb872
.long 0x323e39a8,0x3aa7bb64,0x3bd9b9a8,0xb872b61f,0x3ba8b61f,0x2e46baa7,0x3b0ebb64,0xb913b23e
.long 0x39a8bc00,0xb9a80000,0x39a8bc00,0xb9a80000,0xb4a5b61f,0xbbf63aa7,0x378bbb64,0xba2f323e
.long 0xbbd939a8,0xb8723b64,0x323eb9a8,0xbaa7361f,0xb9133b64,0x34a5323e,0xae46b61f,0xbb0e3872
.long 0x361f8000,0x3b64b9a8,0xb61f0000,0xbb6439a8,0x3bf6bb64,0x3b0ebbd9,0xb913361f,0xbba83aa7
.long 0x3872b9a8,0x323eb61f,0xbaa739a8,0xbbd93b64,0xb78b361f,0xb9133872,0xbba83b64,0xbbf63bd9
.long 0xbc003c00,0xbc003c00,0xbc003c00,0xbc003c00,0xae468000,0xb4a5323e,0xba2f39a8,0xbb0e3aa7
.long 0x3bd9bc00,0x3aa7bb64,0xb23e8000,0xb872361f,0x34a50000,0x3a2fb872,0x378bb9a8,0xae46b23e
.long 0xbb643c00,0xb61f39a8,0x3b64bc00,0x361fb9a8,0xb78b8000,0xbbf63aa7,0x3ba8b9a8,0x3a2fbbd9
.long 0x3aa7bc00,0xb23eb61f,0x38720000,0x3bd9bb64,0x39130000,0x3b0ebbd9,0xae4639a8,0x3ba8b872
.long 0xb9a83c00,0x39a80000,0xb9a83c00,0x39a80000,0xba2f8000,0xb78b3bd9,0xbbf639a8,0x34a53872
.long 0x3872bc00,0xbbd9361f,0xbaa78000,0xb23e3b64,0x3b0e0000,0xae46baa7,0xb4a5b9a8,0xb9133bd9
.long 0xb61f3c00,0x3b64b9a8,0x361fbc00,0xbb6439a8,0xbba88000,0x39133872,0x3b0eb9a8,0xbbf6323e
.long 0x323ebc00,0xb8723b64,0x3bd90000,0xbaa7b61f,0x3bf60000,0xbba8b23e,0x391339a8,0xb78bbaa7
.long 0x80003c00,0xbc00,0x80003c00,0xbc00,0xbbf68000,0x3ba8b23e,0xb91339a8,0x378bbaa7
.long 0xb23ebc00,0x38723b64,0xbbd98000,0x3aa7b61f,0x3ba80000,0xb9133872,0xbb0eb9a8,0x3bf6323e
.long 0x361f3c00,0xbb64b9a8,0xb61fbc00,0x3b6439a8,0xbb0e8000,0x2e46baa7,0x34a5b9a8,0x39133bd9
.long 0xb872bc00,0x3bd9361f,0x3aa70000,0x323e3b64,0x3a2f0000,0x378b3bd9,0x3bf639a8,0xb4a53872
.long 0x39a83c00,0xb9a88000,0x39a83c00,0xb9a88000,0xb9138000,0xbb0ebbd9,0x2e4639a8,0xbba8b872
.long 0xbaa7bc00,0x323eb61f,0xb8728000,0xbbd9bb64,0x378b0000,0x3bf63aa7,0xbba8b9a8,0xba2fbbd9
.long 0x3b643c00,0x361f39a8,0xbb64bc00,0xb61fb9a8,0xb4a58000,0xba2fb872,0xb78bb9a8,0x2e46b23e
.long 0xbbd9bc00,0xbaa7bb64,0x323e0000,0x3872361f,0x2e460000,0x34a5323e,0x3a2f39a8,0x3b0e3aa7
.long 0xbc003c00,0xbc003c00,0xbc003c00,0xbc003c00,0xb78b361f,0xb9133872,0xbba83b64,0xbbf63bd9
.long 0x3872b9a8,0x323eb61f,0xbaa739a8,0xbbd93b64,0x3bf6bb64,0x3b0ebbd9,0xb913361f,0xbba83aa7
.long 0x361f0000,0x3b64b9a8,0xb61f8000,0xbb6439a8,0xb9133b64,0x34a5323e,0xae46b61f,0xbb0e3872
.long 0xbbd939a8,0xb8723b64,0x323eb9a8,0xbaa7361f,0xb4a5b61f,0xbbf63aa7,0x378bbb64,0xba2f323e
.long 0x39a8bc00,0xb9a88000,0x39a8bc00,0xb9a88000,0x3ba8b61f,0x2e46baa7,0x3b0ebb64,0xb913b23e
.long 0x323e39a8,0x3aa7bb64,0x3bd9b9a8,0xb872b61f,0xba2f3b64,0x3ba8b23e,0x3bf6b61f,0xb78bb872
.long 0xbb648000,0x361f39a8,0x3b640000,0xb61fb9a8,0xae46bb64,0xb78b3bd9,0x3a2f361f,0xb4a5baa7
.long 0x3aa7b9a8,0xbbd9361f,0x387239a8,0xb23ebb64,0x3b0e361f,0xba2fb872,0x34a53b64,0xae46bbd9
.long 0x80003c00,0xbc00,0x80003c00,0xbc00,0xbb0e361f,0x3a2fb872,0xb4a53b64,0x2e46bbd9
.long 0xbaa7b9a8,0x3bd9361f,0xb87239a8,0x323ebb64,0x2e46bb64,0x378b3bd9,0xba2f361f,0x34a5baa7
.long 0x3b640000,0xb61f39a8,0xbb648000,0x361fb9a8,0x3a2f3b64,0xbba8b23e,0xbbf6b61f,0x378bb872
.long 0xb23e39a8,0xbaa7bb64,0xbbd9b9a8,0x3872b61f,0xbba8b61f,0xae46baa7,0xbb0ebb64,0x3913b23e
.long 0xb9a8bc00,0x39a80000,0xb9a8bc00,0x39a80000,0x34a5b61f,0x3bf63aa7,0xb78bbb64,0x3a2f323e
.long 0x3bd939a8,0x38723b64,0xb23eb9a8,0x3aa7361f,0x39133b64,0xb4a5323e,0x2e46b61f,0x3b0e3872
.long 0xb61f8000,0xbb64b9a8,0x361f0000,0x3b6439a8,0xbbf6bb64,0xbb0ebbd9,0x3913361f,0x3ba83aa7
.long 0xb872b9a8,0xb23eb61f,0x3aa739a8,0x3bd93b64,0x378b361f,0x39133872,0x3ba83b64,0x3bf63bd9
.long 0x0,0x0,0x0,0x0,0x2e460000,0x34a5323e,0x3a2f39a8,0x3b0e3aa7
.long 0x323e0000,0x3872361f,0x3bd93c00,0x3aa73b64,0x34a50000,0x3a2f3872,0x378b39a8,0xae46323e
.long 0x361f0000,0x3b6439a8,0xb61f0000,0xbb64b9a8,0x378b0000,0x3bf63aa7,0xbba8b9a8,0xba2fbbd9
.long 0x38720000,0x3bd93b64,0xbaa7bc00,0x323eb61f,0x39130000,0x3b0e3bd9,0xae46b9a8,0x3ba83872
.long 0x39a80000,0x39a83c00,0x39a80000,0x39a83c00,0x3a2f0000,0x378b3bd9,0x3bf639a8,0xb4a53872
.long 0x3aa70000,0x323e3b64,0x38723c00,0xbbd9b61f,0x3b0e0000,0xae463aa7,0xb4a539a8,0xb913bbd9
.long 0x3b640000,0xb61f39a8,0xbb640000,0x361fb9a8,0x3ba80000,0xb9133872,0xbb0eb9a8,0x3bf6323e
.long 0x3bd90000,0xbaa7361f,0xb23ebc00,0x38723b64,0x3bf60000,0xbba8323e,0x3913b9a8,0xb78b3aa7
.long 0x3c000000,0xbc000000,0x3c000000,0xbc000000,0x3bf60000,0xbba8b23e,0x391339a8,0xb78bbaa7
.long 0x3bd90000,0xbaa7b61f,0xb23e3c00,0x3872bb64,0x3ba80000,0xb913b872,0xbb0e39a8,0x3bf6b23e
.long 0x3b640000,0xb61fb9a8,0xbb640000,0x361f39a8,0x3b0e0000,0xae46baa7,0xb4a5b9a8,0xb9133bd9
.long 0x3aa70000,0x323ebb64,0x3872bc00,0xbbd9361f,0x3a2f0000,0x378bbbd9,0x3bf6b9a8,0xb4a5b872
.long 0x39a80000,0x39a8bc00,0x39a80000,0x39a8bc00,0x39130000,0x3b0ebbd9,0xae4639a8,0x3ba8b872
.long 0x38720000,0x3bd9bb64,0xbaa73c00,0x323e361f,0x378b0000,0x3bf6baa7,0xbba839a8,0xba2f3bd9
.long 0x361f0000,0x3b64b9a8,0xb61f0000,0xbb6439a8,0x34a50000,0x3a2fb872,0x378bb9a8,0xae46b23e
.long 0x323e0000,0x3872b61f,0x3bd9bc00,0x3aa7bb64,0x2e460000,0x34a5b23e,0x3a2fb9a8,0x3b0ebaa7
.long 0x0,0x0,0x0,0x0,0x378b361f,0x39133872,0x3ba83b64,0x3bf63bd9
.long 0x3aa739a8,0x3bd93b64,0x387239a8,0x323e361f,0x3bf63b64,0x3b0e3bd9,0xb913b61f,0xbba8baa7
.long 0x3b643c00,0x361f39a8,0xbb64bc00,0xb61fb9a8,0x39133b64,0xb4a5323e,0x2e46b61f,0x3b0e3872
.long 0x323e39a8,0xbaa7b61f,0x3bd939a8,0x38723b64,0xb4a5361f,0xbbf6baa7,0x378b3b64,0xba2fb23e
.long 0xb9a80000,0xb9a8bc00,0xb9a80000,0xb9a8bc00,0xbba8b61f,0xae46baa7,0xbb0ebb64,0x3913b23e
.long 0xbbd9b9a8,0x3872b61f,0x323eb9a8,0x3aa73b64,0xba2fbb64,0x3ba8323e,0x3bf6361f,0xb78b3872
.long 0xb61fbc00,0x3b6439a8,0x361f3c00,0xbb64b9a8,0x2e46bb64,0x378b3bd9,0xba2f361f,0x34a5baa7
.long 0x3872b9a8,0xb23e3b64,0xbaa7b9a8,0x3bd9361f,0x3b0eb61f,0xba2f3872,0x34a5bb64,0xae463bd9
.long 0x3c000000,0xbc000000,0x3c000000,0xbc000000,0x3b0e361f,0xba2fb872,0x34a53b64,0xae46bbd9
.long 0x387239a8,0xb23ebb64,0xbaa739a8,0x3bd9b61f,0x2e463b64,0x378bbbd9,0xba2fb61f,0x34a53aa7
.long 0xb61f3c00,0x3b64b9a8,0x361fbc00,0xbb6439a8,0xba2f3b64,0x3ba8b23e,0x3bf6b61f,0xb78bb872
.long 0xbbd939a8,0x3872361f,0x323e39a8,0x3aa7bb64,0xbba8361f,0xae463aa7,0xbb0e3b64,0x3913323e
.long 0xb9a80000,0xb9a83c00,0xb9a80000,0xb9a83c00,0xb4a5b61f,0xbbf63aa7,0x378bbb64,0xba2f323e
.long 0x323eb9a8,0xbaa7361f,0x3bd9b9a8,0x3872bb64,0x3913bb64,0xb4a5b23e,0x2e46361f,0x3b0eb872
.long 0x3b64bc00,0x361fb9a8,0xbb643c00,0xb61f39a8,0x3bf6bb64,0x3b0ebbd9,0xb913361f,0xbba83aa7
.long 0x3aa7b9a8,0x3bd9bb64,0x3872b9a8,0x323eb61f,0x378bb61f,0x3913b872,0x3ba8bb64,0x3bf6bbd9
.long 0x0,0x0,0x0,0x0,0xae460000,0xb4a5323e,0xba2f39a8,0xbb0e3aa7
.long 0xb23e0000,0xb872361f,0xbbd93c00,0xbaa73b64,0xb4a50000,0xba2f3872,0xb78b39a8,0x2e46323e
.long 0xb61f0000,0xbb6439a8,0x361f0000,0x3b64b9a8,0xb78b0000,0xbbf63aa7,0x3ba8b9a8,0x3a2fbbd9
.long 0xb8720000,0xbbd93b64,0x3aa7bc00,0xb23eb61f,0xb9130000,0xbb0e3bd9,0x2e46b9a8,0xbba83872
.long 0xb9a80000,0xb9a83c00,0xb9a80000,0xb9a83c00,0xba2f0000,0xb78b3bd9,0xbbf639a8,0x34a53872
.long 0xbaa70000,0xb23e3b64,0xb8723c00,0x3bd9b61f,0xbb0e0000,0x2e463aa7,0x34a539a8,0x3913bbd9
.long 0xbb640000,0x361f39a8,0x3b640000,0xb61fb9a8,0xbba80000,0x39133872,0x3b0eb9a8,0xbbf6323e
.long 0xbbd90000,0x3aa7361f,0x323ebc00,0xb8723b64,0xbbf60000,0x3ba8323e,0xb913b9a8,0x378b3aa7
.long 0xbc000000,0x3c000000,0xbc000000,0x3c000000,0xbbf60000,0x3ba8b23e,0xb91339a8,0x378bbaa7
.long 0xbbd90000,0x3aa7b61f,0x323e3c00,0xb872bb64,0xbba80000,0x3913b872,0x3b0e39a8,0xbbf6b23e
.long 0xbb640000,0x361fb9a8,0x3b640000,0xb61f39a8,0xbb0e0000,0x2e46baa7,0x34a5b9a8,0x39133bd9
.long 0xbaa70000,0xb23ebb64,0xb872bc00,0x3bd9361f,0xba2f0000,0xb78bbbd9,0xbbf6b9a8,0x34a5b872
.long 0xb9a80000,0xb9a8bc00,0xb9a80000,0xb9a8bc00,0xb9130000,0xbb0ebbd9,0x2e4639a8,0xbba8b872
.long 0xb8720000,0xbbd9bb64,0x3aa73c00,0xb23e361f,0xb78b0000,0xbbf6baa7,0x3ba839a8,0x3a2f3bd9
.long 0xb61f0000,0xbb64b9a8,0x361f0000,0x3b6439a8,0xb4a50000,0xba2fb872,0xb78bb9a8,0x2e46b23e
.long 0xb23e0000,0xb872b61f,0xbbd9bc00,0xbaa7bb64,0xae460000,0xb4a5b23e,0xba2fb9a8,0xbb0ebaa7
.long 0x0,0x0,0x0,0x0,0xb78b361f,0xb9133872,0xbba83b64,0xbbf63bd9
.long 0xbaa739a8,0xbbd93b64,0xb87239a8,0xb23e361f,0xbbf63b64,0xbb0e3bd9,0x3913b61f,0x3ba8baa7
.long 0xbb643c00,0xb61f39a8,0x3b64bc00,0x361fb9a8,0xb9133b64,0x34a5323e,0xae46b61f,0xbb0e3872
.long 0xb23e39a8,0x3aa7b61f,0xbbd939a8,0xb8723b64,0x34a5361f,0x3bf6baa7,0xb78b3b64,0x3a2fb23e
.long 0x39a80000,0x39a8bc00,0x39a80000,0x39a8bc00,0x3ba8b61f,0x2e46baa7,0x3b0ebb64,0xb913b23e
.long 0x3bd9b9a8,0xb872b61f,0xb23eb9a8,0xbaa73b64,0x3a2fbb64,0xbba8323e,0xbbf6361f,0x378b3872
.long 0x361fbc00,0xbb6439a8,0xb61f3c00,0x3b64b9a8,0xae46bb64,0xb78b3bd9,0x3a2f361f,0xb4a5baa7
.long 0xb872b9a8,0x323e3b64,0x3aa7b9a8,0xbbd9361f,0xbb0eb61f,0x3a2f3872,0xb4a5bb64,0x2e463bd9
.long 0xbc000000,0x3c000000,0xbc000000,0x3c000000,0xbb0e361f,0x3a2fb872,0xb4a53b64,0x2e46bbd9
.long 0xb87239a8,0x323ebb64,0x3aa739a8,0xbbd9b61f,0xae463b64,0xb78bbbd9,0x3a2fb61f,0xb4a53aa7
.long 0x361f3c00,0xbb64b9a8,0xb61fbc00,0x3b6439a8,0x3a2f3b64,0xbba8b23e,0xbbf6b61f,0x378bb872
.long 0x3bd939a8,0xb872361f,0xb23e39a8,0xbaa7bb64,0x3ba8361f,0x2e463aa7,0x3b0e3b64,0xb913323e
.long 0x39a80000,0x39a83c00,0x39a80000,0x39a83c00,0x34a5b61f,0x3bf63aa7,0xb78bbb64,0x3a2f323e
.long 0xb23eb9a8,0x3aa7361f,0xbbd9b9a8,0xb872bb64,0xb913bb64,0x34a5b23e,0xae46361f,0xbb0eb872
.long 0xbb64bc00,0xb61fb9a8,0x3b643c00,0x361f39a8,0xbbf6bb64,0xbb0ebbd9,0x3913361f,0x3ba83aa7
.long 0xbaa7b9a8,0xbbd9bb64,0xb872b9a8,0xb23eb61f,0xb78bb61f,0xb913b872,0xbba8bb64,0xbbf6bbd9
.long 0x0,0x0,0x0,0x0,0x3bf63c00,0x3ba83bd9,0x391339a8,0x378b3872
.long 0xb23e0000,0xb872b61f,0xbbd9bc00,0xbaa7bb64,0xbba8bc00,0xb913baa7,0x3b0e39a8,0x3bf63bd9
.long 0x361f0000,0x3b6439a8,0xb61f0000,0xbb64b9a8,0x3b0e3c00,0x2e463872,0xb4a5b9a8,0x3913323e
.long 0xb8720000,0xbbd9bb64,0x3aa73c00,0xb23e361f,0xba2fbc00,0x378bb23e,0xbbf6b9a8,0xb4a5baa7
.long 0x39a80000,0x39a83c00,0x39a80000,0x39a83c00,0x39133c00,0xbb0eb23e,0xae4639a8,0xbba8baa7
.long 0xbaa70000,0xb23ebb64,0xb872bc00,0x3bd9361f,0xb78bbc00,0x3bf63872,0x3ba839a8,0xba2f323e
.long 0x3b640000,0xb61f39a8,0xbb640000,0x361fb9a8,0x34a53c00,0xba2fbaa7,0x378bb9a8,0x2e463bd9
.long 0xbbd90000,0x3aa7b61f,0x323e3c00,0xb872bb64,0xae46bc00,0x34a53bd9,0xba2fb9a8,0x3b0e3872
.long 0x3c000000,0xbc000000,0x3c000000,0xbc000000,0xae463c00,0x34a5bbd9,0xba2f39a8,0x3b0eb872
.long 0xbbd90000,0x3aa7361f,0x323ebc00,0xb8723b64,0x34a5bc00,0xba2f3aa7,0x378b39a8,0x2e46bbd9
.long 0x3b640000,0xb61fb9a8,0xbb640000,0x361f39a8,0xb78b3c00,0x3bf6b872,0x3ba8b9a8,0xba2fb23e
.long 0xbaa70000,0xb23e3b64,0xb8723c00,0x3bd9b61f,0x3913bc00,0xbb0e323e,0xae46b9a8,0xbba83aa7
.long 0x39a80000,0x39a8bc00,0x39a80000,0x39a8bc00,0xba2f3c00,0x378b323e,0xbbf639a8,0xb4a53aa7
.long 0xb8720000,0xbbd93b64,0x3aa7bc00,0xb23eb61f,0x3b0ebc00,0x2e46b872,0xb4a539a8,0x3913b23e
.long 0x361f0000,0x3b64b9a8,0xb61f0000,0xbb6439a8,0xbba83c00,0xb9133aa7,0x3b0eb9a8,0x3bf6bbd9
.long 0xb23e0000,0xb872361f,0xbbd93c00,0xbaa73b64,0x3bf6bc00,0x3ba8bbd9,0x3913b9a8,0x378bb872
.long 0x0,0x0,0x0,0x0,0x3b0e3b64,0x3a2f3aa7,0x34a5361f,0x2e46323e
.long 0xbaa7b9a8,0xbbd9bb64,0xb872b9a8,0xb23eb61f,0xae46b61f,0x378b323e,0x3a2f3b64,0x34a53872
.long 0x3b643c00,0x361f39a8,0xbb64bc00,0xb61fb9a8,0xba2fb61f,0xbba8bbd9,0x3bf63b64,0x378b3aa7
.long 0xb23eb9a8,0x3aa7361f,0xbbd9b9a8,0xb872bb64,0x3ba83b64,0xae463872,0x3b0e361f,0x39133bd9
.long 0xb9a80000,0xb9a8bc00,0xb9a80000,0xb9a8bc00,0xb4a5bb64,0x3bf63872,0x378bb61f,0x3a2f3bd9
.long 0x3bd939a8,0xb872361f,0xb23e39a8,0xbaa7bb64,0xb913361f,0xb4a5bbd9,0xae46bb64,0x3b0e3aa7
.long 0xb61fbc00,0x3b6439a8,0x361f3c00,0xbb64b9a8,0x3bf6361f,0xbb0e323e,0xb913bb64,0x3ba83872
.long 0xb87239a8,0x323ebb64,0x3aa739a8,0xbbd9b61f,0xb78bbb64,0x39133aa7,0xbba8b61f,0x3bf6323e
.long 0x3c000000,0xbc000000,0x3c000000,0xbc000000,0xb78b3b64,0x3913baa7,0xbba8361f,0x3bf6b23e
.long 0xb872b9a8,0x323e3b64,0x3aa7b9a8,0xbbd9361f,0x3bf6b61f,0xbb0eb23e,0xb9133b64,0x3ba8b872
.long 0xb61f3c00,0x3b64b9a8,0x361fbc00,0xbb6439a8,0xb913b61f,0xb4a53bd9,0xae463b64,0x3b0ebaa7
.long 0x3bd9b9a8,0xb872b61f,0xb23eb9a8,0xbaa73b64,0xb4a53b64,0x3bf6b872,0x378b361f,0x3a2fbbd9
.long 0xb9a80000,0xb9a83c00,0xb9a80000,0xb9a83c00,0x3ba8bb64,0xae46b872,0x3b0eb61f,0x3913bbd9
.long 0xb23e39a8,0x3aa7b61f,0xbbd939a8,0xb8723b64,0xba2f361f,0xbba83bd9,0x3bf6bb64,0x378bbaa7
.long 0x3b64bc00,0x361fb9a8,0xbb643c00,0xb61f39a8,0xae46361f,0x378bb23e,0x3a2fbb64,0x34a5b872
.long 0xbaa739a8,0xbbd93b64,0xb87239a8,0xb23e361f,0x3b0ebb64,0x3a2fbaa7,0x34a5b61f,0x2e46b23e
.long 0x0,0x0,0x0,0x0,0xbbf63c00,0xbba83bd9,0xb91339a8,0xb78b3872
.long 0x323e0000,0x3872b61f,0x3bd9bc00,0x3aa7bb64,0x3ba8bc00,0x3913baa7,0xbb0e39a8,0xbbf63bd9
.long 0xb61f0000,0xbb6439a8,0x361f0000,0x3b64b9a8,0xbb0e3c00,0xae463872,0x34a5b9a8,0xb913323e
.long 0x38720000,0x3bd9bb64,0xbaa73c00,0x323e361f,0x3a2fbc00,0xb78bb23e,0x3bf6b9a8,0x34a5baa7
.long 0xb9a80000,0xb9a83c00,0xb9a80000,0xb9a83c00,0xb9133c00,0x3b0eb23e,0x2e4639a8,0x3ba8baa7
.long 0x3aa70000,0x323ebb64,0x3872bc00,0xbbd9361f,0x378bbc00,0xbbf63872,0xbba839a8,0x3a2f323e
.long 0xbb640000,0x361f39a8,0x3b640000,0xb61fb9a8,0xb4a53c00,0x3a2fbaa7,0xb78bb9a8,0xae463bd9
.long 0x3bd90000,0xbaa7b61f,0xb23e3c00,0x3872bb64,0x2e46bc00,0xb4a53bd9,0x3a2fb9a8,0xbb0e3872
.long 0xbc000000,0x3c000000,0xbc000000,0x3c000000,0x2e463c00,0xb4a5bbd9,0x3a2f39a8,0xbb0eb872
.long 0x3bd90000,0xbaa7361f,0xb23ebc00,0x38723b64,0xb4a5bc00,0x3a2f3aa7,0xb78b39a8,0xae46bbd9
.long 0xbb640000,0x361fb9a8,0x3b640000,0xb61f39a8,0x378b3c00,0xbbf6b872,0xbba8b9a8,0x3a2fb23e
.long 0x3aa70000,0x323e3b64,0x38723c00,0xbbd9b61f,0xb913bc00,0x3b0e323e,0x2e46b9a8,0x3ba83aa7
.long 0xb9a80000,0xb9a8bc00,0xb9a80000,0xb9a8bc00,0x3a2f3c00,0xb78b323e,0x3bf639a8,0x34a53aa7
.long 0x38720000,0x3bd93b64,0xbaa7bc00,0x323eb61f,0xbb0ebc00,0xae46b872,0x34a539a8,0xb913b23e
.long 0xb61f0000,0xbb64b9a8,0x361f0000,0x3b6439a8,0x3ba83c00,0x39133aa7,0xbb0eb9a8,0xbbf6bbd9
.long 0x323e0000,0x3872361f,0x3bd93c00,0x3aa73b64,0xbbf6bc00,0xbba8bbd9,0xb913b9a8,0xb78bb872
.long 0x0,0x0,0x0,0x0,0xbb0e3b64,0xba2f3aa7,0xb4a5361f,0xae46323e
.long 0x3aa7b9a8,0x3bd9bb64,0x3872b9a8,0x323eb61f,0x2e46b61f,0xb78b323e,0xba2f3b64,0xb4a53872
.long 0xbb643c00,0xb61f39a8,0x3b64bc00,0x361fb9a8,0x3a2fb61f,0x3ba8bbd9,0xbbf63b64,0xb78b3aa7
.long 0x323eb9a8,0xbaa7361f,0x3bd9b9a8,0x3872bb64,0xbba83b64,0x2e463872,0xbb0e361f,0xb9133bd9
.long 0x39a80000,0x39a8bc00,0x39a80000,0x39a8bc00,0x34a5bb64,0xbbf63872,0xb78bb61f,0xba2f3bd9
.long 0xbbd939a8,0x3872361f,0x323e39a8,0x3aa7bb64,0x3913361f,0x34a5bbd9,0x2e46bb64,0xbb0e3aa7
.long 0x361fbc00,0xbb6439a8,0xb61f3c00,0x3b64b9a8,0xbbf6361f,0x3b0e323e,0x3913bb64,0xbba83872
.long 0x387239a8,0xb23ebb64,0xbaa739a8,0x3bd9b61f,0x378bbb64,0xb9133aa7,0x3ba8b61f,0xbbf6323e
.long 0xbc000000,0x3c000000,0xbc000000,0x3c000000,0x378b3b64,0xb913baa7,0x3ba8361f,0xbbf6b23e
.long 0x3872b9a8,0xb23e3b64,0xbaa7b9a8,0x3bd9361f,0xbbf6b61f,0x3b0eb23e,0x39133b64,0xbba8b872
.long 0x361f3c00,0xbb64b9a8,0xb61fbc00,0x3b6439a8,0x3913b61f,0x34a53bd9,0x2e463b64,0xbb0ebaa7
.long 0xbbd9b9a8,0x3872b61f,0x323eb9a8,0x3aa73b64,0x34a53b64,0xbbf6b872,0xb78b361f,0xba2fbbd9
.long 0x39a80000,0x39a83c00,0x39a80000,0x39a83c00,0xbba8bb64,0x2e46b872,0xbb0eb61f,0xb913bbd9
.long 0x323e39a8,0xbaa7b61f,0x3bd939a8,0x38723b64,0x3a2f361f,0x3ba83bd9,0xbbf6bb64,0xb78bbaa7
.long 0xbb64bc00,0xb61fb9a8,0x3b643c00,0x361f39a8,0x2e46361f,0xb78bb23e,0xba2fbb64,0xb4a5b872
.long 0x3aa739a8,0x3bd93b64,0x387239a8,0x323e361f,0xbb0ebb64,0xba2fbaa7,0xb4a5b61f,0xae46b23e
.long 0x0,0x0,0x0,0x0,0xae460000,0xb4a5b23e,0xba2fb9a8,0xbb0ebaa7
.long 0x323e0000,0x3872361f,0x3bd93c00,0x3aa73b64,0xb4a50000,0xba2fb872,0xb78bb9a8,0x2e46b23e
.long 0x361f0000,0x3b6439a8,0xb61f0000,0xbb64b9a8,0xb78b0000,0xbbf6baa7,0x3ba839a8,0x3a2f3bd9
.long 0x38720000,0x3bd93b64,0xbaa7bc00,0x323eb61f,0xb9130000,0xbb0ebbd9,0x2e4639a8,0xbba8b872
.long 0x39a80000,0x39a83c00,0x39a80000,0x39a83c00,0xba2f0000,0xb78bbbd9,0xbbf6b9a8,0x34a5b872
.long 0x3aa70000,0x323e3b64,0x38723c00,0xbbd9b61f,0xbb0e0000,0x2e46baa7,0x34a5b9a8,0x39133bd9
.long 0x3b640000,0xb61f39a8,0xbb640000,0x361fb9a8,0xbba80000,0x3913b872,0x3b0e39a8,0xbbf6b23e
.long 0x3bd90000,0xbaa7361f,0xb23ebc00,0x38723b64,0xbbf60000,0x3ba8b23e,0xb91339a8,0x378bbaa7
.long 0x3c000000,0xbc000000,0x3c000000,0xbc000000,0xbbf60000,0x3ba8323e,0xb913b9a8,0x378b3aa7
.long 0x3bd90000,0xbaa7b61f,0xb23e3c00,0x3872bb64,0xbba80000,0x39133872,0x3b0eb9a8,0xbbf6323e
.long 0x3b640000,0xb61fb9a8,0xbb640000,0x361f39a8,0xbb0e0000,0x2e463aa7,0x34a539a8,0x3913bbd9
.long 0x3aa70000,0x323ebb64,0x3872bc00,0xbbd9361f,0xba2f0000,0xb78b3bd9,0xbbf639a8,0x34a53872
.long 0x39a80000,0x39a8bc00,0x39a80000,0x39a8bc00,0xb9130000,0xbb0e3bd9,0x2e46b9a8,0xbba83872
.long 0x38720000,0x3bd9bb64,0xbaa73c00,0x323e361f,0xb78b0000,0xbbf63aa7,0x3ba8b9a8,0x3a2fbbd9
.long 0x361f0000,0x3b64b9a8,0xb61f0000,0xbb6439a8,0xb4a50000,0xba2f3872,0xb78b39a8,0x2e46323e
.long 0x323e0000,0x3872b61f,0x3bd9bc00,0x3aa7bb64,0xae460000,0xb4a5323e,0xba2f39a8,0xbb0e3aa7
.long 0x0,0x0,0x0,0x0,0xb78bb61f,0xb913b872,0xbba8bb64,0xbbf6bbd9
.long 0x3aa739a8,0x3bd93b64,0x387239a8,0x323e361f,0xbbf6bb64,0xbb0ebbd9,0x3913361f,0x3ba83aa7
.long 0x3b643c00,0x361f39a8,0xbb64bc00,0xb61fb9a8,0xb913bb64,0x34a5b23e,0xae46361f,0xbb0eb872
.long 0x323e39a8,0xbaa7b61f,0x3bd939a8,0x38723b64,0x34a5b61f,0x3bf63aa7,0xb78bbb64,0x3a2f323e
.long 0xb9a80000,0xb9a8bc00,0xb9a80000,0xb9a8bc00,0x3ba8361f,0x2e463aa7,0x3b0e3b64,0xb913323e
.long 0xbbd9b9a8,0x3872b61f,0x323eb9a8,0x3aa73b64,0x3a2f3b64,0xbba8b23e,0xbbf6b61f,0x378bb872
.long 0xb61fbc00,0x3b6439a8,0x361f3c00,0xbb64b9a8,0xae463b64,0xb78bbbd9,0x3a2fb61f,0xb4a53aa7
.long 0x3872b9a8,0xb23e3b64,0xbaa7b9a8,0x3bd9361f,0xbb0e361f,0x3a2fb872,0xb4a53b64,0x2e46bbd9
.long 0x3c000000,0xbc000000,0x3c000000,0xbc000000,0xbb0eb61f,0x3a2f3872,0xb4a5bb64,0x2e463bd9
.long 0x387239a8,0xb23ebb64,0xbaa739a8,0x3bd9b61f,0xae46bb64,0xb78b3bd9,0x3a2f361f,0xb4a5baa7
.long 0xb61f3c00,0x3b64b9a8,0x361fbc00,0xbb6439a8,0x3a2fbb64,0xbba8323e,0xbbf6361f,0x378b3872
.long 0xbbd939a8,0x3872361f,0x323e39a8,0x3aa7bb64,0x3ba8b61f,0x2e46baa7,0x3b0ebb64,0xb913b23e
.long 0xb9a80000,0xb9a83c00,0xb9a80000,0xb9a83c00,0x34a5361f,0x3bf6baa7,0xb78b3b64,0x3a2fb23e
.long 0x323eb9a8,0xbaa7361f,0x3bd9b9a8,0x3872bb64,0xb9133b64,0x34a5323e,0xae46b61f,0xbb0e3872
.long 0x3b64bc00,0x361fb9a8,0xbb643c00,0xb61f39a8,0xbbf63b64,0xbb0e3bd9,0x3913b61f,0x3ba8baa7
.long 0x3aa7b9a8,0x3bd9bb64,0x3872b9a8,0x323eb61f,0xb78b361f,0xb9133872,0xbba83b64,0xbbf63bd9
.long 0x0,0x0,0x0,0x0,0x2e460000,0x34a5b23e,0x3a2fb9a8,0x3b0ebaa7
.long 0xb23e0000,0xb872361f,0xbbd93c00,0xbaa73b64,0x34a50000,0x3a2fb872,0x378bb9a8,0xae46b23e
.long 0xb61f0000,0xbb6439a8,0x361f0000,0x3b64b9a8,0x378b0000,0x3bf6baa7,0xbba839a8,0xba2f3bd9
.long 0xb8720000,0xbbd93b64,0x3aa7bc00,0xb23eb61f,0x39130000,0x3b0ebbd9,0xae4639a8,0x3ba8b872
.long 0xb9a80000,0xb9a83c00,0xb9a80000,0xb9a83c00,0x3a2f0000,0x378bbbd9,0x3bf6b9a8,0xb4a5b872
.long 0xbaa70000,0xb23e3b64,0xb8723c00,0x3bd9b61f,0x3b0e0000,0xae46baa7,0xb4a5b9a8,0xb9133bd9
.long 0xbb640000,0x361f39a8,0x3b640000,0xb61fb9a8,0x3ba80000,0xb913b872,0xbb0e39a8,0x3bf6b23e
.long 0xbbd90000,0x3aa7361f,0x323ebc00,0xb8723b64,0x3bf60000,0xbba8b23e,0x391339a8,0xb78bbaa7
.long 0xbc000000,0x3c000000,0xbc000000,0x3c000000,0x3bf60000,0xbba8323e,0x3913b9a8,0xb78b3aa7
.long 0xbbd90000,0x3aa7b61f,0x323e3c00,0xb872bb64,0x3ba80000,0xb9133872,0xbb0eb9a8,0x3bf6323e
.long 0xbb640000,0x361fb9a8,0x3b640000,0xb61f39a8,0x3b0e0000,0xae463aa7,0xb4a539a8,0xb913bbd9
.long 0xbaa70000,0xb23ebb64,0xb872bc00,0x3bd9361f,0x3a2f0000,0x378b3bd9,0x3bf639a8,0xb4a53872
.long 0xb9a80000,0xb9a8bc00,0xb9a80000,0xb9a8bc00,0x39130000,0x3b0e3bd9,0xae46b9a8,0x3ba83872
.long 0xb8720000,0xbbd9bb64,0x3aa73c00,0xb23e361f,0x378b0000,0x3bf63aa7,0xbba8b9a8,0xba2fbbd9
.long 0xb61f0000,0xbb64b9a8,0x361f0000,0x3b6439a8,0x34a50000,0x3a2f3872,0x378b39a8,0xae46323e
.long 0xb23e0000,0xb872b61f,0xbbd9bc00,0xbaa7bb64,0x2e460000,0x34a5323e,0x3a2f39a8,0x3b0e3aa7
.long 0x0,0x0,0x0,0x0,0x378bb61f,0x3913b872,0x3ba8bb64,0x3bf6bbd9
.long 0xbaa739a8,0xbbd93b64,0xb87239a8,0xb23e361f,0x3bf6bb64,0x3b0ebbd9,0xb913361f,0xbba83aa7
.long 0xbb643c00,0xb61f39a8,0x3b64bc00,0x361fb9a8,0x3913bb64,0xb4a5b23e,0x2e46361f,0x3b0eb872
.long 0xb23e39a8,0x3aa7b61f,0xbbd939a8,0xb8723b64,0xb4a5b61f,0xbbf63aa7,0x378bbb64,0xba2f323e
.long 0x39a80000,0x39a8bc00,0x39a80000,0x39a8bc00,0xbba8361f,0xae463aa7,0xbb0e3b64,0x3913323e
.long 0x3bd9b9a8,0xb872b61f,0xb23eb9a8,0xbaa73b64,0xba2f3b64,0x3ba8b23e,0x3bf6b61f,0xb78bb872
.long 0x361fbc00,0xbb6439a8,0xb61f3c00,0x3b64b9a8,0x2e463b64,0x378bbbd9,0xba2fb61f,0x34a53aa7
.long 0xb872b9a8,0x323e3b64,0x3aa7b9a8,0xbbd9361f,0x3b0e361f,0xba2fb872,0x34a53b64,0xae46bbd9
.long 0xbc000000,0x3c000000,0xbc000000,0x3c000000,0x3b0eb61f,0xba2f3872,0x34a5bb64,0xae463bd9
.long 0xb87239a8,0x323ebb64,0x3aa739a8,0xbbd9b61f,0x2e46bb64,0x378b3bd9,0xba2f361f,0x34a5baa7
.long 0x361f3c00,0xbb64b9a8,0xb61fbc00,0x3b6439a8,0xba2fbb64,0x3ba8323e,0x3bf6361f,0xb78b3872
.long 0x3bd939a8,0xb872361f,0xb23e39a8,0xbaa7bb64,0xbba8b61f,0xae46baa7,0xbb0ebb64,0x3913b23e
.long 0x39a80000,0x39a83c00,0x39a80000,0x39a83c00,0xb4a5361f,0xbbf6baa7,0x378b3b64,0xba2fb23e
.long 0xb23eb9a8,0x3aa7361f,0xbbd9b9a8,0xb872bb64,0x39133b64,0xb4a5323e,0x2e46b61f,0x3b0e3872
.long 0xbb64bc00,0xb61fb9a8,0x3b643c00,0x361f39a8,0x3bf63b64,0x3b0e3bd9,0xb913b61f,0xbba8baa7
.long 0xbaa7b9a8,0xbbd9bb64,0xb872b9a8,0xb23eb61f,0x378b361f,0x39133872,0x3ba83b64,0x3bf63bd9
.long 0x0,0x0,0x0,0x0,0xbbf6bc00,0xbba8bbd9,0xb913b9a8,0xb78bb872
.long 0xb23e0000,0xb872b61f,0xbbd9bc00,0xbaa7bb64,0x3ba83c00,0x39133aa7,0xbb0eb9a8,0xbbf6bbd9
.long 0x361f0000,0x3b6439a8,0xb61f0000,0xbb64b9a8,0xbb0ebc00,0xae46b872,0x34a539a8,0xb913b23e
.long 0xb8720000,0xbbd9bb64,0x3aa73c00,0xb23e361f,0x3a2f3c00,0xb78b323e,0x3bf639a8,0x34a53aa7
.long 0x39a80000,0x39a83c00,0x39a80000,0x39a83c00,0xb913bc00,0x3b0e323e,0x2e46b9a8,0x3ba83aa7
.long 0xbaa70000,0xb23ebb64,0xb872bc00,0x3bd9361f,0x378b3c00,0xbbf6b872,0xbba8b9a8,0x3a2fb23e
.long 0x3b640000,0xb61f39a8,0xbb640000,0x361fb9a8,0xb4a5bc00,0x3a2f3aa7,0xb78b39a8,0xae46bbd9
.long 0xbbd90000,0x3aa7b61f,0x323e3c00,0xb872bb64,0x2e463c00,0xb4a5bbd9,0x3a2f39a8,0xbb0eb872
.long 0x3c000000,0xbc000000,0x3c000000,0xbc000000,0x2e46bc00,0xb4a53bd9,0x3a2fb9a8,0xbb0e3872
.long 0xbbd90000,0x3aa7361f,0x323ebc00,0xb8723b64,0xb4a53c00,0x3a2fbaa7,0xb78bb9a8,0xae463bd9
.long 0x3b640000,0xb61fb9a8,0xbb640000,0x361f39a8,0x378bbc00,0xbbf63872,0xbba839a8,0x3a2f323e
.long 0xbaa70000,0xb23e3b64,0xb8723c00,0x3bd9b61f,0xb9133c00,0x3b0eb23e,0x2e4639a8,0x3ba8baa7
.long 0x39a80000,0x39a8bc00,0x39a80000,0x39a8bc00,0x3a2fbc00,0xb78bb23e,0x3bf6b9a8,0x34a5baa7
.long 0xb8720000,0xbbd93b64,0x3aa7bc00,0xb23eb61f,0xbb0e3c00,0xae463872,0x34a5b9a8,0xb913323e
.long 0x361f0000,0x3b64b9a8,0xb61f0000,0xbb6439a8,0x3ba8bc00,0x3913baa7,0xbb0e39a8,0xbbf63bd9
.long 0xb23e0000,0xb872361f,0xbbd93c00,0xbaa73b64,0xbbf63c00,0xbba83bd9,0xb91339a8,0xb78b3872
.long 0x0,0x0,0x0,0x0,0xbb0ebb64,0xba2fbaa7,0xb4a5b61f,0xae46b23e
.long 0xbaa7b9a8,0xbbd9bb64,0xb872b9a8,0xb23eb61f,0x2e46361f,0xb78bb23e,0xba2fbb64,0xb4a5b872
.long 0x3b643c00,0x361f39a8,0xbb64bc00,0xb61fb9a8,0x3a2f361f,0x3ba83bd9,0xbbf6bb64,0xb78bbaa7
.long 0xb23eb9a8,0x3aa7361f,0xbbd9b9a8,0xb872bb64,0xbba8bb64,0x2e46b872,0xbb0eb61f,0xb913bbd9
.long 0xb9a80000,0xb9a8bc00,0xb9a80000,0xb9a8bc00,0x34a53b64,0xbbf6b872,0xb78b361f,0xba2fbbd9
.long 0x3bd939a8,0xb872361f,0xb23e39a8,0xbaa7bb64,0x3913b61f,0x34a53bd9,0x2e463b64,0xbb0ebaa7
.long 0xb61fbc00,0x3b6439a8,0x361f3c00,0xbb64b9a8,0xbbf6b61f,0x3b0eb23e,0x39133b64,0xbba8b872
.long 0xb87239a8,0x323ebb64,0x3aa739a8,0xbbd9b61f,0x378b3b64,0xb913baa7,0x3ba8361f,0xbbf6b23e
.long 0x3c000000,0xbc000000,0x3c000000,0xbc000000,0x378bbb64,0xb9133aa7,0x3ba8b61f,0xbbf6323e
.long 0xb872b9a8,0x323e3b64,0x3aa7b9a8,0xbbd9361f,0xbbf6361f,0x3b0e323e,0x3913bb64,0xbba83872
.long 0xb61f3c00,0x3b64b9a8,0x361fbc00,0xbb6439a8,0x3913361f,0x34a5bbd9,0x2e46bb64,0xbb0e3aa7
.long 0x3bd9b9a8,0xb872b61f,0xb23eb9a8,0xbaa73b64,0x34a5bb64,0xbbf63872,0xb78bb61f,0xba2f3bd9
.long 0xb9a80000,0xb9a83c00,0xb9a80000,0xb9a83c00,0xbba83b64,0x2e463872,0xbb0e361f,0xb9133bd9
.long 0xb23e39a8,0x3aa7b61f,0xbbd939a8,0xb8723b64,0x3a2fb61f,0x3ba8bbd9,0xbbf63b64,0xb78b3aa7
.long 0x3b64bc00,0x361fb9a8,0xbb643c00,0xb61f39a8,0x2e46b61f,0xb78b323e,0xba2f3b64,0xb4a53872
.long 0xbaa739a8,0xbbd93b64,0xb87239a8,0xb23e361f,0xbb0e3b64,0xba2f3aa7,0xb4a5361f,0xae46323e
.long 0x0,0x0,0x0,0x0,0x3bf6bc00,0x3ba8bbd9,0x3913b9a8,0x378bb872
.long 0x323e0000,0x3872b61f,0x3bd9bc00,0x3aa7bb64,0xbba83c00,0xb9133aa7,0x3b0eb9a8,0x3bf6bbd9
.long 0xb61f0000,0xbb6439a8,0x361f0000,0x3b64b9a8,0x3b0ebc00,0x2e46b872,0xb4a539a8,0x3913b23e
.long 0x38720000,0x3bd9bb64,0xbaa73c00,0x323e361f,0xba2f3c00,0x378b323e,0xbbf639a8,0xb4a53aa7
.long 0xb9a80000,0xb9a83c00,0xb9a80000,0xb9a83c00,0x3913bc00,0xbb0e323e,0xae46b9a8,0xbba83aa7
.long 0x3aa70000,0x323ebb64,0x3872bc00,0xbbd9361f,0xb78b3c00,0x3bf6b872,0x3ba8b9a8,0xba2fb23e
.long 0xbb640000,0x361f39a8,0x3b640000,0xb61fb9a8,0x34a5bc00,0xba2f3aa7,0x378b39a8,0x2e46bbd9
.long 0x3bd90000,0xbaa7b61f,0xb23e3c00,0x3872bb64,0xae463c00,0x34a5bbd9,0xba2f39a8,0x3b0eb872
.long 0xbc000000,0x3c000000,0xbc000000,0x3c000000,0xae46bc00,0x34a53bd9,0xba2fb9a8,0x3b0e3872
.long 0x3bd90000,0xbaa7361f,0xb23ebc00,0x38723b64,0x34a53c00,0xba2fbaa7,0x378bb9a8,0x2e463bd9
.long 0xbb640000,0x361fb9a8,0x3b640000,0xb61f39a8,0xb78bbc00,0x3bf63872,0x3ba839a8,0xba2f323e
.long 0x3aa70000,0x323e3b64,0x38723c00,0xbbd9b61f,0x39133c00,0xbb0eb23e,0xae4639a8,0xbba8baa7
.long 0xb9a80000,0xb9a8bc00,0xb9a80000,0xb9a8bc00,0xba2fbc00,0x378bb23e,0xbbf6b9a8,0xb4a5baa7
.long 0x38720000,0x3bd93b64,0xbaa7bc00,0x323eb61f,0x3b0e3c00,0x2e463872,0xb4a5b9a8,0x3913323e
.long 0xb61f0000,0xbb64b9a8,0x361f0000,0x3b6439a8,0xbba8bc00,0xb913baa7,0x3b0e39a8,0x3bf63bd9
.long 0x323e0000,0x3872361f,0x3bd93c00,0x3aa73b64,0x3bf63c00,0x3ba83bd9,0x391339a8,0x378b3872
.long 0x0,0x0,0x0,0x0,0x3b0ebb64,0x3a2fbaa7,0x34a5b61f,0x2e46b23e
.long 0x3aa7b9a8,0x3bd9bb64,0x3872b9a8,0x323eb61f,0xae46361f,0x378bb23e,0x3a2fbb64,0x34a5b872
.long 0xbb643c00,0xb61f39a8,0x3b64bc00,0x361fb9a8,0xba2f361f,0xbba83bd9,0x3bf6bb64,0x378bbaa7
.long 0x323eb9a8,0xbaa7361f,0x3bd9b9a8,0x3872bb64,0x3ba8bb64,0xae46b872,0x3b0eb61f,0x3913bbd9
.long 0x39a80000,0x39a8bc00,0x39a80000,0x39a8bc00,0xb4a53b64,0x3bf6b872,0x378b361f,0x3a2fbbd9
.long 0xbbd939a8,0x3872361f,0x323e39a8,0x3aa7bb64,0xb913b61f,0xb4a53bd9,0xae463b64,0x3b0ebaa7
.long 0x361fbc00,0xbb6439a8,0xb61f3c00,0x3b64b9a8,0x3bf6b61f,0xbb0eb23e,0xb9133b64,0x3ba8b872
.long 0x387239a8,0xb23ebb64,0xbaa739a8,0x3bd9b61f,0xb78b3b64,0x3913baa7,0xbba8361f,0x3bf6b23e
.long 0xbc000000,0x3c000000,0xbc000000,0x3c000000,0xb78bbb64,0x39133aa7,0xbba8b61f,0x3bf6323e
.long 0x3872b9a8,0xb23e3b64,0xbaa7b9a8,0x3bd9361f,0x3bf6361f,0xbb0e323e,0xb913bb64,0x3ba83872
.long 0x361f3c00,0xbb64b9a8,0xb61fbc00,0x3b6439a8,0xb913361f,0xb4a5bbd9,0xae46bb64,0x3b0e3aa7
.long 0xbbd9b9a8,0x3872b61f,0x323eb9a8,0x3aa73b64,0xb4a5bb64,0x3bf63872,0x378bb61f,0x3a2f3bd9
.long 0x39a80000,0x39a83c00,0x39a80000,0x39a83c00,0x3ba83b64,0xae463872,0x3b0e361f,0x39133bd9
.long 0x323e39a8,0xbaa7b61f,0x3bd939a8,0x38723b64,0xba2fb61f,0xbba8bbd9,0x3bf63b64,0x378b3aa7
.long 0xbb64bc00,0xb61fb9a8,0x3b643c00,0x361f39a8,0xae46b61f,0x378b323e,0x3a2f3b64,0x34a53872
.long 0x3aa739a8,0x3bd93b64,0x387239a8,0x323e361f,0x3b0e3b64,0x3a2f3aa7,0x34a5361f,0x2e46323e
.long 0x80008000,0x80008000,0x80008000,0x80008000,0xae468000,0xb4a5b23e,0xba2fb9a8,0xbb0ebaa7
.long 0xb23e8000,0xb872b61f,0xbbd9bc00,0xbaa7bb64,0xb4a58000,0xba2fb872,0xb78bb9a8,0x2e46b23e
.long 0xb61f8000,0xbb64b9a8,0x361f8000,0x3b6439a8,0xb78b8000,0xbbf6baa7,0x3ba839a8,0x3a2f3bd9
.long 0xb8728000,0xbbd9bb64,0x3aa73c00,0xb23e361f,0xb9138000,0xbb0ebbd9,0x2e4639a8,0xbba8b872
.long 0xb9a88000,0xb9a8bc00,0xb9a88000,0xb9a8bc00,0xba2f8000,0xb78bbbd9,0xbbf6b9a8,0x34a5b872
.long 0xbaa78000,0xb23ebb64,0xb872bc00,0x3bd9361f,0xbb0e8000,0x2e46baa7,0x34a5b9a8,0x39133bd9
.long 0xbb648000,0x361fb9a8,0x3b648000,0xb61f39a8,0xbba88000,0x3913b872,0x3b0e39a8,0xbbf6b23e
.long 0xbbd98000,0x3aa7b61f,0x323e3c00,0xb872bb64,0xbbf68000,0x3ba8b23e,0xb91339a8,0x378bbaa7
.long 0xbc008000,0x3c008000,0xbc008000,0x3c008000,0xbbf68000,0x3ba8323e,0xb913b9a8,0x378b3aa7
.long 0xbbd98000,0x3aa7361f,0x323ebc00,0xb8723b64,0xbba88000,0x39133872,0x3b0eb9a8,0xbbf6323e
.long 0xbb648000,0x361f39a8,0x3b648000,0xb61fb9a8,0xbb0e8000,0x2e463aa7,0x34a539a8,0x3913bbd9
.long 0xbaa78000,0xb23e3b64,0xb8723c00,0x3bd9b61f,0xba2f8000,0xb78b3bd9,0xbbf639a8,0x34a53872
.long 0xb9a88000,0xb9a83c00,0xb9a88000,0xb9a83c00,0xb9138000,0xbb0e3bd9,0x2e46b9a8,0xbba83872
.long 0xb8728000,0xbbd93b64,0x3aa7bc00,0xb23eb61f,0xb78b8000,0xbbf63aa7,0x3ba8b9a8,0x3a2fbbd9
.long 0xb61f8000,0xbb6439a8,0x361f8000,0x3b64b9a8,0xb4a58000,0xba2f3872,0xb78b39a8,0x2e46323e
.long 0xb23e8000,0xb872361f,0xbbd93c00,0xbaa73b64,0xae468000,0xb4a5323e,0xba2f39a8,0xbb0e3aa7
.long 0x80008000,0x80008000,0x80008000,0x80008000,0xb78bb61f,0xb913b872,0xbba8bb64,0xbbf6bbd9
.long 0xbaa7b9a8,0xbbd9bb64,0xb872b9a8,0xb23eb61f,0xbbf6bb64,0xbb0ebbd9,0x3913361f,0x3ba83aa7
.long 0xbb64bc00,0xb61fb9a8,0x3b643c00,0x361f39a8,0xb913bb64,0x34a5b23e,0xae46361f,0xbb0eb872
.long 0xb23eb9a8,0x3aa7361f,0xbbd9b9a8,0xb872bb64,0x34a5b61f,0x3bf63aa7,0xb78bbb64,0x3a2f323e
.long 0x39a88000,0x39a83c00,0x39a88000,0x39a83c00,0x3ba8361f,0x2e463aa7,0x3b0e3b64,0xb913323e
.long 0x3bd939a8,0xb872361f,0xb23e39a8,0xbaa7bb64,0x3a2f3b64,0xbba8b23e,0xbbf6b61f,0x378bb872
.long 0x361f3c00,0xbb64b9a8,0xb61fbc00,0x3b6439a8,0xae463b64,0xb78bbbd9,0x3a2fb61f,0xb4a53aa7
.long 0xb87239a8,0x323ebb64,0x3aa739a8,0xbbd9b61f,0xbb0e361f,0x3a2fb872,0xb4a53b64,0x2e46bbd9
.long 0xbc008000,0x3c008000,0xbc008000,0x3c008000,0xbb0eb61f,0x3a2f3872,0xb4a5bb64,0x2e463bd9
.long 0xb872b9a8,0x323e3b64,0x3aa7b9a8,0xbbd9361f,0xae46bb64,0xb78b3bd9,0x3a2f361f,0xb4a5baa7
.long 0x361fbc00,0xbb6439a8,0xb61f3c00,0x3b64b9a8,0x3a2fbb64,0xbba8323e,0xbbf6361f,0x378b3872
.long 0x3bd9b9a8,0xb872b61f,0xb23eb9a8,0xbaa73b64,0x3ba8b61f,0x2e46baa7,0x3b0ebb64,0xb913b23e
.long 0x39a88000,0x39a8bc00,0x39a88000,0x39a8bc00,0x34a5361f,0x3bf6baa7,0xb78b3b64,0x3a2fb23e
.long 0xb23e39a8,0x3aa7b61f,0xbbd939a8,0xb8723b64,0xb9133b64,0x34a5323e,0xae46b61f,0xbb0e3872
.long 0xbb643c00,0xb61f39a8,0x3b64bc00,0x361fb9a8,0xbbf63b64,0xbb0e3bd9,0x3913b61f,0x3ba8baa7
.long 0xbaa739a8,0xbbd93b64,0xb87239a8,0xb23e361f,0xb78b361f,0xb9133872,0xbba83b64,0xbbf63bd9
.long 0x80008000,0x80008000,0x80008000,0x80008000,0x2e468000,0x34a5b23e,0x3a2fb9a8,0x3b0ebaa7
.long 0x323e8000,0x3872b61f,0x3bd9bc00,0x3aa7bb64,0x34a58000,0x3a2fb872,0x378bb9a8,0xae46b23e
.long 0x361f8000,0x3b64b9a8,0xb61f8000,0xbb6439a8,0x378b8000,0x3bf6baa7,0xbba839a8,0xba2f3bd9
.long 0x38728000,0x3bd9bb64,0xbaa73c00,0x323e361f,0x39138000,0x3b0ebbd9,0xae4639a8,0x3ba8b872
.long 0x39a88000,0x39a8bc00,0x39a88000,0x39a8bc00,0x3a2f8000,0x378bbbd9,0x3bf6b9a8,0xb4a5b872
.long 0x3aa78000,0x323ebb64,0x3872bc00,0xbbd9361f,0x3b0e8000,0xae46baa7,0xb4a5b9a8,0xb9133bd9
.long 0x3b648000,0xb61fb9a8,0xbb648000,0x361f39a8,0x3ba88000,0xb913b872,0xbb0e39a8,0x3bf6b23e
.long 0x3bd98000,0xbaa7b61f,0xb23e3c00,0x3872bb64,0x3bf68000,0xbba8b23e,0x391339a8,0xb78bbaa7
.long 0x3c008000,0xbc008000,0x3c008000,0xbc008000,0x3bf68000,0xbba8323e,0x3913b9a8,0xb78b3aa7
.long 0x3bd98000,0xbaa7361f,0xb23ebc00,0x38723b64,0x3ba88000,0xb9133872,0xbb0eb9a8,0x3bf6323e
.long 0x3b648000,0xb61f39a8,0xbb648000,0x361fb9a8,0x3b0e8000,0xae463aa7,0xb4a539a8,0xb913bbd9
.long 0x3aa78000,0x323e3b64,0x38723c00,0xbbd9b61f,0x3a2f8000,0x378b3bd9,0x3bf639a8,0xb4a53872
.long 0x39a88000,0x39a83c00,0x39a88000,0x39a83c00,0x39138000,0x3b0e3bd9,0xae46b9a8,0x3ba83872
.long 0x38728000,0x3bd93b64,0xbaa7bc00,0x323eb61f,0x378b8000,0x3bf63aa7,0xbba8b9a8,0xba2fbbd9
.long 0x361f8000,0x3b6439a8,0xb61f8000,0xbb64b9a8,0x34a58000,0x3a2f3872,0x378b39a8,0xae46323e
.long 0x323e8000,0x3872361f,0x3bd93c00,0x3aa73b64,0x2e468000,0x34a5323e,0x3a2f39a8,0x3b0e3aa7
.long 0x80008000,0x80008000,0x80008000,0x80008000,0x378bb61f,0x3913b872,0x3ba8bb64,0x3bf6bbd9
.long 0x3aa7b9a8,0x3bd9bb64,0x3872b9a8,0x323eb61f,0x3bf6bb64,0x3b0ebbd9,0xb913361f,0xbba83aa7
.long 0x3b64bc00,0x361fb9a8,0xbb643c00,0xb61f39a8,0x3913bb64,0xb4a5b23e,0x2e46361f,0x3b0eb872
.long 0x323eb9a8,0xbaa7361f,0x3bd9b9a8,0x3872bb64,0xb4a5b61f,0xbbf63aa7,0x378bbb64,0xba2f323e
.long 0xb9a88000,0xb9a83c00,0xb9a88000,0xb9a83c00,0xbba8361f,0xae463aa7,0xbb0e3b64,0x3913323e
.long 0xbbd939a8,0x3872361f,0x323e39a8,0x3aa7bb64,0xba2f3b64,0x3ba8b23e,0x3bf6b61f,0xb78bb872
.long 0xb61f3c00,0x3b64b9a8,0x361fbc00,0xbb6439a8,0x2e463b64,0x378bbbd9,0xba2fb61f,0x34a53aa7
.long 0x387239a8,0xb23ebb64,0xbaa739a8,0x3bd9b61f,0x3b0e361f,0xba2fb872,0x34a53b64,0xae46bbd9
.long 0x3c008000,0xbc008000,0x3c008000,0xbc008000,0x3b0eb61f,0xba2f3872,0x34a5bb64,0xae463bd9
.long 0x3872b9a8,0xb23e3b64,0xbaa7b9a8,0x3bd9361f,0x2e46bb64,0x378b3bd9,0xba2f361f,0x34a5baa7
.long 0xb61fbc00,0x3b6439a8,0x361f3c00,0xbb64b9a8,0xba2fbb64,0x3ba8323e,0x3bf6361f,0xb78b3872
.long 0xbbd9b9a8,0x3872b61f,0x323eb9a8,0x3aa73b64,0xbba8b61f,0xae46baa7,0xbb0ebb64,0x3913b23e
.long 0xb9a88000,0xb9a8bc00,0xb9a88000,0xb9a8bc00,0xb4a5361f,0xbbf6baa7,0x378b3b64,0xba2fb23e
.long 0x323e39a8,0xbaa7b61f,0x3bd939a8,0x38723b64,0x39133b64,0xb4a5323e,0x2e46b61f,0x3b0e3872
.long 0x3b643c00,0x361f39a8,0xbb64bc00,0xb61fb9a8,0x3bf63b64,0x3b0e3bd9,0xb913b61f,0xbba8baa7
.long 0x3aa739a8,0x3bd93b64,0x387239a8,0x323e361f,0x378b361f,0x39133872,0x3ba83b64,0x3bf63bd9
.long 0x80008000,0x80008000,0x80008000,0x80008000,0xbbf6bc00,0xbba8bbd9,0xb913b9a8,0xb78bb872
.long 0x323e8000,0x3872361f,0x3bd93c00,0x3aa73b64,0x3ba83c00,0x39133aa7,0xbb0eb9a8,0xbbf6bbd9
.long 0xb61f8000,0xbb64b9a8,0x361f8000,0x3b6439a8,0xbb0ebc00,0xae46b872,0x34a539a8,0xb913b23e
.long 0x38728000,0x3bd93b64,0xbaa7bc00,0x323eb61f,0x3a2f3c00,0xb78b323e,0x3bf639a8,0x34a53aa7
.long 0xb9a88000,0xb9a8bc00,0xb9a88000,0xb9a8bc00,0xb913bc00,0x3b0e323e,0x2e46b9a8,0x3ba83aa7
.long 0x3aa78000,0x323e3b64,0x38723c00,0xbbd9b61f,0x378b3c00,0xbbf6b872,0xbba8b9a8,0x3a2fb23e
.long 0xbb648000,0x361fb9a8,0x3b648000,0xb61f39a8,0xb4a5bc00,0x3a2f3aa7,0xb78b39a8,0xae46bbd9
.long 0x3bd98000,0xbaa7361f,0xb23ebc00,0x38723b64,0x2e463c00,0xb4a5bbd9,0x3a2f39a8,0xbb0eb872
.long 0xbc008000,0x3c008000,0xbc008000,0x3c008000,0x2e46bc00,0xb4a53bd9,0x3a2fb9a8,0xbb0e3872
.long 0x3bd98000,0xbaa7b61f,0xb23e3c00,0x3872bb64,0xb4a53c00,0x3a2fbaa7,0xb78bb9a8,0xae463bd9
.long 0xbb648000,0x361f39a8,0x3b648000,0xb61fb9a8,0x378bbc00,0xbbf63872,0xbba839a8,0x3a2f323e
.long 0x3aa78000,0x323ebb64,0x3872bc00,0xbbd9361f,0xb9133c00,0x3b0eb23e,0x2e4639a8,0x3ba8baa7
.long 0xb9a88000,0xb9a83c00,0xb9a88000,0xb9a83c00,0x3a2fbc00,0xb78bb23e,0x3bf6b9a8,0x34a5baa7
.long 0x38728000,0x3bd9bb64,0xbaa73c00,0x323e361f,0xbb0e3c00,0xae463872,0x34a5b9a8,0xb913323e
.long 0xb61f8000,0xbb6439a8,0x361f8000,0x3b64b9a8,0x3ba8bc00,0x3913baa7,0xbb0e39a8,0xbbf63bd9
.long 0x323e8000,0x3872b61f,0x3bd9bc00,0x3aa7bb64,0xbbf63c00,0xbba83bd9,0xb91339a8,0xb78b3872
.long 0x80008000,0x80008000,0x80008000,0x80008000,0xbb0ebb64,0xba2fbaa7,0xb4a5b61f,0xae46b23e
.long 0x3aa739a8,0x3bd93b64,0x387239a8,0x323e361f,0x2e46361f,0xb78bb23e,0xba2fbb64,0xb4a5b872
.long 0xbb64bc00,0xb61fb9a8,0x3b643c00,0x361f39a8,0x3a2f361f,0x3ba83bd9,0xbbf6bb64,0xb78bbaa7
.long 0x323e39a8,0xbaa7b61f,0x3bd939a8,0x38723b64,0xbba8bb64,0x2e46b872,0xbb0eb61f,0xb913bbd9
.long 0x39a88000,0x39a83c00,0x39a88000,0x39a83c00,0x34a53b64,0xbbf6b872,0xb78b361f,0xba2fbbd9
.long 0xbbd9b9a8,0x3872b61f,0x323eb9a8,0x3aa73b64,0x3913b61f,0x34a53bd9,0x2e463b64,0xbb0ebaa7
.long 0x361f3c00,0xbb64b9a8,0xb61fbc00,0x3b6439a8,0xbbf6b61f,0x3b0eb23e,0x39133b64,0xbba8b872
.long 0x3872b9a8,0xb23e3b64,0xbaa7b9a8,0x3bd9361f,0x378b3b64,0xb913baa7,0x3ba8361f,0xbbf6b23e
.long 0xbc008000,0x3c008000,0xbc008000,0x3c008000,0x378bbb64,0xb9133aa7,0x3ba8b61f,0xbbf6323e
.long 0x387239a8,0xb23ebb64,0xbaa739a8,0x3bd9b61f,0xbbf6361f,0x3b0e323e,0x3913bb64,0xbba83872
.long 0x361fbc00,0xbb6439a8,0xb61f3c00,0x3b64b9a8,0x3913361f,0x34a5bbd9,0x2e46bb64,0xbb0e3aa7
.long 0xbbd939a8,0x3872361f,0x323e39a8,0x3aa7bb64,0x34a5bb64,0xbbf63872,0xb78bb61f,0xba2f3bd9
.long 0x39a88000,0x39a8bc00,0x39a88000,0x39a8bc00,0xbba83b64,0x2e463872,0xbb0e361f,0xb9133bd9
.long 0x323eb9a8,0xbaa7361f,0x3bd9b9a8,0x3872bb64,0x3a2fb61f,0x3ba8bbd9,0xbbf63b64,0xb78b3aa7
.long 0xbb643c00,0xb61f39a8,0x3b64bc00,0x361fb9a8,0x2e46b61f,0xb78b323e,0xba2f3b64,0xb4a53872
.long 0x3aa7b9a8,0x3bd9bb64,0x3872b9a8,0x323eb61f,0xbb0e3b64,0xba2f3aa7,0xb4a5361f,0xae46323e
.long 0x80008000,0x80008000,0x80008000,0x80008000,0x3bf6bc00,0x3ba8bbd9,0x3913b9a8,0x378bb872
.long 0xb23e8000,0xb872361f,0xbbd93c00,0xbaa73b64,0xbba83c00,0xb9133aa7,0x3b0eb9a8,0x3bf6bbd9
.long 0x361f8000,0x3b64b9a8,0xb61f8000,0xbb6439a8,0x3b0ebc00,0x2e46b872,0xb4a539a8,0x3913b23e
.long 0xb8728000,0xbbd93b64,0x3aa7bc00,0xb23eb61f,0xba2f3c00,0x378b323e,0xbbf639a8,0xb4a53aa7
.long 0x39a88000,0x39a8bc00,0x39a88000,0x39a8bc00,0x3913bc00,0xbb0e323e,0xae46b9a8,0xbba83aa7
.long 0xbaa78000,0xb23e3b64,0xb8723c00,0x3bd9b61f,0xb78b3c00,0x3bf6b872,0x3ba8b9a8,0xba2fb23e
.long 0x3b648000,0xb61fb9a8,0xbb648000,0x361f39a8,0x34a5bc00,0xba2f3aa7,0x378b39a8,0x2e46bbd9
.long 0xbbd98000,0x3aa7361f,0x323ebc00,0xb8723b64,0xae463c00,0x34a5bbd9,0xba2f39a8,0x3b0eb872
.long 0x3c008000,0xbc008000,0x3c008000,0xbc008000,0xae46bc00,0x34a53bd9,0xba2fb9a8,0x3b0e3872
.long 0xbbd98000,0x3aa7b61f,0x323e3c00,0xb872bb64,0x34a53c00,0xba2fbaa7,0x378bb9a8,0x2e463bd9
.long 0x3b648000,0xb61f39a8,0xbb648000,0x361fb9a8,0xb78bbc00,0x3bf63872,0x3ba839a8,0xba2f323e
.long 0xbaa78000,0xb23ebb64,0xb872bc00,0x3bd9361f,0x39133c00,0xbb0eb23e,0xae4639a8,0xbba8baa7
.long 0x39a88000,0x39a83c00,0x39a88000,0x39a83c00,0xba2fbc00,0x378bb23e,0xbbf6b9a8,0xb4a5baa7
.long 0xb8728000,0xbbd9bb64,0x3aa73c00,0xb23e361f,0x3b0e3c00,0x2e463872,0xb4a5b9a8,0x3913323e
.long 0x361f8000,0x3b6439a8,0xb61f8000,0xbb64b9a8,0xbba8bc00,0xb913baa7,0x3b0e39a8,0x3bf63bd9
.long 0xb23e8000,0xb872b61f,0xbbd9bc00,0xbaa7bb64,0x3bf63c00,0x3ba83bd9,0x391339a8,0x378b3872
.long 0x80008000,0x80008000,0x80008000,0x80008000,0x3b0ebb64,0x3a2fbaa7,0x34a5b61f,0x2e46b23e
.long 0xbaa739a8,0xbbd93b64,0xb87239a8,0xb23e361f,0xae46361f,0x378bb23e,0x3a2fbb64,0x34a5b872
.long 0x3b64bc00,0x361fb9a8,0xbb643c00,0xb61f39a8,0xba2f361f,0xbba83bd9,0x3bf6bb64,0x378bbaa7
.long 0xb23e39a8,0x3aa7b61f,0xbbd939a8,0xb8723b64,0x3ba8bb64,0xae46b872,0x3b0eb61f,0x3913bbd9
.long 0xb9a88000,0xb9a83c00,0xb9a88000,0xb9a83c00,0xb4a53b64,0x3bf6b872,0x378b361f,0x3a2fbbd9
.long 0x3bd9b9a8,0xb872b61f,0xb23eb9a8,0xbaa73b64,0xb913b61f,0xb4a53bd9,0xae463b64,0x3b0ebaa7
.long 0xb61f3c00,0x3b64b9a8,0x361fbc00,0xbb6439a8,0x3bf6b61f,0xbb0eb23e,0xb9133b64,0x3ba8b872
.long 0xb872b9a8,0x323e3b64,0x3aa7b9a8,0xbbd9361f,0xb78b3b64,0x3913baa7,0xbba8361f,0x3bf6b23e
.long 0x3c008000,0xbc008000,0x3c008000,0xbc008000,0xb78bbb64,0x39133aa7,0xbba8b61f,0x3bf6323e
.long 0xb87239a8,0x323ebb64,0x3aa739a8,0xbbd9b61f,0x3bf6361f,0xbb0e323e,0xb913bb64,0x3ba83872
.long 0xb61fbc00,0x3b6439a8,0x361f3c00,0xbb64b9a8,0xb913361f,0xb4a5bbd9,0xae46bb64,0x3b0e3aa7
.long 0x3bd939a8,0xb872361f,0xb23e39a8,0xbaa7bb64,0xb4a5bb64,0x3bf63872,0x378bb61f,0x3a2f3bd9
.long 0xb9a88000,0xb9a8bc00,0xb9a88000,0xb9a8bc00,0x3ba83b64,0xae463872,0x3b0e361f,0x39133bd9
.long 0xb23eb9a8,0x3aa7361f,0xbbd9b9a8,0xb872bb64,0xba2fb61f,0xbba8bbd9,0x3bf63b64,0x378b3aa7
.long 0x3b643c00,0x361f39a8,0xbb64bc00,0xb61fb9a8,0xae46b61f,0x378b323e,0x3a2f3b64,0x34a53872
.long 0xbaa7b9a8,0xbbd9bb64,0xb872b9a8,0xb23eb61f,0x3b0e3b64,0x3a2f3aa7,0x34a5361f,0x2e46323e
.long 0x80008000,0x80008000,0x80008000,0x80008000,0x2e468000,0x34a5323e,0x3a2f39a8,0x3b0e3aa7
.long 0xb23e8000,0xb872b61f,0xbbd9bc00,0xbaa7bb64,0x34a58000,0x3a2f3872,0x378b39a8,0xae46323e
.long 0xb61f8000,0xbb64b9a8,0x361f8000,0x3b6439a8,0x378b8000,0x3bf63aa7,0xbba8b9a8,0xba2fbbd9
.long 0xb8728000,0xbbd9bb64,0x3aa73c00,0xb23e361f,0x39138000,0x3b0e3bd9,0xae46b9a8,0x3ba83872
.long 0xb9a88000,0xb9a8bc00,0xb9a88000,0xb9a8bc00,0x3a2f8000,0x378b3bd9,0x3bf639a8,0xb4a53872
.long 0xbaa78000,0xb23ebb64,0xb872bc00,0x3bd9361f,0x3b0e8000,0xae463aa7,0xb4a539a8,0xb913bbd9
.long 0xbb648000,0x361fb9a8,0x3b648000,0xb61f39a8,0x3ba88000,0xb9133872,0xbb0eb9a8,0x3bf6323e
.long 0xbbd98000,0x3aa7b61f,0x323e3c00,0xb872bb64,0x3bf68000,0xbba8323e,0x3913b9a8,0xb78b3aa7
.long 0xbc008000,0x3c008000,0xbc008000,0x3c008000,0x3bf68000,0xbba8b23e,0x391339a8,0xb78bbaa7
.long 0xbbd98000,0x3aa7361f,0x323ebc00,0xb8723b64,0x3ba88000,0xb913b872,0xbb0e39a8,0x3bf6b23e
.long 0xbb648000,0x361f39a8,0x3b648000,0xb61fb9a8,0x3b0e8000,0xae46baa7,0xb4a5b9a8,0xb9133bd9
.long 0xbaa78000,0xb23e3b64,0xb8723c00,0x3bd9b61f,0x3a2f8000,0x378bbbd9,0x3bf6b9a8,0xb4a5b872
.long 0xb9a88000,0xb9a83c00,0xb9a88000,0xb9a83c00,0x39138000,0x3b0ebbd9,0xae4639a8,0x3ba8b872
.long 0xb8728000,0xbbd93b64,0x3aa7bc00,0xb23eb61f,0x378b8000,0x3bf6baa7,0xbba839a8,0xba2f3bd9
.long 0xb61f8000,0xbb6439a8,0x361f8000,0x3b64b9a8,0x34a58000,0x3a2fb872,0x378bb9a8,0xae46b23e
.long 0xb23e8000,0xb872361f,0xbbd93c00,0xbaa73b64,0x2e468000,0x34a5b23e,0x3a2fb9a8,0x3b0ebaa7
.long 0x80008000,0x80008000,0x80008000,0x80008000,0x378b361f,0x39133872,0x3ba83b64,0x3bf63bd9
.long 0xbaa7b9a8,0xbbd9bb64,0xb872b9a8,0xb23eb61f,0x3bf63b64,0x3b0e3bd9,0xb913b61f,0xbba8baa7
.long 0xbb64bc00,0xb61fb9a8,0x3b643c00,0x361f39a8,0x39133b64,0xb4a5323e,0x2e46b61f,0x3b0e3872
.long 0xb23eb9a8,0x3aa7361f,0xbbd9b9a8,0xb872bb64,0xb4a5361f,0xbbf6baa7,0x378b3b64,0xba2fb23e
.long 0x39a88000,0x39a83c00,0x39a88000,0x39a83c00,0xbba8b61f,0xae46baa7,0xbb0ebb64,0x3913b23e
.long 0x3bd939a8,0xb872361f,0xb23e39a8,0xbaa7bb64,0xba2fbb64,0x3ba8323e,0x3bf6361f,0xb78b3872
.long 0x361f3c00,0xbb64b9a8,0xb61fbc00,0x3b6439a8,0x2e46bb64,0x378b3bd9,0xba2f361f,0x34a5baa7
.long 0xb87239a8,0x323ebb64,0x3aa739a8,0xbbd9b61f,0x3b0eb61f,0xba2f3872,0x34a5bb64,0xae463bd9
.long 0xbc008000,0x3c008000,0xbc008000,0x3c008000,0x3b0e361f,0xba2fb872,0x34a53b64,0xae46bbd9
.long 0xb872b9a8,0x323e3b64,0x3aa7b9a8,0xbbd9361f,0x2e463b64,0x378bbbd9,0xba2fb61f,0x34a53aa7
.long 0x361fbc00,0xbb6439a8,0xb61f3c00,0x3b64b9a8,0xba2f3b64,0x3ba8b23e,0x3bf6b61f,0xb78bb872
.long 0x3bd9b9a8,0xb872b61f,0xb23eb9a8,0xbaa73b64,0xbba8361f,0xae463aa7,0xbb0e3b64,0x3913323e
.long 0x39a88000,0x39a8bc00,0x39a88000,0x39a8bc00,0xb4a5b61f,0xbbf63aa7,0x378bbb64,0xba2f323e
.long 0xb23e39a8,0x3aa7b61f,0xbbd939a8,0xb8723b64,0x3913bb64,0xb4a5b23e,0x2e46361f,0x3b0eb872
.long 0xbb643c00,0xb61f39a8,0x3b64bc00,0x361fb9a8,0x3bf6bb64,0x3b0ebbd9,0xb913361f,0xbba83aa7
.long 0xbaa739a8,0xbbd93b64,0xb87239a8,0xb23e361f,0x378bb61f,0x3913b872,0x3ba8bb64,0x3bf6bbd9
.long 0x80008000,0x80008000,0x80008000,0x80008000,0xae468000,0xb4a5323e,0xba2f39a8,0xbb0e3aa7
.long 0x323e8000,0x3872b61f,0x3bd9bc00,0x3aa7bb64,0xb4a58000,0xba2f3872,0xb78b39a8,0x2e46323e
.long 0x361f8000,0x3b64b9a8,0xb61f8000,0xbb6439a8,0xb78b8000,0xbbf63aa7,0x3ba8b9a8,0x3a2fbbd9
.long 0x38728000,0x3bd9bb64,0xbaa73c00,0x323e361f,0xb9138000,0xbb0e3bd9,0x2e46b9a8,0xbba83872
.long 0x39a88000,0x39a8bc00,0x39a88000,0x39a8bc00,0xba2f8000,0xb78b3bd9,0xbbf639a8,0x34a53872
.long 0x3aa78000,0x323ebb64,0x3872bc00,0xbbd9361f,0xbb0e8000,0x2e463aa7,0x34a539a8,0x3913bbd9
.long 0x3b648000,0xb61fb9a8,0xbb648000,0x361f39a8,0xbba88000,0x39133872,0x3b0eb9a8,0xbbf6323e
.long 0x3bd98000,0xbaa7b61f,0xb23e3c00,0x3872bb64,0xbbf68000,0x3ba8323e,0xb913b9a8,0x378b3aa7
.long 0x3c008000,0xbc008000,0x3c008000,0xbc008000,0xbbf68000,0x3ba8b23e,0xb91339a8,0x378bbaa7
.long 0x3bd98000,0xbaa7361f,0xb23ebc00,0x38723b64,0xbba88000,0x3913b872,0x3b0e39a8,0xbbf6b23e
.long 0x3b648000,0xb61f39a8,0xbb648000,0x361fb9a8,0xbb0e8000,0x2e46baa7,0x34a5b9a8,0x39133bd9
.long 0x3aa78000,0x323e3b64,0x38723c00,0xbbd9b61f,0xba2f8000,0xb78bbbd9,0xbbf6b9a8,0x34a5b872
.long 0x39a88000,0x39a83c00,0x39a88000,0x39a83c00,0xb9138000,0xbb0ebbd9,0x2e4639a8,0xbba8b872
.long 0x38728000,0x3bd93b64,0xbaa7bc00,0x323eb61f,0xb78b8000,0xbbf6baa7,0x3ba839a8,0x3a2f3bd9
.long 0x361f8000,0x3b6439a8,0xb61f8000,0xbb64b9a8,0xb4a58000,0xba2fb872,0xb78bb9a8,0x2e46b23e
.long 0x323e8000,0x3872361f,0x3bd93c00,0x3aa73b64,0xae468000,0xb4a5b23e,0xba2fb9a8,0xbb0ebaa7
.long 0x80008000,0x80008000,0x80008000,0x80008000,0xb78b361f,0xb9133872,0xbba83b64,0xbbf63bd9
.long 0x3aa7b9a8,0x3bd9bb64,0x3872b9a8,0x323eb61f,0xbbf63b64,0xbb0e3bd9,0x3913b61f,0x3ba8baa7
.long 0x3b64bc00,0x361fb9a8,0xbb643c00,0xb61f39a8,0xb9133b64,0x34a5323e,0xae46b61f,0xbb0e3872
.long 0x323eb9a8,0xbaa7361f,0x3bd9b9a8,0x3872bb64,0x34a5361f,0x3bf6baa7,0xb78b3b64,0x3a2fb23e
.long 0xb9a88000,0xb9a83c00,0xb9a88000,0xb9a83c00,0x3ba8b61f,0x2e46baa7,0x3b0ebb64,0xb913b23e
.long 0xbbd939a8,0x3872361f,0x323e39a8,0x3aa7bb64,0x3a2fbb64,0xbba8323e,0xbbf6361f,0x378b3872
.long 0xb61f3c00,0x3b64b9a8,0x361fbc00,0xbb6439a8,0xae46bb64,0xb78b3bd9,0x3a2f361f,0xb4a5baa7
.long 0x387239a8,0xb23ebb64,0xbaa739a8,0x3bd9b61f,0xbb0eb61f,0x3a2f3872,0xb4a5bb64,0x2e463bd9
.long 0x3c008000,0xbc008000,0x3c008000,0xbc008000,0xbb0e361f,0x3a2fb872,0xb4a53b64,0x2e46bbd9
.long 0x3872b9a8,0xb23e3b64,0xbaa7b9a8,0x3bd9361f,0xae463b64,0xb78bbbd9,0x3a2fb61f,0xb4a53aa7
.long 0xb61fbc00,0x3b6439a8,0x361f3c00,0xbb64b9a8,0x3a2f3b64,0xbba8b23e,0xbbf6b61f,0x378bb872
.long 0xbbd9b9a8,0x3872b61f,0x323eb9a8,0x3aa73b64,0x3ba8361f,0x2e463aa7,0x3b0e3b64,0xb913323e
.long 0xb9a88000,0xb9a8bc00,0xb9a88000,0xb9a8bc00,0x34a5b61f,0x3bf63aa7,0xb78bbb64,0x3a2f323e
.long 0x323e39a8,0xbaa7b61f,0x3bd939a8,0x38723b64,0xb913bb64,0x34a5b23e,0xae46361f,0xbb0eb872
.long 0x3b643c00,0x361f39a8,0xbb64bc00,0xb61fb9a8,0xbbf6bb64,0xbb0ebbd9,0x3913361f,0x3ba83aa7
.long 0x3aa739a8,0x3bd93b64,0x387239a8,0x323e361f,0xb78bb61f,0xb913b872,0xbba8bb64,0xbbf6bbd9
.long 0x80008000,0x80008000,0x80008000,0x80008000,0x3bf63c00,0x3ba83bd9,0x391339a8,0x378b3872
.long 0x323e8000,0x3872361f,0x3bd93c00,0x3aa73b64,0xbba8bc00,0xb913baa7,0x3b0e39a8,0x3bf63bd9
.long 0xb61f8000,0xbb64b9a8,0x361f8000,0x3b6439a8,0x3b0e3c00,0x2e463872,0xb4a5b9a8,0x3913323e
.long 0x38728000,0x3bd93b64,0xbaa7bc00,0x323eb61f,0xba2fbc00,0x378bb23e,0xbbf6b9a8,0xb4a5baa7
.long 0xb9a88000,0xb9a8bc00,0xb9a88000,0xb9a8bc00,0x39133c00,0xbb0eb23e,0xae4639a8,0xbba8baa7
.long 0x3aa78000,0x323e3b64,0x38723c00,0xbbd9b61f,0xb78bbc00,0x3bf63872,0x3ba839a8,0xba2f323e
.long 0xbb648000,0x361fb9a8,0x3b648000,0xb61f39a8,0x34a53c00,0xba2fbaa7,0x378bb9a8,0x2e463bd9
.long 0x3bd98000,0xbaa7361f,0xb23ebc00,0x38723b64,0xae46bc00,0x34a53bd9,0xba2fb9a8,0x3b0e3872
.long 0xbc008000,0x3c008000,0xbc008000,0x3c008000,0xae463c00,0x34a5bbd9,0xba2f39a8,0x3b0eb872
.long 0x3bd98000,0xbaa7b61f,0xb23e3c00,0x3872bb64,0x34a5bc00,0xba2f3aa7,0x378b39a8,0x2e46bbd9
.long 0xbb648000,0x361f39a8,0x3b648000,0xb61fb9a8,0xb78b3c00,0x3bf6b872,0x3ba8b9a8,0xba2fb23e
.long 0x3aa78000,0x323ebb64,0x3872bc00,0xbbd9361f,0x3913bc00,0xbb0e323e,0xae46b9a8,0xbba83aa7
.long 0xb9a88000,0xb9a83c00,0xb9a88000,0xb9a83c00,0xba2f3c00,0x378b323e,0xbbf639a8,0xb4a53aa7
.long 0x38728000,0x3bd9bb64,0xbaa73c00,0x323e361f,0x3b0ebc00,0x2e46b872,0xb4a539a8,0x3913b23e
.long 0xb61f8000,0xbb6439a8,0x361f8000,0x3b64b9a8,0xbba83c00,0xb9133aa7,0x3b0eb9a8,0x3bf6bbd9
.long 0x323e8000,0x3872b61f,0x3bd9bc00,0x3aa7bb64,0x3bf6bc00,0x3ba8bbd9,0x3913b9a8,0x378bb872
.long 0x80008000,0x80008000,0x80008000,0x80008000,0x3b0e3b64,0x3a2f3aa7,0x34a5361f,0x2e46323e
.long 0x3aa739a8,0x3bd93b64,0x387239a8,0x323e361f,0xae46b61f,0x378b323e,0x3a2f3b64,0x34a53872
.long 0xbb64bc00,0xb61fb9a8,0x3b643c00,0x361f39a8,0xba2fb61f,0xbba8bbd9,0x3bf63b64,0x378b3aa7
.long 0x323e39a8,0xbaa7b61f,0x3bd939a8,0x38723b64,0x3ba83b64,0xae463872,0x3b0e361f,0x39133bd9
.long 0x39a88000,0x39a83c00,0x39a88000,0x39a83c00,0xb4a5bb64,0x3bf63872,0x378bb61f,0x3a2f3bd9
.long 0xbbd9b9a8,0x3872b61f,0x323eb9a8,0x3aa73b64,0xb913361f,0xb4a5bbd9,0xae46bb64,0x3b0e3aa7
.long 0x361f3c00,0xbb64b9a8,0xb61fbc00,0x3b6439a8,0x3bf6361f,0xbb0e323e,0xb913bb64,0x3ba83872
.long 0x3872b9a8,0xb23e3b64,0xbaa7b9a8,0x3bd9361f,0xb78bbb64,0x39133aa7,0xbba8b61f,0x3bf6323e
.long 0xbc008000,0x3c008000,0xbc008000,0x3c008000,0xb78b3b64,0x3913baa7,0xbba8361f,0x3bf6b23e
.long 0x387239a8,0xb23ebb64,0xbaa739a8,0x3bd9b61f,0x3bf6b61f,0xbb0eb23e,0xb9133b64,0x3ba8b872
.long 0x361fbc00,0xbb6439a8,0xb61f3c00,0x3b64b9a8,0xb913b61f,0xb4a53bd9,0xae463b64,0x3b0ebaa7
.long 0xbbd939a8,0x3872361f,0x323e39a8,0x3aa7bb64,0xb4a53b64,0x3bf6b872,0x378b361f,0x3a2fbbd9
.long 0x39a88000,0x39a8bc00,0x39a88000,0x39a8bc00,0x3ba8bb64,0xae46b872,0x3b0eb61f,0x3913bbd9
.long 0x323eb9a8,0xbaa7361f,0x3bd9b9a8,0x3872bb64,0xba2f361f,0xbba83bd9,0x3bf6bb64,0x378bbaa7
.long 0xbb643c00,0xb61f39a8,0x3b64bc00,0x361fb9a8,0xae46361f,0x378bb23e,0x3a2fbb64,0x34a5b872
.long 0x3aa7b9a8,0x3bd9bb64,0x3872b9a8,0x323eb61f,0x3b0ebb64,0x3a2fbaa7,0x34a5b61f,0x2e46b23e
.long 0x80008000,0x80008000,0x80008000,0x80008000,0xbbf63c00,0xbba83bd9,0xb91339a8,0xb78b3872
.long 0xb23e8000,0xb872361f,0xbbd93c00,0xbaa73b64,0x3ba8bc00,0x3913baa7,0xbb0e39a8,0xbbf63bd9
.long 0x361f8000,0x3b64b9a8,0xb61f8000,0xbb6439a8,0xbb0e3c00,0xae463872,0x34a5b9a8,0xb913323e
.long 0xb8728000,0xbbd93b64,0x3aa7bc00,0xb23eb61f,0x3a2fbc00,0xb78bb23e,0x3bf6b9a8,0x34a5baa7
.long 0x39a88000,0x39a8bc00,0x39a88000,0x39a8bc00,0xb9133c00,0x3b0eb23e,0x2e4639a8,0x3ba8baa7
.long 0xbaa78000,0xb23e3b64,0xb8723c00,0x3bd9b61f,0x378bbc00,0xbbf63872,0xbba839a8,0x3a2f323e
.long 0x3b648000,0xb61fb9a8,0xbb648000,0x361f39a8,0xb4a53c00,0x3a2fbaa7,0xb78bb9a8,0xae463bd9
.long 0xbbd98000,0x3aa7361f,0x323ebc00,0xb8723b64,0x2e46bc00,0xb4a53bd9,0x3a2fb9a8,0xbb0e3872
.long 0x3c008000,0xbc008000,0x3c008000,0xbc008000,0x2e463c00,0xb4a5bbd9,0x3a2f39a8,0xbb0eb872
.long 0xbbd98000,0x3aa7b61f,0x323e3c00,0xb872bb64,0xb4a5bc00,0x3a2f3aa7,0xb78b39a8,0xae46bbd9
.long 0x3b648000,0xb61f39a8,0xbb648000,0x361fb9a8,0x378b3c00,0xbbf6b872,0xbba8b9a8,0x3a2fb23e
.long 0xbaa78000,0xb23ebb64,0xb872bc00,0x3bd9361f,0xb913bc00,0x3b0e323e,0x2e46b9a8,0x3ba83aa7
.long 0x39a88000,0x39a83c00,0x39a88000,0x39a83c00,0x3a2f3c00,0xb78b323e,0x3bf639a8,0x34a53aa7
.long 0xb8728000,0xbbd9bb64,0x3aa73c00,0xb23e361f,0xbb0ebc00,0xae46b872,0x34a539a8,0xb913b23e
.long 0x361f8000,0x3b6439a8,0xb61f8000,0xbb64b9a8,0x3ba83c00,0x39133aa7,0xbb0eb9a8,0xbbf6bbd9
.long 0xb23e8000,0xb872b61f,0xbbd9bc00,0xbaa7bb64,0xbbf6bc00,0xbba8bbd9,0xb913b9a8,0xb78bb872
.long 0x80008000,0x80008000,0x80008000,0x80008000,0xbb0e3b64,0xba2f3aa7,0xb4a5361f,0xae46323e
.long 0xbaa739a8,0xbbd93b64,0xb87239a8,0xb23e361f,0x2e46b61f,0xb78b323e,0xba2f3b64,0xb4a53872
.long 0x3b64bc00,0x361fb9a8,0xbb643c00,0xb61f39a8,0x3a2fb61f,0x3ba8bbd9,0xbbf63b64,0xb78b3aa7
.long 0xb23e39a8,0x3aa7b61f,0xbbd939a8,0xb8723b64,0xbba83b64,0x2e463872,0xbb0e361f,0xb9133bd9
.long 0xb9a88000,0xb9a83c00,0xb9a88000,0xb9a83c00,0x34a5bb64,0xbbf63872,0xb78bb61f,0xba2f3bd9
.long 0x3bd9b9a8,0xb872b61f,0xb23eb9a8,0xbaa73b64,0x3913361f,0x34a5bbd9,0x2e46bb64,0xbb0e3aa7
.long 0xb61f3c00,0x3b64b9a8,0x361fbc00,0xbb6439a8,0xbbf6361f,0x3b0e323e,0x3913bb64,0xbba83872
.long 0xb872b9a8,0x323e3b64,0x3aa7b9a8,0xbbd9361f,0x378bbb64,0xb9133aa7,0x3ba8b61f,0xbbf6323e
.long 0x3c008000,0xbc008000,0x3c008000,0xbc008000,0x378b3b64,0xb913baa7,0x3ba8361f,0xbbf6b23e
.long 0xb87239a8,0x323ebb64,0x3aa739a8,0xbbd9b61f,0xbbf6b61f,0x3b0eb23e,0x39133b64,0xbba8b872
.long 0xb61fbc00,0x3b6439a8,0x361f3c00,0xbb64b9a8,0x3913b61f,0x34a53bd9,0x2e463b64,0xbb0ebaa7
.long 0x3bd939a8,0xb872361f,0xb23e39a8,0xbaa7bb64,0x34a53b64,0xbbf6b872,0xb78b361f,0xba2fbbd9
.long 0xb9a88000,0xb9a8bc00,0xb9a88000,0xb9a8bc00,0xbba8bb64,0x2e46b872,0xbb0eb61f,0xb913bbd9
.long 0xb23eb9a8,0x3aa7361f,0xbbd9b9a8,0xb872bb64,0x3a2f361f,0x3ba83bd9,0xbbf6bb64,0xb78bbaa7
.long 0x3b643c00,0x361f39a8,0xbb64bc00,0xb61fb9a8,0x2e46361f,0xb78bb23e,0xba2fbb64,0xb4a5b872
.long 0xbaa7b9a8,0xbbd9bb64,0xb872b9a8,0xb23eb61f,0xbb0ebb64,0xba2fbaa7,0xb4a5b61f,0xae46b23e
.long 0x3c003c00,0x3c003c00,0x3c003c00,0x3c003c00,0x3bd93c00,0x3aa73b64,0xb23e0000,0xb872b61f
.long 0x3b643c00,0x361f39a8,0xbb64bc00,0xb61fb9a8,0x3aa73c00,0xb23e361f,0x38728000,0x3bd93b64
.long 0x39a83c00,0xb9a80000,0x39a83c00,0xb9a80000,0x38723c00,0xbbd9b61f,0xbaa70000,0xb23ebb64
.long 0x361f3c00,0xbb64b9a8,0xb61fbc00,0x3b6439a8,0x323e3c00,0xb872bb64,0x3bd98000,0xbaa7361f
.long 0x3c00,0x8000bc00,0x3c00,0x8000bc00,0xb23e3c00,0x3872bb64,0xbbd90000,0x3aa7361f
.long 0xb61f3c00,0x3b64b9a8,0x361fbc00,0xbb6439a8,0xb8723c00,0x3bd9b61f,0x3aa78000,0x323ebb64
.long 0xb9a83c00,0x39a88000,0xb9a83c00,0x39a88000,0xbaa73c00,0x323e361f,0xb8720000,0xbbd93b64
.long 0xbb643c00,0xb61f39a8,0x3b64bc00,0x361fb9a8,0xbbd93c00,0xbaa73b64,0x323e8000,0x3872b61f
.long 0xbc003c00,0xbc003c00,0xbc003c00,0xbc003c00,0xbbd93c00,0xbaa73b64,0x323e0000,0x3872b61f
.long 0xbb643c00,0xb61f39a8,0x3b64bc00,0x361fb9a8,0xbaa73c00,0x323e361f,0xb8728000,0xbbd93b64
.long 0xb9a83c00,0x39a80000,0xb9a83c00,0x39a80000,0xb8723c00,0x3bd9b61f,0x3aa70000,0x323ebb64
.long 0xb61f3c00,0x3b64b9a8,0x361fbc00,0xbb6439a8,0xb23e3c00,0x3872bb64,0xbbd98000,0x3aa7361f
.long 0x80003c00,0xbc00,0x80003c00,0xbc00,0x323e3c00,0xb872bb64,0x3bd90000,0xbaa7361f
.long 0x361f3c00,0xbb64b9a8,0xb61fbc00,0x3b6439a8,0x38723c00,0xbbd9b61f,0xbaa78000,0xb23ebb64
.long 0x39a83c00,0xb9a88000,0x39a83c00,0xb9a88000,0x3aa73c00,0xb23e361f,0x38720000,0x3bd93b64
.long 0x3b643c00,0x361f39a8,0xbb64bc00,0xb61fb9a8,0x3bd93c00,0x3aa73b64,0xb23e8000,0xb872b61f
.long 0x3c003c00,0x3c003c00,0x3c003c00,0x3c003c00,0x387239a8,0x323e361f,0xbaa7b9a8,0xbbd9bb64
.long 0xb61f0000,0xbb64b9a8,0x361f8000,0x3b6439a8,0xbbd9b9a8,0xb872bb64,0x323e39a8,0xbaa7b61f
.long 0xb9a8bc00,0x39a88000,0xb9a8bc00,0x39a88000,0x323eb9a8,0x3aa73b64,0x3bd939a8,0xb872361f
.long 0x3b648000,0xb61f39a8,0xbb640000,0x361fb9a8,0x3aa739a8,0xbbd9b61f,0x3872b9a8,0xb23e3b64
.long 0x3c00,0x8000bc00,0x3c00,0x8000bc00,0xbaa739a8,0x3bd9b61f,0xb872b9a8,0x323e3b64
.long 0xbb640000,0x361f39a8,0x3b648000,0xb61fb9a8,0xb23eb9a8,0xbaa73b64,0xbbd939a8,0x3872361f
.long 0x39a8bc00,0xb9a80000,0x39a8bc00,0xb9a80000,0x3bd9b9a8,0x3872bb64,0xb23e39a8,0x3aa7b61f
.long 0x361f8000,0x3b64b9a8,0xb61f0000,0xbb6439a8,0xb87239a8,0xb23e361f,0x3aa7b9a8,0x3bd9bb64
.long 0xbc003c00,0xbc003c00,0xbc003c00,0xbc003c00,0xb87239a8,0xb23e361f,0x3aa7b9a8,0x3bd9bb64
.long 0x361f0000,0x3b64b9a8,0xb61f8000,0xbb6439a8,0x3bd9b9a8,0x3872bb64,0xb23e39a8,0x3aa7b61f
.long 0x39a8bc00,0xb9a88000,0x39a8bc00,0xb9a88000,0xb23eb9a8,0xbaa73b64,0xbbd939a8,0x3872361f
.long 0xbb648000,0x361f39a8,0x3b640000,0xb61fb9a8,0xbaa739a8,0x3bd9b61f,0xb872b9a8,0x323e3b64
.long 0x80003c00,0xbc00,0x80003c00,0xbc00,0x3aa739a8,0xbbd9b61f,0x3872b9a8,0xb23e3b64
.long 0x3b640000,0xb61f39a8,0xbb648000,0x361fb9a8,0x323eb9a8,0x3aa73b64,0x3bd939a8,0xb872361f
.long 0xb9a8bc00,0x39a80000,0xb9a8bc00,0x39a80000,0xbbd9b9a8,0xb872bb64,0x323e39a8,0xbaa7b61f
.long 0xb61f8000,0xbb64b9a8,0x361f0000,0x3b6439a8,0x387239a8,0x323e361f,0xbaa7b9a8,0xbbd9bb64
.long 0x3c003c00,0x3c003c00,0x3c003c00,0x3c003c00,0xbbd9bc00,0xbaa7bb64,0x323e8000,0x3872361f
.long 0x3b643c00,0x361f39a8,0xbb64bc00,0xb61fb9a8,0xbaa7bc00,0x323eb61f,0xb8720000,0xbbd9bb64
.long 0x39a83c00,0xb9a80000,0x39a83c00,0xb9a80000,0xb872bc00,0x3bd9361f,0x3aa78000,0x323e3b64
.long 0x361f3c00,0xbb64b9a8,0xb61fbc00,0x3b6439a8,0xb23ebc00,0x38723b64,0xbbd90000,0x3aa7b61f
.long 0x3c00,0x8000bc00,0x3c00,0x8000bc00,0x323ebc00,0xb8723b64,0x3bd98000,0xbaa7b61f
.long 0xb61f3c00,0x3b64b9a8,0x361fbc00,0xbb6439a8,0x3872bc00,0xbbd9361f,0xbaa70000,0xb23e3b64
.long 0xb9a83c00,0x39a88000,0xb9a83c00,0x39a88000,0x3aa7bc00,0xb23eb61f,0x38728000,0x3bd9bb64
.long 0xbb643c00,0xb61f39a8,0x3b64bc00,0x361fb9a8,0x3bd9bc00,0x3aa7bb64,0xb23e0000,0xb872361f
.long 0xbc003c00,0xbc003c00,0xbc003c00,0xbc003c00,0x3bd9bc00,0x3aa7bb64,0xb23e8000,0xb872361f
.long 0xbb643c00,0xb61f39a8,0x3b64bc00,0x361fb9a8,0x3aa7bc00,0xb23eb61f,0x38720000,0x3bd9bb64
.long 0xb9a83c00,0x39a80000,0xb9a83c00,0x39a80000,0x3872bc00,0xbbd9361f,0xbaa78000,0xb23e3b64
.long 0xb61f3c00,0x3b64b9a8,0x361fbc00,0xbb6439a8,0x323ebc00,0xb8723b64,0x3bd90000,0xbaa7b61f
.long 0x80003c00,0xbc00,0x80003c00,0xbc00,0xb23ebc00,0x38723b64,0xbbd98000,0x3aa7b61f
.long 0x361f3c00,0xbb64b9a8,0xb61fbc00,0x3b6439a8,0xb872bc00,0x3bd9361f,0x3aa70000,0x323e3b64
.long 0x39a83c00,0xb9a88000,0x39a83c00,0xb9a88000,0xbaa7bc00,0x323eb61f,0xb8728000,0xbbd9bb64
.long 0x3b643c00,0x361f39a8,0xbb64bc00,0xb61fb9a8,0xbbd9bc00,0xbaa7bb64,0x323e0000,0x3872361f
.long 0x3c003c00,0x3c003c00,0x3c003c00,0x3c003c00,0xb872b9a8,0xb23eb61f,0x3aa739a8,0x3bd93b64
.long 0xb61f0000,0xbb64b9a8,0x361f8000,0x3b6439a8,0x3bd939a8,0x38723b64,0xb23eb9a8,0x3aa7361f
.long 0xb9a8bc00,0x39a88000,0xb9a8bc00,0x39a88000,0xb23e39a8,0xbaa7bb64,0xbbd9b9a8,0x3872b61f
.long 0x3b648000,0xb61f39a8,0xbb640000,0x361fb9a8,0xbaa7b9a8,0x3bd9361f,0xb87239a8,0x323ebb64
.long 0x3c00,0x8000bc00,0x3c00,0x8000bc00,0x3aa7b9a8,0xbbd9361f,0x387239a8,0xb23ebb64
.long 0xbb640000,0x361f39a8,0x3b648000,0xb61fb9a8,0x323e39a8,0x3aa7bb64,0x3bd9b9a8,0xb872b61f
.long 0x39a8bc00,0xb9a80000,0x39a8bc00,0xb9a80000,0xbbd939a8,0xb8723b64,0x323eb9a8,0xbaa7361f
.long 0x361f8000,0x3b64b9a8,0xb61f0000,0xbb6439a8,0x3872b9a8,0x323eb61f,0xbaa739a8,0xbbd93b64
.long 0xbc003c00,0xbc003c00,0xbc003c00,0xbc003c00,0x3872b9a8,0x323eb61f,0xbaa739a8,0xbbd93b64
.long 0x361f0000,0x3b64b9a8,0xb61f8000,0xbb6439a8,0xbbd939a8,0xb8723b64,0x323eb9a8,0xbaa7361f
.long 0x39a8bc00,0xb9a88000,0x39a8bc00,0xb9a88000,0x323e39a8,0x3aa7bb64,0x3bd9b9a8,0xb872b61f
.long 0xbb648000,0x361f39a8,0x3b640000,0xb61fb9a8,0x3aa7b9a8,0xbbd9361f,0x387239a8,0xb23ebb64
.long 0x80003c00,0xbc00,0x80003c00,0xbc00,0xbaa7b9a8,0x3bd9361f,0xb87239a8,0x323ebb64
.long 0x3b640000,0xb61f39a8,0xbb648000,0x361fb9a8,0xb23e39a8,0xbaa7bb64,0xbbd9b9a8,0x3872b61f
.long 0xb9a8bc00,0x39a80000,0xb9a8bc00,0x39a80000,0x3bd939a8,0x38723b64,0xb23eb9a8,0x3aa7361f
.long 0xb61f8000,0xbb64b9a8,0x361f0000,0x3b6439a8,0xb872b9a8,0xb23eb61f,0x3aa739a8,0x3bd93b64
.long 0x0,0x0,0x0,0x0,0x323e0000,0x3872361f,0x3bd93c00,0x3aa73b64
.long 0x361f0000,0x3b6439a8,0xb61f0000,0xbb64b9a8,0x38720000,0x3bd93b64,0xbaa7bc00,0x323eb61f
.long 0x39a80000,0x39a83c00,0x39a80000,0x39a83c00,0x3aa70000,0x323e3b64,0x38723c00,0xbbd9b61f
.long 0x3b640000,0xb61f39a8,0xbb640000,0x361fb9a8,0x3bd90000,0xbaa7361f,0xb23ebc00,0x38723b64
.long 0x3c000000,0xbc000000,0x3c000000,0xbc000000,0x3bd90000,0xbaa7b61f,0xb23e3c00,0x3872bb64
.long 0x3b640000,0xb61fb9a8,0xbb640000,0x361f39a8,0x3aa70000,0x323ebb64,0x3872bc00,0xbbd9361f
.long 0x39a80000,0x39a8bc00,0x39a80000,0x39a8bc00,0x38720000,0x3bd9bb64,0xbaa73c00,0x323e361f
.long 0x361f0000,0x3b64b9a8,0xb61f0000,0xbb6439a8,0x323e0000,0x3872b61f,0x3bd9bc00,0x3aa7bb64
.long 0x0,0x0,0x0,0x0,0xb23e0000,0xb872361f,0xbbd93c00,0xbaa73b64
.long 0xb61f0000,0xbb6439a8,0x361f0000,0x3b64b9a8,0xb8720000,0xbbd93b64,0x3aa7bc00,0xb23eb61f
.long 0xb9a80000,0xb9a83c00,0xb9a80000,0xb9a83c00,0xbaa70000,0xb23e3b64,0xb8723c00,0x3bd9b61f
.long 0xbb640000,0x361f39a8,0x3b640000,0xb61fb9a8,0xbbd90000,0x3aa7361f,0x323ebc00,0xb8723b64
.long 0xbc000000,0x3c000000,0xbc000000,0x3c000000,0xbbd90000,0x3aa7b61f,0x323e3c00,0xb872bb64
.long 0xbb640000,0x361fb9a8,0x3b640000,0xb61f39a8,0xbaa70000,0xb23ebb64,0xb872bc00,0x3bd9361f
.long 0xb9a80000,0xb9a8bc00,0xb9a80000,0xb9a8bc00,0xb8720000,0xbbd9bb64,0x3aa73c00,0xb23e361f
.long 0xb61f0000,0xbb64b9a8,0x361f0000,0x3b6439a8,0xb23e0000,0xb872b61f,0xbbd9bc00,0xbaa7bb64
.long 0x0,0x0,0x0,0x0,0x3aa739a8,0x3bd93b64,0x387239a8,0x323e361f
.long 0x3b643c00,0x361f39a8,0xbb64bc00,0xb61fb9a8,0x323e39a8,0xbaa7b61f,0x3bd939a8,0x38723b64
.long 0xb9a80000,0xb9a8bc00,0xb9a80000,0xb9a8bc00,0xbbd9b9a8,0x3872b61f,0x323eb9a8,0x3aa73b64
.long 0xb61fbc00,0x3b6439a8,0x361f3c00,0xbb64b9a8,0x3872b9a8,0xb23e3b64,0xbaa7b9a8,0x3bd9361f
.long 0x3c000000,0xbc000000,0x3c000000,0xbc000000,0x387239a8,0xb23ebb64,0xbaa739a8,0x3bd9b61f
.long 0xb61f3c00,0x3b64b9a8,0x361fbc00,0xbb6439a8,0xbbd939a8,0x3872361f,0x323e39a8,0x3aa7bb64
.long 0xb9a80000,0xb9a83c00,0xb9a80000,0xb9a83c00,0x323eb9a8,0xbaa7361f,0x3bd9b9a8,0x3872bb64
.long 0x3b64bc00,0x361fb9a8,0xbb643c00,0xb61f39a8,0x3aa7b9a8,0x3bd9bb64,0x3872b9a8,0x323eb61f
.long 0x0,0x0,0x0,0x0,0xbaa739a8,0xbbd93b64,0xb87239a8,0xb23e361f
.long 0xbb643c00,0xb61f39a8,0x3b64bc00,0x361fb9a8,0xb23e39a8,0x3aa7b61f,0xbbd939a8,0xb8723b64
.long 0x39a80000,0x39a8bc00,0x39a80000,0x39a8bc00,0x3bd9b9a8,0xb872b61f,0xb23eb9a8,0xbaa73b64
.long 0x361fbc00,0xbb6439a8,0xb61f3c00,0x3b64b9a8,0xb872b9a8,0x323e3b64,0x3aa7b9a8,0xbbd9361f
.long 0xbc000000,0x3c000000,0xbc000000,0x3c000000,0xb87239a8,0x323ebb64,0x3aa739a8,0xbbd9b61f
.long 0x361f3c00,0xbb64b9a8,0xb61fbc00,0x3b6439a8,0x3bd939a8,0xb872361f,0xb23e39a8,0xbaa7bb64
.long 0x39a80000,0x39a83c00,0x39a80000,0x39a83c00,0xb23eb9a8,0x3aa7361f,0xbbd9b9a8,0xb872bb64
.long 0xbb64bc00,0xb61fb9a8,0x3b643c00,0x361f39a8,0xbaa7b9a8,0xbbd9bb64,0xb872b9a8,0xb23eb61f
.long 0x0,0x0,0x0,0x0,0xb23e0000,0xb872b61f,0xbbd9bc00,0xbaa7bb64
.long 0x361f0000,0x3b6439a8,0xb61f0000,0xbb64b9a8,0xb8720000,0xbbd9bb64,0x3aa73c00,0xb23e361f
.long 0x39a80000,0x39a83c00,0x39a80000,0x39a83c00,0xbaa70000,0xb23ebb64,0xb872bc00,0x3bd9361f
.long 0x3b640000,0xb61f39a8,0xbb640000,0x361fb9a8,0xbbd90000,0x3aa7b61f,0x323e3c00,0xb872bb64
.long 0x3c000000,0xbc000000,0x3c000000,0xbc000000,0xbbd90000,0x3aa7361f,0x323ebc00,0xb8723b64
.long 0x3b640000,0xb61fb9a8,0xbb640000,0x361f39a8,0xbaa70000,0xb23e3b64,0xb8723c00,0x3bd9b61f
.long 0x39a80000,0x39a8bc00,0x39a80000,0x39a8bc00,0xb8720000,0xbbd93b64,0x3aa7bc00,0xb23eb61f
.long 0x361f0000,0x3b64b9a8,0xb61f0000,0xbb6439a8,0xb23e0000,0xb872361f,0xbbd93c00,0xbaa73b64
.long 0x0,0x0,0x0,0x0,0x323e0000,0x3872b61f,0x3bd9bc00,0x3aa7bb64
.long 0xb61f0000,0xbb6439a8,0x361f0000,0x3b64b9a8,0x38720000,0x3bd9bb64,0xbaa73c00,0x323e361f
.long 0xb9a80000,0xb9a83c00,0xb9a80000,0xb9a83c00,0x3aa70000,0x323ebb64,0x3872bc00,0xbbd9361f
.long 0xbb640000,0x361f39a8,0x3b640000,0xb61fb9a8,0x3bd90000,0xbaa7b61f,0xb23e3c00,0x3872bb64
.long 0xbc000000,0x3c000000,0xbc000000,0x3c000000,0x3bd90000,0xbaa7361f,0xb23ebc00,0x38723b64
.long 0xbb640000,0x361fb9a8,0x3b640000,0xb61f39a8,0x3aa70000,0x323e3b64,0x38723c00,0xbbd9b61f
.long 0xb9a80000,0xb9a8bc00,0xb9a80000,0xb9a8bc00,0x38720000,0x3bd93b64,0xbaa7bc00,0x323eb61f
.long 0xb61f0000,0xbb64b9a8,0x361f0000,0x3b6439a8,0x323e0000,0x3872361f,0x3bd93c00,0x3aa73b64
.long 0x0,0x0,0x0,0x0,0xbaa7b9a8,0xbbd9bb64,0xb872b9a8,0xb23eb61f
.long 0x3b643c00,0x361f39a8,0xbb64bc00,0xb61fb9a8,0xb23eb9a8,0x3aa7361f,0xbbd9b9a8,0xb872bb64
.long 0xb9a80000,0xb9a8bc00,0xb9a80000,0xb9a8bc00,0x3bd939a8,0xb872361f,0xb23e39a8,0xbaa7bb64
.long 0xb61fbc00,0x3b6439a8,0x361f3c00,0xbb64b9a8,0xb87239a8,0x323ebb64,0x3aa739a8,0xbbd9b61f
.long 0x3c000000,0xbc000000,0x3c000000,0xbc000000,0xb872b9a8,0x323e3b64,0x3aa7b9a8,0xbbd9361f
.long 0xb61f3c00,0x3b64b9a8,0x361fbc00,0xbb6439a8,0x3bd9b9a8,0xb872b61f,0xb23eb9a8,0xbaa73b64
.long 0xb9a80000,0xb9a83c00,0xb9a80000,0xb9a83c00,0xb23e39a8,0x3aa7b61f,0xbbd939a8,0xb8723b64
.long 0x3b64bc00,0x361fb9a8,0xbb643c00,0xb61f39a8,0xbaa739a8,0xbbd93b64,0xb87239a8,0xb23e361f
.long 0x0,0x0,0x0,0x0,0x3aa7b9a8,0x3bd9bb64,0x3872b9a8,0x323eb61f
.long 0xbb643c00,0xb61f39a8,0x3b64bc00,0x361fb9a8,0x323eb9a8,0xbaa7361f,0x3bd9b9a8,0x3872bb64
.long 0x39a80000,0x39a8bc00,0x39a80000,0x39a8bc00,0xbbd939a8,0x3872361f,0x323e39a8,0x3aa7bb64
.long 0x361fbc00,0xbb6439a8,0xb61f3c00,0x3b64b9a8,0x387239a8,0xb23ebb64,0xbaa739a8,0x3bd9b61f
.long 0xbc000000,0x3c000000,0xbc000000,0x3c000000,0x3872b9a8,0xb23e3b64,0xbaa7b9a8,0x3bd9361f
.long 0x361f3c00,0xbb64b9a8,0xb61fbc00,0x3b6439a8,0xbbd9b9a8,0x3872b61f,0x323eb9a8,0x3aa73b64
.long 0x39a80000,0x39a83c00,0x39a80000,0x39a83c00,0x323e39a8,0xbaa7b61f,0x3bd939a8,0x38723b64
.long 0xbb64bc00,0xb61fb9a8,0x3b643c00,0x361f39a8,0x3aa739a8,0x3bd93b64,0x387239a8,0x323e361f
.long 0x80008000,0x80008000,0x80008000,0x80008000,0xb23e8000,0xb872b61f,0xbbd9bc00,0xbaa7bb64
.long 0xb61f8000,0xbb64b9a8,0x361f8000,0x3b6439a8,0xb8728000,0xbbd9bb64,0x3aa73c00,0xb23e361f
.long 0xb9a88000,0xb9a8bc00,0xb9a88000,0xb9a8bc00,0xbaa78000,0xb23ebb64,0xb872bc00,0x3bd9361f
.long 0xbb648000,0x361fb9a8,0x3b648000,0xb61f39a8,0xbbd98000,0x3aa7b61f,0x323e3c00,0xb872bb64
.long 0xbc008000,0x3c008000,0xbc008000,0x3c008000,0xbbd98000,0x3aa7361f,0x323ebc00,0xb8723b64
.long 0xbb648000,0x361f39a8,0x3b648000,0xb61fb9a8,0xbaa78000,0xb23e3b64,0xb8723c00,0x3bd9b61f
.long 0xb9a88000,0xb9a83c00,0xb9a88000,0xb9a83c00,0xb8728000,0xbbd93b64,0x3aa7bc00,0xb23eb61f
.long 0xb61f8000,0xbb6439a8,0x361f8000,0x3b64b9a8,0xb23e8000,0xb872361f,0xbbd93c00,0xbaa73b64
.long 0x80008000,0x80008000,0x80008000,0x80008000,0x323e8000,0x3872b61f,0x3bd9bc00,0x3aa7bb64
.long 0x361f8000,0x3b64b9a8,0xb61f8000,0xbb6439a8,0x38728000,0x3bd9bb64,0xbaa73c00,0x323e361f
.long 0x39a88000,0x39a8bc00,0x39a88000,0x39a8bc00,0x3aa78000,0x323ebb64,0x3872bc00,0xbbd9361f
.long 0x3b648000,0xb61fb9a8,0xbb648000,0x361f39a8,0x3bd98000,0xbaa7b61f,0xb23e3c00,0x3872bb64
.long 0x3c008000,0xbc008000,0x3c008000,0xbc008000,0x3bd98000,0xbaa7361f,0xb23ebc00,0x38723b64
.long 0x3b648000,0xb61f39a8,0xbb648000,0x361fb9a8,0x3aa78000,0x323e3b64,0x38723c00,0xbbd9b61f
.long 0x39a88000,0x39a83c00,0x39a88000,0x39a83c00,0x38728000,0x3bd93b64,0xbaa7bc00,0x323eb61f
.long 0x361f8000,0x3b6439a8,0xb61f8000,0xbb64b9a8,0x323e8000,0x3872361f,0x3bd93c00,0x3aa73b64
.long 0x80008000,0x80008000,0x80008000,0x80008000,0xbaa7b9a8,0xbbd9bb64,0xb872b9a8,0xb23eb61f
.long 0xbb64bc00,0xb61fb9a8,0x3b643c00,0x361f39a8,0xb23eb9a8,0x3aa7361f,0xbbd9b9a8,0xb872bb64
.long 0x39a88000,0x39a83c00,0x39a88000,0x39a83c00,0x3bd939a8,0xb872361f,0xb23e39a8,0xbaa7bb64
.long 0x361f3c00,0xbb64b9a8,0xb61fbc00,0x3b6439a8,0xb87239a8,0x323ebb64,0x3aa739a8,0xbbd9b61f
.long 0xbc008000,0x3c008000,0xbc008000,0x3c008000,0xb872b9a8,0x323e3b64,0x3aa7b9a8,0xbbd9361f
.long 0x361fbc00,0xbb6439a8,0xb61f3c00,0x3b64b9a8,0x3bd9b9a8,0xb872b61f,0xb23eb9a8,0xbaa73b64
.long 0x39a88000,0x39a8bc00,0x39a88000,0x39a8bc00,0xb23e39a8,0x3aa7b61f,0xbbd939a8,0xb8723b64
.long 0xbb643c00,0xb61f39a8,0x3b64bc00,0x361fb9a8,0xbaa739a8,0xbbd93b64,0xb87239a8,0xb23e361f
.long 0x80008000,0x80008000,0x80008000,0x80008000,0x3aa7b9a8,0x3bd9bb64,0x3872b9a8,0x323eb61f
.long 0x3b64bc00,0x361fb9a8,0xbb643c00,0xb61f39a8,0x323eb9a8,0xbaa7361f,0x3bd9b9a8,0x3872bb64
.long 0xb9a88000,0xb9a83c00,0xb9a88000,0xb9a83c00,0xbbd939a8,0x3872361f,0x323e39a8,0x3aa7bb64
.long 0xb61f3c00,0x3b64b9a8,0x361fbc00,0xbb6439a8,0x387239a8,0xb23ebb64,0xbaa739a8,0x3bd9b61f
.long 0x3c008000,0xbc008000,0x3c008000,0xbc008000,0x3872b9a8,0xb23e3b64,0xbaa7b9a8,0x3bd9361f
.long 0xb61fbc00,0x3b6439a8,0x361f3c00,0xbb64b9a8,0xbbd9b9a8,0x3872b61f,0x323eb9a8,0x3aa73b64
.long 0xb9a88000,0xb9a8bc00,0xb9a88000,0xb9a8bc00,0x323e39a8,0xbaa7b61f,0x3bd939a8,0x38723b64
.long 0x3b643c00,0x361f39a8,0xbb64bc00,0xb61fb9a8,0x3aa739a8,0x3bd93b64,0x387239a8,0x323e361f
.long 0x80008000,0x80008000,0x80008000,0x80008000,0x323e8000,0x3872361f,0x3bd93c00,0x3aa73b64
.long 0xb61f8000,0xbb64b9a8,0x361f8000,0x3b6439a8,0x38728000,0x3bd93b64,0xbaa7bc00,0x323eb61f
.long 0xb9a88000,0xb9a8bc00,0xb9a88000,0xb9a8bc00,0x3aa78000,0x323e3b64,0x38723c00,0xbbd9b61f
.long 0xbb648000,0x361fb9a8,0x3b648000,0xb61f39a8,0x3bd98000,0xbaa7361f,0xb23ebc00,0x38723b64
.long 0xbc008000,0x3c008000,0xbc008000,0x3c008000,0x3bd98000,0xbaa7b61f,0xb23e3c00,0x3872bb64
.long 0xbb648000,0x361f39a8,0x3b648000,0xb61fb9a8,0x3aa78000,0x323ebb64,0x3872bc00,0xbbd9361f
.long 0xb9a88000,0xb9a83c00,0xb9a88000,0xb9a83c00,0x38728000,0x3bd9bb64,0xbaa73c00,0x323e361f
.long 0xb61f8000,0xbb6439a8,0x361f8000,0x3b64b9a8,0x323e8000,0x3872b61f,0x3bd9bc00,0x3aa7bb64
.long 0x80008000,0x80008000,0x80008000,0x80008000,0xb23e8000,0xb872361f,0xbbd93c00,0xbaa73b64
.long 0x361f8000,0x3b64b9a8,0xb61f8000,0xbb6439a8,0xb8728000,0xbbd93b64,0x3aa7bc00,0xb23eb61f
.long 0x39a88000,0x39a8bc00,0x39a88000,0x39a8bc00,0xbaa78000,0xb23e3b64,0xb8723c00,0x3bd9b61f
.long 0x3b648000,0xb61fb9a8,0xbb648000,0x361f39a8,0xbbd98000,0x3aa7361f,0x323ebc00,0xb8723b64
.long 0x3c008000,0xbc008000,0x3c008000,0xbc008000,0xbbd98000,0x3aa7b61f,0x323e3c00,0xb872bb64
.long 0x3b648000,0xb61f39a8,0xbb648000,0x361fb9a8,0xbaa78000,0xb23ebb64,0xb872bc00,0x3bd9361f
.long 0x39a88000,0x39a83c00,0x39a88000,0x39a83c00,0xb8728000,0xbbd9bb64,0x3aa73c00,0xb23e361f
.long 0x361f8000,0x3b6439a8,0xb61f8000,0xbb64b9a8,0xb23e8000,0xb872b61f,0xbbd9bc00,0xbaa7bb64
.long 0x80008000,0x80008000,0x80008000,0x80008000,0x3aa739a8,0x3bd93b64,0x387239a8,0x323e361f
.long 0xbb64bc00,0xb61fb9a8,0x3b643c00,0x361f39a8,0x323e39a8,0xbaa7b61f,0x3bd939a8,0x38723b64
.long 0x39a88000,0x39a83c00,0x39a88000,0x39a83c00,0xbbd9b9a8,0x3872b61f,0x323eb9a8,0x3aa73b64
.long 0x361f3c00,0xbb64b9a8,0xb61fbc00,0x3b6439a8,0x3872b9a8,0xb23e3b64,0xbaa7b9a8,0x3bd9361f
.long 0xbc008000,0x3c008000,0xbc008000,0x3c008000,0x387239a8,0xb23ebb64,0xbaa739a8,0x3bd9b61f
.long 0x361fbc00,0xbb6439a8,0xb61f3c00,0x3b64b9a8,0xbbd939a8,0x3872361f,0x323e39a8,0x3aa7bb64
.long 0x39a88000,0x39a8bc00,0x39a88000,0x39a8bc00,0x323eb9a8,0xbaa7361f,0x3bd9b9a8,0x3872bb64
.long 0xbb643c00,0xb61f39a8,0x3b64bc00,0x361fb9a8,0x3aa7b9a8,0x3bd9bb64,0x3872b9a8,0x323eb61f
.long 0x80008000,0x80008000,0x80008000,0x80008000,0xbaa739a8,0xbbd93b64,0xb87239a8,0xb23e361f
.long 0x3b64bc00,0x361fb9a8,0xbb643c00,0xb61f39a8,0xb23e39a8,0x3aa7b61f,0xbbd939a8,0xb8723b64
.long 0xb9a88000,0xb9a83c00,0xb9a88000,0xb9a83c00,0x3bd9b9a8,0xb872b61f,0xb23eb9a8,0xbaa73b64
.long 0xb61f3c00,0x3b64b9a8,0x361fbc00,0xbb6439a8,0xb872b9a8,0x323e3b64,0x3aa7b9a8,0xbbd9361f
.long 0x3c008000,0xbc008000,0x3c008000,0xbc008000,0xb87239a8,0x323ebb64,0x3aa739a8,0xbbd9b61f
.long 0xb61fbc00,0x3b6439a8,0x361f3c00,0xbb64b9a8,0x3bd939a8,0xb872361f,0xb23e39a8,0xbaa7bb64
.long 0xb9a88000,0xb9a8bc00,0xb9a88000,0xb9a8bc00,0xb23eb9a8,0x3aa7361f,0xbbd9b9a8,0xb872bb64
.long 0x3b643c00,0x361f39a8,0xbb64bc00,0xb61fb9a8,0xbaa7b9a8,0xbbd9bb64,0xb872b9a8,0xb23eb61f
.long 0x3e000000,0x3e000000,0x3e000000,0x3e000000,0x3e000000,0x3dffffb1,0x3dfffec4,0x3dfffd39
.long 0x3e000000,0x3dfffec4,0x3dfffb11,0x3dfff4e6,0x3e000000,0x3dfffd39,0x3dfff4e6,0x3dffe705
.long 0x3e000000,0x3dfffb11,0x3dffec43,0x3dffd397,0x3e000000,0x3dfff84a,0x3dffe129,0x3dffba9e
.long 0x3e000000,0x3dfff4e6,0x3dffd397,0x3dff9c18,0x3e000000,0x3dfff0e3,0x3dffc38f,0x3dff7808
.long 0x3e000000,0x3dffec43,0x3dffb10f,0x3dff4e6d,0x3e000000,0x3dffe705,0x3dff9c18,0x3dff1f49
.long 0x3e000000,0x3dffe129,0x3dff84ab,0x3dfeea9d,0x3e000000,0x3dffdaaf,0x3dff6ac7,0x3dfeb069
.long 0x3e000000,0x3dffd397,0x3dff4e6d,0x3dfe70b0,0x3e000000,0x3dffcbe2,0x3dff2f9d,0x3dfe2b72
.long 0x3e000000,0x3dffc38f,0x3dff0e58,0x3dfde0b1,0x3e000000,0x3dffba9e,0x3dfeea9d,0x3dfd906e
.long 0x3e000000,0x3dffb10f,0x3dfec46d,0x3dfd3aac,0x3e000000,0x3dffa6e3,0x3dfe9bc9,0x3dfcdf6c
.long 0x3e000000,0x3dff9c18,0x3dfe70b0,0x3dfc7eb0,0x3e000000,0x3dff90b1,0x3dfe4323,0x3dfc187a
.long 0x3e000000,0x3dff84ab,0x3dfe1324,0x3dfbaccd,0x3e000000,0x3dff7808,0x3dfde0b1,0x3dfb3bab
.long 0x3e000000,0x3dff6ac7,0x3dfdabcc,0x3dfac516,0x3e000000,0x3dff5ce9,0x3dfd7474,0x3dfa4910
.long 0x3e000000,0x3dff4e6d,0x3dfd3aac,0x3df9c79d,0x3e000000,0x3dff3f54,0x3dfcfe73,0x3df940c0
.long 0x3e000000,0x3dff2f9d,0x3dfcbfc9,0x3df8b47b,0x3e000000,0x3dff1f49,0x3dfc7eb0,0x3df822d1
.long 0x3e000000,0x3dff0e58,0x3dfc3b28,0x3df78bc5,0x3e000000,0x3dfefcc9,0x3dfbf531,0x3df6ef5b
.long 0x3e000000,0x3dfeea9d,0x3dfbaccd,0x3df64d97,0x3e000000,0x3dfed7d4,0x3dfb61fc,0x3df5a67b
.long 0x3e000000,0x3e000000,0x3e000000,0x3e000000,0x3dfffb11,0x3dfff84a,0x3dfff4e6,0x3dfff0e3
.long 0x3dffec43,0x3dffe129,0x3dffd397,0x3dffc38f,0x3dffd397,0x3dffba9e,0x3dff9c18,0x3dff7808
.long 0x3dffb10f,0x3dff84ab,0x3dff4e6d,0x3dff0e58,0x3dff84ab,0x3dff3f54,0x3dfeea9d,0x3dfe868b
.long 0x3dff4e6d,0x3dfeea9d,0x3dfe70b0,0x3dfde0b1,0x3dff0e58,0x3dfe868b,0x3dfde0b1,0x3dfd1cdd
.long 0x3dfec46d,0x3dfe1324,0x3dfd3aac,0x3dfc3b28,0x3dfe70b0,0x3dfd906e,0x3dfc7eb0,0x3dfb3bab
.long 0x3dfe1324,0x3dfcfe73,0x3dfbaccd,0x3dfa1e84,0x3dfdabcc,0x3dfc5d3a,0x3dfac516,0x3df8e3d6
.long 0x3dfd3aac,0x3dfbaccd,0x3df9c79d,0x3df78bc5,0x3dfcbfc9,0x3dfaed37,0x3df8b47b,0x3df6167a
.long 0x3dfc3b28,0x3dfa1e84,0x3df78bc5,0x3df48422,0x3dfbaccd,0x3df940c0,0x3df64d97,0x3df2d4eb
.long 0x3dfb14be,0x3df853f8,0x3df4fa0b,0x3df10908,0x3dfa7302,0x3df7583a,0x3df3913f,0x3def20b0
.long 0x3df9c79d,0x3df64d97,0x3df21352,0x3ded1c1d,0x3df91298,0x3df5341d,0x3df08066,0x3deafb8c
.long 0x3df853f8,0x3df40bdd,0x3deed89e,0x3de8bf3c,0x3df78bc5,0x3df2d4eb,0x3ded1c1d,0x3de66771
.long 0x3df6ba07,0x3df18f57,0x3deb4b0c,0x3de3f473,0x3df5dec6,0x3df03b37,0x3de96591,0x3de1668a
.long 0x3df4fa0b,0x3deed89e,0x3de76bd8,0x3ddebe05,0x3df40bdd,0x3ded67a1,0x3de55e0b,0x3ddbfb34
.long 0x3df31447,0x3debe858,0x3de33c5a,0x3dd91e6a,0x3df21352,0x3dea5ad9,0x3de106f2,0x3dd627fe
.long 0x3df10908,0x3de8bf3c,0x3ddebe05,0x3dd31849,0x3deff573,0x3de71599,0x3ddc61c7,0x3dcfefa8
.long 0x3deed89e,0x3de55e0b,0x3dd9f26a,0x3dccae79,0x3dedb293,0x3de398ac,0x3dd77026,0x3dc95521
.long 0x3e000000,0x3e000000,0x3e000000,0x3e000000,0x3dffec43,0x3dffe705,0x3dffe129,0x3dffdaaf
.long 0x3dffb10f,0x3dff9c18,0x3dff84ab,0x3dff6ac7,0x3dff4e6d,0x3dff1f49,0x3dfeea9d,0x3dfeb069
.long 0x3dfec46d,0x3dfe70b0,0x3dfe1324,0x3dfdabcc,0x3dfe1324,0x3dfd906e,0x3dfcfe73,0x3dfc5d3a
.long 0x3dfd3aac,0x3dfc7eb0,0x3dfbaccd,0x3dfac516,0x3dfc3b28,0x3dfb3bab,0x3dfa1e84,0x3df8e3d6
.long 0x3dfb14be,0x3df9c79d,0x3df853f8,0x3df6ba07,0x3df9c79d,0x3df822d1,0x3df64d97,0x3df4484b
.long 0x3df853f8,0x3df64d97,0x3df40bdd,0x3df18f57,0x3df6ba07,0x3df4484b,0x3df18f57,0x3dee8ff8
.long 0x3df4fa0b,0x3df21352,0x3deed89e,0x3deb4b0c,0x3df31447,0x3defaf1b,0x3debe858,0x3de7c187
.long 0x3df10908,0x3ded1c1d,0x3de8bf3c,0x3de3f473,0x3deed89e,0x3dea5ad9,0x3de55e0b,0x3ddfe4e9
.long 0x3dec835e,0x3de76bd8,0x3de1c598,0x3ddb941a,0x3dea09a7,0x3de44fac,0x3dddf6be,0x3dd70348
.long 0x3de76bd8,0x3de106f2,0x3dd9f26a,0x3dd233c6,0x3de4aa59,0x3ddd924d,0x3dd5b993,0x3dcd26fd
.long 0x3de1c598,0x3dd9f26a,0x3dd14d3d,0x3dc7de65,0x3ddebe05,0x3dd627fe,0x3dccae79,0x3dc25b89
.long 0x3ddb941a,0x3dd233c6,0x3dc7de65,0x3dbca003,0x3dd84853,0x3dce1689,0x3dc2de29,0x3db6ad7f
.long 0x3dd4db31,0x3dc9d112,0x3dbdaef9,0x3db085bb,0x3dd14d3d,0x3dc56439,0x3db85216,0x3daa2a80
.long 0x3dcd9f02,0x3dc0d0da,0x3db2c8c9,0x3da39da9,0x3dc9d112,0x3dbc17d9,0x3dad1469,0x3d9ce11f
.long 0x3dc5e403,0x3db73a23,0x3da73656,0x3d95f6d9,0x3dc1d870,0x3db238aa,0x3da12ff9,0x3d8ee0db
.long 0x3dbdaef9,0x3dad1469,0x3d9b02c6,0x3d87a136,0x3db96842,0x3da7ce61,0x3d94b039,0x3d803a06
.long 0x3e000000,0x3e000000,0x3e000000,0x3e000000,0x3dffd397,0x3dffcbe2,0x3dffc38f,0x3dffba9e
.long 0x3dff4e6d,0x3dff2f9d,0x3dff0e58,0x3dfeea9d,0x3dfe70b0,0x3dfe2b72,0x3dfde0b1,0x3dfd906e
.long 0x3dfd3aac,0x3dfcbfc9,0x3dfc3b28,0x3dfbaccd,0x3dfbaccd,0x3dfaed37,0x3dfa1e84,0x3df940c0
.long 0x3df9c79d,0x3df8b47b,0x3df78bc5,0x3df64d97,0x3df78bc5,0x3df6167a,0x3df48422,0x3df2d4eb
.long 0x3df4fa0b,0x3df31447,0x3df10908,0x3deed89e,0x3df21352,0x3defaf1b,0x3ded1c1d,0x3dea5ad9
.long 0x3deed89e,0x3debe858,0x3de8bf3c,0x3de55e0b,0x3deb4b0c,0x3de7c187,0x3de3f473,0x3ddfe4e9
.long 0x3de76bd8,0x3de33c5a,0x3ddebe05,0x3dd9f26a,0x3de33c5a,0x3dde5aa6,0x3dd91e6a,0x3dd389c7
.long 0x3ddebe05,0x3dd91e6a,0x3dd31849,0x3dccae79,0x3dd9f26a,0x3dd389c7,0x3dccae79,0x3dc56439
.long 0x3dd4db31,0x3dcd9f02,0x3dc5e403,0x3dbdaef9,0x3dcf7a1f,0x3dc76085,0x3dbebc1b,0x3db592e7
.long 0x3dc9d112,0x3dc0d0da,0x3db73a23,0x3dad1469,0x3dc3e200,0x3db9f2ac,0x3daf61a5,0x3da4381a
.long 0x3dbdaef9,0x3db2c8c9,0x3da73656,0x3d9b02c6,0x3db73a23,0x3dab561b,0x3d9ebc12,0x3d91796b
.long 0x3db085bb,0x3da39da9,0x3d95f6d9,0x3d87a136,0x3da99415,0x3d9ba299,0x3d8cead0,0x3d7afef7
.long 0x3da26799,0x3d93682a,0x3d839c3d,0x3d663375,0x3d9b02c6,0x3d8af1b7,0x3d741f07,0x3d50eb2a
.long 0x3d93682a,0x3d8242b1,0x3d60924f,0x3d3b31a0,0x3d8b9a6b,0x3d72bd43,0x3d4c9b8b,0x3d25129f
.long 0x3d839c3d,0x3d60924f,0x3d38442a,0x3d0e9a22,0x3d76e0cb,0x3d4e0bea,0x3d2395c5,0x3cefa8b2
.long 0x3d663375,0x3d3b31a0,0x3d0e9a22,0x3cc19b37,0x3d553641,0x3d280b1f,0x3cf2b651,0x3c9324ca
.long 0x3e000000,0x3e000000,0x3e000000,0x3e000000,0x3dffb10f,0x3dffa6e3,0x3dff9c18,0x3dff90b1
.long 0x3dfec46d,0x3dfe9bc9,0x3dfe70b0,0x3dfe4323,0x3dfd3aac,0x3dfcdf6c,0x3dfc7eb0,0x3dfc187a
.long 0x3dfb14be,0x3dfa7302,0x3df9c79d,0x3df91298,0x3df853f8,0x3df7583a,0x3df64d97,0x3df5341d
.long 0x3df4fa0b,0x3df3913f,0x3df21352,0x3df08066,0x3df10908,0x3def20b0,0x3ded1c1d,0x3deafb8c
.long 0x3dec835e,0x3dea09a7,0x3de76bd8,0x3de4aa59,0x3de76bd8,0x3de44fac,0x3de106f2,0x3ddd924d
.long 0x3de1c598,0x3dddf6be,0x3dd9f26a,0x3dd5b993,0x3ddb941a,0x3dd70348,0x3dd233c6,0x3dcd26fd
.long 0x3dd4db31,0x3dcf7a1f,0x3dc9d112,0x3dc3e200,0x3dcd9f02,0x3dc76085,0x3dc0d0da,0x3db9f2ac
.long 0x3dc5e403,0x3dbebc1b,0x3db73a23,0x3daf61a5,0x3dbdaef9,0x3db592e7,0x3dad1469,0x3da4381a
.long 0x3db504f3,0x3dabeb4a,0x3da26799,0x3d987fc0,0x3dabeb4a,0x3da1cbfb,0x3d973c07,0x3d8c42c9
.long 0x3da26799,0x3d973c07,0x3d8b9a6b,0x3d7f17b2,0x3d987fc0,0x3d8c42c9,0x3d7f17b2,0x3d64cbfe
.long 0x3d8e39da,0x3d80e7e4,0x3d663375,0x3d49b953,0x3d839c3d,0x3d6a6681,0x3d4c9b8b,0x3d2df73c
.long 0x3d715aea,0x3d525a09,0x3d3263ef,0x3d119ddd,0x3d5ae880,0x3d39bb1e,0x3d17a117,0x3ce98bba
.long 0x3d43ef15,0x3d209ae5,0x3cf8cfcc,0x3caf10a2,0x3d2c7cd4,0x3d070ada,0x3cc19b37,0x3c67fa9a
.long 0x3d14a031,0x3cda3997,0x3c89cf86,0x3be21469,0x3cf8cfcc,0x3ca5c58c,0x3c23308c,0xb9c90fc6
.long 0x3cc7c5c2,0x3c61bc2e,0x3b490ab0,0xbbfb2b74,0x3c964083,0x3beea038,0xbb7b49ba,0xbc7475c0
.long 0x3c48bd36,0x3a490f88,0xbc2fb680,0xbcb54098,0x3bc8fb30,0xbbbc6dd5,0xbc9008b7,0xbcefa8b2
.long 0x3e000000,0x3e000000,0x3e000000,0x3e000000,0x3dff84ab,0x3dff7808,0x3dff6ac7,0x3dff5ce9
.long 0x3dfe1324,0x3dfde0b1,0x3dfdabcc,0x3dfd7474,0x3dfbaccd,0x3dfb3bab,0x3dfac516,0x3dfa4910
.long 0x3df853f8,0x3df78bc5,0x3df6ba07,0x3df5dec6,0x3df40bdd,0x3df2d4eb,0x3df18f57,0x3df03b37
.long 0x3deed89e,0x3ded1c1d,0x3deb4b0c,0x3de96591,0x3de8bf3c,0x3de66771,0x3de3f473,0x3de1668a
.long 0x3de1c598,0x3ddebe05,0x3ddb941a,0x3dd84853,0x3dd9f26a,0x3dd627fe,0x3dd233c6,0x3dce1689
.long 0x3dd14d3d,0x3dccae79,0x3dc7de65,0x3dc2de29,0x3dc7de65,0x3dc25b89,0x3dbca003,0x3db6ad7f
.long 0x3dbdaef9,0x3db73a23,0x3db085bb,0x3da99415,0x3db2c8c9,0x3dab561b,0x3da39da9,0x3d9ba299
.long 0x3da73656,0x3d9ebc12,0x3d95f6d9,0x3d8cead0,0x3d9b02c6,0x3d91796b,0x3d87a136,0x3d7afef7
.long 0x3d8e39da,0x3d839c3d,0x3d715aea,0x3d5ae880,0x3d80e7e4,0x3d6a6681,0x3d525a09,0x3d39bb1e
.long 0x3d663375,0x3d4c9b8b,0x3d3263ef,0x3d17a117,0x3d49b953,0x3d2df73c,0x3d119ddd,0x3ce98bba
.long 0x3d2c7cd4,0x3d0e9a22,0x3ce05c13,0x3ca2abb6,0x3d0e9a22,0x3cdd4b1a,0x3c9c76de,0x3c35f8da
.long 0x3ce05c13,0x3c9c76de,0x3c2fb680,0x3b16c9b6,0x3ca2abb6,0x3c35f8da,0x3b16c9b6,0xbbd5880e
.long 0x3c48bd36,0x3b490ab0,0xbbc8fb30,0xbc7ab273,0x3b96c32c,0xbba351cb,0xbc6e3876,0xbcc4b0b9
.long 0xbb490ab0,0xbc553db9,0xbcbb6ecf,0xbd0586ce,0xbc2fb680,0xbcabf804,0xbcfee6e1,0xbd280b1f
.long 0xbc964083,0xbcec9a7f,0xbd209ae5,0xbd49b953,0xbcd41501,0xbd1620d2,0xbd41071e,0xbd6a6681
.long 0xbd088e93,0xbd3554ec,0xbd60924f,0xbd84f484,0xbd268f12,0xbd53c867,0xbd7f17b2,0xbd940c5f
.long 0x3e000000,0x3e000000,0x3e000000,0x3e000000,0x3dff4e6d,0x3dff3f54,0x3dff2f9d,0x3dff1f49
.long 0x3dfd3aac,0x3dfcfe73,0x3dfcbfc9,0x3dfc7eb0,0x3df9c79d,0x3df940c0,0x3df8b47b,0x3df822d1
.long 0x3df4fa0b,0x3df40bdd,0x3df31447,0x3df21352,0x3deed89e,0x3ded67a1,0x3debe858,0x3dea5ad9
.long 0x3de76bd8,0x3de55e0b,0x3de33c5a,0x3de106f2,0x3ddebe05,0x3ddbfb34,0x3dd91e6a,0x3dd627fe
.long 0x3dd4db31,0x3dd14d3d,0x3dcd9f02,0x3dc9d112,0x3dc9d112,0x3dc56439,0x3dc0d0da,0x3dbc17d9
.long 0x3dbdaef9,0x3db85216,0x3db2c8c9,0x3dad1469,0x3db085bb,0x3daa2a80,0x3da39da9,0x3d9ce11f
.long 0x3da26799,0x3d9b02c6,0x3d93682a,0x3d8b9a6b,0x3d93682a,0x3d8af1b7,0x3d8242b1,0x3d72bd43
.long 0x3d839c3d,0x3d741f07,0x3d60924f,0x3d4c9b8b,0x3d663375,0x3d50eb2a,0x3d3b31a0,0x3d25129f
.long 0x3d43ef15,0x3d2c7cd4,0x3d14a031,0x3cf8cfcc,0x3d209ae5,0x3d070ada,0x3cda3997,0x3ca5c58c
.long 0x3cf8cfcc,0x3cc19b37,0x3c89cf86,0x3c23308c,0x3caf10a2,0x3c67fa9a,0x3be21469,0xb9c90fc6
.long 0x3c48bd36,0x3b96c32c,0xbb490ab0,0xbc2fb680,0x3b490ab0,0xbba351cb,0xbc553db9,0xbcabf804
.long 0xbbc8fb30,0xbc6e3876,0xbcbb6ecf,0xbcfee6e1,0xbc7ab273,0xbcc4b0b9,0xbd0586ce,0xbd280b1f
.long 0xbcc7c5c2,0xbd088e93,0xbd2c7cd4,0xbd4f7bca,0xbd088e93,0xbd2df73c,0xbd525a09,0xbd758035
.long 0xbd2c7cd4,0xbd525a09,0xbd76e0cb,0xbd8cead0,0xbd4f7bca,0xbd758035,0xbd8cead0,0xbd9e1e22
.long 0xbd715aea,0xbd8b9a6b,0xbd9d7fd1,0xbdae3bde,0xbd88f59b,0xbd9ba299,0xbdad1469,0xbdbd27b8
.long 0xbd987fc0,0xbdaac082,0xbdbb8f3b,0xbdcac77f,0xbda73656,0xbdb8dd65,0xbdc8d8b3,0xbdd70348
.long 0x3e000000,0x3e000000,0x3e000000,0x3e000000,0x3dff0e58,0x3dfefcc9,0x3dfeea9d,0x3dfed7d4
.long 0x3dfc3b28,0x3dfbf531,0x3dfbaccd,0x3dfb61fc,0x3df78bc5,0x3df6ef5b,0x3df64d97,0x3df5a67b
.long 0x3df10908,0x3deff573,0x3deed89e,0x3dedb293,0x3de8bf3c,0x3de71599,0x3de55e0b,0x3de398ac
.long 0x3ddebe05,0x3ddc61c7,0x3dd9f26a,0x3dd77026,0x3dd31849,0x3dcfefa8,0x3dccae79,0x3dc95521
.long 0x3dc5e403,0x3dc1d870,0x3dbdaef9,0x3db96842,0x3db73a23,0x3db238aa,0x3dad1469,0x3da7ce61
.long 0x3da73656,0x3da12ff9,0x3d9b02c6,0x3d94b039,0x3d95f6d9,0x3d8ee0db,0x3d87a136,0x3d803a06
.long 0x3d839c3d,0x3d76e0cb,0x3d663375,0x3d553641,0x3d60924f,0x3d4e0bea,0x3d3b31a0,0x3d280b1f
.long 0x3d38442a,0x3d2395c5,0x3d0e9a22,0x3cf2b651,0x3d0e9a22,0x3cefa8b2,0x3cc19b37,0x3c9324ca
.long 0x3cc7c5c2,0x3c964083,0x3c48bd36,0x3bc8fb30,0x3c61bc2e,0x3beea038,0x3a490f88,0xbbbc6dd5
.long 0x3b490ab0,0xbb7b49ba,0xbc2fb680,0xbc9008b7,0xbbfb2b74,0xbc7475c0,0xbcb54098,0xbcefa8b2
.long 0xbc964083,0xbcd41501,0xbd088e93,0xbd268f12,0xbcec9a7f,0xbd1620d2,0xbd3554ec,0xbd53c867
.long 0xbd209ae5,0xbd41071e,0xbd60924f,0xbd7f17b2,0xbd49b953,0xbd6a6681,0xbd84f484,0xbd940c5f
.long 0xbd715aea,0xbd88f59b,0xbd987fc0,0xbda73656,0xbd8b9a6b,0xbd9ba299,0xbdaac082,0xbdb8dd65
.long 0xbd9d7fd1,0xbdad1469,0xbdbb8f3b,0xbdc8d8b3,0xbdae3bde,0xbdbd27b8,0xbdcac77f,0xbdd70348
.long 0xbdbdaef9,0xbdcbbbf8,0xbdd84853,0xbde33c5a,0xbdcbbbf8,0xbdd8b3a1,0xbde3f473,0xbded67a1
.long 0xbdd84853,0xbde3f473,0xbdedb293,0xbdf56d97,0xbde33c5a,0xbded67a1,0xbdf56d97,0xbdfb3bab
.long 0x3e000000,0x3dfec46d,0x3dfb14be,0x3df4fa0b,0x3e000000,0x3dfeb069,0x3dfac516,0x3df4484b
.long 0x3e000000,0x3dfe9bc9,0x3dfa7302,0x3df3913f,0x3e000000,0x3dfe868b,0x3dfa1e84,0x3df2d4eb
.long 0x3e000000,0x3dfe70b0,0x3df9c79d,0x3df21352,0x3e000000,0x3dfe5a38,0x3df96e4e,0x3df14c7a
.long 0x3e000000,0x3dfe4323,0x3df91298,0x3df08066,0x3e000000,0x3dfe2b72,0x3df8b47b,0x3defaf1b
.long 0x3e000000,0x3dfe1324,0x3df853f8,0x3deed89e,0x3e000000,0x3dfdfa38,0x3df7f110,0x3dedfcf2
.long 0x3e000000,0x3dfde0b1,0x3df78bc5,0x3ded1c1d,0x3e000000,0x3dfdc68c,0x3df72417,0x3dec3624
.long 0x3e000000,0x3dfdabcc,0x3df6ba07,0x3deb4b0c,0x3e000000,0x3dfd906e,0x3df64d97,0x3dea5ad9
.long 0x3e000000,0x3dfd7474,0x3df5dec6,0x3de96591,0x3e000000,0x3dfd57de,0x3df56d97,0x3de86b39
.long 0x3e000000,0x3dfd3aac,0x3df4fa0b,0x3de76bd8,0x3e000000,0x3dfd1cdd,0x3df48422,0x3de66771
.long 0x3e000000,0x3dfcfe73,0x3df40bdd,0x3de55e0b,0x3e000000,0x3dfcdf6c,0x3df3913f,0x3de44fac
.long 0x3e000000,0x3dfcbfc9,0x3df31447,0x3de33c5a,0x3e000000,0x3dfc9f8a,0x3df294f8,0x3de2241a
.long 0x3e000000,0x3dfc7eb0,0x3df21352,0x3de106f2,0x3e000000,0x3dfc5d3a,0x3df18f57,0x3ddfe4e9
.long 0x3e000000,0x3dfc3b28,0x3df10908,0x3ddebe05,0x3e000000,0x3dfc187a,0x3df08066,0x3ddd924d
.long 0x3e000000,0x3dfbf531,0x3deff573,0x3ddc61c7,0x3e000000,0x3dfbd14d,0x3def6830,0x3ddb2c79
.long 0x3e000000,0x3dfbaccd,0x3deed89e,0x3dd9f26a,0x3e000000,0x3dfb87b2,0x3dee46be,0x3dd8b3a1
.long 0x3e000000,0x3dfb61fc,0x3dedb293,0x3dd77026,0x3e000000,0x3dfb3bab,0x3ded1c1d,0x3dd627fe
.long 0x3dec835e,0x3de1c598,0x3dd4db31,0x3dc5e403,0x3deb4b0c,0x3ddfe4e9,0x3dd233c6,0x3dc25b89
.long 0x3dea09a7,0x3dddf6be,0x3dcf7a1f,0x3dbebc1b,0x3de8bf3c,0x3ddbfb34,0x3dccae79,0x3dbb0629
.long 0x3de76bd8,0x3dd9f26a,0x3dc9d112,0x3db73a23,0x3de60f88,0x3dd7dc7f,0x3dc6e22a,0x3db3587a
.long 0x3de4aa59,0x3dd5b993,0x3dc3e200,0x3daf61a5,0x3de33c5a,0x3dd389c7,0x3dc0d0da,0x3dab561b
.long 0x3de1c598,0x3dd14d3d,0x3dbdaef9,0x3da73656,0x3de04621,0x3dcf0417,0x3dba7ca4,0x3da302d3
.long 0x3ddebe05,0x3dccae79,0x3db73a23,0x3d9ebc12,0x3ddd2d53,0x3dca4c87,0x3db3e7bc,0x3d9a6293
.long 0x3ddb941a,0x3dc7de65,0x3db085bb,0x3d95f6d9,0x3dd9f26a,0x3dc56439,0x3dad1469,0x3d91796b
.long 0x3dd84853,0x3dc2de29,0x3da99415,0x3d8cead0,0x3dd695e5,0x3dc04c5c,0x3da6050a,0x3d884b92
.long 0x3dd4db31,0x3dbdaef9,0x3da26799,0x3d839c3d,0x3dd31849,0x3dbb0629,0x3d9ebc12,0x3d7dbabb
.long 0x3dd14d3d,0x3db85216,0x3d9b02c6,0x3d741f07,0x3dcf7a1f,0x3db592e7,0x3d973c07,0x3d6a6681
.long 0x3dcd9f02,0x3db2c8c9,0x3d93682a,0x3d60924f,0x3dcbbbf8,0x3daff3e6,0x3d8f8784,0x3d56a399
.long 0x3dc9d112,0x3dad1469,0x3d8b9a6b,0x3d4c9b8b,0x3dc7de65,0x3daa2a80,0x3d87a136,0x3d427b55
.long 0x3dc5e403,0x3da73656,0x3d839c3d,0x3d38442a,0x3dc3e200,0x3da4381a,0x3d7f17b2,0x3d2df73c
.long 0x3dc1d870,0x3da12ff9,0x3d76e0cb,0x3d2395c5,0x3dbfc767,0x3d9e1e22,0x3d6e9479,0x3d1920fe
.long 0x3dbdaef9,0x3d9b02c6,0x3d663375,0x3d0e9a22,0x3dbb8f3b,0x3d97de12,0x3d5dbe79,0x3d040270
.long 0x3db96842,0x3d94b039,0x3d553641,0x3cf2b651,0x3db73a23,0x3d91796b,0x3d4c9b8b,0x3cdd4b1a
.long 0x3db504f3,0x3da26799,0x3d8e39da,0x3d715aea,0x3db085bb,0x3d9ce11f,0x3d87a136,0x3d61fb6a
.long 0x3dabeb4a,0x3d973c07,0x3d80e7e4,0x3d525a09,0x3da73656,0x3d91796b,0x3d741f07,0x3d427b55
.long 0x3da26799,0x3d8b9a6b,0x3d663375,0x3d3263ef,0x3d9d7fd1,0x3d85a02c,0x3d58106b,0x3d221887
.long 0x3d987fc0,0x3d7f17b2,0x3d49b953,0x3d119ddd,0x3d93682a,0x3d72bd43,0x3d3b31a0,0x3d00f8c0
.long 0x3d8e39da,0x3d663375,0x3d2c7cd4,0x3ce05c13,0x3d88f59b,0x3d597cb9,0x3d1d9e78,0x3cbe853e
.long 0x3d839c3d,0x3d4c9b8b,0x3d0e9a22,0x3c9c76de,0x3d7c5d27,0x3d3f926f,0x3cfee6e1,0x3c7475c0
.long 0x3d715aea,0x3d3263ef,0x3ce05c13,0x3c2fb680,0x3d663375,0x3d25129f,0x3cc19b37,0x3bd5880e
.long 0x3d5ae880,0x3d17a117,0x3ca2abb6,0x3b16c9b6,0x3d4f7bca,0x3d0a11f7,0x3c839502,0xbafb514b
.long 0x3d43ef15,0x3cf8cfcc,0x3c48bd36,0xbbc8fb30,0x3d38442a,0x3cdd4b1a,0x3c0a200a,0xbc2973ba
.long 0x3d2c7cd4,0x3cc19b37,0x3b96c32c,0xbc6e3876,0x3d209ae5,0x3ca5c58c,0x3a490f88,0xbc995be0
.long 0x3d14a031,0x3c89cf86,0xbb490ab0,0xbcbb6ecf,0x3d088e93,0x3c5b7d37,0xbbe21469,0xbcdd4b1a
.long 0x3cf8cfcc,0x3c23308c,0xbc2fb680,0xbcfee6e1,0x3ce05c13,0x3bd5880e,0xbc6e3876,0xbd101c2c
.long 0x3cc7c5c2,0x3b490ab0,0xbc964083,0xbd209ae5,0x3caf10a2,0xb9c90fc6,0xbcb54098,0xbd30eacb
.long 0x3c964083,0xbb7b49ba,0xbcd41501,0xbd41071e,0x3c7ab273,0xbbeea038,0xbcf2b651,0xbd50eb2a
.long 0x3c48bd36,0xbc2fb680,0xbd088e93,0xbd60924f,0x3c16a905,0xbc67fa9a,0xbd17a117,0xbd6ff7fb
.long 0x3bc8fb30,0xbc9008b7,0xbd268f12,0xbd7f17b2,0x3b490ab0,0xbcabf804,0xbd3554ec,0xbd86f686
.long 0x3d43ef15,0x3d14a031,0x3cc7c5c2,0x3c48bd36,0x3d3263ef,0x3d00f8c0,0x3c9c76de,0x3bd5880e
.long 0x3d209ae5,0x3cda3997,0x3c61bc2e,0x3a490f88,0x3d0e9a22,0x3cb228d4,0x3c0a200a,0xbba351cb
.long 0x3cf8cfcc,0x3c89cf86,0x3b490ab0,0xbc2fb680,0x3cd41501,0x3c427c39,0xbb16c9b6,0xbc86b26e
.long 0x3caf10a2,0x3be21469,0xbbfb2b74,0xbcb54098,0x3c89cf86,0x3afb514b,0xbc553db9,0xbce36c83
.long 0x3c48bd36,0xbb490ab0,0xbc964083,0xbd088e93,0x3bfb2b74,0xbc03db0a,0xbcc19b37,0xbd1f1cdf
.long 0x3b490ab0,0xbc553db9,0xbcec9a7f,0xbd3554ec,0xbac90e90,0xbc9324ca,0xbd0b9507,0xbd4b2aae
.long 0xbbc8fb30,0xbcbb6ecf,0xbd209ae5,0xbd60924f,0xbc2fb680,0xbce36c83,0xbd3554ec,0xbd758035
.long 0xbc7ab273,0xbd0586ce,0xbd49b953,0xbd84f484,0xbca2abb6,0xbd1920fe,0xbd5dbe79,0xbd8ee0db
.long 0xbcc7c5c2,0xbd2c7cd4,0xbd715aea,0xbd987fc0,0xbcec9a7f,0xbd3f926f,0xbd8242b1,0xbda1cbfb
.long 0xbd088e93,0xbd525a09,0xbd8b9a6b,0xbdaac082,0xbd1aa086,0xbd64cbfe,0xbd94b039,0xbdb3587a
.long 0xbd2c7cd4,0xbd76e0cb,0xbd9d7fd1,0xbdbb8f3b,0xbd3e1d4a,0xbd844889,0xbda6050a,0xbdc36051
.long 0xbd4f7bca,0xbd8cead0,0xbdae3bde,0xbdcac77f,0xbd60924f,0xbd9553b7,0xbdb6206c,0xbdd1c0c2
.long 0xbd715aea,0xbd9d7fd1,0xbdbdaef9,0xbdd84853,0xbd80e7e4,0xbda56bcb,0xbdc4e3f5,0xbdde5aa6
.long 0xbd88f59b,0xbdad1469,0xbdcbbbf8,0xbde3f473,0xbd90d3cd,0xbdb4768f,0xbdd233c6,0xbde912ae
.long 0xbd987fc0,0xbdbb8f3b,0xbdd84853,0xbdedb293,0xbd9ff6cb,0xbdc25b89,0xbdddf6be,0xbdf1d19f
.long 0xbda73656,0xbdc8d8b3,0xbde33c5a,0xbdf56d97,0xbdae3bde,0xbdcf0417,0xbde816a8,0xbdf88486
.long 0x230d3132,0xbc48bd36,0xbcc7c5c2,0xbd14a031,0xbbc8fb30,0xbc995be0,0xbcfee6e1,0xbd30eacb
.long 0xbc48bd36,0xbccdee60,0xbd1aa086,0xbd4c9b8b,0xbc964083,0xbd00f8c0,0xbd3554ec,0xbd679a5d
.long 0xbcc7c5c2,0xbd1aa086,0xbd4f7bca,0xbd80e7e4,0xbcf8cfcc,0xbd33dca5,0xbd6900b7,0xbd8d9281
.long 0xbd14a031,0xbd4c9b8b,0xbd80e7e4,0xbd99c200,0xbd2c7cd4,0xbd64cbfe,0xbd8cead0,0xbda56bcb
.long 0xbd43ef15,0xbd7c5d27,0xbd987fc0,0xbdb085bb,0xbd5ae880,0xbd899f4e,0xbda39da9,0xbdbb0629
.long 0xbd715aea,0xbd94b039,0xbdae3bde,0xbdc4e3f5,0xbd839c3d,0xbd9f599f,0xbdb85216,0xbdce1689
.long 0xbd8e39da,0xbda99415,0xbdc1d870,0xbdd695e5,0xbd987fc0,0xbdb3587a,0xbdcac77f,0xbdde5aa6
.long 0xbda26799,0xbdbca003,0xbdd31849,0xbde55e0b,0xbdabeb4a,0xbdc56439,0xbddac450,0xbdeb99fb
.long 0xbdb504f3,0xbdcd9f02,0xbde1c598,0xbdf10908,0xbdbdaef9,0xbdd54aa4,0xbde816a8,0xbdf5a67b
.long 0xbdc5e403,0xbddc61c7,0xbdedb293,0xbdf96e4e,0xbdcd9f02,0xbde2df7b,0xbdf294f8,0xbdfc5d3a
.long 0xbdd4db31,0xbde8bf3c,0xbdf6ba07,0xbdfe70b0,0xbddb941a,0xbdedfcf2,0xbdfa1e84,0xbdffa6e3
.long 0xbde1c598,0xbdf294f8,0xbdfcbfc9,0xbdfffec4,0xbde76bd8,0xbdf6841b,0xbdfe9bc9,0xbdff7808
.long 0xbdec835e,0xbdf9c79d,0xbdffb10f,0xbdfe1324,0xbdf10908,0xbdfc5d3a,0xbdfffec4,0xbdfbd14d
.long 0xbdf4fa0b,0xbdfe4323,0xbdff84ab,0xbdf8b47b,0xbdf853f8,0xbdff7808,0xbdfe4323,0xbdf4bf62
.long 0xbdfb14be,0xbdfffb11,0xbdfc3b28,0xbdeff573,0xbdfd3aac,0xbdffcbe2,0xbdf96e4e,0xbdea5ad9
.long 0xbdfec46d,0xbdfeea9d,0xbdf5dec6,0xbde3f473,0xbdffb10f,0xbdfd57de,0xbdf18f57,0xbddcc7d1
.long 0xbd43ef15,0xbd715aea,0xbd8e39da,0xbda26799,0xbd60924f,0xbd86f686,0xbd9c420c,0xbdaff3e6
.long 0xbd7c5d27,0xbd94b039,0xbda99415,0xbdbca003,0xbd8b9a6b,0xbda1cbfb,0xbdb6206c,0xbdc85bca
.long 0xbd987fc0,0xbdae3bde,0xbdc1d870,0xbdd31849,0xbda4d225,0xbdb9f2ac,0xbdccae79,0xbddcc7d1
.long 0xbdb085bb,0xbdc4e3f5,0xbdd695e5,0xbde55e0b,0xbdbb8f3b,0xbdcf0417,0xbddf8327,0xbdecd007
.long 0xbdc5e403,0xbdd84853,0xbde76bd8,0xbdf31447,0xbdcf7a1f,0xbde0a6cf,0xbdee46be,0xbdf822d1
.long 0xbdd84853,0xbde816a8,0xbdf40bdd,0xbdfbf531,0xbde04621,0xbdee8ff8,0xbdf8b47b,0xbdfe868b
.long 0xbde76bd8,0xbdf40bdd,0xbdfc3b28,0xbdffd397,0xbdedb293,0xbdf88486,0xbdfe9bc9,0xbdffdaaf
.long 0xbdf31447,0xbdfbf531,0xbdffd397,0xbdfe9bc9,0xbdf78bc5,0xbdfe5a38,0xbdffe129,0xbdfc187a
.long 0xbdfb14be,0xbdffb10f,0xbdfec46d,0xbdf853f8,0xbdfdabcc,0xbdfff84a,0xbdfc7eb0,0xbdf3530e
.long 0xbdff4e6d,0xbdff2f9d,0xbdf91298,0xbded1c1d,0xbdfffb11,0xbdfd57de,0xbdf48422,0xbde5b710
.long 0xbdffb10f,0xbdfa7302,0xbdeed89e,0xbddd2d53,0xbdfe70b0,0xbdf6841b,0xbde816a8,0xbdd389c7
.long 0xbdfc3b28,0xbdf18f57,0xbde04621,0xbdc8d8b3,0xbdf91298,0xbdeb99fb,0xbdd77026,0xbdbd27b8
.long 0xbdf4fa0b,0xbde4aa59,0xbdcd9f02,0xbdb085bb,0xbdeff573,0xbddcc7d1,0xbdc2de29,0xbda302d3
.long 0xbdea09a7,0xbdd3fac3,0xbdb73a23,0xbd94b039,0xbde33c5a,0xbdca4c87,0xbdaac082,0xbd85a02c
.long 0xbddb941a,0xbdbfc767,0xbd9d7fd1,0xbd6bcbbb,0xbdd31849,0xbdb4768f,0xbd8f8784,0xbd4b2aae
.long 0xbdc9d112,0xbda86605,0xbd80e7e4,0xbd2986c4,0xbdbfc767,0xbd9ba299,0xbd6363fa,0xbd070ada
.long 0xbdb504f3,0xbdc5e403,0xbdd4db31,0xbde1c598,0xbdc1d870,0xbdd1c0c2,0xbddf8327,0xbdeafb8c
.long 0xbdcd9f02,0xbddc61c7,0xbde8bf3c,0xbdf294f8,0xbdd84853,0xbde5b710,0xbdf08066,0xbdf88486
.long 0xbde1c598,0xbdedb293,0xbdf6ba07,0xbdfcbfc9,0xbdea09a7,0xbdf4484b,0xbdfb61fc,0xbdff3f54
.long 0xbdf10908,0xbdf96e4e,0xbdfe70b0,0xbdfffec4,0xbdf6ba07,0xbdfd1cdd,0xbdffe129,0xbdfefcc9
.long 0xbdfb14be,0xbdff4e6d,0xbdffb10f,0xbdfc3b28,0xbdfe1324,0xbdffffb1,0xbdfde0b1,0xbdf7beb7
.long 0xbdffb10f,0xbdff2f9d,0xbdfa7302,0xbdf18f57,0xbdffec43,0xbdfcdf6c,0xbdf56d97,0xbde9b7e4
.long 0xbdfec46d,0xbdf91298,0xbdeed89e,0xbde04621,0xbdfc3b28,0xbdf3ced9,0xbde6becc,0xbdd54aa4
.long 0xbdf853f8,0xbded1c1d,0xbddd2d53,0xbdc8d8b3,0xbdf31447,0xbde50479,0xbdd233c6,0xbdbb0629
.long 0xbdec835e,0xbddb941a,0xbdc5e403,0xbdabeb4a,0xbde4aa59,0xbdd0d937,0xbdb85216,0xbd9ba299
.long 0xbddb941a,0xbdc4e3f5,0xbda99415,0xbd8a48ad,0xbdd14d3d,0xbdb7c655,0xbd99c200,0xbd6ff7fb
.long 0xbdc5e403,0xbda99415,0xbd88f59b,0xbd49b953,0xbdb96842,0xbd9a6293,0xbd6e9479,0xbd221887
.long 0xbdabeb4a,0xbd8a48ad,0xbd49b953,0xbcf2b651,0xbd9d7fd1,0xbd72bd43,0xbd2395c5,0xbc9f917b
.long 0xbd8e39da,0xbd4f7bca,0xbcf8cfcc,0xbc16a905,0xbd7c5d27,0xbd2b0201,0xbca8defc,0x3a96cb58
.long 0xbd5ae880,0xbd0586ce,0xbc2fb680,0x3c3c3ac3,0xbd38442a,0xbcbe853e,0xba490f88,0x3cb228d4
.long 0xbd14a031,0xbc61bc2e,0x3c16a905,0x3d027dc0,0xbce05c13,0xbb8a342f,0x3c9c76de,0x3d2b0201
.long 0xbc964083,0x3bafe007,0x3cec9a7f,0x3d525a09,0xbc16a905,0x3c7475c0,0x3d1d9e78,0x3d7840c8
.long 0xbdec835e,0xbdf4fa0b,0xbdfb14be,0xbdfec46d,0xbdf40bdd,0xbdfa9c59,0xbdfe9bc9,0xbdffffb1
.long 0xbdf9c79d,0xbdfe4323,0xbdfffb11,0xbdfeea9d,0xbdfdabcc,0xbdffe705,0xbdff2f9d,0xbdfb87b2
.long 0xbdffb10f,0xbdff84ab,0xbdfc3b28,0xbdf5dec6,0xbdffd397,0xbdfd1cdd,0xbdf72417,0xbdedfcf2
.long 0xbdfe1324,0xbdf8b47b,0xbdeff573,0xbde3f473,0xbdfa7302,0xbdf25470,0xbde6becc,0xbdd7dc7f
.long 0xbdf4fa0b,0xbdea09a7,0xbddb941a,0xbdc9d112,0xbdedb293,0xbddfe4e9,0xbdce8d90,0xbdb9f2ac
.long 0xbde4aa59,0xbdd3fac3,0xbdbfc767,0xbda86605,0xbdd9f26a,0xbdc66354,0xbdaf61a5,0xbd9553b7
.long 0xbdcd9f02,0xbdb73a23,0xbd9d7fd1,0xbd80e7e4,0xbdbfc767,0xbda69de3,0xbd8a48ad,0xbd56a399
.long 0xbdb085bb,0xbd94b039,0xbd6bcbbb,0xbd2986c4,0xbd9ff6cb,0xbd819573,0xbd41071e,0xbcf5c35a
.long 0xbd8e39da,0xbd5ae880,0xbd14a031,0xbc964083,0xbd76e0cb,0xbd30eacb,0xbccdee60,0xbbd5880e
.long 0xbd4f7bca,0xbd0586ce,0xbc61bc2e,0x3bafe007,0xbd268f12,0xbcb228d4,0xbb16c9b6,0x3c8cec4a
.long 0xbcf8cfcc,0xbc2fb680,0x3c16a905,0x3cec9a7f,0xbca2abb6,0x39c90fc6,0x3ca8defc,0x3d25129f
.long 0xbc16a905,0x3c3c3ac3,0x3d027dc0,0x3d525a09,0x3ac90e90,0x3cb857ec,0x3d2f713a,0x3d7dbabb
.long 0x3c48bd36,0x3d088e93,0x3d5ae880,0x3d93682a,0x3cbb6ecf,0x3d33dca5,0x3d8242b1,0x3da69de3
.long 0x3d088e93,0x3d5dbe79,0x3d95f6d9,0x3db85216,0x3d3263ef,0x3d82ef9f,0x3da86605,0x3dc85bca
.long 0x3d5ae880,0x3d95f6d9,0x3db96842,0x3dd695e5,0x3d80e7e4,0x3da7ce61,0x3dc8d8b3,0x3de2df7b
.long 0x3d93682a,0x3db85216,0x3dd695e5,0x3ded1c1d,0x3da4d225,0x3dc76085,0x3de28210,0x3df5341d
.long 0x80000000,0x80000000,0x80000000,0x80000000,0x80000000,0xb9c90fc6,0xba490f88,0xba96cb58
.long 0x80000000,0xba490f88,0xbac90e90,0xbb16c9b6,0x80000000,0xba96cb58,0xbb16c9b6,0xbb622a7a
.long 0x80000000,0xbac90e90,0xbb490ab0,0xbb96c32c,0x80000000,0xbafb514b,0xbb7b49ba,0xbbbc6dd5
.long 0x80000000,0xbb16c9b6,0xbb96c32c,0xbbe21469,0x80000000,0xbb2fea69,0xbbafe007,0xbc03db0a
.long 0x80000000,0xbb490ab0,0xbbc8fb30,0xbc16a905,0x80000000,0xbb622a7a,0xbbe21469,0xbc2973ba
.long 0x80000000,0xbb7b49ba,0xbbfb2b74,0xbc3c3ac3,0x80000000,0xbb8a342f,0xbc0a200a,0xbc4efdb7
.long 0x80000000,0xbb96c32c,0xbc16a905,0xbc61bc2e,0x80000000,0xbba351cb,0xbc23308c,0xbc7475c0
.long 0x80000000,0xbbafe007,0xbc2fb680,0xbc839502,0x80000000,0xbbbc6dd5,0xbc3c3ac3,0xbc8cec4a
.long 0x80000000,0xbbc8fb30,0xbc48bd36,0xbc964083,0x80000000,0xbbd5880e,0xbc553db9,0xbc9f917b
.long 0x80000000,0xbbe21469,0xbc61bc2e,0xbca8defc,0x80000000,0xbbeea038,0xbc6e3876,0xbcb228d4
.long 0x80000000,0xbbfb2b74,0xbc7ab273,0xbcbb6ecf,0x80000000,0xbc03db0a,0xbc839502,0xbcc4b0b9
.long 0x80000000,0xbc0a200a,0xbc89cf86,0xbccdee60,0x80000000,0xbc1064b4,0xbc9008b7,0xbcd7278f
.long 0x80000000,0xbc16a905,0xbc964083,0xbce05c13,0x80000000,0xbc1cecf9,0xbc9c76de,0xbce98bba
.long 0x80000000,0xbc23308c,0xbca2abb6,0xbcf2b651,0x80000000,0xbc2973ba,0xbca8defc,0xbcfbdba4
.long 0x80000000,0xbc2fb680,0xbcaf10a2,0xbd027dc0,0x80000000,0xbc35f8da,0xbcb54098,0xbd070ada
.long 0x80000000,0xbc3c3ac3,0xbcbb6ecf,0xbd0b9507,0x80000000,0xbc427c39,0xbcc19b37,0xbd101c2c
.long 0x80000000,0x80000000,0x80000000,0x80000000,0xbac90e90,0xbafb514b,0xbb16c9b6,0xbb2fea69
.long 0xbb490ab0,0xbb7b49ba,0xbb96c32c,0xbbafe007,0xbb96c32c,0xbbbc6dd5,0xbbe21469,0xbc03db0a
.long 0xbbc8fb30,0xbbfb2b74,0xbc16a905,0xbc2fb680,0xbbfb2b74,0xbc1cecf9,0xbc3c3ac3,0xbc5b7d37
.long 0xbc16a905,0xbc3c3ac3,0xbc61bc2e,0xbc839502,0xbc2fb680,0xbc5b7d37,0xbc839502,0xbc995be0
.long 0xbc48bd36,0xbc7ab273,0xbc964083,0xbcaf10a2,0xbc61bc2e,0xbc8cec4a,0xbca8defc,0xbcc4b0b9
.long 0xbc7ab273,0xbc9c76de,0xbcbb6ecf,0xbcda3997,0xbc89cf86,0xbcabf804,0xbccdee60,0xbcefa8b2
.long 0xbc964083,0xbcbb6ecf,0xbce05c13,0xbd027dc0,0xbca2abb6,0xbccada4f,0xbcf2b651,0xbd0d17c0
.long 0xbcaf10a2,0xbcda3997,0xbd027dc0,0xbd17a117,0xbcbb6ecf,0xbce98bba,0xbd0b9507,0xbd221887
.long 0xbcc7c5c2,0xbcf8cfcc,0xbd14a031,0xbd2c7cd4,0xbcd41501,0xbd040270,0xbd1d9e78,0xbd36ccc3
.long 0xbce05c13,0xbd0b9507,0xbd268f12,0xbd41071e,0xbcec9a7f,0xbd131f35,0xbd2f713a,0xbd4b2aae
.long 0xbcf8cfcc,0xbd1aa086,0xbd38442a,0xbd553641,0xbd027dc0,0xbd221887,0xbd41071e,0xbd5f28a9
.long 0xbd088e93,0xbd2986c4,0xbd49b953,0xbd6900b7,0xbd0e9a22,0xbd30eacb,0xbd525a09,0xbd72bd43
.long 0xbd14a031,0xbd38442a,0xbd5ae880,0xbd7c5d27,0xbd1aa086,0xbd3f926f,0xbd6363fa,0xbd82ef9f
.long 0xbd209ae5,0xbd46d529,0xbd6bcbbb,0xbd87a136,0xbd268f12,0xbd4e0bea,0xbd741f07,0xbd8c42c9
.long 0xbd2c7cd4,0xbd553641,0xbd7c5d27,0xbd90d3cd,0xbd3263ef,0xbd5c53c1,0xbd8242b1,0xbd9553b7
.long 0xbd38442a,0xbd6363fa,0xbd864b82,0xbd99c200,0xbd3e1d4a,0xbd6a6681,0xbd8a48ad,0xbd9e1e22
.long 0x80000000,0x80000000,0x80000000,0x80000000,0xbb490ab0,0xbb622a7a,0xbb7b49ba,0xbb8a342f
.long 0xbbc8fb30,0xbbe21469,0xbbfb2b74,0xbc0a200a,0xbc16a905,0xbc2973ba,0xbc3c3ac3,0xbc4efdb7
.long 0xbc48bd36,0xbc61bc2e,0xbc7ab273,0xbc89cf86,0xbc7ab273,0xbc8cec4a,0xbc9c76de,0xbcabf804
.long 0xbc964083,0xbca8defc,0xbcbb6ecf,0xbccdee60,0xbcaf10a2,0xbcc4b0b9,0xbcda3997,0xbcefa8b2
.long 0xbcc7c5c2,0xbce05c13,0xbcf8cfcc,0xbd088e93,0xbce05c13,0xbcfbdba4,0xbd0b9507,0xbd1920fe
.long 0xbcf8cfcc,0xbd0b9507,0xbd1aa086,0xbd2986c4,0xbd088e93,0xbd1920fe,0xbd2986c4,0xbd39bb1e
.long 0xbd14a031,0xbd268f12,0xbd38442a,0xbd49b953,0xbd209ae5,0xbd33dca5,0xbd46d529,0xbd597cb9
.long 0xbd2c7cd4,0xbd41071e,0xbd553641,0xbd6900b7,0xbd38442a,0xbd4e0bea,0xbd6363fa,0xbd7840c8
.long 0xbd43ef15,0xbd5ae880,0xbd715aea,0xbd839c3d,0xbd4f7bca,0xbd679a5d,0xbd7f17b2,0xbd8af1b7
.long 0xbd5ae880,0xbd741f07,0xbd864b82,0xbd921eb0,0xbd663375,0xbd803a06,0xbd8cead0,0xbd99210f
.long 0xbd715aea,0xbd864b82,0xbd93682a,0xbd9ff6cb,0xbd7c5d27,0xbd8c42c9,0xbd99c200,0xbda69de3
.long 0xbd839c3d,0xbd921eb0,0xbd9ff6cb,0xbdad1469,0xbd88f59b,0xbd97de12,0xbda6050a,0xbdb3587a
.long 0xbd8e39da,0xbd9d7fd1,0xbdabeb4a,0xbdb96842,0xbd93682a,0xbda302d3,0xbdb1a81d,0xbdbf41fc
.long 0xbd987fc0,0xbda86605,0xbdb73a23,0xbdc4e3f5,0xbd9d7fd1,0xbdada859,0xbdbca003,0xbdca4c87
.long 0xbda26799,0xbdb2c8c9,0xbdc1d870,0xbdcf7a1f,0xbda73656,0xbdb7c655,0xbdc6e22a,0xbdd46b3b
.long 0xbdabeb4a,0xbdbca003,0xbdcbbbf8,0xbdd91e6a,0xbdb085bb,0xbdc154e1,0xbdd064af,0xbddd924d
.long 0x80000000,0x80000000,0x80000000,0x80000000,0xbb96c32c,0xbba351cb,0xbbafe007,0xbbbc6dd5
.long 0xbc16a905,0xbc23308c,0xbc2fb680,0xbc3c3ac3,0xbc61bc2e,0xbc7475c0,0xbc839502,0xbc8cec4a
.long 0xbc964083,0xbca2abb6,0xbcaf10a2,0xbcbb6ecf,0xbcbb6ecf,0xbccada4f,0xbcda3997,0xbce98bba
.long 0xbce05c13,0xbcf2b651,0xbd027dc0,0xbd0b9507,0xbd027dc0,0xbd0d17c0,0xbd17a117,0xbd221887
.long 0xbd14a031,0xbd209ae5,0xbd2c7cd4,0xbd38442a,0xbd268f12,0xbd33dca5,0xbd41071e,0xbd4e0bea
.long 0xbd38442a,0xbd46d529,0xbd553641,0xbd6363fa,0xbd49b953,0xbd597cb9,0xbd6900b7,0xbd7840c8
.long 0xbd5ae880,0xbd6bcbbb,0xbd7c5d27,0xbd864b82,0xbd6bcbbb,0xbd7dbabb,0xbd87a136,0xbd902dd5
.long 0xbd7c5d27,0xbd87a136,0xbd90d3cd,0xbd99c200,0xbd864b82,0xbd902dd5,0xbd99c200,0xbda302d3
.long 0xbd8e39da,0xbd987fc0,0xbda26799,0xbdabeb4a,0xbd95f6d9,0xbda09393,0xbdaac082,0xbdb4768f
.long 0xbd9d7fd1,0xbda86605,0xbdb2c8c9,0xbdbca003,0xbda4d225,0xbdaff3e6,0xbdba7ca4,0xbdc46337
.long 0xbdabeb4a,0xbdb73a23,0xbdc1d870,0xbdcbbbf8,0xbdb2c8c9,0xbdbe35c5,0xbdc8d8b3,0xbdd2a649
.long 0xbdb96842,0xbdc4e3f5,0xbdcf7a1f,0xbdd91e6a,0xbdbfc767,0xbdcb41fa,0xbdd5b993,0xbddf20db
.long 0xbdc5e403,0xbdd14d3d,0xbddb941a,0xbde4aa59,0xbdcbbbf8,0xbdd70348,0xbde106f2,0xbde9b7e4
.long 0xbdd14d3d,0xbddc61c7,0xbde60f88,0xbdee46be,0xbdd695e5,0xbde1668a,0xbdeaab7b,0xbdf25470
.long 0xbddb941a,0xbde60f88,0xbdeed89e,0xbdf5dec6,0xbde04621,0xbdea5ad9,0xbdf294f8,0xbdf8e3d6
.long 0xbde4aa59,0xbdee46be,0xbdf5dec6,0xbdfb61fc,0xbde8bf3c,0xbdf1d19f,0xbdf8b47b,0xbdfd57de
.long 0x80000000,0x80000000,0x80000000,0x80000000,0xbbc8fb30,0xbbd5880e,0xbbe21469,0xbbeea038
.long 0xbc48bd36,0xbc553db9,0xbc61bc2e,0xbc6e3876,0xbc964083,0xbc9f917b,0xbca8defc,0xbcb228d4
.long 0xbcc7c5c2,0xbcd41501,0xbce05c13,0xbcec9a7f,0xbcf8cfcc,0xbd040270,0xbd0b9507,0xbd131f35
.long 0xbd14a031,0xbd1d9e78,0xbd268f12,0xbd2f713a,0xbd2c7cd4,0xbd36ccc3,0xbd41071e,0xbd4b2aae
.long 0xbd43ef15,0xbd4f7bca,0xbd5ae880,0xbd663375,0xbd5ae880,0xbd679a5d,0xbd741f07,0xbd803a06
.long 0xbd715aea,0xbd7f17b2,0xbd864b82,0xbd8cead0,0xbd839c3d,0xbd8af1b7,0xbd921eb0,0xbd99210f
.long 0xbd8e39da,0xbd95f6d9,0xbd9d7fd1,0xbda4d225,0xbd987fc0,0xbda09393,0xbda86605,0xbdaff3e6
.long 0xbda26799,0xbdaac082,0xbdb2c8c9,0xbdba7ca4,0xbdabeb4a,0xbdb4768f,0xbdbca003,0xbdc46337
.long 0xbdb504f3,0xbdbdaef9,0xbdc5e403,0xbdcd9f02,0xbdbdaef9,0xbdc66354,0xbdce8d90,0xbdd627fe
.long 0xbdc5e403,0xbdce8d90,0xbdd695e5,0xbdddf6be,0xbdcd9f02,0xbdd627fe,0xbdddf6be,0xbde50479
.long 0xbdd4db31,0xbddd2d53,0xbde4aa59,0xbdeb4b0c,0xbddb941a,0xbde398ac,0xbdeaab7b,0xbdf0c501
.long 0xbde1c598,0xbde96591,0xbdeff573,0xbdf56d97,0xbde76bd8,0xbdee8ff8,0xbdf48422,0xbdf940c0
.long 0xbdec835e,0xbdf31447,0xbdf853f8,0xbdfc3b28,0xbdf10908,0xbdf6ef5b,0xbdfb61fc,0xbdfe5a38
.long 0xbdf4fa0b,0xbdfa1e84,0xbdfdabcc,0xbdff9c18,0xbdf853f8,0xbdfc9f8a,0xbdff2f9d,0xbdffffb1
.long 0xbdfb14be,0xbdfe70b0,0xbdffec43,0xbdff84ab,0xbdfd3aac,0xbdff90b1,0xbdffe129,0xbdfe2b72
.long 0xbdfec46d,0xbdfffec4,0xbdff0e58,0xbdfbf531,0xbdffb10f,0xbdffba9e,0xbdfd7474,0xbdf8e3d6
.long 0x80000000,0x80000000,0x80000000,0x80000000,0xbbfb2b74,0xbc03db0a,0xbc0a200a,0xbc1064b4
.long 0xbc7ab273,0xbc839502,0xbc89cf86,0xbc9008b7,0xbcbb6ecf,0xbcc4b0b9,0xbccdee60,0xbcd7278f
.long 0xbcf8cfcc,0xbd027dc0,0xbd088e93,0xbd0e9a22,0xbd1aa086,0xbd221887,0xbd2986c4,0xbd30eacb
.long 0xbd38442a,0xbd41071e,0xbd49b953,0xbd525a09,0xbd553641,0xbd5f28a9,0xbd6900b7,0xbd72bd43
.long 0xbd715aea,0xbd7c5d27,0xbd839c3d,0xbd88f59b,0xbd864b82,0xbd8c42c9,0xbd921eb0,0xbd97de12
.long 0xbd93682a,0xbd99c200,0xbd9ff6cb,0xbda6050a,0xbd9ff6cb,0xbda69de3,0xbdad1469,0xbdb3587a
.long 0xbdabeb4a,0xbdb2c8c9,0xbdb96842,0xbdbfc767,0xbdb73a23,0xbdbe35c5,0xbdc4e3f5,0xbdcb41fa
.long 0xbdc1d870,0xbdc8d8b3,0xbdcf7a1f,0xbdd5b993,0xbdcbbbf8,0xbdd2a649,0xbdd91e6a,0xbddf20db
.long 0xbdd4db31,0xbddb941a,0xbde1c598,0xbde76bd8,0xbddd2d53,0xbde398ac,0xbde96591,0xbdee8ff8
.long 0xbde4aa59,0xbdeaab7b,0xbdeff573,0xbdf48422,0xbdeb4b0c,0xbdf0c501,0xbdf56d97,0xbdf940c0
.long 0xbdf10908,0xbdf5dec6,0xbdf9c79d,0xbdfcbfc9,0xbdf5dec6,0xbdf9f35e,0xbdfcfe73,0xbdfefcc9
.long 0xbdf9c79d,0xbdfcfe73,0xbdff0e58,0xbdfff4e6,0xbdfcbfc9,0xbdfefcc9,0xbdfff4e6,0xbdffa6e3
.long 0xbdfec46d,0xbdffec43,0xbdffb10f,0xbdfe1324,0xbdffd397,0xbdffcbe2,0xbdfe4323,0xbdfb3bab
.long 0xbdffec43,0xbdfe9bc9,0xbdfbaccd,0xbdf72417,0xbdff0e58,0xbdfc5d3a,0xbdf7f110,0xbdf1d19f
.long 0xbdfd3aac,0xbdf91298,0xbdf31447,0xbdeb4b0c,0xbdfa7302,0xbdf4bf62,0xbded1c1d,0xbde398ac
.long 0xbdf6ba07,0xbdef6830,0xbde60f88,0xbddac450,0xbdf21352,0xbde912ae,0xbdddf6be,0xbdd0d937
.long 0x80000000,0x80000000,0x80000000,0x80000000,0xbc16a905,0xbc1cecf9,0xbc23308c,0xbc2973ba
.long 0xbc964083,0xbc9c76de,0xbca2abb6,0xbca8defc,0xbce05c13,0xbce98bba,0xbcf2b651,0xbcfbdba4
.long 0xbd14a031,0xbd1aa086,0xbd209ae5,0xbd268f12,0xbd38442a,0xbd3f926f,0xbd46d529,0xbd4e0bea
.long 0xbd5ae880,0xbd6363fa,0xbd6bcbbb,0xbd741f07,0xbd7c5d27,0xbd82ef9f,0xbd87a136,0xbd8c42c9
.long 0xbd8e39da,0xbd93682a,0xbd987fc0,0xbd9d7fd1,0xbd9d7fd1,0xbda302d3,0xbda86605,0xbdada859
.long 0xbdabeb4a,0xbdb1a81d,0xbdb73a23,0xbdbca003,0xbdb96842,0xbdbf41fc,0xbdc4e3f5,0xbdca4c87
.long 0xbdc5e403,0xbdcbbbf8,0xbdd14d3d,0xbdd695e5,0xbdd14d3d,0xbdd70348,0xbddc61c7,0xbde1668a
.long 0xbddb941a,0xbde106f2,0xbde60f88,0xbdeaab7b,0xbde4aa59,0xbde9b7e4,0xbdee46be,0xbdf25470
.long 0xbdec835e,0xbdf10908,0xbdf4fa0b,0xbdf853f8,0xbdf31447,0xbdf6ef5b,0xbdfa1e84,0xbdfc9f8a
.long 0xbdf853f8,0xbdfb61fc,0xbdfdabcc,0xbdff2f9d,0xbdfc3b28,0xbdfe5a38,0xbdff9c18,0xbdffffb1
.long 0xbdfec46d,0xbdffd397,0xbdffec43,0xbdff0e58,0xbdffec43,0xbdffcbe2,0xbdfe9bc9,0xbdfc5d3a
.long 0xbdffb10f,0xbdfe4323,0xbdfbaccd,0xbdf7f110,0xbdfe1324,0xbdfb3bab,0xbdf72417,0xbdf1d19f
.long 0xbdfb14be,0xbdf6ba07,0xbdf10908,0xbdea09a7,0xbdf6ba07,0xbdf0c501,0xbde96591,0xbde0a6cf
.long 0xbdf10908,0xbde96591,0xbde04621,0xbdd5b993,0xbdea09a7,0xbde0a6cf,0xbdd5b993,0xbdc95521
.long 0xbde1c598,0xbdd695e5,0xbdc9d112,0xbdbb8f3b,0xbdd84853,0xbdcb41fa,0xbdbca003,0xbdac800f
.long 0xbdcd9f02,0xbdbebc1b,0xbdae3bde,0xbd9c420c,0xbdc1d870,0xbdb11722,0xbd9ebc12,0xbd8af1b7
.long 0x80000000,0x80000000,0x80000000,0x80000000,0xbc2fb680,0xbc35f8da,0xbc3c3ac3,0xbc427c39
.long 0xbcaf10a2,0xbcb54098,0xbcbb6ecf,0xbcc19b37,0xbd027dc0,0xbd070ada,0xbd0b9507,0xbd101c2c
.long 0xbd2c7cd4,0xbd3263ef,0xbd38442a,0xbd3e1d4a,0xbd553641,0xbd5c53c1,0xbd6363fa,0xbd6a6681
.long 0xbd7c5d27,0xbd8242b1,0xbd864b82,0xbd8a48ad,0xbd90d3cd,0xbd9553b7,0xbd99c200,0xbd9e1e22
.long 0xbda26799,0xbda73656,0xbdabeb4a,0xbdb085bb,0xbdb2c8c9,0xbdb7c655,0xbdbca003,0xbdc154e1
.long 0xbdc1d870,0xbdc6e22a,0xbdcbbbf8,0xbdd064af,0xbdcf7a1f,0xbdd46b3b,0xbdd91e6a,0xbddd924d
.long 0xbddb941a,0xbde04621,0xbde4aa59,0xbde8bf3c,0xbde60f88,0xbdea5ad9,0xbdee46be,0xbdf1d19f
.long 0xbdeed89e,0xbdf294f8,0xbdf5dec6,0xbdf8b47b,0xbdf5dec6,0xbdf8e3d6,0xbdfb61fc,0xbdfd57de
.long 0xbdfb14be,0xbdfd3aac,0xbdfec46d,0xbdffb10f,0xbdfe70b0,0xbdff90b1,0xbdfffec4,0xbdffba9e
.long 0xbdffec43,0xbdffe129,0xbdff0e58,0xbdfd7474,0xbdff84ab,0xbdfe2b72,0xbdfbf531,0xbdf8e3d6
.long 0xbdfd3aac,0xbdfa7302,0xbdf6ba07,0xbdf21352,0xbdf91298,0xbdf4bf62,0xbdef6830,0xbde912ae
.long 0xbdf31447,0xbded1c1d,0xbde60f88,0xbdddf6be,0xbdeb4b0c,0xbde398ac,0xbddac450,0xbdd0d937
.long 0xbde1c598,0xbdd84853,0xbdcd9f02,0xbdc1d870,0xbdd695e5,0xbdcb41fa,0xbdbebc1b,0xbdb11722
.long 0xbdc9d112,0xbdbca003,0xbdae3bde,0xbd9ebc12,0xbdbb8f3b,0xbdac800f,0xbd9c420c,0xbd8af1b7
.long 0xbdabeb4a,0xbd9b02c6,0xbd88f59b,0xbd6bcbbb,0xbd9b02c6,0xbd884b92,0xbd6900b7,0xbd3f926f
.long 0xbd88f59b,0xbd6900b7,0xbd3e1d4a,0xbd119ddd,0xbd6bcbbb,0xbd3f926f,0xbd119ddd,0xbcc4b0b9
.long 0x80000000,0xbc48bd36,0xbcc7c5c2,0xbd14a031,0x80000000,0xbc4efdb7,0xbccdee60,0xbd1920fe
.long 0x80000000,0xbc553db9,0xbcd41501,0xbd1d9e78,0x80000000,0xbc5b7d37,0xbcda3997,0xbd221887
.long 0x80000000,0xbc61bc2e,0xbce05c13,0xbd268f12,0x80000000,0xbc67fa9a,0xbce67c66,0xbd2b0201
.long 0x80000000,0xbc6e3876,0xbcec9a7f,0xbd2f713a,0x80000000,0xbc7475c0,0xbcf2b651,0xbd33dca5
.long 0x80000000,0xbc7ab273,0xbcf8cfcc,0xbd38442a,0x80000000,0xbc807745,0xbcfee6e1,0xbd3ca7af
.long 0x80000000,0xbc839502,0xbd027dc0,0xbd41071e,0x80000000,0xbc86b26e,0xbd0586ce,0xbd45625c
.long 0x80000000,0xbc89cf86,0xbd088e93,0xbd49b953,0x80000000,0xbc8cec4a,0xbd0b9507,0xbd4e0bea
.long 0x80000000,0xbc9008b7,0xbd0e9a22,0xbd525a09,0x80000000,0xbc9324ca,0xbd119ddd,0xbd56a399
.long 0x80000000,0xbc964083,0xbd14a031,0xbd5ae880,0x80000000,0xbc995be0,0xbd17a117,0xbd5f28a9
.long 0x80000000,0xbc9c76de,0xbd1aa086,0xbd6363fa,0x80000000,0xbc9f917b,0xbd1d9e78,0xbd679a5d
.long 0x80000000,0xbca2abb6,0xbd209ae5,0xbd6bcbbb,0x80000000,0xbca5c58c,0xbd2395c5,0xbd6ff7fb
.long 0x80000000,0xbca8defc,0xbd268f12,0xbd741f07,0x80000000,0xbcabf804,0xbd2986c4,0xbd7840c8
.long 0x80000000,0xbcaf10a2,0xbd2c7cd4,0xbd7c5d27,0x80000000,0xbcb228d4,0xbd2f713a,0xbd803a06
.long 0x80000000,0xbcb54098,0xbd3263ef,0xbd8242b1,0x80000000,0xbcb857ec,0xbd3554ec,0xbd844889
.long 0x80000000,0xbcbb6ecf,0xbd38442a,0xbd864b82,0x80000000,0xbcbe853e,0xbd3b31a0,0xbd884b92
.long 0x80000000,0xbcc19b37,0xbd3e1d4a,0xbd8a48ad,0x80000000,0xbcc4b0b9,0xbd41071e,0xbd8c42c9
.long 0xbd43ef15,0xbd715aea,0xbd8e39da,0xbda26799,0xbd49b953,0xbd7840c8,0xbd921eb0,0xbda69de3
.long 0xbd4f7bca,0xbd7f17b2,0xbd95f6d9,0xbdaac082,0xbd553641,0xbd82ef9f,0xbd99c200,0xbdaecef7
.long 0xbd5ae880,0xbd864b82,0xbd9d7fd1,0xbdb2c8c9,0xbd60924f,0xbd899f4e,0xbda12ff9,0xbdb6ad7f
.long 0xbd663375,0xbd8cead0,0xbda4d225,0xbdba7ca4,0xbd6bcbbb,0xbd902dd5,0xbda86605,0xbdbe35c5
.long 0xbd715aea,0xbd93682a,0xbdabeb4a,0xbdc1d870,0xbd76e0cb,0xbd96999f,0xbdaf61a5,0xbdc56439
.long 0xbd7c5d27,0xbd99c200,0xbdb2c8c9,0xbdc8d8b3,0xbd80e7e4,0xbd9ce11f,0xbdb6206c,0xbdcc3578
.long 0xbd839c3d,0xbd9ff6cb,0xbdb96842,0xbdcf7a1f,0xbd864b82,0xbda302d3,0xbdbca003,0xbdd2a649
.long 0xbd88f59b,0xbda6050a,0xbdbfc767,0xbdd5b993,0xbd8b9a6b,0xbda8fd41,0xbdc2de29,0xbdd8b3a1
.long 0xbd8e39da,0xbdabeb4a,0xbdc5e403,0xbddb941a,0xbd90d3cd,0xbdaecef7,0xbdc8d8b3,0xbdde5aa6
.long 0xbd93682a,0xbdb1a81d,0xbdcbbbf8,0xbde106f2,0xbd95f6d9,0xbdb4768f,0xbdce8d90,0xbde398ac
.long 0xbd987fc0,0xbdb73a23,0xbdd14d3d,0xbde60f88,0xbd9b02c6,0xbdb9f2ac,0xbdd3fac3,0xbde86b39
.long 0xbd9d7fd1,0xbdbca003,0xbdd695e5,0xbdeaab7b,0xbd9ff6cb,0xbdbf41fc,0xbdd91e6a,0xbdecd007
.long 0xbda26799,0xbdc1d870,0xbddb941a,0xbdeed89e,0xbda4d225,0xbdc46337,0xbdddf6be,0xbdf0c501
.long 0xbda73656,0xbdc6e22a,0xbde04621,0xbdf294f8,0xbda99415,0xbdc95521,0xbde28210,0xbdf4484b
.long 0xbdabeb4a,0xbdcbbbf8,0xbde4aa59,0xbdf5dec6,0xbdae3bde,0xbdce1689,0xbde6becc,0xbdf7583a
.long 0xbdb085bb,0xbdd064af,0xbde8bf3c,0xbdf8b47b,0xbdb2c8c9,0xbdd2a649,0xbdeaab7b,0xbdf9f35e
.long 0xbdb504f3,0xbdc5e403,0xbdd4db31,0xbde1c598,0xbdb96842,0xbdca4c87,0xbdd91e6a,0xbde5b710
.long 0xbdbdaef9,0xbdce8d90,0xbddd2d53,0xbde96591,0xbdc1d870,0xbdd2a649,0xbde106f2,0xbdecd007
.long 0xbdc5e403,0xbdd695e5,0xbde4aa59,0xbdeff573,0xbdc9d112,0xbdda5ba0,0xbde816a8,0xbdf2d4eb
.long 0xbdcd9f02,0xbdddf6be,0xbdeb4b0c,0xbdf56d97,0xbdd14d3d,0xbde1668a,0xbdee46be,0xbdf7beb7
.long 0xbdd4db31,0xbde4aa59,0xbdf10908,0xbdf9c79d,0xbdd84853,0xbde7c187,0xbdf3913f,0xbdfb87b2
.long 0xbddb941a,0xbdeaab7b,0xbdf5dec6,0xbdfcfe73,0xbddebe05,0xbded67a1,0xbdf7f110,0xbdfe2b72
.long 0xbde1c598,0xbdeff573,0xbdf9c79d,0xbdff0e58,0xbde4aa59,0xbdf25470,0xbdfb61fc,0xbdffa6e3
.long 0xbde76bd8,0xbdf48422,0xbdfcbfc9,0xbdfff4e6,0xbdea09a7,0xbdf6841b,0xbdfde0b1,0xbdfff84a
.long 0xbdec835e,0xbdf853f8,0xbdfec46d,0xbdffb10f,0xbdeed89e,0xbdf9f35e,0xbdff6ac7,0xbdff1f49
.long 0xbdf10908,0xbdfb61fc,0xbdffd397,0xbdfe4323,0xbdf31447,0xbdfc9f8a,0xbdfffec4,0xbdfd1cdd
.long 0xbdf4fa0b,0xbdfdabcc,0xbdffec43,0xbdfbaccd,0xbdf6ba07,0xbdfe868b,0xbdff9c18,0xbdf9f35e
.long 0xbdf853f8,0xbdff2f9d,0xbdff0e58,0xbdf7f110,0xbdf9c79d,0xbdffa6e3,0xbdfe4323,0xbdf5a67b
.long 0xbdfb14be,0xbdffec43,0xbdfd3aac,0xbdf31447,0xbdfc3b28,0xbdffffb1,0xbdfbf531,0xbdf03b37
.long 0xbdfd3aac,0xbdffe129,0xbdfa7302,0xbded1c1d,0xbdfe1324,0xbdff90b1,0xbdf8b47b,0xbde9b7e4
.long 0xbdfec46d,0xbdff0e58,0xbdf6ba07,0xbde60f88,0xbdff4e6d,0xbdfe5a38,0xbdf48422,0xbde2241a
.long 0xbdffb10f,0xbdfd7474,0xbdf21352,0xbdddf6be,0xbdffec43,0xbdfc5d3a,0xbdef6830,0xbdd988ad
.long 0xbdec835e,0xbdf4fa0b,0xbdfb14be,0xbdfec46d,0xbdeff573,0xbdf7beb7,0xbdfcfe73,0xbdffa6e3
.long 0xbdf31447,0xbdfa1e84,0xbdfe70b0,0xbdfffec4,0xbdf5dec6,0xbdfc187a,0xbdff6ac7,0xbdffcbe2
.long 0xbdf853f8,0xbdfdabcc,0xbdffec43,0xbdff0e58,0xbdfa7302,0xbdfed7d4,0xbdfff4e6,0xbdfdc68c
.long 0xbdfc3b28,0xbdff9c18,0xbdff84ab,0xbdfbf531,0xbdfdabcc,0xbdfff84a,0xbdfe9bc9,0xbdf99b43
.long 0xbdfec46d,0xbdffec43,0xbdfd3aac,0xbdf6ba07,0xbdff84ab,0xbdff7808,0xbdfb61fc,0xbdf3530e
.long 0xbdffec43,0xbdfe9bc9,0xbdf91298,0xbdef6830,0xbdfffb11,0xbdfd57de,0xbdf64d97,0xbdeafb8c
.long 0xbdffb10f,0xbdfbaccd,0xbdf31447,0xbde60f88,0xbdff0e58,0xbdf99b43,0xbdef6830,0xbde0a6cf
.long 0xbdfe1324,0xbdf72417,0xbdeb4b0c,0xbddac450,0xbdfcbfc9,0xbdf4484b,0xbde6becc,0xbdd46b3b
.long 0xbdfb14be,0xbdf10908,0xbde1c598,0xbdcd9f02,0xbdf91298,0xbded67a1,0xbddc61c7,0xbdc66354
.long 0xbdf6ba07,0xbde96591,0xbdd695e5,0xbdbebc1b,0xbdf40bdd,0xbde50479,0xbdd064af,0xbdb6ad7f
.long 0xbdf10908,0xbde04621,0xbdc9d112,0xbdae3bde,0xbdedb293,0xbddb2c79,0xbdc2de29,0xbda56bcb
.long 0xbdea09a7,0xbdd5b993,0xbdbb8f3b,0xbd9c420c,0xbde60f88,0xbdcfefa8,0xbdb3e7bc,0xbd92c39a
.long 0xbde1c598,0xbdc9d112,0xbdabeb4a,0xbd88f59b,0xbddd2d53,0xbdc36051,0xbda39da9,0xbd7dbabb
.long 0xbdd84853,0xbdbca003,0xbd9b02c6,0xbd6900b7,0xbdd31849,0xbdb592e7,0xbd921eb0,0xbd53c867
.long 0xbdcd9f02,0xbdae3bde,0xbd88f59b,0xbd3e1d4a,0xbdc7de65,0xbda69de3,0xbd7f17b2,0xbd280b1f
.long 0xbdc1d870,0xbd9ebc12,0xbd6bcbbb,0xbd119ddd,0xbdbb8f3b,0xbd96999f,0xbd58106b,0xbcf5c35a
.long 0xbe000000,0xbdfec46d,0xbdfb14be,0xbdf4fa0b,0xbdffb10f,0xbdfd1cdd,0xbdf7f110,0xbdf03b37
.long 0xbdfec46d,0xbdfac516,0xbdf40bdd,0xbdeaab7b,0xbdfd3aac,0xbdf7beb7,0xbdef6830,0xbde44fac
.long 0xbdfb14be,0xbdf40bdd,0xbdea09a7,0xbddd2d53,0xbdf853f8,0xbdefaf1b,0xbde3f473,0xbdd54aa4
.long 0xbdf4fa0b,0xbdeaab7b,0xbddd2d53,0xbdccae79,0xbdf10908,0xbde50479,0xbdd5b993,0xbdc36051
.long 0xbdec835e,0xbddebe05,0xbdcd9f02,0xbdb96842,0xbde76bd8,0xbdd7dc7f,0xbdc4e3f5,0xbdaecef7
.long 0xbde1c598,0xbdd064af,0xbdbb8f3b,0xbda39da9,0xbddb941a,0xbdc85bca,0xbdb1a81d,0xbd97de12
.long 0xbdd4db31,0xbdbfc767,0xbda73656,0xbd8b9a6b,0xbdcd9f02,0xbdb6ad7f,0xbd9c420c,0xbd7dbabb
.long 0xbdc5e403,0xbdad1469,0xbd90d3cd,0xbd6363fa,0xbdbdaef9,0xbda302d3,0xbd84f484,0xbd48477c
.long 0xbdb504f3,0xbd987fc0,0xbd715aea,0xbd2c7cd4,0xbdabeb4a,0xbd8d9281,0xbd58106b,0xbd101c2c
.long 0xbda26799,0xbd8242b1,0xbd3e1d4a,0xbce67c66,0xbd987fc0,0xbd6d3063,0xbd2395c5,0xbcabf804
.long 0xbd8e39da,0xbd553641,0xbd088e93,0xbc61bc2e,0xbd839c3d,0xbd3ca7af,0xbcda3997,0xbbd5880e
.long 0xbd715aea,0xbd2395c5,0xbca2abb6,0x3a490f88,0xbd5ae880,0xbd0a11f7,0xbc553db9,0x3c03db0a
.long 0xbd43ef15,0xbce05c13,0xbbc8fb30,0x3c7ab273,0xbd2c7cd4,0xbcabf804,0x3a490f88,0x3cb857ec
.long 0xbd14a031,0xbc6e3876,0x3bfb2b74,0x3cf2b651,0xbcf8cfcc,0xbc03db0a,0x3c6e3876,0x3d1620d2
.long 0xbcc7c5c2,0xbac90e90,0x3caf10a2,0x3d3263ef,0xbc964083,0x3ba351cb,0x3ce67c66,0x3d4e0bea
.long 0xbc48bd36,0x3c3c3ac3,0x3d0e9a22,0x3d6900b7,0xbbc8fb30,0x3c9324ca,0x3d2986c4,0x3d819573
.long 0xbdec835e,0xbde1c598,0xbdd4db31,0xbdc5e403,0xbde60f88,0xbdd988ad,0xbdcac77f,0xbdb9f2ac
.long 0xbddebe05,0xbdd064af,0xbdbfc767,0xbdad1469,0xbdd695e5,0xbdc66354,0xbdb3e7bc,0xbd9f599f
.long 0xbdcd9f02,0xbdbb8f3b,0xbda73656,0xbd90d3cd,0xbdc3e200,0xbdaff3e6,0xbd99c200,0xbd819573
.long 0xbdb96842,0xbda39da9,0xbd8b9a6b,0xbd6363fa,0xbdae3bde,0xbd96999f,0xbd79a02d,0xbd427b55
.long 0xbda26799,0xbd88f59b,0xbd5ae880,0xbd209ae5,0xbd95f6d9,0xbd758035,0xbd3b31a0,0xbcfbdba4
.long 0xbd88f59b,0xbd58106b,0xbd1aa086,0xbcb54098,0xbd76e0cb,0xbd39bb1e,0xbcf2b651,0xbc5b7d37
.long 0xbd5ae880,0xbd1aa086,0xbcaf10a2,0xbb96c32c,0xbd3e1d4a,0xbcf5c35a,0xbc553db9,0x3b8a342f
.long 0xbd209ae5,0xbcb54098,0xbb96c32c,0x3c553db9,0xbd027dc0,0xbc67fa9a,0x3b7b49ba,0x3cb228d4
.long 0xbcc7c5c2,0xbbc8fb30,0x3c48bd36,0x3cf8cfcc,0xbc89cf86,0x3afb514b,0x3ca8defc,0x3d1f1cdf
.long 0xbc16a905,0x3c23308c,0x3cec9a7f,0x3d41071e,0xbac90e90,0x3c9324ca,0x3d17a117,0x3d61fb6a
.long 0x3bc8fb30,0x3cd41501,0x3d38442a,0x3d80e7e4,0x3c61bc2e,0x3d0a11f7,0x3d58106b,0x3d902dd5
.long 0x3caf10a2,0x3d2986c4,0x3d76e0cb,0x3d9ebc12,0x3cec9a7f,0x3d48477c,0x3d8a48ad,0x3dac800f
.long 0x3d14a031,0x3d663375,0x3d987fc0,0x3db96842,0x3d3263ef,0x3d819573,0x3da6050a,0x3dc56439
.long 0x3d4f7bca,0x3d8f8784,0x3db2c8c9,0x3dd064af,0x3d6bcbbb,0x3d9ce11f,0x3dbebc1b,0x3dda5ba0
.long 0x3d839c3d,0x3da99415,0x3dc9d112,0x3de33c5a,0x3d90d3cd,0x3db592e7,0x3dd3fac3,0x3deafb8c
.long 0x3d9d7fd1,0x3dc0d0da,0x3ddd2d53,0x3df18f57,0x3da99415,0x3dcb41fa,0x3de55e0b,0x3df6ef5b
.long 0xbdb504f3,0xbda26799,0xbd8e39da,0xbd715aea,0xbda73656,0xbd92c39a,0xbd79a02d,0xbd4b2aae
.long 0xbd987fc0,0xbd8242b1,0xbd553641,0xbd2395c5,0xbd88f59b,0xbd61fb6a,0xbd2f713a,0xbcf5c35a
.long 0xbd715aea,0xbd3e1d4a,0xbd088e93,0xbca2abb6,0xbd4f7bca,0xbd1920fe,0xbcc19b37,0xbc1cecf9
.long 0xbd2c7cd4,0xbce67c66,0xbc61bc2e,0x3a490f88,0xbd088e93,0xbc995be0,0xbb7b49ba,0x3c35f8da
.long 0xbcc7c5c2,0xbc16a905,0x3bc8fb30,0x3caf10a2,0xbc7ab273,0x39c90fc6,0x3c839502,0x3d00f8c0
.long 0xbbc8fb30,0x3c23308c,0x3cd41501,0x3d2986c4,0x3b490ab0,0x3c9f917b,0x3d119ddd,0x3d50eb2a
.long 0x3c48bd36,0x3cec9a7f,0x3d38442a,0x3d76e0cb,0x3caf10a2,0x3d1c1faf,0x3d5dbe79,0x3d8d9281
.long 0x3cf8cfcc,0x3d41071e,0x3d80e7e4,0x3d9ebc12,0x3d209ae5,0x3d64cbfe,0x3d921eb0,0x3daecef7
.long 0x3d43ef15,0x3d839c3d,0x3da26799,0x3dbdaef9,0x3d663375,0x3d940c5f,0x3db1a81d,0x3dcb41fa
.long 0x3d839c3d,0x3da39da9,0x3dbfc767,0x3dd77026,0x3d93682a,0x3db238aa,0x3dccae79,0x3de2241a
.long 0x3da26799,0x3dbfc767,0x3dd84853,0x3deb4b0c,0x3db085bb,0x3dcc3578,0x3de28210,0x3df2d4eb
.long 0x3dbdaef9,0x3dd77026,0x3deb4b0c,0x3df8b47b,0x3dc9d112,0x3de1668a,0x3df294f8,0x3dfcdf6c
.long 0x3dd4db31,0x3dea09a7,0x3df853f8,0x3dff4e6d,0x3ddebe05,0x3df14c7a,0x3dfc7eb0,0x3dfffd39
.long 0x3de76bd8,0x3df72417,0x3dff0e58,0x3dfeea9d,0x3deed89e,0x3dfb87b2,0x3dfffec4,0x3dfc187a
.long 0x3df4fa0b,0x3dfe70b0,0x3dff4e6d,0x3df78bc5,0x3df9c79d,0x3dffdaaf,0x3dfcfe73,0x3df14c7a
.long 0x3dfd3aac,0x3dffc38f,0x3df91298,0x3de96591,0x3dff4e6d,0x3dfe2b72,0x3df3913f,0x3ddfe4e9
.long 0xbd43ef15,0xbd14a031,0xbcc7c5c2,0xbc48bd36,0xbd1aa086,0xbcd101f1,0xbc553db9,0xb9c90fc6
.long 0xbce05c13,0xbc6e3876,0xbac90e90,0x3c3c3ac3,0xbc89cf86,0xbb622a7a,0x3c23308c,0x3cbe853e
.long 0xbbc8fb30,0x3bfb2b74,0x3caf10a2,0x3d0e9a22,0x3b96c32c,0x3c995be0,0x3d0586ce,0x3d3ca7af
.long 0x3c7ab273,0x3cf2b651,0x3d3263ef,0x3d6900b7,0x3cd41501,0x3d25129f,0x3d5dbe79,0x3d899f4e
.long 0x3d14a031,0x3d4f7bca,0x3d839c3d,0x3d9d7fd1,0x3d3e1d4a,0x3d7840c8,0x3d973c07,0x3daff3e6
.long 0x3d663375,0x3d8f8784,0x3da99415,0x3dc0d0da,0x3d864b82,0x3da1cbfb,0x3dba7ca4,0x3dcfefa8
.long 0x3d987fc0,0x3db2c8c9,0x3dc9d112,0x3ddd2d53,0x3da99415,0x3dc25b89,0x3dd77026,0x3de86b39
.long 0x3db96842,0x3dd064af,0x3de33c5a,0x3df18f57,0x3dc7de65,0x3ddcc7d1,0x3ded1c1d,0x3df88486
.long 0x3dd4db31,0x3de76bd8,0x3df4fa0b,0x3dfd3aac,0x3de04621,0x3df03b37,0x3dfac516,0x3dffa6e3
.long 0x3dea09a7,0x3df72417,0x3dfe70b0,0x3dffc38f,0x3df21352,0x3dfc187a,0x3dfff4e6,0x3dfd906e
.long 0x3df853f8,0x3dff0e58,0x3dff4e6d,0x3df91298,0x3dfcbfc9,0x3dffffb1,0x3dfc7eb0,0x3df25470
.long 0x3dff4e6d,0x3dfeea9d,0x3df78bc5,0x3de96591,0x3dfffb11,0x3dfbd14d,0x3df08066,0x3dde5aa6
.long 0x3dfec46d,0x3df6ba07,0x3de76bd8,0x3dd14d3d,0x3dfbaccd,0x3defaf1b,0x3ddc61c7,0x3dc25b89
.long 0x3df6ba07,0x3de6becc,0x3dcf7a1f,0x3db1a81d,0x3deff573,0x3ddbfb34,0x3dc0d0da,0x3d9f599f
.long 0x3de76bd8,0x3dcf7a1f,0x3db085bb,0x3d8b9a6b,0x3ddd2d53,0x3dc154e1,0x3d9ebc12,0x3d6d3063
.long 0x3dd14d3d,0x3db1a81d,0x3d8b9a6b,0x3d41071e,0x3dc3e200,0x3da09393,0x3d6e9479,0x3d131f35
.long 0x3d000000,0x3d000000,0x3d000000,0x3d000000,0x3d000000,0x3cffffb1,0x3cfffec4,0x3cfffd39
.long 0x3d000000,0x3cfffec4,0x3cfffb11,0x3cfff4e6,0x3d000000,0x3cfffd39,0x3cfff4e6,0x3cffe705
.long 0x3d000000,0x3cfffb11,0x3cffec43,0x3cffd397,0x3d000000,0x3cfff84a,0x3cffe129,0x3cffba9e
.long 0x3d000000,0x3cfff4e6,0x3cffd397,0x3cff9c18,0x3d000000,0x3cfff0e3,0x3cffc38f,0x3cff7808
.long 0x3d000000,0x3cffec43,0x3cffb10f,0x3cff4e6d,0x3d000000,0x3cffe705,0x3cff9c18,0x3cff1f49
.long 0x3d000000,0x3cffe129,0x3cff84ab,0x3cfeea9d,0x3d000000,0x3cffdaaf,0x3cff6ac7,0x3cfeb069
.long 0x3d000000,0x3cffd397,0x3cff4e6d,0x3cfe70b0,0x3d000000,0x3cffcbe2,0x3cff2f9d,0x3cfe2b72
.long 0x3d000000,0x3cffc38f,0x3cff0e58,0x3cfde0b1,0x3d000000,0x3cffba9e,0x3cfeea9d,0x3cfd906e
.long 0x3d000000,0x3cffb10f,0x3cfec46d,0x3cfd3aac,0x3d000000,0x3cffa6e3,0x3cfe9bc9,0x3cfcdf6c
.long 0x3d000000,0x3cff9c18,0x3cfe70b0,0x3cfc7eb0,0x3d000000,0x3cff90b1,0x3cfe4323,0x3cfc187a
.long 0x3d000000,0x3cff84ab,0x3cfe1324,0x3cfbaccd,0x3d000000,0x3cff7808,0x3cfde0b1,0x3cfb3bab
.long 0x3d000000,0x3cff6ac7,0x3cfdabcc,0x3cfac516,0x3d000000,0x3cff5ce9,0x3cfd7474,0x3cfa4910
.long 0x3d000000,0x3cff4e6d,0x3cfd3aac,0x3cf9c79d,0x3d000000,0x3cff3f54,0x3cfcfe73,0x3cf940c0
.long 0x3d000000,0x3cff2f9d,0x3cfcbfc9,0x3cf8b47b,0x3d000000,0x3cff1f49,0x3cfc7eb0,0x3cf822d1
.long 0x3d000000,0x3cff0e58,0x3cfc3b28,0x3cf78bc5,0x3d000000,0x3cfefcc9,0x3cfbf531,0x3cf6ef5b
.long 0x3d000000,0x3cfeea9d,0x3cfbaccd,0x3cf64d97,0x3d000000,0x3cfed7d4,0x3cfb61fc,0x3cf5a67b
.long 0x3d000000,0x3d000000,0x3d000000,0x3d000000,0x3cfffb11,0x3cfff84a,0x3cfff4e6,0x3cfff0e3
.long 0x3cffec43,0x3cffe129,0x3cffd397,0x3cffc38f,0x3cffd397,0x3cffba9e,0x3cff9c18,0x3cff7808
.long 0x3cffb10f,0x3cff84ab,0x3cff4e6d,0x3cff0e58,0x3cff84ab,0x3cff3f54,0x3cfeea9d,0x3cfe868b
.long 0x3cff4e6d,0x3cfeea9d,0x3cfe70b0,0x3cfde0b1,0x3cff0e58,0x3cfe868b,0x3cfde0b1,0x3cfd1cdd
.long 0x3cfec46d,0x3cfe1324,0x3cfd3aac,0x3cfc3b28,0x3cfe70b0,0x3cfd906e,0x3cfc7eb0,0x3cfb3bab
.long 0x3cfe1324,0x3cfcfe73,0x3cfbaccd,0x3cfa1e84,0x3cfdabcc,0x3cfc5d3a,0x3cfac516,0x3cf8e3d6
.long 0x3cfd3aac,0x3cfbaccd,0x3cf9c79d,0x3cf78bc5,0x3cfcbfc9,0x3cfaed37,0x3cf8b47b,0x3cf6167a
.long 0x3cfc3b28,0x3cfa1e84,0x3cf78bc5,0x3cf48422,0x3cfbaccd,0x3cf940c0,0x3cf64d97,0x3cf2d4eb
.long 0x3cfb14be,0x3cf853f8,0x3cf4fa0b,0x3cf10908,0x3cfa7302,0x3cf7583a,0x3cf3913f,0x3cef20b0
.long 0x3cf9c79d,0x3cf64d97,0x3cf21352,0x3ced1c1d,0x3cf91298,0x3cf5341d,0x3cf08066,0x3ceafb8c
.long 0x3cf853f8,0x3cf40bdd,0x3ceed89e,0x3ce8bf3c,0x3cf78bc5,0x3cf2d4eb,0x3ced1c1d,0x3ce66771
.long 0x3cf6ba07,0x3cf18f57,0x3ceb4b0c,0x3ce3f473,0x3cf5dec6,0x3cf03b37,0x3ce96591,0x3ce1668a
.long 0x3cf4fa0b,0x3ceed89e,0x3ce76bd8,0x3cdebe05,0x3cf40bdd,0x3ced67a1,0x3ce55e0b,0x3cdbfb34
.long 0x3cf31447,0x3cebe858,0x3ce33c5a,0x3cd91e6a,0x3cf21352,0x3cea5ad9,0x3ce106f2,0x3cd627fe
.long 0x3cf10908,0x3ce8bf3c,0x3cdebe05,0x3cd31849,0x3ceff573,0x3ce71599,0x3cdc61c7,0x3ccfefa8
.long 0x3ceed89e,0x3ce55e0b,0x3cd9f26a,0x3cccae79,0x3cedb293,0x3ce398ac,0x3cd77026,0x3cc95521
.long 0x3d000000,0x3d000000,0x3d000000,0x3d000000,0x3cffec43,0x3cffe705,0x3cffe129,0x3cffdaaf
.long 0x3cffb10f,0x3cff9c18,0x3cff84ab,0x3cff6ac7,0x3cff4e6d,0x3cff1f49,0x3cfeea9d,0x3cfeb069
.long 0x3cfec46d,0x3cfe70b0,0x3cfe1324,0x3cfdabcc,0x3cfe1324,0x3cfd906e,0x3cfcfe73,0x3cfc5d3a
.long 0x3cfd3aac,0x3cfc7eb0,0x3cfbaccd,0x3cfac516,0x3cfc3b28,0x3cfb3bab,0x3cfa1e84,0x3cf8e3d6
.long 0x3cfb14be,0x3cf9c79d,0x3cf853f8,0x3cf6ba07,0x3cf9c79d,0x3cf822d1,0x3cf64d97,0x3cf4484b
.long 0x3cf853f8,0x3cf64d97,0x3cf40bdd,0x3cf18f57,0x3cf6ba07,0x3cf4484b,0x3cf18f57,0x3cee8ff8
.long 0x3cf4fa0b,0x3cf21352,0x3ceed89e,0x3ceb4b0c,0x3cf31447,0x3cefaf1b,0x3cebe858,0x3ce7c187
.long 0x3cf10908,0x3ced1c1d,0x3ce8bf3c,0x3ce3f473,0x3ceed89e,0x3cea5ad9,0x3ce55e0b,0x3cdfe4e9
.long 0x3cec835e,0x3ce76bd8,0x3ce1c598,0x3cdb941a,0x3cea09a7,0x3ce44fac,0x3cddf6be,0x3cd70348
.long 0x3ce76bd8,0x3ce106f2,0x3cd9f26a,0x3cd233c6,0x3ce4aa59,0x3cdd924d,0x3cd5b993,0x3ccd26fd
.long 0x3ce1c598,0x3cd9f26a,0x3cd14d3d,0x3cc7de65,0x3cdebe05,0x3cd627fe,0x3cccae79,0x3cc25b89
.long 0x3cdb941a,0x3cd233c6,0x3cc7de65,0x3cbca003,0x3cd84853,0x3cce1689,0x3cc2de29,0x3cb6ad7f
.long 0x3cd4db31,0x3cc9d112,0x3cbdaef9,0x3cb085bb,0x3cd14d3d,0x3cc56439,0x3cb85216,0x3caa2a80
.long 0x3ccd9f02,0x3cc0d0da,0x3cb2c8c9,0x3ca39da9,0x3cc9d112,0x3cbc17d9,0x3cad1469,0x3c9ce11f
.long 0x3cc5e403,0x3cb73a23,0x3ca73656,0x3c95f6d9,0x3cc1d870,0x3cb238aa,0x3ca12ff9,0x3c8ee0db
.long 0x3cbdaef9,0x3cad1469,0x3c9b02c6,0x3c87a136,0x3cb96842,0x3ca7ce61,0x3c94b039,0x3c803a06
.long 0x3d000000,0x3d000000,0x3d000000,0x3d000000,0x3cffd397,0x3cffcbe2,0x3cffc38f,0x3cffba9e
.long 0x3cff4e6d,0x3cff2f9d,0x3cff0e58,0x3cfeea9d,0x3cfe70b0,0x3cfe2b72,0x3cfde0b1,0x3cfd906e
.long 0x3cfd3aac,0x3cfcbfc9,0x3cfc3b28,0x3cfbaccd,0x3cfbaccd,0x3cfaed37,0x3cfa1e84,0x3cf940c0
.long 0x3cf9c79d,0x3cf8b47b,0x3cf78bc5,0x3cf64d97,0x3cf78bc5,0x3cf6167a,0x3cf48422,0x3cf2d4eb
.long 0x3cf4fa0b,0x3cf31447,0x3cf10908,0x3ceed89e,0x3cf21352,0x3cefaf1b,0x3ced1c1d,0x3cea5ad9
.long 0x3ceed89e,0x3cebe858,0x3ce8bf3c,0x3ce55e0b,0x3ceb4b0c,0x3ce7c187,0x3ce3f473,0x3cdfe4e9
.long 0x3ce76bd8,0x3ce33c5a,0x3cdebe05,0x3cd9f26a,0x3ce33c5a,0x3cde5aa6,0x3cd91e6a,0x3cd389c7
.long 0x3cdebe05,0x3cd91e6a,0x3cd31849,0x3cccae79,0x3cd9f26a,0x3cd389c7,0x3cccae79,0x3cc56439
.long 0x3cd4db31,0x3ccd9f02,0x3cc5e403,0x3cbdaef9,0x3ccf7a1f,0x3cc76085,0x3cbebc1b,0x3cb592e7
.long 0x3cc9d112,0x3cc0d0da,0x3cb73a23,0x3cad1469,0x3cc3e200,0x3cb9f2ac,0x3caf61a5,0x3ca4381a
.long 0x3cbdaef9,0x3cb2c8c9,0x3ca73656,0x3c9b02c6,0x3cb73a23,0x3cab561b,0x3c9ebc12,0x3c91796b
.long 0x3cb085bb,0x3ca39da9,0x3c95f6d9,0x3c87a136,0x3ca99415,0x3c9ba299,0x3c8cead0,0x3c7afef7
.long 0x3ca26799,0x3c93682a,0x3c839c3d,0x3c663375,0x3c9b02c6,0x3c8af1b7,0x3c741f07,0x3c50eb2a
.long 0x3c93682a,0x3c8242b1,0x3c60924f,0x3c3b31a0,0x3c8b9a6b,0x3c72bd43,0x3c4c9b8b,0x3c25129f
.long 0x3c839c3d,0x3c60924f,0x3c38442a,0x3c0e9a22,0x3c76e0cb,0x3c4e0bea,0x3c2395c5,0x3befa8b2
.long 0x3c663375,0x3c3b31a0,0x3c0e9a22,0x3bc19b37,0x3c553641,0x3c280b1f,0x3bf2b651,0x3b9324ca
.long 0x3d000000,0x3d000000,0x3d000000,0x3d000000,0x3cffb10f,0x3cffa6e3,0x3cff9c18,0x3cff90b1
.long 0x3cfec46d,0x3cfe9bc9,0x3cfe70b0,0x3cfe4323,0x3cfd3aac,0x3cfcdf6c,0x3cfc7eb0,0x3cfc187a
.long 0x3cfb14be,0x3cfa7302,0x3cf9c79d,0x3cf91298,0x3cf853f8,0x3cf7583a,0x3cf64d97,0x3cf5341d
.long 0x3cf4fa0b,0x3cf3913f,0x3cf21352,0x3cf08066,0x3cf10908,0x3cef20b0,0x3ced1c1d,0x3ceafb8c
.long 0x3cec835e,0x3cea09a7,0x3ce76bd8,0x3ce4aa59,0x3ce76bd8,0x3ce44fac,0x3ce106f2,0x3cdd924d
.long 0x3ce1c598,0x3cddf6be,0x3cd9f26a,0x3cd5b993,0x3cdb941a,0x3cd70348,0x3cd233c6,0x3ccd26fd
.long 0x3cd4db31,0x3ccf7a1f,0x3cc9d112,0x3cc3e200,0x3ccd9f02,0x3cc76085,0x3cc0d0da,0x3cb9f2ac
.long 0x3cc5e403,0x3cbebc1b,0x3cb73a23,0x3caf61a5,0x3cbdaef9,0x3cb592e7,0x3cad1469,0x3ca4381a
.long 0x3cb504f3,0x3cabeb4a,0x3ca26799,0x3c987fc0,0x3cabeb4a,0x3ca1cbfb,0x3c973c07,0x3c8c42c9
.long 0x3ca26799,0x3c973c07,0x3c8b9a6b,0x3c7f17b2,0x3c987fc0,0x3c8c42c9,0x3c7f17b2,0x3c64cbfe
.long 0x3c8e39da,0x3c80e7e4,0x3c663375,0x3c49b953,0x3c839c3d,0x3c6a6681,0x3c4c9b8b,0x3c2df73c
.long 0x3c715aea,0x3c525a09,0x3c3263ef,0x3c119ddd,0x3c5ae880,0x3c39bb1e,0x3c17a117,0x3be98bba
.long 0x3c43ef15,0x3c209ae5,0x3bf8cfcc,0x3baf10a2,0x3c2c7cd4,0x3c070ada,0x3bc19b37,0x3b67fa9a
.long 0x3c14a031,0x3bda3997,0x3b89cf86,0x3ae21469,0x3bf8cfcc,0x3ba5c58c,0x3b23308c,0xb8c90fc6
.long 0x3bc7c5c2,0x3b61bc2e,0x3a490ab0,0xbafb2b74,0x3b964083,0x3aeea038,0xba7b49ba,0xbb7475c0
.long 0x3b48bd36,0x39490f88,0xbb2fb680,0xbbb54098,0x3ac8fb30,0xbabc6dd5,0xbb9008b7,0xbbefa8b2
.long 0x3d000000,0x3d000000,0x3d000000,0x3d000000,0x3cff84ab,0x3cff7808,0x3cff6ac7,0x3cff5ce9
.long 0x3cfe1324,0x3cfde0b1,0x3cfdabcc,0x3cfd7474,0x3cfbaccd,0x3cfb3bab,0x3cfac516,0x3cfa4910
.long 0x3cf853f8,0x3cf78bc5,0x3cf6ba07,0x3cf5dec6,0x3cf40bdd,0x3cf2d4eb,0x3cf18f57,0x3cf03b37
.long 0x3ceed89e,0x3ced1c1d,0x3ceb4b0c,0x3ce96591,0x3ce8bf3c,0x3ce66771,0x3ce3f473,0x3ce1668a
.long 0x3ce1c598,0x3cdebe05,0x3cdb941a,0x3cd84853,0x3cd9f26a,0x3cd627fe,0x3cd233c6,0x3cce1689
.long 0x3cd14d3d,0x3cccae79,0x3cc7de65,0x3cc2de29,0x3cc7de65,0x3cc25b89,0x3cbca003,0x3cb6ad7f
.long 0x3cbdaef9,0x3cb73a23,0x3cb085bb,0x3ca99415,0x3cb2c8c9,0x3cab561b,0x3ca39da9,0x3c9ba299
.long 0x3ca73656,0x3c9ebc12,0x3c95f6d9,0x3c8cead0,0x3c9b02c6,0x3c91796b,0x3c87a136,0x3c7afef7
.long 0x3c8e39da,0x3c839c3d,0x3c715aea,0x3c5ae880,0x3c80e7e4,0x3c6a6681,0x3c525a09,0x3c39bb1e
.long 0x3c663375,0x3c4c9b8b,0x3c3263ef,0x3c17a117,0x3c49b953,0x3c2df73c,0x3c119ddd,0x3be98bba
.long 0x3c2c7cd4,0x3c0e9a22,0x3be05c13,0x3ba2abb6,0x3c0e9a22,0x3bdd4b1a,0x3b9c76de,0x3b35f8da
.long 0x3be05c13,0x3b9c76de,0x3b2fb680,0x3a16c9b6,0x3ba2abb6,0x3b35f8da,0x3a16c9b6,0xbad5880e
.long 0x3b48bd36,0x3a490ab0,0xbac8fb30,0xbb7ab273,0x3a96c32c,0xbaa351cb,0xbb6e3876,0xbbc4b0b9
.long 0xba490ab0,0xbb553db9,0xbbbb6ecf,0xbc0586ce,0xbb2fb680,0xbbabf804,0xbbfee6e1,0xbc280b1f
.long 0xbb964083,0xbbec9a7f,0xbc209ae5,0xbc49b953,0xbbd41501,0xbc1620d2,0xbc41071e,0xbc6a6681
.long 0xbc088e93,0xbc3554ec,0xbc60924f,0xbc84f484,0xbc268f12,0xbc53c867,0xbc7f17b2,0xbc940c5f
.long 0x3d000000,0x3d000000,0x3d000000,0x3d000000,0x3cff4e6d,0x3cff3f54,0x3cff2f9d,0x3cff1f49
.long 0x3cfd3aac,0x3cfcfe73,0x3cfcbfc9,0x3cfc7eb0,0x3cf9c79d,0x3cf940c0,0x3cf8b47b,0x3cf822d1
.long 0x3cf4fa0b,0x3cf40bdd,0x3cf31447,0x3cf21352,0x3ceed89e,0x3ced67a1,0x3cebe858,0x3cea5ad9
.long 0x3ce76bd8,0x3ce55e0b,0x3ce33c5a,0x3ce106f2,0x3cdebe05,0x3cdbfb34,0x3cd91e6a,0x3cd627fe
.long 0x3cd4db31,0x3cd14d3d,0x3ccd9f02,0x3cc9d112,0x3cc9d112,0x3cc56439,0x3cc0d0da,0x3cbc17d9
.long 0x3cbdaef9,0x3cb85216,0x3cb2c8c9,0x3cad1469,0x3cb085bb,0x3caa2a80,0x3ca39da9,0x3c9ce11f
.long 0x3ca26799,0x3c9b02c6,0x3c93682a,0x3c8b9a6b,0x3c93682a,0x3c8af1b7,0x3c8242b1,0x3c72bd43
.long 0x3c839c3d,0x3c741f07,0x3c60924f,0x3c4c9b8b,0x3c663375,0x3c50eb2a,0x3c3b31a0,0x3c25129f
.long 0x3c43ef15,0x3c2c7cd4,0x3c14a031,0x3bf8cfcc,0x3c209ae5,0x3c070ada,0x3bda3997,0x3ba5c58c
.long 0x3bf8cfcc,0x3bc19b37,0x3b89cf86,0x3b23308c,0x3baf10a2,0x3b67fa9a,0x3ae21469,0xb8c90fc6
.long 0x3b48bd36,0x3a96c32c,0xba490ab0,0xbb2fb680,0x3a490ab0,0xbaa351cb,0xbb553db9,0xbbabf804
.long 0xbac8fb30,0xbb6e3876,0xbbbb6ecf,0xbbfee6e1,0xbb7ab273,0xbbc4b0b9,0xbc0586ce,0xbc280b1f
.long 0xbbc7c5c2,0xbc088e93,0xbc2c7cd4,0xbc4f7bca,0xbc088e93,0xbc2df73c,0xbc525a09,0xbc758035
.long 0xbc2c7cd4,0xbc525a09,0xbc76e0cb,0xbc8cead0,0xbc4f7bca,0xbc758035,0xbc8cead0,0xbc9e1e22
.long 0xbc715aea,0xbc8b9a6b,0xbc9d7fd1,0xbcae3bde,0xbc88f59b,0xbc9ba299,0xbcad1469,0xbcbd27b8
.long 0xbc987fc0,0xbcaac082,0xbcbb8f3b,0xbccac77f,0xbca73656,0xbcb8dd65,0xbcc8d8b3,0xbcd70348
.long 0x3d000000,0x3d000000,0x3d000000,0x3d000000,0x3cff0e58,0x3cfefcc9,0x3cfeea9d,0x3cfed7d4
.long 0x3cfc3b28,0x3cfbf531,0x3cfbaccd,0x3cfb61fc,0x3cf78bc5,0x3cf6ef5b,0x3cf64d97,0x3cf5a67b
.long 0x3cf10908,0x3ceff573,0x3ceed89e,0x3cedb293,0x3ce8bf3c,0x3ce71599,0x3ce55e0b,0x3ce398ac
.long 0x3cdebe05,0x3cdc61c7,0x3cd9f26a,0x3cd77026,0x3cd31849,0x3ccfefa8,0x3cccae79,0x3cc95521
.long 0x3cc5e403,0x3cc1d870,0x3cbdaef9,0x3cb96842,0x3cb73a23,0x3cb238aa,0x3cad1469,0x3ca7ce61
.long 0x3ca73656,0x3ca12ff9,0x3c9b02c6,0x3c94b039,0x3c95f6d9,0x3c8ee0db,0x3c87a136,0x3c803a06
.long 0x3c839c3d,0x3c76e0cb,0x3c663375,0x3c553641,0x3c60924f,0x3c4e0bea,0x3c3b31a0,0x3c280b1f
.long 0x3c38442a,0x3c2395c5,0x3c0e9a22,0x3bf2b651,0x3c0e9a22,0x3befa8b2,0x3bc19b37,0x3b9324ca
.long 0x3bc7c5c2,0x3b964083,0x3b48bd36,0x3ac8fb30,0x3b61bc2e,0x3aeea038,0x39490f88,0xbabc6dd5
.long 0x3a490ab0,0xba7b49ba,0xbb2fb680,0xbb9008b7,0xbafb2b74,0xbb7475c0,0xbbb54098,0xbbefa8b2
.long 0xbb964083,0xbbd41501,0xbc088e93,0xbc268f12,0xbbec9a7f,0xbc1620d2,0xbc3554ec,0xbc53c867
.long 0xbc209ae5,0xbc41071e,0xbc60924f,0xbc7f17b2,0xbc49b953,0xbc6a6681,0xbc84f484,0xbc940c5f
.long 0xbc715aea,0xbc88f59b,0xbc987fc0,0xbca73656,0xbc8b9a6b,0xbc9ba299,0xbcaac082,0xbcb8dd65
.long 0xbc9d7fd1,0xbcad1469,0xbcbb8f3b,0xbcc8d8b3,0xbcae3bde,0xbcbd27b8,0xbccac77f,0xbcd70348
.long 0xbcbdaef9,0xbccbbbf8,0xbcd84853,0xbce33c5a,0xbccbbbf8,0xbcd8b3a1,0xbce3f473,0xbced67a1
.long 0xbcd84853,0xbce3f473,0xbcedb293,0xbcf56d97,0xbce33c5a,0xbced67a1,0xbcf56d97,0xbcfb3bab
.long 0x3d000000,0x3d000000,0x3d000000,0x3d000000,0x3cfec46d,0x3cfeb069,0x3cfe9bc9,0x3cfe868b
.long 0x3cfb14be,0x3cfac516,0x3cfa7302,0x3cfa1e84,0x3cf4fa0b,0x3cf4484b,0x3cf3913f,0x3cf2d4eb
.long 0x3cec835e,0x3ceb4b0c,0x3cea09a7,0x3ce8bf3c,0x3ce1c598,0x3cdfe4e9,0x3cddf6be,0x3cdbfb34
.long 0x3cd4db31,0x3cd233c6,0x3ccf7a1f,0x3cccae79,0x3cc5e403,0x3cc25b89,0x3cbebc1b,0x3cbb0629
.long 0x3cb504f3,0x3cb085bb,0x3cabeb4a,0x3ca73656,0x3ca26799,0x3c9ce11f,0x3c973c07,0x3c91796b
.long 0x3c8e39da,0x3c87a136,0x3c80e7e4,0x3c741f07,0x3c715aea,0x3c61fb6a,0x3c525a09,0x3c427b55
.long 0x3c43ef15,0x3c3263ef,0x3c209ae5,0x3c0e9a22,0x3c14a031,0x3c00f8c0,0x3bda3997,0x3bb228d4
.long 0x3bc7c5c2,0x3b9c76de,0x3b61bc2e,0x3b0a200a,0x3b48bd36,0x3ad5880e,0x39490f88,0xbaa351cb
.long 0x220d3132,0xbac8fb30,0xbb48bd36,0xbb964083,0xbb48bd36,0xbb995be0,0xbbcdee60,0xbc00f8c0
.long 0xbbc7c5c2,0xbbfee6e1,0xbc1aa086,0xbc3554ec,0xbc14a031,0xbc30eacb,0xbc4c9b8b,0xbc679a5d
.long 0xbc43ef15,0xbc60924f,0xbc7c5d27,0xbc8b9a6b,0xbc715aea,0xbc86f686,0xbc94b039,0xbca1cbfb
.long 0xbc8e39da,0xbc9c420c,0xbca99415,0xbcb6206c,0xbca26799,0xbcaff3e6,0xbcbca003,0xbcc85bca
.long 0xbcb504f3,0xbcc1d870,0xbccd9f02,0xbcd84853,0xbcc5e403,0xbcd1c0c2,0xbcdc61c7,0xbce5b710
.long 0xbcd4db31,0xbcdf8327,0xbce8bf3c,0xbcf08066,0xbce1c598,0xbceafb8c,0xbcf294f8,0xbcf88486
.long 0xbcec835e,0xbcf40bdd,0xbcf9c79d,0xbcfdabcc,0xbcf4fa0b,0xbcfa9c59,0xbcfe4323,0xbcffe705
.long 0xbcfb14be,0xbcfe9bc9,0xbcfffb11,0xbcff2f9d,0xbcfec46d,0xbcffffb1,0xbcfeea9d,0xbcfb87b2
.long 0x3d000000,0x3d000000,0x3d000000,0x3d000000,0x3cfe70b0,0x3cfe5a38,0x3cfe4323,0x3cfe2b72
.long 0x3cf9c79d,0x3cf96e4e,0x3cf91298,0x3cf8b47b,0x3cf21352,0x3cf14c7a,0x3cf08066,0x3cefaf1b
.long 0x3ce76bd8,0x3ce60f88,0x3ce4aa59,0x3ce33c5a,0x3cd9f26a,0x3cd7dc7f,0x3cd5b993,0x3cd389c7
.long 0x3cc9d112,0x3cc6e22a,0x3cc3e200,0x3cc0d0da,0x3cb73a23,0x3cb3587a,0x3caf61a5,0x3cab561b
.long 0x3ca26799,0x3c9d7fd1,0x3c987fc0,0x3c93682a,0x3c8b9a6b,0x3c85a02c,0x3c7f17b2,0x3c72bd43
.long 0x3c663375,0x3c58106b,0x3c49b953,0x3c3b31a0,0x3c3263ef,0x3c221887,0x3c119ddd,0x3c00f8c0
.long 0x3bf8cfcc,0x3bd41501,0x3baf10a2,0x3b89cf86,0x3b89cf86,0x3b427c39,0x3ae21469,0x39fb514b
.long 0x3a490ab0,0xba16c9b6,0xbafb2b74,0xbb553db9,0xbb2fb680,0xbb86b26e,0xbbb54098,0xbbe36c83
.long 0xbbc7c5c2,0xbbf8cfcc,0xbc14a031,0xbc2c7cd4,0xbc1aa086,0xbc33dca5,0xbc4c9b8b,0xbc64cbfe
.long 0xbc4f7bca,0xbc6900b7,0xbc80e7e4,0xbc8cead0,0xbc80e7e4,0xbc8d9281,0xbc99c200,0xbca56bcb
.long 0xbc987fc0,0xbca4d225,0xbcb085bb,0xbcbb8f3b,0xbcae3bde,0xbcb9f2ac,0xbcc4e3f5,0xbccf0417
.long 0xbcc1d870,0xbcccae79,0xbcd695e5,0xbcdf8327,0xbcd31849,0xbcdcc7d1,0xbce55e0b,0xbcecd007
.long 0xbce1c598,0xbcea09a7,0xbcf10908,0xbcf6ba07,0xbcedb293,0xbcf4484b,0xbcf96e4e,0xbcfd1cdd
.long 0xbcf6ba07,0xbcfb61fc,0xbcfe70b0,0xbcffe129,0xbcfcbfc9,0xbcff3f54,0xbcfffec4,0xbcfefcc9
.long 0xbcffb10f,0xbcffd397,0xbcfe1324,0xbcfa7302,0xbcff84ab,0xbcfd1cdd,0xbcf8b47b,0xbcf25470
.long 0xbcfc3b28,0xbcf72417,0xbceff573,0xbce6becc,0xbcf5dec6,0xbcedfcf2,0xbce3f473,0xbcd7dc7f
.long 0x3d000000,0x3d000000,0x3d000000,0x3d000000,0x3cfe1324,0x3cfdfa38,0x3cfde0b1,0x3cfdc68c
.long 0x3cf853f8,0x3cf7f110,0x3cf78bc5,0x3cf72417,0x3ceed89e,0x3cedfcf2,0x3ced1c1d,0x3cec3624
.long 0x3ce1c598,0x3ce04621,0x3cdebe05,0x3cdd2d53,0x3cd14d3d,0x3ccf0417,0x3cccae79,0x3cca4c87
.long 0x3cbdaef9,0x3cba7ca4,0x3cb73a23,0x3cb3e7bc,0x3ca73656,0x3ca302d3,0x3c9ebc12,0x3c9a6293
.long 0x3c8e39da,0x3c88f59b,0x3c839c3d,0x3c7c5d27,0x3c663375,0x3c597cb9,0x3c4c9b8b,0x3c3f926f
.long 0x3c2c7cd4,0x3c1d9e78,0x3c0e9a22,0x3bfee6e1,0x3be05c13,0x3bbe853e,0x3b9c76de,0x3b7475c0
.long 0x3b48bd36,0x3afb2b74,0x3a490ab0,0xb9c90e90,0xba490ab0,0xbb03db0a,0xbb553db9,0xbb9324ca
.long 0xbb964083,0xbbc19b37,0xbbec9a7f,0xbc0b9507,0xbc088e93,0xbc1f1cdf,0xbc3554ec,0xbc4b2aae
.long 0xbc43ef15,0xbc5ae880,0xbc715aea,0xbc839c3d,0xbc7c5d27,0xbc899f4e,0xbc94b039,0xbc9f599f
.long 0xbc987fc0,0xbca39da9,0xbcae3bde,0xbcb85216,0xbcb085bb,0xbcbb0629,0xbcc4e3f5,0xbcce1689
.long 0xbcc5e403,0xbccf7a1f,0xbcd84853,0xbce04621,0xbcd84853,0xbce0a6cf,0xbce816a8,0xbcee8ff8
.long 0xbce76bd8,0xbcee46be,0xbcf40bdd,0xbcf8b47b,0xbcf31447,0xbcf822d1,0xbcfbf531,0xbcfe868b
.long 0xbcfb14be,0xbcfe1324,0xbcffb10f,0xbcffec43,0xbcff4e6d,0xbcffffb1,0xbcff2f9d,0xbcfcdf6c
.long 0xbcffb10f,0xbcfde0b1,0xbcfa7302,0xbcf56d97,0xbcfc3b28,0xbcf7beb7,0xbcf18f57,0xbce9b7e4
.long 0xbcf4fa0b,0xbcedb293,0xbce4aa59,0xbcd9f26a,0xbcea09a7,0xbcdfe4e9,0xbcd3fac3,0xbcc66354
.long 0xbcdb941a,0xbcce8d90,0xbcbfc767,0xbcaf61a5,0xbcc9d112,0xbcb9f2ac,0xbca86605,0xbc9553b7
.long 0x3d000000,0x3d000000,0x3d000000,0x3d000000,0x3cfdabcc,0x3cfd906e,0x3cfd7474,0x3cfd57de
.long 0x3cf6ba07,0x3cf64d97,0x3cf5dec6,0x3cf56d97,0x3ceb4b0c,0x3cea5ad9,0x3ce96591,0x3ce86b39
.long 0x3cdb941a,0x3cd9f26a,0x3cd84853,0x3cd695e5,0x3cc7de65,0x3cc56439,0x3cc2de29,0x3cc04c5c
.long 0x3cb085bb,0x3cad1469,0x3ca99415,0x3ca6050a,0x3c95f6d9,0x3c91796b,0x3c8cead0,0x3c884b92
.long 0x3c715aea,0x3c663375,0x3c5ae880,0x3c4f7bca,0x3c3263ef,0x3c25129f,0x3c17a117,0x3c0a11f7
.long 0x3be05c13,0x3bc19b37,0x3ba2abb6,0x3b839502,0x3b2fb680,0x3ad5880e,0x3a16c9b6,0xb9fb514b
.long 0xbac8fb30,0xbb2fb680,0xbb7ab273,0xbba2abb6,0xbbbb6ecf,0xbbe36c83,0xbc0586ce,0xbc1920fe
.long 0xbc209ae5,0xbc3554ec,0xbc49b953,0xbc5dbe79,0xbc60924f,0xbc758035,0xbc84f484,0xbc8ee0db
.long 0xbc8e39da,0xbc987fc0,0xbca26799,0xbcabeb4a,0xbca99415,0xbcb3587a,0xbcbca003,0xbcc56439
.long 0xbcc1d870,0xbccac77f,0xbcd31849,0xbcdac450,0xbcd695e5,0xbcde5aa6,0xbce55e0b,0xbceb99fb
.long 0xbce76bd8,0xbcedb293,0xbcf31447,0xbcf78bc5,0xbcf40bdd,0xbcf88486,0xbcfbf531,0xbcfe5a38
.long 0xbcfc3b28,0xbcfe9bc9,0xbcffd397,0xbcffe129,0xbcffd397,0xbcffdaaf,0xbcfe9bc9,0xbcfc187a
.long 0xbcfec46d,0xbcfc3b28,0xbcf853f8,0xbcf31447,0xbcf91298,0xbcf3ced9,0xbced1c1d,0xbce50479
.long 0xbceed89e,0xbce6becc,0xbcdd2d53,0xbcd233c6,0xbce04621,0xbcd54aa4,0xbcc8d8b3,0xbcbb0629
.long 0xbccd9f02,0xbcbfc767,0xbcb085bb,0xbc9ff6cb,0xbcb73a23,0xbca69de3,0xbc94b039,0xbc819573
.long 0xbc9d7fd1,0xbc8a48ad,0xbc6bcbbb,0xbc41071e,0xbc80e7e4,0xbc56a399,0xbc2986c4,0xbbf5c35a
.long 0x3d000000,0x3d000000,0x3d000000,0x3d000000,0x3cfd3aac,0x3cfd1cdd,0x3cfcfe73,0x3cfcdf6c
.long 0x3cf4fa0b,0x3cf48422,0x3cf40bdd,0x3cf3913f,0x3ce76bd8,0x3ce66771,0x3ce55e0b,0x3ce44fac
.long 0x3cd4db31,0x3cd31849,0x3cd14d3d,0x3ccf7a1f,0x3cbdaef9,0x3cbb0629,0x3cb85216,0x3cb592e7
.long 0x3ca26799,0x3c9ebc12,0x3c9b02c6,0x3c973c07,0x3c839c3d,0x3c7dbabb,0x3c741f07,0x3c6a6681
.long 0x3c43ef15,0x3c38442a,0x3c2c7cd4,0x3c209ae5,0x3bf8cfcc,0x3bdd4b1a,0x3bc19b37,0x3ba5c58c
.long 0x3b48bd36,0x3b0a200a,0x3a96c32c,0x39490f88,0xbac8fb30,0xbb2973ba,0xbb6e3876,0xbb995be0
.long 0xbbc7c5c2,0xbbec9a7f,0xbc088e93,0xbc1aa086,0xbc2c7cd4,0xbc3f926f,0xbc525a09,0xbc64cbfe
.long 0xbc715aea,0xbc8242b1,0xbc8b9a6b,0xbc94b039,0xbc987fc0,0xbca1cbfb,0xbcaac082,0xbcb3587a
.long 0xbcb504f3,0xbcbdaef9,0xbcc5e403,0xbccd9f02,0xbccd9f02,0xbcd54aa4,0xbcdc61c7,0xbce2df7b
.long 0xbce1c598,0xbce816a8,0xbcedb293,0xbcf294f8,0xbcf10908,0xbcf5a67b,0xbcf96e4e,0xbcfc5d3a
.long 0xbcfb14be,0xbcfdabcc,0xbcff4e6d,0xbcfffb11,0xbcffb10f,0xbcfff84a,0xbcff2f9d,0xbcfd57de
.long 0xbcfec46d,0xbcfc7eb0,0xbcf91298,0xbcf48422,0xbcf853f8,0xbcf3530e,0xbced1c1d,0xbce5b710
.long 0xbcec835e,0xbce4aa59,0xbcdb941a,0xbcd14d3d,0xbcdb941a,0xbcd0d937,0xbcc4e3f5,0xbcb7c655
.long 0xbcc5e403,0xbcb85216,0xbca99415,0xbc99c200,0xbcabeb4a,0xbc9ba299,0xbc8a48ad,0xbc6ff7fb
.long 0xbc8e39da,0xbc76e0cb,0xbc4f7bca,0xbc268f12,0xbc5ae880,0xbc30eacb,0xbc0586ce,0xbbb228d4
.long 0xbc14a031,0xbbcdee60,0xbb61bc2e,0xba16c9b6,0xbb964083,0xbad5880e,0x3aafe007,0x3b8cec4a
.long 0x3d000000,0x3d000000,0x3d000000,0x3d000000,0x3cfcbfc9,0x3cfc9f8a,0x3cfc7eb0,0x3cfc5d3a
.long 0x3cf31447,0x3cf294f8,0x3cf21352,0x3cf18f57,0x3ce33c5a,0x3ce2241a,0x3ce106f2,0x3cdfe4e9
.long 0x3ccd9f02,0x3ccbbbf8,0x3cc9d112,0x3cc7de65,0x3cb2c8c9,0x3caff3e6,0x3cad1469,0x3caa2a80
.long 0x3c93682a,0x3c8f8784,0x3c8b9a6b,0x3c87a136,0x3c60924f,0x3c56a399,0x3c4c9b8b,0x3c427b55
.long 0x3c14a031,0x3c088e93,0x3bf8cfcc,0x3be05c13,0x3b89cf86,0x3b5b7d37,0x3b23308c,0x3ad5880e
.long 0xba490ab0,0xbae21469,0xbb2fb680,0xbb6e3876,0xbbbb6ecf,0xbbdd4b1a,0xbbfee6e1,0xbc101c2c
.long 0xbc2c7cd4,0xbc3e1d4a,0xbc4f7bca,0xbc60924f,0xbc76e0cb,0xbc844889,0xbc8cead0,0xbc9553b7
.long 0xbc9d7fd1,0xbca6050a,0xbcae3bde,0xbcb6206c,0xbcbb8f3b,0xbcc36051,0xbccac77f,0xbcd1c0c2
.long 0xbcd4db31,0xbcdb941a,0xbce1c598,0xbce76bd8,0xbce8bf3c,0xbcedfcf2,0xbcf294f8,0xbcf6841b
.long 0xbcf6ba07,0xbcfa1e84,0xbcfcbfc9,0xbcfe9bc9,0xbcfe70b0,0xbcffa6e3,0xbcfffec4,0xbcff7808
.long 0xbcffb10f,0xbcfe70b0,0xbcfc3b28,0xbcf91298,0xbcfa7302,0xbcf6841b,0xbcf18f57,0xbceb99fb
.long 0xbceed89e,0xbce816a8,0xbce04621,0xbcd77026,0xbcdd2d53,0xbcd389c7,0xbcc8d8b3,0xbcbd27b8
.long 0xbcc5e403,0xbcb96842,0xbcabeb4a,0xbc9d7fd1,0xbca99415,0xbc9a6293,0xbc8a48ad,0xbc72bd43
.long 0xbc88f59b,0xbc6e9479,0xbc49b953,0xbc2395c5,0xbc49b953,0xbc221887,0xbbf2b651,0xbb9f917b
.long 0xbbf8cfcc,0xbba2abb6,0xbb16a905,0x39c90e90,0xbb2fb680,0x38c90fc6,0x3b3c3ac3,0x3bb857ec
.long 0x3b16a905,0x3ba8defc,0x3c027dc0,0x3c2f713a,0x3bec9a7f,0x3c25129f,0x3c525a09,0x3c7dbabb
.long 0x3d000000,0x3d000000,0x3d000000,0x3d000000,0x3cfc3b28,0x3cfc187a,0x3cfbf531,0x3cfbd14d
.long 0x3cf10908,0x3cf08066,0x3ceff573,0x3cef6830,0x3cdebe05,0x3cdd924d,0x3cdc61c7,0x3cdb2c79
.long 0x3cc5e403,0x3cc3e200,0x3cc1d870,0x3cbfc767,0x3ca73656,0x3ca4381a,0x3ca12ff9,0x3c9e1e22
.long 0x3c839c3d,0x3c7f17b2,0x3c76e0cb,0x3c6e9479,0x3c38442a,0x3c2df73c,0x3c2395c5,0x3c1920fe
.long 0x3bc7c5c2,0x3baf10a2,0x3b964083,0x3b7ab273,0x3a490ab0,0xb8c90fc6,0xba7b49ba,0xbaeea038
.long 0xbb964083,0xbbb54098,0xbbd41501,0xbbf2b651,0xbc209ae5,0xbc30eacb,0xbc41071e,0xbc50eb2a
.long 0xbc715aea,0xbc80e7e4,0xbc88f59b,0xbc90d3cd,0xbc9d7fd1,0xbca56bcb,0xbcad1469,0xbcb4768f
.long 0xbcbdaef9,0xbcc4e3f5,0xbccbbbf8,0xbcd233c6,0xbcd84853,0xbcde5aa6,0xbce3f473,0xbce912ae
.long 0xbcec835e,0xbcf10908,0xbcf4fa0b,0xbcf853f8,0xbcf9c79d,0xbcfc5d3a,0xbcfe4323,0xbcff7808
.long 0xbcffb10f,0xbcfffec4,0xbcff84ab,0xbcfe4323,0xbcfe1324,0xbcfbd14d,0xbcf8b47b,0xbcf4bf62
.long 0xbcf4fa0b,0xbceff573,0xbcea09a7,0xbce33c5a,0xbce4aa59,0xbcdcc7d1,0xbcd3fac3,0xbcca4c87
.long 0xbccd9f02,0xbcc2de29,0xbcb73a23,0xbcaac082,0xbcb085bb,0xbca302d3,0xbc94b039,0xbc85a02c
.long 0xbc8e39da,0xbc7c5d27,0xbc5ae880,0xbc38442a,0xbc4f7bca,0xbc2b0201,0xbc0586ce,0xbbbe853e
.long 0xbbf8cfcc,0xbba8defc,0xbb2fb680,0xb9490f88,0xbb16a905,0x3996cb58,0x3b3c3ac3,0x3bb228d4
.long 0x3b48bd36,0x3bbb6ecf,0x3c088e93,0x3c3263ef,0x3c088e93,0x3c33dca5,0x3c5dbe79,0x3c82ef9f
.long 0x3c5ae880,0x3c8242b1,0x3c95f6d9,0x3ca86605,0x3c93682a,0x3ca69de3,0x3cb85216,0x3cc85bca
.long 0x3d000000,0x3d000000,0x3d000000,0x3d000000,0x3cfbaccd,0x3cfb87b2,0x3cfb61fc,0x3cfb3bab
.long 0x3ceed89e,0x3cee46be,0x3cedb293,0x3ced1c1d,0x3cd9f26a,0x3cd8b3a1,0x3cd77026,0x3cd627fe
.long 0x3cbdaef9,0x3cbb8f3b,0x3cb96842,0x3cb73a23,0x3c9b02c6,0x3c97de12,0x3c94b039,0x3c91796b
.long 0x3c663375,0x3c5dbe79,0x3c553641,0x3c4c9b8b,0x3c0e9a22,0x3c040270,0x3bf2b651,0x3bdd4b1a
.long 0x3b48bd36,0x3b16a905,0x3ac8fb30,0x3a490ab0,0xbb2fb680,0xbb67fa9a,0xbb9008b7,0xbbabf804
.long 0xbc088e93,0xbc17a117,0xbc268f12,0xbc3554ec,0xbc60924f,0xbc6ff7fb,0xbc7f17b2,0xbc86f686
.long 0xbc987fc0,0xbc9ff6cb,0xbca73656,0xbcae3bde,0xbcbb8f3b,0xbcc25b89,0xbcc8d8b3,0xbccf0417
.long 0xbcd84853,0xbcddf6be,0xbce33c5a,0xbce816a8,0xbcedb293,0xbcf1d19f,0xbcf56d97,0xbcf88486
.long 0xbcfb14be,0xbcfd3aac,0xbcfec46d,0xbcffb10f,0xbcfffb11,0xbcffcbe2,0xbcfeea9d,0xbcfd57de
.long 0xbcfc3b28,0xbcf96e4e,0xbcf5dec6,0xbcf18f57,0xbceff573,0xbcea5ad9,0xbce3f473,0xbcdcc7d1
.long 0xbcdb941a,0xbcd31849,0xbcc9d112,0xbcbfc767,0xbcbfc767,0xbcb4768f,0xbca86605,0xbc9ba299
.long 0xbc9d7fd1,0xbc8f8784,0xbc80e7e4,0xbc6363fa,0xbc6bcbbb,0xbc4b2aae,0xbc2986c4,0xbc070ada
.long 0xbc14a031,0xbbe05c13,0xbb964083,0xbb16a905,0xbb61bc2e,0xba8a342f,0x3aafe007,0x3b7475c0
.long 0x3b16a905,0x3b9c76de,0x3bec9a7f,0x3c1d9e78,0x3c027dc0,0x3c2b0201,0x3c525a09,0x3c7840c8
.long 0x3c5ae880,0x3c80e7e4,0x3c93682a,0x3ca4d225,0x3c95f6d9,0x3ca7ce61,0x3cb85216,0x3cc76085
.long 0x3cb96842,0x3cc8d8b3,0x3cd695e5,0x3ce28210,0x3cd695e5,0x3ce2df7b,0x3ced1c1d,0x3cf5341d
.long 0x0,0x0,0x0,0x0,0x0,0x38c90fc6,0x39490f88,0x3996cb58
.long 0x0,0x39490f88,0x39c90e90,0x3a16c9b6,0x0,0x3996cb58,0x3a16c9b6,0x3a622a7a
.long 0x0,0x39c90e90,0x3a490ab0,0x3a96c32c,0x0,0x39fb514b,0x3a7b49ba,0x3abc6dd5
.long 0x0,0x3a16c9b6,0x3a96c32c,0x3ae21469,0x0,0x3a2fea69,0x3aafe007,0x3b03db0a
.long 0x0,0x3a490ab0,0x3ac8fb30,0x3b16a905,0x0,0x3a622a7a,0x3ae21469,0x3b2973ba
.long 0x0,0x3a7b49ba,0x3afb2b74,0x3b3c3ac3,0x0,0x3a8a342f,0x3b0a200a,0x3b4efdb7
.long 0x0,0x3a96c32c,0x3b16a905,0x3b61bc2e,0x0,0x3aa351cb,0x3b23308c,0x3b7475c0
.long 0x0,0x3aafe007,0x3b2fb680,0x3b839502,0x0,0x3abc6dd5,0x3b3c3ac3,0x3b8cec4a
.long 0x0,0x3ac8fb30,0x3b48bd36,0x3b964083,0x0,0x3ad5880e,0x3b553db9,0x3b9f917b
.long 0x0,0x3ae21469,0x3b61bc2e,0x3ba8defc,0x0,0x3aeea038,0x3b6e3876,0x3bb228d4
.long 0x0,0x3afb2b74,0x3b7ab273,0x3bbb6ecf,0x0,0x3b03db0a,0x3b839502,0x3bc4b0b9
.long 0x0,0x3b0a200a,0x3b89cf86,0x3bcdee60,0x0,0x3b1064b4,0x3b9008b7,0x3bd7278f
.long 0x0,0x3b16a905,0x3b964083,0x3be05c13,0x0,0x3b1cecf9,0x3b9c76de,0x3be98bba
.long 0x0,0x3b23308c,0x3ba2abb6,0x3bf2b651,0x0,0x3b2973ba,0x3ba8defc,0x3bfbdba4
.long 0x0,0x3b2fb680,0x3baf10a2,0x3c027dc0,0x0,0x3b35f8da,0x3bb54098,0x3c070ada
.long 0x0,0x3b3c3ac3,0x3bbb6ecf,0x3c0b9507,0x0,0x3b427c39,0x3bc19b37,0x3c101c2c
.long 0x0,0x0,0x0,0x0,0x39c90e90,0x39fb514b,0x3a16c9b6,0x3a2fea69
.long 0x3a490ab0,0x3a7b49ba,0x3a96c32c,0x3aafe007,0x3a96c32c,0x3abc6dd5,0x3ae21469,0x3b03db0a
.long 0x3ac8fb30,0x3afb2b74,0x3b16a905,0x3b2fb680,0x3afb2b74,0x3b1cecf9,0x3b3c3ac3,0x3b5b7d37
.long 0x3b16a905,0x3b3c3ac3,0x3b61bc2e,0x3b839502,0x3b2fb680,0x3b5b7d37,0x3b839502,0x3b995be0
.long 0x3b48bd36,0x3b7ab273,0x3b964083,0x3baf10a2,0x3b61bc2e,0x3b8cec4a,0x3ba8defc,0x3bc4b0b9
.long 0x3b7ab273,0x3b9c76de,0x3bbb6ecf,0x3bda3997,0x3b89cf86,0x3babf804,0x3bcdee60,0x3befa8b2
.long 0x3b964083,0x3bbb6ecf,0x3be05c13,0x3c027dc0,0x3ba2abb6,0x3bcada4f,0x3bf2b651,0x3c0d17c0
.long 0x3baf10a2,0x3bda3997,0x3c027dc0,0x3c17a117,0x3bbb6ecf,0x3be98bba,0x3c0b9507,0x3c221887
.long 0x3bc7c5c2,0x3bf8cfcc,0x3c14a031,0x3c2c7cd4,0x3bd41501,0x3c040270,0x3c1d9e78,0x3c36ccc3
.long 0x3be05c13,0x3c0b9507,0x3c268f12,0x3c41071e,0x3bec9a7f,0x3c131f35,0x3c2f713a,0x3c4b2aae
.long 0x3bf8cfcc,0x3c1aa086,0x3c38442a,0x3c553641,0x3c027dc0,0x3c221887,0x3c41071e,0x3c5f28a9
.long 0x3c088e93,0x3c2986c4,0x3c49b953,0x3c6900b7,0x3c0e9a22,0x3c30eacb,0x3c525a09,0x3c72bd43
.long 0x3c14a031,0x3c38442a,0x3c5ae880,0x3c7c5d27,0x3c1aa086,0x3c3f926f,0x3c6363fa,0x3c82ef9f
.long 0x3c209ae5,0x3c46d529,0x3c6bcbbb,0x3c87a136,0x3c268f12,0x3c4e0bea,0x3c741f07,0x3c8c42c9
.long 0x3c2c7cd4,0x3c553641,0x3c7c5d27,0x3c90d3cd,0x3c3263ef,0x3c5c53c1,0x3c8242b1,0x3c9553b7
.long 0x3c38442a,0x3c6363fa,0x3c864b82,0x3c99c200,0x3c3e1d4a,0x3c6a6681,0x3c8a48ad,0x3c9e1e22
.long 0x0,0x0,0x0,0x0,0x3a490ab0,0x3a622a7a,0x3a7b49ba,0x3a8a342f
.long 0x3ac8fb30,0x3ae21469,0x3afb2b74,0x3b0a200a,0x3b16a905,0x3b2973ba,0x3b3c3ac3,0x3b4efdb7
.long 0x3b48bd36,0x3b61bc2e,0x3b7ab273,0x3b89cf86,0x3b7ab273,0x3b8cec4a,0x3b9c76de,0x3babf804
.long 0x3b964083,0x3ba8defc,0x3bbb6ecf,0x3bcdee60,0x3baf10a2,0x3bc4b0b9,0x3bda3997,0x3befa8b2
.long 0x3bc7c5c2,0x3be05c13,0x3bf8cfcc,0x3c088e93,0x3be05c13,0x3bfbdba4,0x3c0b9507,0x3c1920fe
.long 0x3bf8cfcc,0x3c0b9507,0x3c1aa086,0x3c2986c4,0x3c088e93,0x3c1920fe,0x3c2986c4,0x3c39bb1e
.long 0x3c14a031,0x3c268f12,0x3c38442a,0x3c49b953,0x3c209ae5,0x3c33dca5,0x3c46d529,0x3c597cb9
.long 0x3c2c7cd4,0x3c41071e,0x3c553641,0x3c6900b7,0x3c38442a,0x3c4e0bea,0x3c6363fa,0x3c7840c8
.long 0x3c43ef15,0x3c5ae880,0x3c715aea,0x3c839c3d,0x3c4f7bca,0x3c679a5d,0x3c7f17b2,0x3c8af1b7
.long 0x3c5ae880,0x3c741f07,0x3c864b82,0x3c921eb0,0x3c663375,0x3c803a06,0x3c8cead0,0x3c99210f
.long 0x3c715aea,0x3c864b82,0x3c93682a,0x3c9ff6cb,0x3c7c5d27,0x3c8c42c9,0x3c99c200,0x3ca69de3
.long 0x3c839c3d,0x3c921eb0,0x3c9ff6cb,0x3cad1469,0x3c88f59b,0x3c97de12,0x3ca6050a,0x3cb3587a
.long 0x3c8e39da,0x3c9d7fd1,0x3cabeb4a,0x3cb96842,0x3c93682a,0x3ca302d3,0x3cb1a81d,0x3cbf41fc
.long 0x3c987fc0,0x3ca86605,0x3cb73a23,0x3cc4e3f5,0x3c9d7fd1,0x3cada859,0x3cbca003,0x3cca4c87
.long 0x3ca26799,0x3cb2c8c9,0x3cc1d870,0x3ccf7a1f,0x3ca73656,0x3cb7c655,0x3cc6e22a,0x3cd46b3b
.long 0x3cabeb4a,0x3cbca003,0x3ccbbbf8,0x3cd91e6a,0x3cb085bb,0x3cc154e1,0x3cd064af,0x3cdd924d
.long 0x0,0x0,0x0,0x0,0x3a96c32c,0x3aa351cb,0x3aafe007,0x3abc6dd5
.long 0x3b16a905,0x3b23308c,0x3b2fb680,0x3b3c3ac3,0x3b61bc2e,0x3b7475c0,0x3b839502,0x3b8cec4a
.long 0x3b964083,0x3ba2abb6,0x3baf10a2,0x3bbb6ecf,0x3bbb6ecf,0x3bcada4f,0x3bda3997,0x3be98bba
.long 0x3be05c13,0x3bf2b651,0x3c027dc0,0x3c0b9507,0x3c027dc0,0x3c0d17c0,0x3c17a117,0x3c221887
.long 0x3c14a031,0x3c209ae5,0x3c2c7cd4,0x3c38442a,0x3c268f12,0x3c33dca5,0x3c41071e,0x3c4e0bea
.long 0x3c38442a,0x3c46d529,0x3c553641,0x3c6363fa,0x3c49b953,0x3c597cb9,0x3c6900b7,0x3c7840c8
.long 0x3c5ae880,0x3c6bcbbb,0x3c7c5d27,0x3c864b82,0x3c6bcbbb,0x3c7dbabb,0x3c87a136,0x3c902dd5
.long 0x3c7c5d27,0x3c87a136,0x3c90d3cd,0x3c99c200,0x3c864b82,0x3c902dd5,0x3c99c200,0x3ca302d3
.long 0x3c8e39da,0x3c987fc0,0x3ca26799,0x3cabeb4a,0x3c95f6d9,0x3ca09393,0x3caac082,0x3cb4768f
.long 0x3c9d7fd1,0x3ca86605,0x3cb2c8c9,0x3cbca003,0x3ca4d225,0x3caff3e6,0x3cba7ca4,0x3cc46337
.long 0x3cabeb4a,0x3cb73a23,0x3cc1d870,0x3ccbbbf8,0x3cb2c8c9,0x3cbe35c5,0x3cc8d8b3,0x3cd2a649
.long 0x3cb96842,0x3cc4e3f5,0x3ccf7a1f,0x3cd91e6a,0x3cbfc767,0x3ccb41fa,0x3cd5b993,0x3cdf20db
.long 0x3cc5e403,0x3cd14d3d,0x3cdb941a,0x3ce4aa59,0x3ccbbbf8,0x3cd70348,0x3ce106f2,0x3ce9b7e4
.long 0x3cd14d3d,0x3cdc61c7,0x3ce60f88,0x3cee46be,0x3cd695e5,0x3ce1668a,0x3ceaab7b,0x3cf25470
.long 0x3cdb941a,0x3ce60f88,0x3ceed89e,0x3cf5dec6,0x3ce04621,0x3cea5ad9,0x3cf294f8,0x3cf8e3d6
.long 0x3ce4aa59,0x3cee46be,0x3cf5dec6,0x3cfb61fc,0x3ce8bf3c,0x3cf1d19f,0x3cf8b47b,0x3cfd57de
.long 0x0,0x0,0x0,0x0,0x3ac8fb30,0x3ad5880e,0x3ae21469,0x3aeea038
.long 0x3b48bd36,0x3b553db9,0x3b61bc2e,0x3b6e3876,0x3b964083,0x3b9f917b,0x3ba8defc,0x3bb228d4
.long 0x3bc7c5c2,0x3bd41501,0x3be05c13,0x3bec9a7f,0x3bf8cfcc,0x3c040270,0x3c0b9507,0x3c131f35
.long 0x3c14a031,0x3c1d9e78,0x3c268f12,0x3c2f713a,0x3c2c7cd4,0x3c36ccc3,0x3c41071e,0x3c4b2aae
.long 0x3c43ef15,0x3c4f7bca,0x3c5ae880,0x3c663375,0x3c5ae880,0x3c679a5d,0x3c741f07,0x3c803a06
.long 0x3c715aea,0x3c7f17b2,0x3c864b82,0x3c8cead0,0x3c839c3d,0x3c8af1b7,0x3c921eb0,0x3c99210f
.long 0x3c8e39da,0x3c95f6d9,0x3c9d7fd1,0x3ca4d225,0x3c987fc0,0x3ca09393,0x3ca86605,0x3caff3e6
.long 0x3ca26799,0x3caac082,0x3cb2c8c9,0x3cba7ca4,0x3cabeb4a,0x3cb4768f,0x3cbca003,0x3cc46337
.long 0x3cb504f3,0x3cbdaef9,0x3cc5e403,0x3ccd9f02,0x3cbdaef9,0x3cc66354,0x3cce8d90,0x3cd627fe
.long 0x3cc5e403,0x3cce8d90,0x3cd695e5,0x3cddf6be,0x3ccd9f02,0x3cd627fe,0x3cddf6be,0x3ce50479
.long 0x3cd4db31,0x3cdd2d53,0x3ce4aa59,0x3ceb4b0c,0x3cdb941a,0x3ce398ac,0x3ceaab7b,0x3cf0c501
.long 0x3ce1c598,0x3ce96591,0x3ceff573,0x3cf56d97,0x3ce76bd8,0x3cee8ff8,0x3cf48422,0x3cf940c0
.long 0x3cec835e,0x3cf31447,0x3cf853f8,0x3cfc3b28,0x3cf10908,0x3cf6ef5b,0x3cfb61fc,0x3cfe5a38
.long 0x3cf4fa0b,0x3cfa1e84,0x3cfdabcc,0x3cff9c18,0x3cf853f8,0x3cfc9f8a,0x3cff2f9d,0x3cffffb1
.long 0x3cfb14be,0x3cfe70b0,0x3cffec43,0x3cff84ab,0x3cfd3aac,0x3cff90b1,0x3cffe129,0x3cfe2b72
.long 0x3cfec46d,0x3cfffec4,0x3cff0e58,0x3cfbf531,0x3cffb10f,0x3cffba9e,0x3cfd7474,0x3cf8e3d6
.long 0x0,0x0,0x0,0x0,0x3afb2b74,0x3b03db0a,0x3b0a200a,0x3b1064b4
.long 0x3b7ab273,0x3b839502,0x3b89cf86,0x3b9008b7,0x3bbb6ecf,0x3bc4b0b9,0x3bcdee60,0x3bd7278f
.long 0x3bf8cfcc,0x3c027dc0,0x3c088e93,0x3c0e9a22,0x3c1aa086,0x3c221887,0x3c2986c4,0x3c30eacb
.long 0x3c38442a,0x3c41071e,0x3c49b953,0x3c525a09,0x3c553641,0x3c5f28a9,0x3c6900b7,0x3c72bd43
.long 0x3c715aea,0x3c7c5d27,0x3c839c3d,0x3c88f59b,0x3c864b82,0x3c8c42c9,0x3c921eb0,0x3c97de12
.long 0x3c93682a,0x3c99c200,0x3c9ff6cb,0x3ca6050a,0x3c9ff6cb,0x3ca69de3,0x3cad1469,0x3cb3587a
.long 0x3cabeb4a,0x3cb2c8c9,0x3cb96842,0x3cbfc767,0x3cb73a23,0x3cbe35c5,0x3cc4e3f5,0x3ccb41fa
.long 0x3cc1d870,0x3cc8d8b3,0x3ccf7a1f,0x3cd5b993,0x3ccbbbf8,0x3cd2a649,0x3cd91e6a,0x3cdf20db
.long 0x3cd4db31,0x3cdb941a,0x3ce1c598,0x3ce76bd8,0x3cdd2d53,0x3ce398ac,0x3ce96591,0x3cee8ff8
.long 0x3ce4aa59,0x3ceaab7b,0x3ceff573,0x3cf48422,0x3ceb4b0c,0x3cf0c501,0x3cf56d97,0x3cf940c0
.long 0x3cf10908,0x3cf5dec6,0x3cf9c79d,0x3cfcbfc9,0x3cf5dec6,0x3cf9f35e,0x3cfcfe73,0x3cfefcc9
.long 0x3cf9c79d,0x3cfcfe73,0x3cff0e58,0x3cfff4e6,0x3cfcbfc9,0x3cfefcc9,0x3cfff4e6,0x3cffa6e3
.long 0x3cfec46d,0x3cffec43,0x3cffb10f,0x3cfe1324,0x3cffd397,0x3cffcbe2,0x3cfe4323,0x3cfb3bab
.long 0x3cffec43,0x3cfe9bc9,0x3cfbaccd,0x3cf72417,0x3cff0e58,0x3cfc5d3a,0x3cf7f110,0x3cf1d19f
.long 0x3cfd3aac,0x3cf91298,0x3cf31447,0x3ceb4b0c,0x3cfa7302,0x3cf4bf62,0x3ced1c1d,0x3ce398ac
.long 0x3cf6ba07,0x3cef6830,0x3ce60f88,0x3cdac450,0x3cf21352,0x3ce912ae,0x3cddf6be,0x3cd0d937
.long 0x0,0x0,0x0,0x0,0x3b16a905,0x3b1cecf9,0x3b23308c,0x3b2973ba
.long 0x3b964083,0x3b9c76de,0x3ba2abb6,0x3ba8defc,0x3be05c13,0x3be98bba,0x3bf2b651,0x3bfbdba4
.long 0x3c14a031,0x3c1aa086,0x3c209ae5,0x3c268f12,0x3c38442a,0x3c3f926f,0x3c46d529,0x3c4e0bea
.long 0x3c5ae880,0x3c6363fa,0x3c6bcbbb,0x3c741f07,0x3c7c5d27,0x3c82ef9f,0x3c87a136,0x3c8c42c9
.long 0x3c8e39da,0x3c93682a,0x3c987fc0,0x3c9d7fd1,0x3c9d7fd1,0x3ca302d3,0x3ca86605,0x3cada859
.long 0x3cabeb4a,0x3cb1a81d,0x3cb73a23,0x3cbca003,0x3cb96842,0x3cbf41fc,0x3cc4e3f5,0x3cca4c87
.long 0x3cc5e403,0x3ccbbbf8,0x3cd14d3d,0x3cd695e5,0x3cd14d3d,0x3cd70348,0x3cdc61c7,0x3ce1668a
.long 0x3cdb941a,0x3ce106f2,0x3ce60f88,0x3ceaab7b,0x3ce4aa59,0x3ce9b7e4,0x3cee46be,0x3cf25470
.long 0x3cec835e,0x3cf10908,0x3cf4fa0b,0x3cf853f8,0x3cf31447,0x3cf6ef5b,0x3cfa1e84,0x3cfc9f8a
.long 0x3cf853f8,0x3cfb61fc,0x3cfdabcc,0x3cff2f9d,0x3cfc3b28,0x3cfe5a38,0x3cff9c18,0x3cffffb1
.long 0x3cfec46d,0x3cffd397,0x3cffec43,0x3cff0e58,0x3cffec43,0x3cffcbe2,0x3cfe9bc9,0x3cfc5d3a
.long 0x3cffb10f,0x3cfe4323,0x3cfbaccd,0x3cf7f110,0x3cfe1324,0x3cfb3bab,0x3cf72417,0x3cf1d19f
.long 0x3cfb14be,0x3cf6ba07,0x3cf10908,0x3cea09a7,0x3cf6ba07,0x3cf0c501,0x3ce96591,0x3ce0a6cf
.long 0x3cf10908,0x3ce96591,0x3ce04621,0x3cd5b993,0x3cea09a7,0x3ce0a6cf,0x3cd5b993,0x3cc95521
.long 0x3ce1c598,0x3cd695e5,0x3cc9d112,0x3cbb8f3b,0x3cd84853,0x3ccb41fa,0x3cbca003,0x3cac800f
.long 0x3ccd9f02,0x3cbebc1b,0x3cae3bde,0x3c9c420c,0x3cc1d870,0x3cb11722,0x3c9ebc12,0x3c8af1b7
.long 0x0,0x0,0x0,0x0,0x3b2fb680,0x3b35f8da,0x3b3c3ac3,0x3b427c39
.long 0x3baf10a2,0x3bb54098,0x3bbb6ecf,0x3bc19b37,0x3c027dc0,0x3c070ada,0x3c0b9507,0x3c101c2c
.long 0x3c2c7cd4,0x3c3263ef,0x3c38442a,0x3c3e1d4a,0x3c553641,0x3c5c53c1,0x3c6363fa,0x3c6a6681
.long 0x3c7c5d27,0x3c8242b1,0x3c864b82,0x3c8a48ad,0x3c90d3cd,0x3c9553b7,0x3c99c200,0x3c9e1e22
.long 0x3ca26799,0x3ca73656,0x3cabeb4a,0x3cb085bb,0x3cb2c8c9,0x3cb7c655,0x3cbca003,0x3cc154e1
.long 0x3cc1d870,0x3cc6e22a,0x3ccbbbf8,0x3cd064af,0x3ccf7a1f,0x3cd46b3b,0x3cd91e6a,0x3cdd924d
.long 0x3cdb941a,0x3ce04621,0x3ce4aa59,0x3ce8bf3c,0x3ce60f88,0x3cea5ad9,0x3cee46be,0x3cf1d19f
.long 0x3ceed89e,0x3cf294f8,0x3cf5dec6,0x3cf8b47b,0x3cf5dec6,0x3cf8e3d6,0x3cfb61fc,0x3cfd57de
.long 0x3cfb14be,0x3cfd3aac,0x3cfec46d,0x3cffb10f,0x3cfe70b0,0x3cff90b1,0x3cfffec4,0x3cffba9e
.long 0x3cffec43,0x3cffe129,0x3cff0e58,0x3cfd7474,0x3cff84ab,0x3cfe2b72,0x3cfbf531,0x3cf8e3d6
.long 0x3cfd3aac,0x3cfa7302,0x3cf6ba07,0x3cf21352,0x3cf91298,0x3cf4bf62,0x3cef6830,0x3ce912ae
.long 0x3cf31447,0x3ced1c1d,0x3ce60f88,0x3cddf6be,0x3ceb4b0c,0x3ce398ac,0x3cdac450,0x3cd0d937
.long 0x3ce1c598,0x3cd84853,0x3ccd9f02,0x3cc1d870,0x3cd695e5,0x3ccb41fa,0x3cbebc1b,0x3cb11722
.long 0x3cc9d112,0x3cbca003,0x3cae3bde,0x3c9ebc12,0x3cbb8f3b,0x3cac800f,0x3c9c420c,0x3c8af1b7
.long 0x3cabeb4a,0x3c9b02c6,0x3c88f59b,0x3c6bcbbb,0x3c9b02c6,0x3c884b92,0x3c6900b7,0x3c3f926f
.long 0x3c88f59b,0x3c6900b7,0x3c3e1d4a,0x3c119ddd,0x3c6bcbbb,0x3c3f926f,0x3c119ddd,0x3bc4b0b9
.long 0x0,0x0,0x0,0x0,0x3b48bd36,0x3b4efdb7,0x3b553db9,0x3b5b7d37
.long 0x3bc7c5c2,0x3bcdee60,0x3bd41501,0x3bda3997,0x3c14a031,0x3c1920fe,0x3c1d9e78,0x3c221887
.long 0x3c43ef15,0x3c49b953,0x3c4f7bca,0x3c553641,0x3c715aea,0x3c7840c8,0x3c7f17b2,0x3c82ef9f
.long 0x3c8e39da,0x3c921eb0,0x3c95f6d9,0x3c99c200,0x3ca26799,0x3ca69de3,0x3caac082,0x3caecef7
.long 0x3cb504f3,0x3cb96842,0x3cbdaef9,0x3cc1d870,0x3cc5e403,0x3cca4c87,0x3cce8d90,0x3cd2a649
.long 0x3cd4db31,0x3cd91e6a,0x3cdd2d53,0x3ce106f2,0x3ce1c598,0x3ce5b710,0x3ce96591,0x3cecd007
.long 0x3cec835e,0x3ceff573,0x3cf31447,0x3cf5dec6,0x3cf4fa0b,0x3cf7beb7,0x3cfa1e84,0x3cfc187a
.long 0x3cfb14be,0x3cfcfe73,0x3cfe70b0,0x3cff6ac7,0x3cfec46d,0x3cffa6e3,0x3cfffec4,0x3cffcbe2
.long 0x3d000000,0x3cffb10f,0x3cfec46d,0x3cfd3aac,0x3cfec46d,0x3cfd1cdd,0x3cfac516,0x3cf7beb7
.long 0x3cfb14be,0x3cf7f110,0x3cf40bdd,0x3cef6830,0x3cf4fa0b,0x3cf03b37,0x3ceaab7b,0x3ce44fac
.long 0x3cec835e,0x3ce60f88,0x3cdebe05,0x3cd695e5,0x3ce1c598,0x3cd988ad,0x3cd064af,0x3cc66354
.long 0x3cd4db31,0x3ccac77f,0x3cbfc767,0x3cb3e7bc,0x3cc5e403,0x3cb9f2ac,0x3cad1469,0x3c9f599f
.long 0x3cb504f3,0x3ca73656,0x3c987fc0,0x3c88f59b,0x3ca26799,0x3c92c39a,0x3c8242b1,0x3c61fb6a
.long 0x3c8e39da,0x3c79a02d,0x3c553641,0x3c2f713a,0x3c715aea,0x3c4b2aae,0x3c2395c5,0x3bf5c35a
.long 0x3c43ef15,0x3c1aa086,0x3be05c13,0x3b89cf86,0x3c14a031,0x3bd101f1,0x3b6e3876,0x3a622a7a
.long 0x3bc7c5c2,0x3b553db9,0x39c90e90,0xbb23308c,0x3b48bd36,0x38c90fc6,0xbb3c3ac3,0xbbbe853e
.long 0x0,0x0,0x0,0x0,0x3b61bc2e,0x3b67fa9a,0x3b6e3876,0x3b7475c0
.long 0x3be05c13,0x3be67c66,0x3bec9a7f,0x3bf2b651,0x3c268f12,0x3c2b0201,0x3c2f713a,0x3c33dca5
.long 0x3c5ae880,0x3c60924f,0x3c663375,0x3c6bcbbb,0x3c864b82,0x3c899f4e,0x3c8cead0,0x3c902dd5
.long 0x3c9d7fd1,0x3ca12ff9,0x3ca4d225,0x3ca86605,0x3cb2c8c9,0x3cb6ad7f,0x3cba7ca4,0x3cbe35c5
.long 0x3cc5e403,0x3cc9d112,0x3ccd9f02,0x3cd14d3d,0x3cd695e5,0x3cda5ba0,0x3cddf6be,0x3ce1668a
.long 0x3ce4aa59,0x3ce816a8,0x3ceb4b0c,0x3cee46be,0x3ceff573,0x3cf2d4eb,0x3cf56d97,0x3cf7beb7
.long 0x3cf853f8,0x3cfa7302,0x3cfc3b28,0x3cfdabcc,0x3cfdabcc,0x3cfed7d4,0x3cff9c18,0x3cfff84a
.long 0x3cffec43,0x3cfff4e6,0x3cff84ab,0x3cfe9bc9,0x3cff0e58,0x3cfdc68c,0x3cfbf531,0x3cf99b43
.long 0x3cfb14be,0x3cf853f8,0x3cf4fa0b,0x3cf10908,0x3cf40bdd,0x3cefaf1b,0x3ceaab7b,0x3ce50479
.long 0x3cea09a7,0x3ce3f473,0x3cdd2d53,0x3cd5b993,0x3cdd2d53,0x3cd54aa4,0x3cccae79,0x3cc36051
.long 0x3ccd9f02,0x3cc3e200,0x3cb96842,0x3cae3bde,0x3cbb8f3b,0x3caff3e6,0x3ca39da9,0x3c96999f
.long 0x3ca73656,0x3c99c200,0x3c8b9a6b,0x3c79a02d,0x3c90d3cd,0x3c819573,0x3c6363fa,0x3c427b55
.long 0x3c715aea,0x3c4f7bca,0x3c2c7cd4,0x3c088e93,0x3c3e1d4a,0x3c1920fe,0x3be67c66,0x3b995be0
.long 0x3c088e93,0x3bc19b37,0x3b61bc2e,0x3a7b49ba,0x3ba2abb6,0x3b1cecf9,0xb9490f88,0xbb35f8da
.long 0x3ac8fb30,0xba96c32c,0xbb7ab273,0xbbd41501,0xbafb2b74,0xbb995be0,0xbbf2b651,0xbc25129f
.long 0xbbaf10a2,0xbc0586ce,0xbc3263ef,0xbc5dbe79,0xbc0e9a22,0xbc3ca7af,0xbc6900b7,0xbc899f4e
.long 0x0,0x0,0x0,0x0,0x3b7ab273,0x3b807745,0x3b839502,0x3b86b26e
.long 0x3bf8cfcc,0x3bfee6e1,0x3c027dc0,0x3c0586ce,0x3c38442a,0x3c3ca7af,0x3c41071e,0x3c45625c
.long 0x3c715aea,0x3c76e0cb,0x3c7c5d27,0x3c80e7e4,0x3c93682a,0x3c96999f,0x3c99c200,0x3c9ce11f
.long 0x3cabeb4a,0x3caf61a5,0x3cb2c8c9,0x3cb6206c,0x3cc1d870,0x3cc56439,0x3cc8d8b3,0x3ccc3578
.long 0x3cd4db31,0x3cd84853,0x3cdb941a,0x3cdebe05,0x3ce4aa59,0x3ce7c187,0x3ceaab7b,0x3ced67a1
.long 0x3cf10908,0x3cf3913f,0x3cf5dec6,0x3cf7f110,0x3cf9c79d,0x3cfb87b2,0x3cfcfe73,0x3cfe2b72
.long 0x3cfec46d,0x3cff84ab,0x3cffec43,0x3cfffb11,0x3cffec43,0x3cff7808,0x3cfe9bc9,0x3cfd57de
.long 0x3cfd3aac,0x3cfb61fc,0x3cf91298,0x3cf64d97,0x3cf6ba07,0x3cf3530e,0x3cef6830,0x3ceafb8c
.long 0x3cec835e,0x3ce76bd8,0x3ce1c598,0x3cdb941a,0x3cdebe05,0x3cd7dc7f,0x3cd064af,0x3cc85bca
.long 0x3ccd9f02,0x3cc4e3f5,0x3cbb8f3b,0x3cb1a81d,0x3cb96842,0x3caecef7,0x3ca39da9,0x3c97de12
.long 0x3ca26799,0x3c95f6d9,0x3c88f59b,0x3c76e0cb,0x3c88f59b,0x3c758035,0x3c58106b,0x3c39bb1e
.long 0x3c5ae880,0x3c3b31a0,0x3c1aa086,0x3bf2b651,0x3c209ae5,0x3bfbdba4,0x3bb54098,0x3b5b7d37
.long 0x3bc7c5c2,0x3b7ab273,0x3ac8fb30,0xba490ab0,0x3b16a905,0xb8c90fc6,0xbb23308c,0xbb9f917b
.long 0xbac8fb30,0xbb839502,0xbbd41501,0xbc119ddd,0xbbaf10a2,0xbc00f8c0,0xbc2986c4,0xbc50eb2a
.long 0xbc14a031,0xbc3e1d4a,0xbc663375,0xbc864b82,0xbc4f7bca,0xbc7840c8,0xbc8f8784,0xbca1cbfb
.long 0xbc839c3d,0xbc973c07,0xbca99415,0xbcba7ca4,0xbc9d7fd1,0xbcaff3e6,0xbcc0d0da,0xbccfefa8
.long 0x0,0x0,0x0,0x0,0x3b89cf86,0x3b8cec4a,0x3b9008b7,0x3b9324ca
.long 0x3c088e93,0x3c0b9507,0x3c0e9a22,0x3c119ddd,0x3c49b953,0x3c4e0bea,0x3c525a09,0x3c56a399
.long 0x3c839c3d,0x3c864b82,0x3c88f59b,0x3c8b9a6b,0x3c9ff6cb,0x3ca302d3,0x3ca6050a,0x3ca8fd41
.long 0x3cb96842,0x3cbca003,0x3cbfc767,0x3cc2de29,0x3ccf7a1f,0x3cd2a649,0x3cd5b993,0x3cd8b3a1
.long 0x3ce1c598,0x3ce4aa59,0x3ce76bd8,0x3cea09a7,0x3ceff573,0x3cf25470,0x3cf48422,0x3cf6841b
.long 0x3cf9c79d,0x3cfb61fc,0x3cfcbfc9,0x3cfde0b1,0x3cff0e58,0x3cffa6e3,0x3cfff4e6,0x3cfff84a
.long 0x3cffb10f,0x3cff0e58,0x3cfe1324,0x3cfcbfc9,0x3cfbaccd,0x3cf99b43,0x3cf72417,0x3cf4484b
.long 0x3cf31447,0x3cef6830,0x3ceb4b0c,0x3ce6becc,0x3ce60f88,0x3ce0a6cf,0x3cdac450,0x3cd46b3b
.long 0x3cd4db31,0x3ccd9f02,0x3cc5e403,0x3cbdaef9,0x3cbfc767,0x3cb6ad7f,0x3cad1469,0x3ca302d3
.long 0x3ca73656,0x3c9c420c,0x3c90d3cd,0x3c84f484,0x3c8b9a6b,0x3c7dbabb,0x3c6363fa,0x3c48477c
.long 0x3c5ae880,0x3c3e1d4a,0x3c209ae5,0x3c027dc0,0x3c1aa086,0x3bf5c35a,0x3bb54098,0x3b67fa9a
.long 0x3baf10a2,0x3b553db9,0x3a96c32c,0xba7b49ba,0x3a96c32c,0xba8a342f,0xbb553db9,0xbbb228d4
.long 0xbb48bd36,0xbbaf10a2,0xbbf8cfcc,0xbc209ae5,0xbbec9a7f,0xbc1c1faf,0xbc41071e,0xbc64cbfe
.long 0xbc38442a,0xbc5dbe79,0xbc80e7e4,0xbc921eb0,0xbc76e0cb,0xbc8d9281,0xbc9ebc12,0xbcaecef7
.long 0xbc987fc0,0xbca99415,0xbcb96842,0xbcc7de65,0xbcb2c8c9,0xbcc25b89,0xbcd064af,0xbcdcc7d1
.long 0xbcc9d112,0xbcd77026,0xbce33c5a,0xbced1c1d,0xbcdd2d53,0xbce86b39,0xbcf18f57,0xbcf88486
.long 0x0,0x0,0x0,0x0,0x3b964083,0x3b995be0,0x3b9c76de,0x3b9f917b
.long 0x3c14a031,0x3c17a117,0x3c1aa086,0x3c1d9e78,0x3c5ae880,0x3c5f28a9,0x3c6363fa,0x3c679a5d
.long 0x3c8e39da,0x3c90d3cd,0x3c93682a,0x3c95f6d9,0x3cabeb4a,0x3caecef7,0x3cb1a81d,0x3cb4768f
.long 0x3cc5e403,0x3cc8d8b3,0x3ccbbbf8,0x3cce8d90,0x3cdb941a,0x3cde5aa6,0x3ce106f2,0x3ce398ac
.long 0x3cec835e,0x3ceed89e,0x3cf10908,0x3cf31447,0x3cf853f8,0x3cf9f35e,0x3cfb61fc,0x3cfc9f8a
.long 0x3cfec46d,0x3cff6ac7,0x3cffd397,0x3cfffec4,0x3cffb10f,0x3cff1f49,0x3cfe4323,0x3cfd1cdd
.long 0x3cfb14be,0x3cf91298,0x3cf6ba07,0x3cf40bdd,0x3cf10908,0x3ced67a1,0x3ce96591,0x3ce50479
.long 0x3ce1c598,0x3cdc61c7,0x3cd695e5,0x3cd064af,0x3ccd9f02,0x3cc66354,0x3cbebc1b,0x3cb6ad7f
.long 0x3cb504f3,0x3cabeb4a,0x3ca26799,0x3c987fc0,0x3c987fc0,0x3c8d9281,0x3c8242b1,0x3c6d3063
.long 0x3c715aea,0x3c58106b,0x3c3e1d4a,0x3c2395c5,0x3c2c7cd4,0x3c101c2c,0x3be67c66,0x3babf804
.long 0x3bc7c5c2,0x3b89cf86,0x3b16a905,0x39c90e90,0x3ac8fb30,0xb9fb514b,0xbb23308c,0xbb9324ca
.long 0xbb48bd36,0xbba8defc,0xbbec9a7f,0xbc17a117,0xbbf8cfcc,0xbc1f1cdf,0xbc41071e,0xbc61fb6a
.long 0xbc43ef15,0xbc663375,0xbc839c3d,0xbc93682a,0xbc839c3d,0xbc940c5f,0xbca39da9,0xbcb238aa
.long 0xbca26799,0xbcb1a81d,0xbcbfc767,0xbcccae79,0xbcbdaef9,0xbccb41fa,0xbcd77026,0xbce2241a
.long 0xbcd4db31,0xbce04621,0xbcea09a7,0xbcf21352,0xbce76bd8,0xbcf03b37,0xbcf72417,0xbcfc187a
.long 0xbcf4fa0b,0xbcfac516,0xbcfe70b0,0xbcfff4e6,0xbcfd3aac,0xbcffa6e3,0xbcffc38f,0xbcfd906e
.long 0x0,0x0,0x0,0x0,0x3ba2abb6,0x3ba5c58c,0x3ba8defc,0x3babf804
.long 0x3c209ae5,0x3c2395c5,0x3c268f12,0x3c2986c4,0x3c6bcbbb,0x3c6ff7fb,0x3c741f07,0x3c7840c8
.long 0x3c987fc0,0x3c9b02c6,0x3c9d7fd1,0x3c9ff6cb,0x3cb73a23,0x3cb9f2ac,0x3cbca003,0x3cbf41fc
.long 0x3cd14d3d,0x3cd3fac3,0x3cd695e5,0x3cd91e6a,0x3ce60f88,0x3ce86b39,0x3ceaab7b,0x3cecd007
.long 0x3cf4fa0b,0x3cf6ba07,0x3cf853f8,0x3cf9c79d,0x3cfdabcc,0x3cfe868b,0x3cff2f9d,0x3cffa6e3
.long 0x3cffec43,0x3cff9c18,0x3cff0e58,0x3cfe4323,0x3cfbaccd,0x3cf9f35e,0x3cf7f110,0x3cf5a67b
.long 0x3cf10908,0x3cedb293,0x3cea09a7,0x3ce60f88,0x3ce04621,0x3cdb2c79,0x3cd5b993,0x3ccfefa8
.long 0x3cc9d112,0x3cc2de29,0x3cbb8f3b,0x3cb3e7bc,0x3cae3bde,0x3ca56bcb,0x3c9c420c,0x3c92c39a
.long 0x3c8e39da,0x3c839c3d,0x3c715aea,0x3c5ae880,0x3c553641,0x3c3ca7af,0x3c2395c5,0x3c0a11f7
.long 0x3c088e93,0x3bda3997,0x3ba2abb6,0x3b553db9,0x3b61bc2e,0x3ad5880e,0xb9490f88,0xbb03db0a
.long 0xbac8fb30,0xbb61bc2e,0xbbaf10a2,0xbbec9a7f,0xbbd41501,0xbc0a11f7,0xbc2986c4,0xbc48477c
.long 0xbc38442a,0xbc58106b,0xbc76e0cb,0xbc8a48ad,0xbc80e7e4,0xbc902dd5,0xbc9ebc12,0xbcac800f
.long 0xbca26799,0xbcb085bb,0xbcbdaef9,0xbcc9d112,0xbcbfc767,0xbccc3578,0xbcd77026,0xbce1668a
.long 0xbcd84853,0xbce28210,0xbceb4b0c,0xbcf294f8,0xbceb4b0c,0xbcf2d4eb,0xbcf8b47b,0xbcfcdf6c
.long 0xbcf853f8,0xbcfcbfc9,0xbcff4e6d,0xbcfffb11,0xbcff0e58,0xbcffffb1,0xbcfeea9d,0xbcfbd14d
.long 0xbcff4e6d,0xbcfc7eb0,0xbcf78bc5,0xbcf08066,0xbcf91298,0xbcf25470,0xbce96591,0xbcde5aa6
.long 0x0,0x0,0x0,0x0,0x3baf10a2,0x3bb228d4,0x3bb54098,0x3bb857ec
.long 0x3c2c7cd4,0x3c2f713a,0x3c3263ef,0x3c3554ec,0x3c7c5d27,0x3c803a06,0x3c8242b1,0x3c844889
.long 0x3ca26799,0x3ca4d225,0x3ca73656,0x3ca99415,0x3cc1d870,0x3cc46337,0x3cc6e22a,0x3cc95521
.long 0x3cdb941a,0x3cddf6be,0x3ce04621,0x3ce28210,0x3ceed89e,0x3cf0c501,0x3cf294f8,0x3cf4484b
.long 0x3cfb14be,0x3cfc3b28,0x3cfd3aac,0x3cfe1324,0x3cffec43,0x3cffffb1,0x3cffe129,0x3cff90b1
.long 0x3cfd3aac,0x3cfbf531,0x3cfa7302,0x3cf8b47b,0x3cf31447,0x3cf03b37,0x3ced1c1d,0x3ce9b7e4
.long 0x3ce1c598,0x3cdd2d53,0x3cd84853,0x3cd31849,0x3cc9d112,0x3cc36051,0x3cbca003,0x3cb592e7
.long 0x3cabeb4a,0x3ca39da9,0x3c9b02c6,0x3c921eb0,0x3c88f59b,0x3c7dbabb,0x3c6900b7,0x3c53c867
.long 0x3c43ef15,0x3c2c7cd4,0x3c14a031,0x3bf8cfcc,0x3be05c13,0x3babf804,0x3b6e3876,0x3b03db0a
.long 0x3ac8fb30,0xb9490f88,0xbafb2b74,0xbb6e3876,0xbb7ab273,0xbbb857ec,0xbbf2b651,0xbc1620d2
.long 0xbc14a031,0xbc3263ef,0xbc4f7bca,0xbc6bcbbb,0xbc663375,0xbc819573,0xbc8f8784,0xbc9ce11f
.long 0xbc987fc0,0xbca6050a,0xbcb2c8c9,0xbcbebc1b,0xbcb96842,0xbcc56439,0xbcd064af,0xbcda5ba0
.long 0xbcd4db31,0xbcdebe05,0xbce76bd8,0xbceed89e,0xbcea09a7,0xbcf14c7a,0xbcf72417,0xbcfb87b2
.long 0xbcf853f8,0xbcfc7eb0,0xbcff0e58,0xbcfffec4,0xbcff4e6d,0xbcfffd39,0xbcfeea9d,0xbcfc187a
.long 0xbcfec46d,0xbcfbaccd,0xbcf6ba07,0xbceff573,0xbcf6ba07,0xbcefaf1b,0xbce6becc,0xbcdbfb34
.long 0xbce76bd8,0xbcdc61c7,0xbccf7a1f,0xbcc0d0da,0xbcd14d3d,0xbcc25b89,0xbcb1a81d,0xbc9f599f
.long 0x0,0x0,0x0,0x0,0x3bbb6ecf,0x3bbe853e,0x3bc19b37,0x3bc4b0b9
.long 0x3c38442a,0x3c3b31a0,0x3c3e1d4a,0x3c41071e,0x3c864b82,0x3c884b92,0x3c8a48ad,0x3c8c42c9
.long 0x3cabeb4a,0x3cae3bde,0x3cb085bb,0x3cb2c8c9,0x3ccbbbf8,0x3cce1689,0x3cd064af,0x3cd2a649
.long 0x3ce4aa59,0x3ce6becc,0x3ce8bf3c,0x3ceaab7b,0x3cf5dec6,0x3cf7583a,0x3cf8b47b,0x3cf9f35e
.long 0x3cfec46d,0x3cff4e6d,0x3cffb10f,0x3cffec43,0x3cff0e58,0x3cfe5a38,0x3cfd7474,0x3cfc5d3a
.long 0x3cf6ba07,0x3cf48422,0x3cf21352,0x3cef6830,0x3ce60f88,0x3ce2241a,0x3cddf6be,0x3cd988ad
.long 0x3ccd9f02,0x3cc7de65,0x3cc1d870,0x3cbb8f3b,0x3cae3bde,0x3ca69de3,0x3c9ebc12,0x3c96999f
.long 0x3c88f59b,0x3c7f17b2,0x3c6bcbbb,0x3c58106b,0x3c3e1d4a,0x3c280b1f,0x3c119ddd,0x3bf5c35a
.long 0x3bc7c5c2,0x3b964083,0x3b48bd36,0x3ac8fb30,0x39c90e90,0xbaa351cb,0xbb3c3ac3,0xbb9324ca
.long 0xbbaf10a2,0xbbe67c66,0xbc0e9a22,0xbc2986c4,0xbc3263ef,0xbc4e0bea,0xbc6900b7,0xbc819573
.long 0xbc839c3d,0xbc90d3cd,0xbc9d7fd1,0xbca99415,0xbca99415,0xbcb592e7,0xbcc0d0da,0xbccb41fa
.long 0xbcc9d112,0xbcd3fac3,0xbcdd2d53,0xbce55e0b,0xbce33c5a,0xbceafb8c,0xbcf18f57,0xbcf6ef5b
.long 0xbcf4fa0b,0xbcf9c79d,0xbcfd3aac,0xbcff4e6d,0xbcfe70b0,0xbcffdaaf,0xbcffc38f,0xbcfe2b72
.long 0xbcff4e6d,0xbcfcfe73,0xbcf91298,0xbcf3913f,0xbcf78bc5,0xbcf14c7a,0xbce96591,0xbcdfe4e9
.long 0xbce76bd8,0xbcdd2d53,0xbcd14d3d,0xbcc3e200,0xbccf7a1f,0xbcc154e1,0xbcb1a81d,0xbca09393
.long 0xbcb085bb,0xbc9ebc12,0xbc8b9a6b,0xbc6e9479,0xbc8b9a6b,0xbc6d3063,0xbc41071e,0xbc131f35
```
